```python
import torch

def _softmax(x, axis=-1):
    return torch.softmax(x, dim=axis)
def _gelu(x):
    return torch.nn.functional.gelu(x, approximate="tanh")
def _silu(x):
    return torch.nn.functional.silu(x)
def _sigmoid(x):
    return torch.sigmoid(x)
def _layernorm(x, axis=-1, eps=1e-5):
    m = x.mean(dim=axis, keepdim=True)
    v = x.var(dim=axis, keepdim=True, unbiased=False)
    return (x - m) / torch.sqrt(v + eps)
def _scatter_add(tgt, idx, src, axis=0):
    return tgt.clone().index_add_(axis, idx, src)
def _segment_sum(src, seg, n):
    out = torch.zeros((n,) + src.shape[1:], dtype=src.dtype)
    return out.index_add_(0, seg, src)
def _pad(x, pw):
    flat = tuple(v for pair in reversed(pw) for v in pair)
    return torch.nn.functional.pad(x, flat)

kernel_name = 'standalone__mha_block_cached__near_ridge'

def setup_inputs():

    _w = (lambda a: (lambda t: t.to(torch.bfloat16) if t.is_floating_point() else t)(torch.as_tensor(a)))
    B, Sq, D = 8, 256, 448
    H, Sk, Dh = 16, 1024, 256
    return {
        "x": _w((lambda *s: torch.randn(*s, dtype=torch.bfloat16) * 0.8)(B, Sq, D)),
        "k_cache": _w((lambda *s: torch.randn(*s, dtype=torch.bfloat16) * 0.8)(B, H, Sk, Dh)),
        "v_cache": _w((lambda *s: torch.randn(*s, dtype=torch.bfloat16) * 0.05)(B, H, Sk, Dh)),
        "wq": _w((lambda *s: torch.randn(*s, dtype=torch.bfloat16) * 0.8)(D, H * Dh) * (D ** -0.5)),
        "wo": _w((lambda *s: torch.randn(*s, dtype=torch.bfloat16) * 0.05)(H * Dh, D) * ((H * Dh) ** -0.5)),
    }

def reference(x, k_cache, v_cache, wq, wo):
    B, Sq, D = x.shape
    H, Dh = 16, 256
    q = (lambda x, *d: x.permute(*d))((x @ wq).reshape(B, Sq, H, Dh), 0, 2, 1, 3)
    scores = torch.einsum("bhqd,bhkd->bhqk", q, k_cache) * (Dh ** -0.5)
    p = _softmax(scores, axis=-1)
    o = torch.einsum("bhqk,bhkd->bhqd", p, v_cache)
    return (lambda x, *d: x.permute(*d))(o, 0, 2, 1, 3).reshape(B, Sq, H * Dh) @ wo
```

```asm
; @launch grid=(256,1,1) block=(256,1,1) lds=163840
.amdgcn_target "amdgcn-amd-amdhsa--gfx950"
.text
.globl standalone__mha_block_cached__near_ridge_kernel
.p2align 8
.type standalone__mha_block_cached__near_ridge_kernel,@function
standalone__mha_block_cached__near_ridge_kernel:
 s_cmp_ge_u32 s2, 256
 s_cbranch_scc1 L_exit
 s_load_dwordx8 s[44:51], s[0:1], 0
 s_load_dwordx2 s[52:53], s[0:1], 32
 s_load_dwordx2 s[6:7], s[0:1], 56
 s_load_dwordx4 s[92:95], s[0:1], 40
 s_getpc_b64 s[54:55]
 s_lshr_b32 s56, s2, 3
 s_mul_i32 s56, s56, 3
 v_min_u32 v1, 2, v0
 v_add_lshl_u32 v1, v1, s56, 7
 v_cmp_gt_u32 vcc, 64, v0
 s_cbranch_vccz L_nopf
 global_load_dword v252, v1, s[54:55]
L_nopf:
 v_and_b32 v244, 63, v0
 v_lshrrev_b32 v1, 6, v0
 v_lshrrev_b32 v224, 3, v244
 v_readfirstlane_b32 s32, v1
 s_and_b32 s3, s2, 7
 s_bfe_u32 s4, s2, 0x10003
 s_lshr_b32 s5, s2, 4
 s_lshl_b32 s33, s32, 12
 v_and_b32 v225, 7, v244
 v_and_b32 v226, 2, v224
 v_xor_b32 v225, v225, v226
 v_lshlrev_b32 v225, 4, v225
 v_xor_b32 v226, 64, v225
 s_and_b32 s43, s32, 1
 s_lshl_b32 s43, s43, 7
 s_lshr_b32 s41, s32, 1
 s_lshl_b32 s41, s41, 18
 s_add_u32 s43, s43, s41
 v_lshlrev_b32 v227, 13, v224
 s_add_u32 s42, s43, 0
 v_add3_u32 v214, v227, v225, s42
 s_add_u32 s42, s43, 64512
 v_add3_u32 v215, v227, v226, s42
 s_add_u32 s42, s43, 129024
 v_add3_u32 v216, v227, v225, s42
 s_add_u32 s42, s43, 193536
 v_add3_u32 v217, v227, v226, s42
 v_lshrrev_b32 v227, 2, v224
 v_and_b32 v228, 3, v224
 v_lshl_add_u32 v227, v227, 4, v228
 v_mul_u32_u24 v227, 896, v227
 s_mul_i32 s40, s32, 28672
 s_add_u32 s41, s40, 0
 v_add3_u32 v218, v227, v225, s41
 s_add_u32 s41, s40, 2560
 v_add3_u32 v219, v227, v226, s41
 s_add_u32 s41, s40, 5120
 v_add3_u32 v220, v227, v225, s41
 s_add_u32 s41, s40, 7680
 v_add3_u32 v221, v227, v226, s41
 s_mov_b32 s84, 0
 s_lshl_b32 s57, s5, 9
 s_lshl_b32 s59, s3, 1
 s_add_u32 s59, s59, s4
 s_mul_i32 s58, s59, 114688
 s_sub_u32 s18, 3670016, s57
 s_mov_b32 s19, 0x00020000
 s_mov_b32 s26, 114688
 s_mov_b32 s27, 0x00020000
 s_waitcnt lgkmcnt(0)
 s_add_u32 s16, s50, s57
 s_addc_u32 s17, s51, 0
 s_add_u32 s24, s44, s58
 s_addc_u32 s25, s45, 0
 s_add_u32 m0, s33, 0
 s_add_u32 s34, s84, 0
 buffer_load_dwordx4 v214, s[16:19], s34 offen lds
 buffer_load_dwordx4 v215, s[16:19], s34 offen offset:1024 lds
 buffer_load_dwordx4 v216, s[16:19], s34 offen offset:2048 lds
 buffer_load_dwordx4 v217, s[16:19], s34 offen offset:3072 lds
 s_add_u32 m0, s33, 114688
 s_lshr_b32 s34, s84, 12
 buffer_load_dwordx4 v218, s[24:27], s34 offen lds
 buffer_load_dwordx4 v219, s[24:27], s34 offen offset:1024 lds
 buffer_load_dwordx4 v220, s[24:27], s34 offen offset:2048 lds
 buffer_load_dwordx4 v221, s[24:27], s34 offen offset:3072 lds
 s_mul_i32 s57, s3, 1
 s_mul_i32 s58, s5, 1
 s_add_u32 s57, s57, s58
 s_mul_i32 s58, s4, 0
 s_add_u32 s57, s57, s58
 s_mul_i32 s58, s57, 10923
 s_lshr_b32 s58, s58, 16
 s_mul_i32 s58, s58, 6
 s_sub_u32 s57, s57, s58
 s_add_u32 s57, s57, 1
 s_lshl_b32 s85, s57, 19
 s_add_u32 s86, s85, 0x80000
 s_cmp_ge_u32 s86, 3670016
 s_cselect_b32 s86, 0x80000, s86
 s_add_u32 s87, s86, 0x80000
 s_cmp_ge_u32 s87, 3670016
 s_cselect_b32 s87, 0x80000, s87
 s_add_u32 s88, s87, 0x80000
 s_cmp_ge_u32 s88, 3670016
 s_cselect_b32 s88, 0x80000, s88
 s_add_u32 s89, s88, 0x80000
 s_cmp_ge_u32 s89, 3670016
 s_cselect_b32 s89, 0x80000, s89
 s_add_u32 s90, s89, 0x80000
 s_cmp_ge_u32 s90, 3670016
 s_cselect_b32 s90, 0x80000, s90
 s_add_u32 m0, s33, 16384
 s_add_u32 s34, s84, 256
 buffer_load_dwordx4 v214, s[16:19], s34 offen lds
 buffer_load_dwordx4 v215, s[16:19], s34 offen offset:1024 lds
 buffer_load_dwordx4 v216, s[16:19], s34 offen offset:2048 lds
 buffer_load_dwordx4 v217, s[16:19], s34 offen offset:3072 lds
 s_add_u32 m0, s33, 131072
 s_lshr_b32 s34, s85, 12
 buffer_load_dwordx4 v218, s[24:27], s34 offen lds
 buffer_load_dwordx4 v219, s[24:27], s34 offen offset:1024 lds
 buffer_load_dwordx4 v220, s[24:27], s34 offen offset:2048 lds
 buffer_load_dwordx4 v221, s[24:27], s34 offen offset:3072 lds
 s_add_u32 m0, s33, 32768
 s_add_u32 s34, s85, 0
 buffer_load_dwordx4 v214, s[16:19], s34 offen lds
 buffer_load_dwordx4 v215, s[16:19], s34 offen offset:1024 lds
 buffer_load_dwordx4 v216, s[16:19], s34 offen offset:2048 lds
 buffer_load_dwordx4 v217, s[16:19], s34 offen offset:3072 lds
 s_add_u32 m0, s33, 147456
 s_lshr_b32 s34, s86, 12
 buffer_load_dwordx4 v218, s[24:27], s34 offen lds
 buffer_load_dwordx4 v219, s[24:27], s34 offen offset:1024 lds
 buffer_load_dwordx4 v220, s[24:27], s34 offen offset:2048 lds
 buffer_load_dwordx4 v221, s[24:27], s34 offen offset:3072 lds
 s_mov_b32 s35, 0x41000000
 s_lshl_b32 s40, s32, 7
 v_lshlrev_b32 v227, 9, v224
 s_add_u32 s41, s40, 0
 v_add3_u32 v210, v227, v225, s41
 s_add_u32 s41, s40, 3072
 v_add3_u32 v211, v227, v226, s41
 s_add_u32 s41, s40, 6144
 v_add3_u32 v212, v227, v225, s41
 s_add_u32 s41, s40, 9216
 v_add3_u32 v213, v227, v226, s41
 s_lshl_b32 s56, s3, 4
 s_add_u32 s56, s56, s5
 s_lshl_b32 s57, s56, 19
 s_mul_i32 s38, s56, 11
 s_and_b32 s38, s38, 31
 s_lshl_b32 s38, s38, 14
 s_add_u32 s8, s46, s57
 s_addc_u32 s9, s47, 0
 s_mov_b32 s10, 0x80000
 s_mov_b32 s11, 0x00020000
 s_add_u32 s12, s48, s57
 s_addc_u32 s13, s49, 0
 s_mov_b32 s14, 0x80000
 s_mov_b32 s15, 0x00020000
 s_mul_i32 s57, s5, 229376
 s_add_u32 s20, s52, s57
 s_addc_u32 s21, s53, 0
 s_mov_b32 s22, 229376
 s_mov_b32 s23, 0x00020000
 s_mul_i32 s58, s59, 788480
 s_add_u32 s28, s6, s58
 s_addc_u32 s29, s7, 0
 s_mov_b32 s30, 788480
 s_mov_b32 s31, 0x00020000
 s_mul_i32 s58, s59, 114688
 s_add_u32 s44, s92, s58
 s_addc_u32 s45, s93, 0
 s_mov_b32 s46, 114688
 s_mov_b32 s47, 0x00020000
 s_mov_b32 s48, s94
 s_mov_b32 s49, s95
 s_mov_b32 s50, 256
 s_mov_b32 s51, 0x00020000
 s_getreg_b32 s91, hwreg(HW_REG_XCC_ID)
 s_and_b32 s91, s91, 7
 s_lshl_b32 s57, s5, 2
 s_add_u32 s57, s57, 786432
 v_lshrrev_b32 v1, 2, v0
 v_lshlrev_b32 v1, 8, v1
 v_and_b32 v2, 3, v0
 v_lshl_add_u32 v1, v2, 6, v1
 v_add_u32 v1, s57, v1
 v_bfrev_b32 v3, 1
 v_cmp_gt_u32 vcc, 28, v0
 v_mov_b32 v2, 0
 s_nop 0
 v_cndmask_b32 v1, v3, v1, vcc
 buffer_store_dword v2, v1, s[28:31], 0 offen sc1
 s_add_u32 s91, s91, 1
 v_mov_b32 v236, s91
 s_lshl_b32 s58, s59, 4
 v_mov_b32 v239, s58
 s_add_u32 s58, s58, s5
 v_mov_b32 v1, s58
 v_cmp_eq_u32 vcc, 0, v0
 v_lshlrev_b32 v241, 2, v244
 v_add_u32 v241, 786432, v241
 v_cndmask_b32 v238, v3, v1, vcc
 s_and_b32 s58, s5, 3
 s_cmp_eq_u32 s58, 0
 s_cselect_b32 s100, 0, 0x1000
 s_and_b32 s58, s5, 3
 s_cmp_eq_u32 s58, 1
 s_cselect_b32 s101, 0, 0x1000
 s_and_b32 s58, s5, 3
 s_cmp_eq_u32 s58, 2
 s_cselect_b32 s39, 0, 0x1000
 s_and_b32 s58, s5, 3
 s_cmp_eq_u32 s58, 3
 s_cselect_b32 s38, 0, 0x1000
 s_lshl_b32 s58, s32, 6
 s_add_u32 s58, s58, s57
 v_mov_b32 v1, s58
 v_cmp_eq_u32 vcc, 0, v244
 s_nop 1
 v_cndmask_b32 v242, v3, v1, vcc
 v_and_b32 v224, 12, v244
 v_lshlrev_b32 v224, 1, v224
 v_and_b32 v225, 3, v244
 v_add_u32 v224, v224, v225
 v_and_b32 v225, 6, v244
 v_lshrrev_b32 v226, 4, v244
 v_xor_b32 v225, v225, v226
 v_lshlrev_b32 v225, 4, v225
 v_lshl_add_u32 v192, v224, 7, v225
 v_xor_b32 v193, 64, v192
 v_add_u32 v194, 65536, v192
 v_add_u32 v195, 65536, v193
 v_add_u32 v196, 131072, v192
 v_add_u32 v197, 131072, v193
 v_add_u32 v246, s33, v192
 v_add_u32 v247, s33, v193
 v_add_u32 v248, s33, v194
 v_add_u32 v249, s33, v195
 v_add_u32 v250, s33, v196
 v_add_u32 v251, s33, v197
 v_bfe_u32 v224, v244, 2, 2
 v_lshl_add_u32 v225, v226, 3, v224
 v_lshlrev_b32 v225, 7, v225
 v_and_b32 v227, 1, v244
 v_lshl_add_u32 v225, v227, 3, v225
 v_and_b32 v224, 2, v224
 v_and_b32 v227, 1, v226
 v_lshl_add_u32 v224, v227, 2, v224
 v_bfe_u32 v227, v244, 1, 1
 v_xor_b32 v224, v224, v227
 v_lshl_add_u32 v198, v224, 4, v225
 v_xor_b32 v199, 32, v198
 v_xor_b32 v200, 64, v198
 v_xor_b32 v201, 96, v198
 v_add_u32 v202, 65536, v198
 v_add_u32 v203, 65536, v199
 v_add_u32 v204, 65536, v200
 v_add_u32 v205, 65536, v201
 v_add_u32 v206, 131072, v198
 v_add_u32 v207, 131072, v199
 v_add_u32 v208, 131072, v200
 v_add_u32 v209, 131072, v201
 v_lshlrev_b32 v240, 4, v244
 v_add_u32 v240, s33, v240
 s_mul_i32 s57, s5, 49152
 v_add_u32 v240, s57, v240
 s_lshr_b32 s56, s2, 3
 s_lshl_b32 s56, s56, 2
 s_add_u32 s56, s56, s32
 s_and_b32 s56, s56, 31
 s_lshl_b32 s56, s56, 7
 v_mov_b32 v245, s56
 s_mov_b32 s60, 0
 s_mov_b32 s61, 0x3db8aa3b
 v_mov_b32 v222, 0
 v_mov_b32 v223, 0
 s_waitcnt vmcnt(17)
 ds_read_b128 a[128:131], v248 offset:49152
 ds_read_b128 a[132:135], v248 offset:49664
 ds_read_b128 a[136:139], v249 offset:49152
 ds_read_b128 a[140:143], v249 offset:49664
 s_barrier
 ds_read_b64_tr_b16 a[0:1], v198 offset:0
 ds_read_b64_tr_b16 a[2:3], v198 offset:512
 ds_read_b64_tr_b16 a[4:5], v198 offset:8192
 ds_read_b64_tr_b16 a[6:7], v198 offset:8704
 ds_read_b64_tr_b16 a[8:9], v199 offset:0
 ds_read_b64_tr_b16 a[10:11], v199 offset:512
 ds_read_b64_tr_b16 a[12:13], v199 offset:8192
 ds_read_b64_tr_b16 a[14:15], v199 offset:8704
 ds_read_b64_tr_b16 a[16:17], v200 offset:0
 ds_read_b64_tr_b16 a[18:19], v200 offset:512
 s_waitcnt lgkmcnt(10)
 s_waitcnt lgkmcnt(8)
 v_mfma_f32_16x16x32_bf16 v[0:3], a[0:3], a[128:131], 0
 s_add_u32 m0, s33, 49152
 ds_read_b64_tr_b16 a[20:21], v200 offset:8192
 ds_read_b64_tr_b16 a[22:23], v200 offset:8704
 v_mfma_f32_16x16x32_bf16 v[4:7], a[0:3], a[132:135], 0
 s_waitcnt vmcnt(13) lgkmcnt(8)
 s_add_u32 s34, s85, 256
 buffer_load_dwordx4 v214, s[16:19], s34 offen lds
 v_mfma_f32_16x16x32_bf16 v[4:7], a[4:7], a[140:143], v[4:7]
 s_barrier
 ds_read_b64_tr_b16 a[24:25], v201 offset:0
 ds_read_b64_tr_b16 a[26:27], v201 offset:512
 v_mfma_f32_16x16x32_bf16 v[0:3], a[4:7], a[136:139], v[0:3]
 s_waitcnt lgkmcnt(8)
 v_mfma_f32_16x16x32_bf16 v[8:11], a[8:11], a[128:131], 0
 ds_read_b64_tr_b16 a[28:29], v201 offset:8192
 ds_read_b64_tr_b16 a[30:31], v201 offset:8704
 v_mfma_f32_16x16x32_bf16 v[12:15], a[8:11], a[132:135], 0
 s_waitcnt lgkmcnt(8)
 buffer_load_dwordx4 v215, s[16:19], s34 offen offset:1024 lds
 v_mfma_f32_16x16x32_bf16 v[12:15], a[12:15], a[140:143], v[12:15]
 ds_read_b64_tr_b16 a[0:1], v198 offset:4096
 ds_read_b64_tr_b16 a[2:3], v198 offset:4608
 v_mfma_f32_16x16x32_bf16 v[8:11], a[12:15], a[136:139], v[8:11]
 s_waitcnt lgkmcnt(8)
 v_mfma_f32_16x16x32_bf16 v[16:19], a[16:19], a[128:131], 0
 ds_read_b64_tr_b16 a[4:5], v198 offset:12288
 ds_read_b64_tr_b16 a[6:7], v198 offset:12800
 v_mfma_f32_16x16x32_bf16 v[20:23], a[16:19], a[132:135], 0
 s_waitcnt lgkmcnt(8)
 buffer_load_dwordx4 v216, s[16:19], s34 offen offset:2048 lds
 v_mfma_f32_16x16x32_bf16 v[20:23], a[20:23], a[140:143], v[20:23]
 ds_read_b64_tr_b16 a[8:9], v199 offset:4096
 ds_read_b64_tr_b16 a[10:11], v199 offset:4608
 v_mfma_f32_16x16x32_bf16 v[16:19], a[20:23], a[136:139], v[16:19]
 s_waitcnt lgkmcnt(8)
 v_mfma_f32_16x16x32_bf16 v[24:27], a[24:27], a[128:131], 0
 ds_read_b64_tr_b16 a[12:13], v199 offset:12288
 ds_read_b64_tr_b16 a[14:15], v199 offset:12800
 v_mfma_f32_16x16x32_bf16 v[28:31], a[24:27], a[132:135], 0
 s_waitcnt lgkmcnt(8)
 buffer_load_dwordx4 v217, s[16:19], s34 offen offset:3072 lds
 v_mfma_f32_16x16x32_bf16 v[28:31], a[28:31], a[140:143], v[28:31]
 s_add_u32 m0, s33, 65536
 ds_read_b64_tr_b16 a[16:17], v200 offset:4096
 ds_read_b64_tr_b16 a[18:19], v200 offset:4608
 v_mfma_f32_16x16x32_bf16 v[24:27], a[28:31], a[136:139], v[24:27]
 s_waitcnt lgkmcnt(8)
 s_add_u32 s34, s86, 0
 v_mfma_f32_16x16x32_bf16 v[32:35], a[0:3], a[128:131], 0
 ds_read_b64_tr_b16 a[20:21], v200 offset:12288
 ds_read_b64_tr_b16 a[22:23], v200 offset:12800
 v_mfma_f32_16x16x32_bf16 v[36:39], a[0:3], a[132:135], 0
 s_waitcnt lgkmcnt(8)
 buffer_load_dwordx4 v214, s[16:19], s34 offen lds
 v_mfma_f32_16x16x32_bf16 v[36:39], a[4:7], a[140:143], v[36:39]
 ds_read_b64_tr_b16 a[24:25], v201 offset:4096
 ds_read_b64_tr_b16 a[26:27], v201 offset:4608
 v_mfma_f32_16x16x32_bf16 v[32:35], a[4:7], a[136:139], v[32:35]
 s_waitcnt lgkmcnt(8)
 v_mfma_f32_16x16x32_bf16 v[40:43], a[8:11], a[128:131], 0
 ds_read_b64_tr_b16 a[28:29], v201 offset:12288
 ds_read_b64_tr_b16 a[30:31], v201 offset:12800
 v_mfma_f32_16x16x32_bf16 v[44:47], a[8:11], a[132:135], 0
 s_waitcnt lgkmcnt(8)
 buffer_load_dwordx4 v215, s[16:19], s34 offen offset:1024 lds
 v_mfma_f32_16x16x32_bf16 v[44:47], a[12:15], a[140:143], v[44:47]
 ds_read_b64_tr_b16 a[0:1], v198 offset:16384
 ds_read_b64_tr_b16 a[2:3], v198 offset:16896
 v_mfma_f32_16x16x32_bf16 v[40:43], a[12:15], a[136:139], v[40:43]
 s_waitcnt lgkmcnt(8)
 v_mfma_f32_16x16x32_bf16 v[48:51], a[16:19], a[128:131], 0
 s_waitcnt vmcnt(15)
 ds_read_b64_tr_b16 a[4:5], v198 offset:24576
 ds_read_b64_tr_b16 a[6:7], v198 offset:25088
 v_mfma_f32_16x16x32_bf16 v[52:55], a[16:19], a[132:135], 0
 s_waitcnt lgkmcnt(8)
 ds_read_b128 a[144:147], v250 offset:0
 ds_read_b128 a[148:151], v250 offset:512
 v_mfma_f32_16x16x32_bf16 v[52:55], a[20:23], a[140:143], v[52:55]
 ds_read_b64_tr_b16 a[8:9], v199 offset:16384
 ds_read_b64_tr_b16 a[10:11], v199 offset:16896
 v_mfma_f32_16x16x32_bf16 v[48:51], a[20:23], a[136:139], v[48:51]
 s_waitcnt lgkmcnt(10)
 ds_read_b128 a[152:155], v251 offset:0
 ds_read_b128 a[156:159], v251 offset:512
 v_mfma_f32_16x16x32_bf16 v[56:59], a[24:27], a[128:131], 0
 ds_read_b64_tr_b16 a[12:13], v199 offset:24576
 ds_read_b64_tr_b16 a[14:15], v199 offset:25088
 v_mfma_f32_16x16x32_bf16 v[60:63], a[24:27], a[132:135], 0
 s_waitcnt lgkmcnt(12)
 buffer_load_dwordx4 v216, s[16:19], s34 offen offset:2048 lds
 v_mfma_f32_16x16x32_bf16 v[60:63], a[28:31], a[140:143], v[60:63]
 ds_read_b64_tr_b16 a[16:17], v200 offset:16384
 ds_read_b64_tr_b16 a[18:19], v200 offset:16896
 v_mfma_f32_16x16x32_bf16 v[56:59], a[28:31], a[136:139], v[56:59]
 s_waitcnt lgkmcnt(12)
 v_mfma_f32_16x16x32_bf16 v[64:67], a[0:3], a[128:131], 0
 s_add_u32 s92, s54, 12288
 s_addc_u32 s93, s55, 0
 ds_read_b64_tr_b16 a[20:21], v200 offset:24576
 ds_read_b64_tr_b16 a[22:23], v200 offset:25088
 v_mfma_f32_16x16x32_bf16 v[68:71], a[0:3], a[132:135], 0
 s_waitcnt vmcnt(12) lgkmcnt(12)
 s_waitcnt lgkmcnt(6)
 buffer_load_dwordx4 v217, s[16:19], s34 offen offset:3072 lds
 v_mfma_f32_16x16x32_bf16 v[68:71], a[4:7], a[140:143], v[68:71]
 s_barrier
 ds_read_b64_tr_b16 a[24:25], v201 offset:16384
 ds_read_b64_tr_b16 a[26:27], v201 offset:16896
 v_mfma_f32_16x16x32_bf16 v[64:67], a[4:7], a[136:139], v[64:67]
 s_add_u32 m0, s33, 0
 s_lshr_b32 s34, s87, 12
 global_load_dword v252, v245, s[92:93]
 v_mfma_f32_16x16x32_bf16 v[72:75], a[8:11], a[128:131], 0
 ds_read_b64_tr_b16 a[28:29], v201 offset:24576
 ds_read_b64_tr_b16 a[30:31], v201 offset:25088
 v_mfma_f32_16x16x32_bf16 v[76:79], a[8:11], a[132:135], 0
 s_waitcnt lgkmcnt(8)
 buffer_load_dwordx4 v218, s[24:27], s34 offen lds
 v_mfma_f32_16x16x32_bf16 v[76:79], a[12:15], a[140:143], v[76:79]
 ds_read_b64_tr_b16 a[0:1], v198 offset:20480
 ds_read_b64_tr_b16 a[2:3], v198 offset:20992
 v_mfma_f32_16x16x32_bf16 v[72:75], a[12:15], a[136:139], v[72:75]
 s_waitcnt lgkmcnt(8)
 v_mfma_f32_16x16x32_bf16 v[80:83], a[16:19], a[128:131], 0
 ds_read_b64_tr_b16 a[4:5], v198 offset:28672
 ds_read_b64_tr_b16 a[6:7], v198 offset:29184
 v_mfma_f32_16x16x32_bf16 v[84:87], a[16:19], a[132:135], 0
 s_waitcnt lgkmcnt(8)
 buffer_load_dwordx4 v219, s[24:27], s34 offen offset:1024 lds
 v_mfma_f32_16x16x32_bf16 v[84:87], a[20:23], a[140:143], v[84:87]
 ds_read_b64_tr_b16 a[8:9], v199 offset:20480
 ds_read_b64_tr_b16 a[10:11], v199 offset:20992
 v_mfma_f32_16x16x32_bf16 v[80:83], a[20:23], a[136:139], v[80:83]
 s_waitcnt lgkmcnt(8)
 v_mfma_f32_16x16x32_bf16 v[88:91], a[24:27], a[128:131], 0
 ds_read_b64_tr_b16 a[12:13], v199 offset:28672
 ds_read_b64_tr_b16 a[14:15], v199 offset:29184
 v_mfma_f32_16x16x32_bf16 v[92:95], a[24:27], a[132:135], 0
 s_waitcnt lgkmcnt(8)
 buffer_load_dwordx4 v220, s[24:27], s34 offen offset:2048 lds
 v_mfma_f32_16x16x32_bf16 v[92:95], a[28:31], a[140:143], v[92:95]
 ds_read_b64_tr_b16 a[16:17], v200 offset:20480
 ds_read_b64_tr_b16 a[18:19], v200 offset:20992
 v_mfma_f32_16x16x32_bf16 v[88:91], a[28:31], a[136:139], v[88:91]
 s_waitcnt lgkmcnt(8)
 v_mfma_f32_16x16x32_bf16 v[96:99], a[0:3], a[128:131], 0
 s_waitcnt vmcnt(13)
 ds_read_b64_tr_b16 a[20:21], v200 offset:28672
 ds_read_b64_tr_b16 a[22:23], v200 offset:29184
 v_mfma_f32_16x16x32_bf16 v[100:103], a[0:3], a[132:135], 0
 s_waitcnt lgkmcnt(8)
 ds_read_b128 a[160:163], v250 offset:16384
 ds_read_b128 a[164:167], v250 offset:16896
 v_mfma_f32_16x16x32_bf16 v[100:103], a[4:7], a[140:143], v[100:103]
 ds_read_b64_tr_b16 a[24:25], v201 offset:20480
 ds_read_b64_tr_b16 a[26:27], v201 offset:20992
 v_mfma_f32_16x16x32_bf16 v[96:99], a[4:7], a[136:139], v[96:99]
 s_waitcnt lgkmcnt(10)
 ds_read_b128 a[168:171], v251 offset:16384
 ds_read_b128 a[172:175], v251 offset:16896
 v_mfma_f32_16x16x32_bf16 v[104:107], a[8:11], a[128:131], 0
 ds_read_b64_tr_b16 a[28:29], v201 offset:28672
 ds_read_b64_tr_b16 a[30:31], v201 offset:29184
 v_mfma_f32_16x16x32_bf16 v[108:111], a[8:11], a[132:135], 0
 s_waitcnt lgkmcnt(12)
 buffer_load_dwordx4 v221, s[24:27], s34 offen offset:3072 lds
 v_mfma_f32_16x16x32_bf16 v[108:111], a[12:15], a[140:143], v[108:111]
 s_add_u32 m0, s33, 81920
 ds_read_b64_tr_b16 a[0:1], v198 offset:32768
 ds_read_b64_tr_b16 a[2:3], v198 offset:33280
 v_mfma_f32_16x16x32_bf16 v[104:107], a[12:15], a[136:139], v[104:107]
 s_waitcnt lgkmcnt(12)
 s_add_u32 s34, s87, 0
 v_mfma_f32_16x16x32_bf16 v[112:115], a[16:19], a[128:131], 0
 ds_read_b64_tr_b16 a[4:5], v198 offset:40960
 ds_read_b64_tr_b16 a[6:7], v198 offset:41472
 v_mfma_f32_16x16x32_bf16 v[116:119], a[16:19], a[132:135], 0
 s_waitcnt lgkmcnt(12)
 s_waitcnt lgkmcnt(6)
 buffer_load_dwordx4 v214, s[16:19], s34 offen lds
 v_mfma_f32_16x16x32_bf16 v[116:119], a[20:23], a[140:143], v[116:119]
 ds_read_b64_tr_b16 a[8:9], v199 offset:32768
 ds_read_b64_tr_b16 a[10:11], v199 offset:33280
 v_mfma_f32_16x16x32_bf16 v[112:115], a[20:23], a[136:139], v[112:115]
 v_mfma_f32_16x16x32_bf16 v[120:123], a[24:27], a[128:131], 0
 ds_read_b64_tr_b16 a[12:13], v199 offset:40960
 ds_read_b64_tr_b16 a[14:15], v199 offset:41472
 v_mfma_f32_16x16x32_bf16 v[124:127], a[24:27], a[132:135], 0
 s_waitcnt lgkmcnt(8)
 buffer_load_dwordx4 v215, s[16:19], s34 offen offset:1024 lds
 v_mfma_f32_16x16x32_bf16 v[124:127], a[28:31], a[140:143], v[124:127]
 ds_read_b64_tr_b16 a[16:17], v200 offset:32768
 ds_read_b64_tr_b16 a[18:19], v200 offset:33280
 v_mfma_f32_16x16x32_bf16 v[120:123], a[28:31], a[136:139], v[120:123]
 s_waitcnt lgkmcnt(8)
 v_mfma_f32_16x16x32_bf16 v[0:3], a[0:3], a[144:147], v[0:3]
 ds_read_b64_tr_b16 a[20:21], v200 offset:40960
 ds_read_b64_tr_b16 a[22:23], v200 offset:41472
 v_mfma_f32_16x16x32_bf16 v[4:7], a[0:3], a[148:151], v[4:7]
 s_waitcnt vmcnt(11) lgkmcnt(8)
 buffer_load_dwordx4 v216, s[16:19], s34 offen offset:2048 lds
 v_mfma_f32_16x16x32_bf16 v[4:7], a[4:7], a[156:159], v[4:7]
 s_barrier
 ds_read_b64_tr_b16 a[24:25], v201 offset:32768
 ds_read_b64_tr_b16 a[26:27], v201 offset:33280
 v_mfma_f32_16x16x32_bf16 v[0:3], a[4:7], a[152:155], v[0:3]
 s_waitcnt lgkmcnt(8)
 v_mfma_f32_16x16x32_bf16 v[8:11], a[8:11], a[144:147], v[8:11]
 ds_read_b64_tr_b16 a[28:29], v201 offset:40960
 ds_read_b64_tr_b16 a[30:31], v201 offset:41472
 v_mfma_f32_16x16x32_bf16 v[12:15], a[8:11], a[148:151], v[12:15]
 s_waitcnt lgkmcnt(8)
 buffer_load_dwordx4 v217, s[16:19], s34 offen offset:3072 lds
 v_mfma_f32_16x16x32_bf16 v[12:15], a[12:15], a[156:159], v[12:15]
 s_add_u32 m0, s33, 16384
 ds_read_b64_tr_b16 a[0:1], v198 offset:36864
 ds_read_b64_tr_b16 a[2:3], v198 offset:37376
 v_mfma_f32_16x16x32_bf16 v[8:11], a[12:15], a[152:155], v[8:11]
 s_waitcnt lgkmcnt(8)
 s_lshr_b32 s34, s88, 12
 v_mfma_f32_16x16x32_bf16 v[16:19], a[16:19], a[144:147], v[16:19]
 ds_read_b64_tr_b16 a[4:5], v198 offset:45056
 ds_read_b64_tr_b16 a[6:7], v198 offset:45568
 v_mfma_f32_16x16x32_bf16 v[20:23], a[16:19], a[148:151], v[20:23]
 s_waitcnt lgkmcnt(8)
 buffer_load_dwordx4 v218, s[24:27], s34 offen lds
 v_mfma_f32_16x16x32_bf16 v[20:23], a[20:23], a[156:159], v[20:23]
 ds_read_b64_tr_b16 a[8:9], v199 offset:36864
 ds_read_b64_tr_b16 a[10:11], v199 offset:37376
 v_mfma_f32_16x16x32_bf16 v[16:19], a[20:23], a[152:155], v[16:19]
 s_waitcnt lgkmcnt(8)
 v_mfma_f32_16x16x32_bf16 v[24:27], a[24:27], a[144:147], v[24:27]
 ds_read_b64_tr_b16 a[12:13], v199 offset:45056
 ds_read_b64_tr_b16 a[14:15], v199 offset:45568
 v_mfma_f32_16x16x32_bf16 v[28:31], a[24:27], a[148:151], v[28:31]
 s_waitcnt lgkmcnt(8)
 buffer_load_dwordx4 v219, s[24:27], s34 offen offset:1024 lds
 v_mfma_f32_16x16x32_bf16 v[28:31], a[28:31], a[156:159], v[28:31]
 ds_read_b64_tr_b16 a[16:17], v200 offset:36864
 ds_read_b64_tr_b16 a[18:19], v200 offset:37376
 v_mfma_f32_16x16x32_bf16 v[24:27], a[28:31], a[152:155], v[24:27]
 s_waitcnt lgkmcnt(8)
 v_mfma_f32_16x16x32_bf16 v[32:35], a[0:3], a[144:147], v[32:35]
 ds_read_b64_tr_b16 a[20:21], v200 offset:45056
 ds_read_b64_tr_b16 a[22:23], v200 offset:45568
 v_mfma_f32_16x16x32_bf16 v[36:39], a[0:3], a[148:151], v[36:39]
 s_waitcnt lgkmcnt(8)
 s_waitcnt vmcnt(6)
 ds_read_b128 a[176:179], v246 offset:0
 v_mfma_f32_16x16x32_bf16 v[36:39], a[4:7], a[156:159], v[36:39]
 ds_read_b64_tr_b16 a[24:25], v201 offset:36864
 ds_read_b64_tr_b16 a[26:27], v201 offset:37376
 v_mfma_f32_16x16x32_bf16 v[32:35], a[4:7], a[152:155], v[32:35]
 s_waitcnt lgkmcnt(9)
 ds_read_b128 a[180:183], v246 offset:512
 ds_read_b128 a[184:187], v247 offset:0
 v_mfma_f32_16x16x32_bf16 v[40:43], a[8:11], a[144:147], v[40:43]
 ds_read_b64_tr_b16 a[28:29], v201 offset:45056
 ds_read_b64_tr_b16 a[30:31], v201 offset:45568
 v_mfma_f32_16x16x32_bf16 v[44:47], a[8:11], a[148:151], v[44:47]
 s_waitcnt lgkmcnt(11)
 ds_read_b128 a[188:191], v247 offset:512
 buffer_load_dwordx4 v220, s[24:27], s34 offen offset:2048 lds
 v_mfma_f32_16x16x32_bf16 v[44:47], a[12:15], a[156:159], v[44:47]
 ds_read_b64_tr_b16 a[0:1], v198 offset:49152
 ds_read_b64_tr_b16 a[2:3], v198 offset:49664
 v_mfma_f32_16x16x32_bf16 v[40:43], a[12:15], a[152:155], v[40:43]
 s_waitcnt lgkmcnt(12)
 v_mfma_f32_16x16x32_bf16 v[48:51], a[16:19], a[144:147], v[48:51]
 ds_read_b64_tr_b16 a[4:5], v198 offset:57344
 ds_read_b64_tr_b16 a[6:7], v198 offset:57856
 v_mfma_f32_16x16x32_bf16 v[52:55], a[16:19], a[148:151], v[52:55]
 s_waitcnt lgkmcnt(12)
 buffer_load_dwordx4 v221, s[24:27], s34 offen offset:3072 lds
 v_mfma_f32_16x16x32_bf16 v[52:55], a[20:23], a[156:159], v[52:55]
 s_add_u32 m0, s33, 98304
 ds_read_b64_tr_b16 a[8:9], v199 offset:49152
 ds_read_b64_tr_b16 a[10:11], v199 offset:49664
 v_mfma_f32_16x16x32_bf16 v[48:51], a[20:23], a[152:155], v[48:51]
 s_waitcnt lgkmcnt(11)
 s_waitcnt lgkmcnt(6)
 v_mfma_f32_16x16x32_bf16 v[56:59], a[24:27], a[144:147], v[56:59]
 s_add_u32 s34, s88, 0
 ds_read_b64_tr_b16 a[12:13], v199 offset:57344
 ds_read_b64_tr_b16 a[14:15], v199 offset:57856
 v_mfma_f32_16x16x32_bf16 v[60:63], a[24:27], a[148:151], v[60:63]
 buffer_load_dwordx4 v214, s[16:19], s34 offen lds
 v_mfma_f32_16x16x32_bf16 v[60:63], a[28:31], a[156:159], v[60:63]
 ds_read_b64_tr_b16 a[16:17], v200 offset:49152
 ds_read_b64_tr_b16 a[18:19], v200 offset:49664
 v_mfma_f32_16x16x32_bf16 v[56:59], a[28:31], a[152:155], v[56:59]
 s_waitcnt lgkmcnt(8)
 v_mfma_f32_16x16x32_bf16 v[64:67], a[0:3], a[144:147], v[64:67]
 ds_read_b64_tr_b16 a[20:21], v200 offset:57344
 ds_read_b64_tr_b16 a[22:23], v200 offset:57856
 v_mfma_f32_16x16x32_bf16 v[68:71], a[0:3], a[148:151], v[68:71]
 s_waitcnt lgkmcnt(8)
 buffer_load_dwordx4 v215, s[16:19], s34 offen offset:1024 lds
 v_mfma_f32_16x16x32_bf16 v[68:71], a[4:7], a[156:159], v[68:71]
 s_barrier
 ds_read_b64_tr_b16 a[24:25], v201 offset:49152
 ds_read_b64_tr_b16 a[26:27], v201 offset:49664
 v_mfma_f32_16x16x32_bf16 v[64:67], a[4:7], a[152:155], v[64:67]
 s_waitcnt lgkmcnt(8)
 v_mfma_f32_16x16x32_bf16 v[72:75], a[8:11], a[144:147], v[72:75]
 ds_read_b64_tr_b16 a[28:29], v201 offset:57344
 ds_read_b64_tr_b16 a[30:31], v201 offset:57856
 v_mfma_f32_16x16x32_bf16 v[76:79], a[8:11], a[148:151], v[76:79]
 s_waitcnt lgkmcnt(8)
 buffer_load_dwordx4 v216, s[16:19], s34 offen offset:2048 lds
 v_mfma_f32_16x16x32_bf16 v[76:79], a[12:15], a[156:159], v[76:79]
 ds_read_b64_tr_b16 a[0:1], v198 offset:53248
 ds_read_b64_tr_b16 a[2:3], v198 offset:53760
 v_mfma_f32_16x16x32_bf16 v[72:75], a[12:15], a[152:155], v[72:75]
 s_waitcnt lgkmcnt(8)
 v_mfma_f32_16x16x32_bf16 v[80:83], a[16:19], a[144:147], v[80:83]
 ds_read_b64_tr_b16 a[4:5], v198 offset:61440
 ds_read_b64_tr_b16 a[6:7], v198 offset:61952
 v_mfma_f32_16x16x32_bf16 v[84:87], a[16:19], a[148:151], v[84:87]
 s_waitcnt lgkmcnt(8)
 buffer_load_dwordx4 v217, s[16:19], s34 offen offset:3072 lds
 v_mfma_f32_16x16x32_bf16 v[84:87], a[20:23], a[156:159], v[84:87]
 s_add_u32 m0, s33, 32768
 ds_read_b64_tr_b16 a[8:9], v199 offset:53248
 ds_read_b64_tr_b16 a[10:11], v199 offset:53760
 v_mfma_f32_16x16x32_bf16 v[80:83], a[20:23], a[152:155], v[80:83]
 s_waitcnt lgkmcnt(8)
 s_lshr_b32 s34, s89, 12
 v_mfma_f32_16x16x32_bf16 v[88:91], a[24:27], a[144:147], v[88:91]
 ds_read_b64_tr_b16 a[12:13], v199 offset:61440
 ds_read_b64_tr_b16 a[14:15], v199 offset:61952
 v_mfma_f32_16x16x32_bf16 v[92:95], a[24:27], a[148:151], v[92:95]
 s_waitcnt lgkmcnt(8)
 buffer_load_dwordx4 v218, s[24:27], s34 offen lds
 v_mfma_f32_16x16x32_bf16 v[92:95], a[28:31], a[156:159], v[92:95]
 ds_read_b64_tr_b16 a[16:17], v200 offset:53248
 ds_read_b64_tr_b16 a[18:19], v200 offset:53760
 v_mfma_f32_16x16x32_bf16 v[88:91], a[28:31], a[152:155], v[88:91]
 s_waitcnt lgkmcnt(8)
 v_mfma_f32_16x16x32_bf16 v[96:99], a[0:3], a[144:147], v[96:99]
 ds_read_b64_tr_b16 a[20:21], v200 offset:61440
 ds_read_b64_tr_b16 a[22:23], v200 offset:61952
 v_mfma_f32_16x16x32_bf16 v[100:103], a[0:3], a[148:151], v[100:103]
 s_waitcnt lgkmcnt(8)
 buffer_load_dwordx4 v219, s[24:27], s34 offen offset:1024 lds
 v_mfma_f32_16x16x32_bf16 v[100:103], a[4:7], a[156:159], v[100:103]
 ds_read_b64_tr_b16 a[24:25], v201 offset:53248
 ds_read_b64_tr_b16 a[26:27], v201 offset:53760
 v_mfma_f32_16x16x32_bf16 v[96:99], a[4:7], a[152:155], v[96:99]
 s_waitcnt lgkmcnt(8)
 v_mfma_f32_16x16x32_bf16 v[104:107], a[8:11], a[144:147], v[104:107]
 ds_read_b64_tr_b16 a[28:29], v201 offset:61440
 ds_read_b64_tr_b16 a[30:31], v201 offset:61952
 v_mfma_f32_16x16x32_bf16 v[108:111], a[8:11], a[148:151], v[108:111]
 s_waitcnt lgkmcnt(8)
 s_waitcnt vmcnt(6)
 ds_read_b128 a[192:195], v246 offset:16384
 v_mfma_f32_16x16x32_bf16 v[108:111], a[12:15], a[156:159], v[108:111]
 ds_read_b64_tr_b16 a[0:1], v202 offset:0
 ds_read_b64_tr_b16 a[2:3], v202 offset:512
 v_mfma_f32_16x16x32_bf16 v[104:107], a[12:15], a[152:155], v[104:107]
 s_waitcnt lgkmcnt(9)
 ds_read_b128 a[196:199], v246 offset:16896
 ds_read_b128 a[200:203], v247 offset:16384
 v_mfma_f32_16x16x32_bf16 v[112:115], a[16:19], a[144:147], v[112:115]
 ds_read_b64_tr_b16 a[4:5], v202 offset:8192
 ds_read_b64_tr_b16 a[6:7], v202 offset:8704
 v_mfma_f32_16x16x32_bf16 v[116:119], a[16:19], a[148:151], v[116:119]
 s_waitcnt lgkmcnt(11)
 ds_read_b128 a[204:207], v247 offset:16896
 buffer_load_dwordx4 v220, s[24:27], s34 offen offset:2048 lds
 v_mfma_f32_16x16x32_bf16 v[116:119], a[20:23], a[156:159], v[116:119]
 ds_read_b64_tr_b16 a[8:9], v203 offset:0
 ds_read_b64_tr_b16 a[10:11], v203 offset:512
 v_mfma_f32_16x16x32_bf16 v[112:115], a[20:23], a[152:155], v[112:115]
 s_waitcnt lgkmcnt(12)
 v_mfma_f32_16x16x32_bf16 v[120:123], a[24:27], a[144:147], v[120:123]
 ds_read_b64_tr_b16 a[12:13], v203 offset:8192
 ds_read_b64_tr_b16 a[14:15], v203 offset:8704
 v_mfma_f32_16x16x32_bf16 v[124:127], a[24:27], a[148:151], v[124:127]
 s_waitcnt lgkmcnt(12)
 buffer_load_dwordx4 v221, s[24:27], s34 offen offset:3072 lds
 v_mfma_f32_16x16x32_bf16 v[124:127], a[28:31], a[156:159], v[124:127]
 s_add_u32 m0, s33, 114688
 ds_read_b64_tr_b16 a[16:17], v204 offset:0
 ds_read_b64_tr_b16 a[18:19], v204 offset:512
 v_mfma_f32_16x16x32_bf16 v[120:123], a[28:31], a[152:155], v[120:123]
 s_waitcnt lgkmcnt(11)
 s_waitcnt lgkmcnt(6)
 v_mfma_f32_16x16x32_bf16 v[0:3], a[0:3], a[160:163], v[0:3]
 s_add_u32 s34, s89, 0
 ds_read_b64_tr_b16 a[20:21], v204 offset:8192
 ds_read_b64_tr_b16 a[22:23], v204 offset:8704
 v_mfma_f32_16x16x32_bf16 v[4:7], a[0:3], a[164:167], v[4:7]
 buffer_load_dwordx4 v214, s[16:19], s34 offen lds
 v_mfma_f32_16x16x32_bf16 v[4:7], a[4:7], a[172:175], v[4:7]
 s_barrier
 ds_read_b64_tr_b16 a[24:25], v205 offset:0
 ds_read_b64_tr_b16 a[26:27], v205 offset:512
 v_mfma_f32_16x16x32_bf16 v[0:3], a[4:7], a[168:171], v[0:3]
 s_waitcnt lgkmcnt(8)
 v_mfma_f32_16x16x32_bf16 v[8:11], a[8:11], a[160:163], v[8:11]
 ds_read_b64_tr_b16 a[28:29], v205 offset:8192
 ds_read_b64_tr_b16 a[30:31], v205 offset:8704
 v_mfma_f32_16x16x32_bf16 v[12:15], a[8:11], a[164:167], v[12:15]
 s_waitcnt lgkmcnt(8)
 buffer_load_dwordx4 v215, s[16:19], s34 offen offset:1024 lds
 v_mfma_f32_16x16x32_bf16 v[12:15], a[12:15], a[172:175], v[12:15]
 ds_read_b64_tr_b16 a[0:1], v202 offset:4096
 ds_read_b64_tr_b16 a[2:3], v202 offset:4608
 v_mfma_f32_16x16x32_bf16 v[8:11], a[12:15], a[168:171], v[8:11]
 s_waitcnt lgkmcnt(8)
 v_mfma_f32_16x16x32_bf16 v[16:19], a[16:19], a[160:163], v[16:19]
 ds_read_b64_tr_b16 a[4:5], v202 offset:12288
 ds_read_b64_tr_b16 a[6:7], v202 offset:12800
 v_mfma_f32_16x16x32_bf16 v[20:23], a[16:19], a[164:167], v[20:23]
 s_waitcnt lgkmcnt(8)
 buffer_load_dwordx4 v216, s[16:19], s34 offen offset:2048 lds
 v_mfma_f32_16x16x32_bf16 v[20:23], a[20:23], a[172:175], v[20:23]
 ds_read_b64_tr_b16 a[8:9], v203 offset:4096
 ds_read_b64_tr_b16 a[10:11], v203 offset:4608
 v_mfma_f32_16x16x32_bf16 v[16:19], a[20:23], a[168:171], v[16:19]
 s_waitcnt lgkmcnt(8)
 v_mfma_f32_16x16x32_bf16 v[24:27], a[24:27], a[160:163], v[24:27]
 ds_read_b64_tr_b16 a[12:13], v203 offset:12288
 ds_read_b64_tr_b16 a[14:15], v203 offset:12800
 v_mfma_f32_16x16x32_bf16 v[28:31], a[24:27], a[164:167], v[28:31]
 s_waitcnt lgkmcnt(8)
 buffer_load_dwordx4 v217, s[16:19], s34 offen offset:3072 lds
 v_mfma_f32_16x16x32_bf16 v[28:31], a[28:31], a[172:175], v[28:31]
 s_add_u32 m0, s33, 49152
 ds_read_b64_tr_b16 a[16:17], v204 offset:4096
 ds_read_b64_tr_b16 a[18:19], v204 offset:4608
 v_mfma_f32_16x16x32_bf16 v[24:27], a[28:31], a[168:171], v[24:27]
 s_waitcnt lgkmcnt(8)
 s_lshr_b32 s34, s90, 12
 v_mfma_f32_16x16x32_bf16 v[32:35], a[0:3], a[160:163], v[32:35]
 ds_read_b64_tr_b16 a[20:21], v204 offset:12288
 ds_read_b64_tr_b16 a[22:23], v204 offset:12800
 v_mfma_f32_16x16x32_bf16 v[36:39], a[0:3], a[164:167], v[36:39]
 s_waitcnt lgkmcnt(8)
 buffer_load_dwordx4 v218, s[24:27], s34 offen lds
 v_mfma_f32_16x16x32_bf16 v[36:39], a[4:7], a[172:175], v[36:39]
 ds_read_b64_tr_b16 a[24:25], v205 offset:4096
 ds_read_b64_tr_b16 a[26:27], v205 offset:4608
 v_mfma_f32_16x16x32_bf16 v[32:35], a[4:7], a[168:171], v[32:35]
 s_waitcnt lgkmcnt(8)
 v_mfma_f32_16x16x32_bf16 v[40:43], a[8:11], a[160:163], v[40:43]
 ds_read_b64_tr_b16 a[28:29], v205 offset:12288
 ds_read_b64_tr_b16 a[30:31], v205 offset:12800
 v_mfma_f32_16x16x32_bf16 v[44:47], a[8:11], a[164:167], v[44:47]
 s_waitcnt lgkmcnt(8)
 buffer_load_dwordx4 v219, s[24:27], s34 offen offset:1024 lds
 v_mfma_f32_16x16x32_bf16 v[44:47], a[12:15], a[172:175], v[44:47]
 ds_read_b64_tr_b16 a[0:1], v202 offset:16384
 ds_read_b64_tr_b16 a[2:3], v202 offset:16896
 v_mfma_f32_16x16x32_bf16 v[40:43], a[12:15], a[168:171], v[40:43]
 s_waitcnt lgkmcnt(8)
 v_mfma_f32_16x16x32_bf16 v[48:51], a[16:19], a[160:163], v[48:51]
 ds_read_b64_tr_b16 a[4:5], v202 offset:24576
 ds_read_b64_tr_b16 a[6:7], v202 offset:25088
 v_mfma_f32_16x16x32_bf16 v[52:55], a[16:19], a[164:167], v[52:55]
 s_waitcnt lgkmcnt(8)
 s_waitcnt vmcnt(6)
 ds_read_b128 a[208:211], v246 offset:32768
 v_mfma_f32_16x16x32_bf16 v[52:55], a[20:23], a[172:175], v[52:55]
 ds_read_b64_tr_b16 a[8:9], v203 offset:16384
 ds_read_b64_tr_b16 a[10:11], v203 offset:16896
 v_mfma_f32_16x16x32_bf16 v[48:51], a[20:23], a[168:171], v[48:51]
 s_waitcnt lgkmcnt(9)
 ds_read_b128 a[212:215], v246 offset:33280
 ds_read_b128 a[216:219], v247 offset:32768
 v_mfma_f32_16x16x32_bf16 v[56:59], a[24:27], a[160:163], v[56:59]
 ds_read_b64_tr_b16 a[12:13], v203 offset:24576
 ds_read_b64_tr_b16 a[14:15], v203 offset:25088
 v_mfma_f32_16x16x32_bf16 v[60:63], a[24:27], a[164:167], v[60:63]
 s_waitcnt lgkmcnt(11)
 ds_read_b128 a[220:223], v247 offset:33280
 buffer_load_dwordx4 v220, s[24:27], s34 offen offset:2048 lds
 v_mfma_f32_16x16x32_bf16 v[60:63], a[28:31], a[172:175], v[60:63]
 ds_read_b64_tr_b16 a[16:17], v204 offset:16384
 ds_read_b64_tr_b16 a[18:19], v204 offset:16896
 v_mfma_f32_16x16x32_bf16 v[56:59], a[28:31], a[168:171], v[56:59]
 s_waitcnt lgkmcnt(12)
 v_mfma_f32_16x16x32_bf16 v[0:3], a[0:3], a[176:179], v[0:3]
 ds_read_b64_tr_b16 a[20:21], v204 offset:24576
 ds_read_b64_tr_b16 a[22:23], v204 offset:25088
 v_mfma_f32_16x16x32_bf16 v[4:7], a[0:3], a[180:183], v[4:7]
 s_waitcnt lgkmcnt(12)
 buffer_load_dwordx4 v221, s[24:27], s34 offen offset:3072 lds
 v_mfma_f32_16x16x32_bf16 v[4:7], a[4:7], a[188:191], v[4:7]
 s_barrier
 ds_read_b64_tr_b16 a[24:25], v205 offset:16384
 ds_read_b64_tr_b16 a[26:27], v205 offset:16896
 v_mfma_f32_16x16x32_bf16 v[0:3], a[4:7], a[184:187], v[0:3]
 s_waitcnt lgkmcnt(11)
 s_waitcnt lgkmcnt(6)
 v_mfma_f32_16x16x32_bf16 v[8:11], a[8:11], a[176:179], v[8:11]
 s_add_u32 m0, s33, 131072
 ds_read_b64_tr_b16 a[28:29], v205 offset:24576
 ds_read_b64_tr_b16 a[30:31], v205 offset:25088
 v_mfma_f32_16x16x32_bf16 v[12:15], a[8:11], a[180:183], v[12:15]
 s_add_u32 s34, s90, 0
 buffer_load_dwordx4 v214, s[16:19], s34 offen lds
 v_mfma_f32_16x16x32_bf16 v[12:15], a[12:15], a[188:191], v[12:15]
 ds_read_b64_tr_b16 a[0:1], v202 offset:20480
 ds_read_b64_tr_b16 a[2:3], v202 offset:20992
 v_mfma_f32_16x16x32_bf16 v[8:11], a[12:15], a[184:187], v[8:11]
 s_waitcnt lgkmcnt(8)
 v_mfma_f32_16x16x32_bf16 v[16:19], a[16:19], a[176:179], v[16:19]
 ds_read_b64_tr_b16 a[4:5], v202 offset:28672
 ds_read_b64_tr_b16 a[6:7], v202 offset:29184
 v_mfma_f32_16x16x32_bf16 v[20:23], a[16:19], a[180:183], v[20:23]
 s_waitcnt lgkmcnt(8)
 buffer_load_dwordx4 v215, s[16:19], s34 offen offset:1024 lds
 v_mfma_f32_16x16x32_bf16 v[20:23], a[20:23], a[188:191], v[20:23]
 ds_read_b64_tr_b16 a[8:9], v203 offset:20480
 ds_read_b64_tr_b16 a[10:11], v203 offset:20992
 v_mfma_f32_16x16x32_bf16 v[16:19], a[20:23], a[184:187], v[16:19]
 s_waitcnt lgkmcnt(8)
 v_mfma_f32_16x16x32_bf16 v[24:27], a[24:27], a[176:179], v[24:27]
 ds_read_b64_tr_b16 a[12:13], v203 offset:28672
 ds_read_b64_tr_b16 a[14:15], v203 offset:29184
 v_mfma_f32_16x16x32_bf16 v[28:31], a[24:27], a[180:183], v[28:31]
 s_waitcnt lgkmcnt(8)
 buffer_load_dwordx4 v216, s[16:19], s34 offen offset:2048 lds
 v_mfma_f32_16x16x32_bf16 v[28:31], a[28:31], a[188:191], v[28:31]
 ds_read_b64_tr_b16 a[16:17], v204 offset:20480
 ds_read_b64_tr_b16 a[18:19], v204 offset:20992
 v_mfma_f32_16x16x32_bf16 v[24:27], a[28:31], a[184:187], v[24:27]
 s_waitcnt lgkmcnt(8)
 v_mfma_f32_16x16x32_bf16 v[32:35], a[0:3], a[176:179], v[32:35]
 ds_read_b64_tr_b16 a[20:21], v204 offset:28672
 ds_read_b64_tr_b16 a[22:23], v204 offset:29184
 v_mfma_f32_16x16x32_bf16 v[36:39], a[0:3], a[180:183], v[36:39]
 s_waitcnt lgkmcnt(8)
 buffer_load_dwordx4 v217, s[16:19], s34 offen offset:3072 lds
 v_mfma_f32_16x16x32_bf16 v[36:39], a[4:7], a[188:191], v[36:39]
 s_add_u32 m0, s33, 147456
 ds_read_b64_tr_b16 a[24:25], v205 offset:20480
 ds_read_b64_tr_b16 a[26:27], v205 offset:20992
 v_mfma_f32_16x16x32_bf16 v[32:35], a[4:7], a[184:187], v[32:35]
 s_waitcnt lgkmcnt(8)
 s_add_u32 s34, s86, 256
 v_mfma_f32_16x16x32_bf16 v[40:43], a[8:11], a[176:179], v[40:43]
 ds_read_b64_tr_b16 a[28:29], v205 offset:28672
 ds_read_b64_tr_b16 a[30:31], v205 offset:29184
 v_mfma_f32_16x16x32_bf16 v[44:47], a[8:11], a[180:183], v[44:47]
 s_waitcnt lgkmcnt(8)
 buffer_load_dwordx4 v214, s[16:19], s34 offen lds
 v_mfma_f32_16x16x32_bf16 v[44:47], a[12:15], a[188:191], v[44:47]
 ds_read_b64_tr_b16 a[0:1], v202 offset:32768
 ds_read_b64_tr_b16 a[2:3], v202 offset:33280
 v_mfma_f32_16x16x32_bf16 v[40:43], a[12:15], a[184:187], v[40:43]
 s_waitcnt lgkmcnt(8)
 v_mfma_f32_16x16x32_bf16 v[48:51], a[16:19], a[176:179], v[48:51]
 ds_read_b64_tr_b16 a[4:5], v202 offset:40960
 ds_read_b64_tr_b16 a[6:7], v202 offset:41472
 v_mfma_f32_16x16x32_bf16 v[52:55], a[16:19], a[180:183], v[52:55]
 s_waitcnt lgkmcnt(8)
 buffer_load_dwordx4 v215, s[16:19], s34 offen offset:1024 lds
 v_mfma_f32_16x16x32_bf16 v[52:55], a[20:23], a[188:191], v[52:55]
 ds_read_b64_tr_b16 a[8:9], v203 offset:32768
 ds_read_b64_tr_b16 a[10:11], v203 offset:33280
 v_mfma_f32_16x16x32_bf16 v[48:51], a[20:23], a[184:187], v[48:51]
 s_waitcnt lgkmcnt(8)
 v_mfma_f32_16x16x32_bf16 v[56:59], a[24:27], a[176:179], v[56:59]
 ds_read_b64_tr_b16 a[12:13], v203 offset:40960
 ds_read_b64_tr_b16 a[14:15], v203 offset:41472
 v_mfma_f32_16x16x32_bf16 v[60:63], a[24:27], a[180:183], v[60:63]
 s_waitcnt lgkmcnt(8)
 s_waitcnt vmcnt(6)
 ds_read_b128 a[224:227], v246 offset:49152
 v_mfma_f32_16x16x32_bf16 v[60:63], a[28:31], a[188:191], v[60:63]
 ds_read_b64_tr_b16 a[16:17], v204 offset:32768
 ds_read_b64_tr_b16 a[18:19], v204 offset:33280
 v_mfma_f32_16x16x32_bf16 v[56:59], a[28:31], a[184:187], v[56:59]
 s_waitcnt lgkmcnt(9)
 ds_read_b128 a[228:231], v246 offset:49664
 ds_read_b128 a[232:235], v247 offset:49152
 v_mfma_f32_16x16x32_bf16 v[0:3], a[0:3], a[192:195], v[0:3]
 ds_read_b64_tr_b16 a[20:21], v204 offset:40960
 ds_read_b64_tr_b16 a[22:23], v204 offset:41472
 v_mfma_f32_16x16x32_bf16 v[4:7], a[0:3], a[196:199], v[4:7]
 s_waitcnt lgkmcnt(11)
 ds_read_b128 a[236:239], v247 offset:49664
 buffer_load_dwordx4 v216, s[16:19], s34 offen offset:2048 lds
 v_mfma_f32_16x16x32_bf16 v[4:7], a[4:7], a[204:207], v[4:7]
 s_barrier
 ds_read_b64_tr_b16 a[24:25], v205 offset:32768
 ds_read_b64_tr_b16 a[26:27], v205 offset:33280
 v_mfma_f32_16x16x32_bf16 v[0:3], a[4:7], a[200:203], v[0:3]
 s_waitcnt lgkmcnt(12)
 v_mfma_f32_16x16x32_bf16 v[8:11], a[8:11], a[192:195], v[8:11]
 ds_read_b64_tr_b16 a[28:29], v205 offset:40960
 ds_read_b64_tr_b16 a[30:31], v205 offset:41472
 v_mfma_f32_16x16x32_bf16 v[12:15], a[8:11], a[196:199], v[12:15]
 s_waitcnt lgkmcnt(12)
 buffer_load_dwordx4 v217, s[16:19], s34 offen offset:3072 lds
 v_mfma_f32_16x16x32_bf16 v[12:15], a[12:15], a[204:207], v[12:15]
 s_add_u32 m0, s33, 0
 ds_read_b64_tr_b16 a[0:1], v202 offset:36864
 ds_read_b64_tr_b16 a[2:3], v202 offset:37376
 v_mfma_f32_16x16x32_bf16 v[8:11], a[12:15], a[200:203], v[8:11]
 s_waitcnt lgkmcnt(11)
 s_waitcnt lgkmcnt(6)
 v_mfma_f32_16x16x32_bf16 v[16:19], a[16:19], a[192:195], v[16:19]
 s_add_u32 s34, s87, 256
 ds_read_b64_tr_b16 a[4:5], v202 offset:45056
 ds_read_b64_tr_b16 a[6:7], v202 offset:45568
 v_mfma_f32_16x16x32_bf16 v[20:23], a[16:19], a[196:199], v[20:23]
 buffer_load_dwordx4 v214, s[16:19], s34 offen lds
 v_mfma_f32_16x16x32_bf16 v[20:23], a[20:23], a[204:207], v[20:23]
 ds_read_b64_tr_b16 a[8:9], v203 offset:36864
 ds_read_b64_tr_b16 a[10:11], v203 offset:37376
 v_mfma_f32_16x16x32_bf16 v[16:19], a[20:23], a[200:203], v[16:19]
 s_waitcnt lgkmcnt(8)
 v_mfma_f32_16x16x32_bf16 v[24:27], a[24:27], a[192:195], v[24:27]
 ds_read_b64_tr_b16 a[12:13], v203 offset:45056
 ds_read_b64_tr_b16 a[14:15], v203 offset:45568
 v_mfma_f32_16x16x32_bf16 v[28:31], a[24:27], a[196:199], v[28:31]
 s_waitcnt lgkmcnt(8)
 buffer_load_dwordx4 v215, s[16:19], s34 offen offset:1024 lds
 v_mfma_f32_16x16x32_bf16 v[28:31], a[28:31], a[204:207], v[28:31]
 ds_read_b64_tr_b16 a[16:17], v204 offset:36864
 ds_read_b64_tr_b16 a[18:19], v204 offset:37376
 v_mfma_f32_16x16x32_bf16 v[24:27], a[28:31], a[200:203], v[24:27]
 s_waitcnt lgkmcnt(8)
 v_mfma_f32_16x16x32_bf16 v[32:35], a[0:3], a[192:195], v[32:35]
 ds_read_b64_tr_b16 a[20:21], v204 offset:45056
 ds_read_b64_tr_b16 a[22:23], v204 offset:45568
 v_mfma_f32_16x16x32_bf16 v[36:39], a[0:3], a[196:199], v[36:39]
 s_waitcnt lgkmcnt(8)
 buffer_load_dwordx4 v216, s[16:19], s34 offen offset:2048 lds
 v_mfma_f32_16x16x32_bf16 v[36:39], a[4:7], a[204:207], v[36:39]
 ds_read_b64_tr_b16 a[24:25], v205 offset:36864
 ds_read_b64_tr_b16 a[26:27], v205 offset:37376
 v_mfma_f32_16x16x32_bf16 v[32:35], a[4:7], a[200:203], v[32:35]
 s_waitcnt lgkmcnt(8)
 v_mfma_f32_16x16x32_bf16 v[40:43], a[8:11], a[192:195], v[40:43]
 ds_read_b64_tr_b16 a[28:29], v205 offset:45056
 ds_read_b64_tr_b16 a[30:31], v205 offset:45568
 v_mfma_f32_16x16x32_bf16 v[44:47], a[8:11], a[196:199], v[44:47]
 s_waitcnt lgkmcnt(8)
 buffer_load_dwordx4 v217, s[16:19], s34 offen offset:3072 lds
 v_mfma_f32_16x16x32_bf16 v[44:47], a[12:15], a[204:207], v[44:47]
 s_add_u32 m0, s33, 16384
 ds_read_b64_tr_b16 a[0:1], v202 offset:49152
 ds_read_b64_tr_b16 a[2:3], v202 offset:49664
 v_mfma_f32_16x16x32_bf16 v[40:43], a[12:15], a[200:203], v[40:43]
 s_waitcnt lgkmcnt(8)
 s_add_u32 s34, s88, 256
 v_mfma_f32_16x16x32_bf16 v[48:51], a[16:19], a[192:195], v[48:51]
 ds_read_b64_tr_b16 a[4:5], v202 offset:57344
 ds_read_b64_tr_b16 a[6:7], v202 offset:57856
 v_mfma_f32_16x16x32_bf16 v[52:55], a[16:19], a[196:199], v[52:55]
 s_waitcnt lgkmcnt(8)
 buffer_load_dwordx4 v214, s[16:19], s34 offen lds
 v_mfma_f32_16x16x32_bf16 v[52:55], a[20:23], a[204:207], v[52:55]
 ds_read_b64_tr_b16 a[8:9], v203 offset:49152
 ds_read_b64_tr_b16 a[10:11], v203 offset:49664
 v_mfma_f32_16x16x32_bf16 v[48:51], a[20:23], a[200:203], v[48:51]
 s_waitcnt lgkmcnt(8)
 v_mfma_f32_16x16x32_bf16 v[56:59], a[24:27], a[192:195], v[56:59]
 ds_read_b64_tr_b16 a[12:13], v203 offset:57344
 ds_read_b64_tr_b16 a[14:15], v203 offset:57856
 v_mfma_f32_16x16x32_bf16 v[60:63], a[24:27], a[196:199], v[60:63]
 s_waitcnt lgkmcnt(8)
 buffer_load_dwordx4 v215, s[16:19], s34 offen offset:1024 lds
 v_mfma_f32_16x16x32_bf16 v[60:63], a[28:31], a[204:207], v[60:63]
 ds_read_b64_tr_b16 a[16:17], v204 offset:49152
 ds_read_b64_tr_b16 a[18:19], v204 offset:49664
 v_mfma_f32_16x16x32_bf16 v[56:59], a[28:31], a[200:203], v[56:59]
 s_waitcnt lgkmcnt(8)
 v_mfma_f32_16x16x32_bf16 v[0:3], a[0:3], a[208:211], v[0:3]
 s_add_u32 s92, s54, 16384
 s_addc_u32 s93, s55, 0
 ds_read_b64_tr_b16 a[20:21], v204 offset:57344
 ds_read_b64_tr_b16 a[22:23], v204 offset:57856
 v_mfma_f32_16x16x32_bf16 v[4:7], a[0:3], a[212:215], v[4:7]
 s_waitcnt vmcnt(10) lgkmcnt(8)
 buffer_load_dwordx4 v216, s[16:19], s34 offen offset:2048 lds
 global_load_dword v252, v245, s[92:93]
 v_mfma_f32_16x16x32_bf16 v[4:7], a[4:7], a[220:223], v[4:7]
 s_barrier
 ds_read_b64_tr_b16 a[24:25], v205 offset:49152
 ds_read_b64_tr_b16 a[26:27], v205 offset:49664
 v_mfma_f32_16x16x32_bf16 v[0:3], a[4:7], a[216:219], v[0:3]
 s_waitcnt lgkmcnt(8)
 v_mfma_f32_16x16x32_bf16 v[8:11], a[8:11], a[208:211], v[8:11]
 ds_read_b64_tr_b16 a[28:29], v205 offset:57344
 ds_read_b64_tr_b16 a[30:31], v205 offset:57856
 v_mfma_f32_16x16x32_bf16 v[12:15], a[8:11], a[212:215], v[12:15]
 s_waitcnt lgkmcnt(8)
 buffer_load_dwordx4 v217, s[16:19], s34 offen offset:3072 lds
 v_mfma_f32_16x16x32_bf16 v[12:15], a[12:15], a[220:223], v[12:15]
 s_add_u32 m0, s33, 32768
 ds_read_b64_tr_b16 a[0:1], v202 offset:53248
 ds_read_b64_tr_b16 a[2:3], v202 offset:53760
 v_mfma_f32_16x16x32_bf16 v[8:11], a[12:15], a[216:219], v[8:11]
 s_waitcnt lgkmcnt(8)
 s_add_u32 s34, s89, 256
 v_mfma_f32_16x16x32_bf16 v[16:19], a[16:19], a[208:211], v[16:19]
 ds_read_b64_tr_b16 a[4:5], v202 offset:61440
 ds_read_b64_tr_b16 a[6:7], v202 offset:61952
 v_mfma_f32_16x16x32_bf16 v[20:23], a[16:19], a[212:215], v[20:23]
 s_waitcnt lgkmcnt(8)
 buffer_load_dwordx4 v214, s[16:19], s34 offen lds
 v_mfma_f32_16x16x32_bf16 v[20:23], a[20:23], a[220:223], v[20:23]
 ds_read_b64_tr_b16 a[8:9], v203 offset:53248
 ds_read_b64_tr_b16 a[10:11], v203 offset:53760
 v_mfma_f32_16x16x32_bf16 v[16:19], a[20:23], a[216:219], v[16:19]
 s_waitcnt lgkmcnt(8)
 v_mfma_f32_16x16x32_bf16 v[24:27], a[24:27], a[208:211], v[24:27]
 ds_read_b64_tr_b16 a[12:13], v203 offset:61440
 ds_read_b64_tr_b16 a[14:15], v203 offset:61952
 v_mfma_f32_16x16x32_bf16 v[28:31], a[24:27], a[212:215], v[28:31]
 s_waitcnt lgkmcnt(8)
 buffer_load_dwordx4 v215, s[16:19], s34 offen offset:1024 lds
 v_mfma_f32_16x16x32_bf16 v[28:31], a[28:31], a[220:223], v[28:31]
 ds_read_b64_tr_b16 a[16:17], v204 offset:53248
 ds_read_b64_tr_b16 a[18:19], v204 offset:53760
 v_mfma_f32_16x16x32_bf16 v[24:27], a[28:31], a[216:219], v[24:27]
 s_waitcnt lgkmcnt(8)
 v_mfma_f32_16x16x32_bf16 v[32:35], a[0:3], a[208:211], v[32:35]
 ds_read_b64_tr_b16 a[20:21], v204 offset:61440
 ds_read_b64_tr_b16 a[22:23], v204 offset:61952
 v_mfma_f32_16x16x32_bf16 v[36:39], a[0:3], a[212:215], v[36:39]
 s_waitcnt lgkmcnt(8)
 buffer_load_dwordx4 v216, s[16:19], s34 offen offset:2048 lds
 v_mfma_f32_16x16x32_bf16 v[36:39], a[4:7], a[220:223], v[36:39]
 ds_read_b64_tr_b16 a[24:25], v205 offset:53248
 ds_read_b64_tr_b16 a[26:27], v205 offset:53760
 v_mfma_f32_16x16x32_bf16 v[32:35], a[4:7], a[216:219], v[32:35]
 s_waitcnt lgkmcnt(8)
 v_mfma_f32_16x16x32_bf16 v[40:43], a[8:11], a[208:211], v[40:43]
 ds_read_b64_tr_b16 a[28:29], v205 offset:61440
 ds_read_b64_tr_b16 a[30:31], v205 offset:61952
 v_mfma_f32_16x16x32_bf16 v[44:47], a[8:11], a[212:215], v[44:47]
 s_waitcnt lgkmcnt(8)
 buffer_load_dwordx4 v217, s[16:19], s34 offen offset:3072 lds
 v_mfma_f32_16x16x32_bf16 v[44:47], a[12:15], a[220:223], v[44:47]
 s_add_u32 m0, s33, 49152
 ds_read_b64_tr_b16 a[0:1], v206 offset:0
 ds_read_b64_tr_b16 a[2:3], v206 offset:512
 v_mfma_f32_16x16x32_bf16 v[40:43], a[12:15], a[216:219], v[40:43]
 s_waitcnt lgkmcnt(8)
 s_add_u32 s34, s90, 256
 v_mfma_f32_16x16x32_bf16 v[48:51], a[16:19], a[208:211], v[48:51]
 ds_read_b64_tr_b16 a[4:5], v206 offset:8192
 ds_read_b64_tr_b16 a[6:7], v206 offset:8704
 v_mfma_f32_16x16x32_bf16 v[52:55], a[16:19], a[212:215], v[52:55]
 s_waitcnt lgkmcnt(8)
 buffer_load_dwordx4 v214, s[16:19], s34 offen lds
 v_mfma_f32_16x16x32_bf16 v[52:55], a[20:23], a[220:223], v[52:55]
 ds_read_b64_tr_b16 a[8:9], v207 offset:0
 ds_read_b64_tr_b16 a[10:11], v207 offset:512
 v_mfma_f32_16x16x32_bf16 v[48:51], a[20:23], a[216:219], v[48:51]
 s_waitcnt lgkmcnt(8)
 v_mfma_f32_16x16x32_bf16 v[56:59], a[24:27], a[208:211], v[56:59]
 ds_read_b64_tr_b16 a[12:13], v207 offset:8192
 ds_read_b64_tr_b16 a[14:15], v207 offset:8704
 v_mfma_f32_16x16x32_bf16 v[60:63], a[24:27], a[212:215], v[60:63]
 s_waitcnt lgkmcnt(8)
 buffer_load_dwordx4 v215, s[16:19], s34 offen offset:1024 lds
 v_mfma_f32_16x16x32_bf16 v[60:63], a[28:31], a[220:223], v[60:63]
 ds_read_b64_tr_b16 a[16:17], v208 offset:0
 ds_read_b64_tr_b16 a[18:19], v208 offset:512
 v_mfma_f32_16x16x32_bf16 v[56:59], a[28:31], a[216:219], v[56:59]
 s_waitcnt lgkmcnt(8)
 v_mfma_f32_16x16x32_bf16 v[0:3], a[0:3], a[224:227], v[0:3]
 ds_read_b64_tr_b16 a[20:21], v208 offset:8192
 ds_read_b64_tr_b16 a[22:23], v208 offset:8704
 v_mfma_f32_16x16x32_bf16 v[4:7], a[0:3], a[228:231], v[4:7]
 s_waitcnt vmcnt(11) lgkmcnt(8)
 buffer_load_dwordx4 v216, s[16:19], s34 offen offset:2048 lds
 v_mfma_f32_16x16x32_bf16 v[4:7], a[4:7], a[236:239], v[4:7]
 s_barrier
 ds_read_b64_tr_b16 a[24:25], v209 offset:0
 ds_read_b64_tr_b16 a[26:27], v209 offset:512
 v_mfma_f32_16x16x32_bf16 v[0:3], a[4:7], a[232:235], v[0:3]
 s_waitcnt lgkmcnt(8)
 v_mfma_f32_16x16x32_bf16 v[8:11], a[8:11], a[224:227], v[8:11]
 ds_read_b64_tr_b16 a[28:29], v209 offset:8192
 ds_read_b64_tr_b16 a[30:31], v209 offset:8704
 v_mfma_f32_16x16x32_bf16 v[12:15], a[8:11], a[228:231], v[12:15]
 s_waitcnt lgkmcnt(8)
 buffer_load_dwordx4 v217, s[16:19], s34 offen offset:3072 lds
 v_mfma_f32_16x16x32_bf16 v[12:15], a[12:15], a[236:239], v[12:15]
 s_add_u32 m0, s33, 65536
 ds_read_b64_tr_b16 a[0:1], v206 offset:4096
 ds_read_b64_tr_b16 a[2:3], v206 offset:4608
 v_mfma_f32_16x16x32_bf16 v[8:11], a[12:15], a[232:235], v[8:11]
 s_waitcnt lgkmcnt(8)
 s_mov_b32 s34, 0
 v_mfma_f32_16x16x32_bf16 v[16:19], a[16:19], a[224:227], v[16:19]
 ds_read_b64_tr_b16 a[4:5], v206 offset:12288
 ds_read_b64_tr_b16 a[6:7], v206 offset:12800
 v_mfma_f32_16x16x32_bf16 v[20:23], a[16:19], a[228:231], v[20:23]
 s_waitcnt lgkmcnt(8)
 v_mul_f32 v0, s61, v0
 v_mul_f32 v1, s61, v1
 v_mfma_f32_16x16x32_bf16 v[20:23], a[20:23], a[236:239], v[20:23]
 ds_read_b64_tr_b16 a[8:9], v207 offset:4096
 ds_read_b64_tr_b16 a[10:11], v207 offset:4608
 v_mfma_f32_16x16x32_bf16 v[16:19], a[20:23], a[232:235], v[16:19]
 s_waitcnt lgkmcnt(8)
 v_mul_f32 v2, s61, v2
 v_mul_f32 v3, s61, v3
 v_mfma_f32_16x16x32_bf16 v[24:27], a[24:27], a[224:227], v[24:27]
 ds_read_b64_tr_b16 a[12:13], v207 offset:12288
 ds_read_b64_tr_b16 a[14:15], v207 offset:12800
 v_mfma_f32_16x16x32_bf16 v[28:31], a[24:27], a[228:231], v[28:31]
 s_waitcnt lgkmcnt(8)
 buffer_load_dwordx4 v210, s[8:11], s34 offen nt lds
 v_mul_f32 v8, s61, v8
 v_mfma_f32_16x16x32_bf16 v[28:31], a[28:31], a[236:239], v[28:31]
 ds_read_b64_tr_b16 a[16:17], v208 offset:4096
 ds_read_b64_tr_b16 a[18:19], v208 offset:4608
 v_mfma_f32_16x16x32_bf16 v[24:27], a[28:31], a[232:235], v[24:27]
 s_waitcnt lgkmcnt(8)
 v_mul_f32 v9, s61, v9
 v_mul_f32 v10, s61, v10
 v_mfma_f32_16x16x32_bf16 v[32:35], a[0:3], a[224:227], v[32:35]
 ds_read_b64_tr_b16 a[20:21], v208 offset:12288
 ds_read_b64_tr_b16 a[22:23], v208 offset:12800
 v_mfma_f32_16x16x32_bf16 v[36:39], a[0:3], a[228:231], v[36:39]
 s_waitcnt lgkmcnt(8)
 v_mul_f32 v11, s61, v11
 v_cvt_pk_bf16_f32 v0, v0, v1
 v_mfma_f32_16x16x32_bf16 v[36:39], a[4:7], a[236:239], v[36:39]
 ds_read_b64_tr_b16 a[24:25], v209 offset:4096
 ds_read_b64_tr_b16 a[26:27], v209 offset:4608
 v_mfma_f32_16x16x32_bf16 v[32:35], a[4:7], a[232:235], v[32:35]
 s_waitcnt lgkmcnt(8)
 v_cvt_pk_bf16_f32 v1, v2, v3
 v_cvt_pk_bf16_f32 v8, v8, v9
 v_mfma_f32_16x16x32_bf16 v[40:43], a[8:11], a[224:227], v[40:43]
 ds_read_b64_tr_b16 a[28:29], v209 offset:12288
 ds_read_b64_tr_b16 a[30:31], v209 offset:12800
 v_mfma_f32_16x16x32_bf16 v[44:47], a[8:11], a[228:231], v[44:47]
 s_waitcnt lgkmcnt(8)
 buffer_load_dwordx4 v211, s[8:11], s34 offen offset:1024 nt lds
 v_cvt_pk_bf16_f32 v9, v10, v11
 v_mfma_f32_16x16x32_bf16 v[44:47], a[12:15], a[236:239], v[44:47]
 ds_read_b64_tr_b16 a[0:1], v206 offset:16384
 ds_read_b64_tr_b16 a[2:3], v206 offset:16896
 v_mfma_f32_16x16x32_bf16 v[40:43], a[12:15], a[232:235], v[40:43]
 s_waitcnt lgkmcnt(8)
 v_permlane32_swap_b32 v0, v8
 v_mfma_f32_16x16x32_bf16 v[48:51], a[16:19], a[224:227], v[48:51]
 ds_read_b64_tr_b16 a[4:5], v206 offset:24576
 ds_read_b64_tr_b16 a[6:7], v206 offset:25088
 v_mfma_f32_16x16x32_bf16 v[52:55], a[16:19], a[228:231], v[52:55]
 s_waitcnt lgkmcnt(8)
 v_permlane32_swap_b32 v1, v9
 v_mfma_f32_16x16x32_bf16 v[52:55], a[20:23], a[236:239], v[52:55]
 ds_read_b64_tr_b16 a[8:9], v207 offset:16384
 ds_read_b64_tr_b16 a[10:11], v207 offset:16896
 v_mfma_f32_16x16x32_bf16 v[48:51], a[20:23], a[232:235], v[48:51]
 s_waitcnt lgkmcnt(8)
 v_permlane16_swap_b32 v0, v8
 v_mfma_f32_16x16x32_bf16 v[56:59], a[24:27], a[224:227], v[56:59]
 ds_read_b64_tr_b16 a[12:13], v207 offset:24576
 ds_read_b64_tr_b16 a[14:15], v207 offset:25088
 v_mfma_f32_16x16x32_bf16 v[60:63], a[24:27], a[228:231], v[60:63]
 s_waitcnt lgkmcnt(8)
 buffer_load_dwordx4 v212, s[8:11], s34 offen offset:2048 nt lds
 v_accvgpr_write_b32 a64, v0
 v_mfma_f32_16x16x32_bf16 v[60:63], a[28:31], a[236:239], v[60:63]
 ds_read_b64_tr_b16 a[16:17], v208 offset:16384
 ds_read_b64_tr_b16 a[18:19], v208 offset:16896
 v_mfma_f32_16x16x32_bf16 v[56:59], a[28:31], a[232:235], v[56:59]
 s_waitcnt lgkmcnt(8)
 v_permlane16_swap_b32 v1, v9
 v_mfma_f32_16x16x32_bf16 v[64:67], a[0:3], a[160:163], v[64:67]
 ds_read_b64_tr_b16 a[20:21], v208 offset:24576
 ds_read_b64_tr_b16 a[22:23], v208 offset:25088
 v_mfma_f32_16x16x32_bf16 v[68:71], a[0:3], a[164:167], v[68:71]
 s_waitcnt lgkmcnt(8)
 v_accvgpr_write_b32 a65, v1
 v_accvgpr_write_b32 a66, v8
 v_mfma_f32_16x16x32_bf16 v[68:71], a[4:7], a[172:175], v[68:71]
 ds_read_b64_tr_b16 a[24:25], v209 offset:16384
 ds_read_b64_tr_b16 a[26:27], v209 offset:16896
 v_mfma_f32_16x16x32_bf16 v[64:67], a[4:7], a[168:171], v[64:67]
 s_waitcnt lgkmcnt(8)
 v_accvgpr_write_b32 a67, v9
 v_mul_f32 v4, s61, v4
 v_mfma_f32_16x16x32_bf16 v[72:75], a[8:11], a[160:163], v[72:75]
 ds_read_b64_tr_b16 a[28:29], v209 offset:24576
 ds_read_b64_tr_b16 a[30:31], v209 offset:25088
 v_mfma_f32_16x16x32_bf16 v[76:79], a[8:11], a[164:167], v[76:79]
 s_waitcnt lgkmcnt(8)
 buffer_load_dwordx4 v213, s[8:11], s34 offen offset:3072 nt lds
 v_mul_f32 v5, s61, v5
 v_mfma_f32_16x16x32_bf16 v[76:79], a[12:15], a[172:175], v[76:79]
 s_add_u32 m0, s33, 81920
 ds_read_b64_tr_b16 a[0:1], v206 offset:20480
 ds_read_b64_tr_b16 a[2:3], v206 offset:20992
 v_mfma_f32_16x16x32_bf16 v[72:75], a[12:15], a[168:171], v[72:75]
 s_waitcnt lgkmcnt(8)
 s_mov_b32 s34, 16384
 v_mul_f32 v6, s61, v6
 v_mfma_f32_16x16x32_bf16 v[80:83], a[16:19], a[160:163], v[80:83]
 ds_read_b64_tr_b16 a[4:5], v206 offset:28672
 ds_read_b64_tr_b16 a[6:7], v206 offset:29184
 v_mfma_f32_16x16x32_bf16 v[84:87], a[16:19], a[164:167], v[84:87]
 s_waitcnt lgkmcnt(8)
 v_mul_f32 v7, s61, v7
 v_mul_f32 v12, s61, v12
 v_mfma_f32_16x16x32_bf16 v[84:87], a[20:23], a[172:175], v[84:87]
 ds_read_b64_tr_b16 a[8:9], v207 offset:20480
 ds_read_b64_tr_b16 a[10:11], v207 offset:20992
 v_mfma_f32_16x16x32_bf16 v[80:83], a[20:23], a[168:171], v[80:83]
 s_waitcnt lgkmcnt(8)
 v_mul_f32 v13, s61, v13
 v_mul_f32 v14, s61, v14
 v_mfma_f32_16x16x32_bf16 v[88:91], a[24:27], a[160:163], v[88:91]
 ds_read_b64_tr_b16 a[12:13], v207 offset:28672
 ds_read_b64_tr_b16 a[14:15], v207 offset:29184
 v_mfma_f32_16x16x32_bf16 v[92:95], a[24:27], a[164:167], v[92:95]
 s_waitcnt lgkmcnt(8)
 buffer_load_dwordx4 v210, s[8:11], s34 offen nt lds
 v_mul_f32 v15, s61, v15
 v_mfma_f32_16x16x32_bf16 v[92:95], a[28:31], a[172:175], v[92:95]
 ds_read_b64_tr_b16 a[16:17], v208 offset:20480
 ds_read_b64_tr_b16 a[18:19], v208 offset:20992
 v_mfma_f32_16x16x32_bf16 v[88:91], a[28:31], a[168:171], v[88:91]
 s_waitcnt lgkmcnt(8)
 v_cvt_pk_bf16_f32 v4, v4, v5
 v_cvt_pk_bf16_f32 v5, v6, v7
 v_mfma_f32_16x16x32_bf16 v[96:99], a[0:3], a[160:163], v[96:99]
 ds_read_b64_tr_b16 a[20:21], v208 offset:28672
 ds_read_b64_tr_b16 a[22:23], v208 offset:29184
 v_mfma_f32_16x16x32_bf16 v[100:103], a[0:3], a[164:167], v[100:103]
 s_waitcnt lgkmcnt(8)
 v_cvt_pk_bf16_f32 v12, v12, v13
 v_cvt_pk_bf16_f32 v13, v14, v15
 v_mfma_f32_16x16x32_bf16 v[100:103], a[4:7], a[172:175], v[100:103]
 ds_read_b64_tr_b16 a[24:25], v209 offset:20480
 ds_read_b64_tr_b16 a[26:27], v209 offset:20992
 v_mfma_f32_16x16x32_bf16 v[96:99], a[4:7], a[168:171], v[96:99]
 s_waitcnt lgkmcnt(8)
 v_permlane32_swap_b32 v4, v12
 v_mfma_f32_16x16x32_bf16 v[104:107], a[8:11], a[160:163], v[104:107]
 ds_read_b64_tr_b16 a[28:29], v209 offset:28672
 ds_read_b64_tr_b16 a[30:31], v209 offset:29184
 v_mfma_f32_16x16x32_bf16 v[108:111], a[8:11], a[164:167], v[108:111]
 s_waitcnt lgkmcnt(8)
 buffer_load_dwordx4 v211, s[8:11], s34 offen offset:1024 nt lds
 v_mul_f32 v16, s61, v16
 v_mfma_f32_16x16x32_bf16 v[108:111], a[12:15], a[172:175], v[108:111]
 ds_read_b64_tr_b16 a[0:1], v198 offset:0
 ds_read_b64_tr_b16 a[2:3], v198 offset:512
 v_mfma_f32_16x16x32_bf16 v[104:107], a[12:15], a[168:171], v[104:107]
 s_waitcnt lgkmcnt(8)
 v_permlane32_swap_b32 v5, v13
 v_mfma_f32_16x16x32_bf16 v[112:115], a[16:19], a[160:163], v[112:115]
 ds_read_b64_tr_b16 a[4:5], v198 offset:8192
 ds_read_b64_tr_b16 a[6:7], v198 offset:8704
 v_mfma_f32_16x16x32_bf16 v[116:119], a[16:19], a[164:167], v[116:119]
 s_waitcnt lgkmcnt(8)
 v_permlane16_swap_b32 v4, v12
 v_mfma_f32_16x16x32_bf16 v[116:119], a[20:23], a[172:175], v[116:119]
 ds_read_b64_tr_b16 a[8:9], v199 offset:0
 ds_read_b64_tr_b16 a[10:11], v199 offset:512
 v_mfma_f32_16x16x32_bf16 v[112:115], a[20:23], a[168:171], v[112:115]
 s_waitcnt lgkmcnt(8)
 v_permlane16_swap_b32 v5, v13
 v_mfma_f32_16x16x32_bf16 v[120:123], a[24:27], a[160:163], v[120:123]
 ds_read_b64_tr_b16 a[12:13], v199 offset:8192
 ds_read_b64_tr_b16 a[14:15], v199 offset:8704
 v_mfma_f32_16x16x32_bf16 v[124:127], a[24:27], a[164:167], v[124:127]
 s_waitcnt lgkmcnt(8)
 buffer_load_dwordx4 v212, s[8:11], s34 offen offset:2048 nt lds
 v_accvgpr_write_b32 a68, v4
 v_mfma_f32_16x16x32_bf16 v[124:127], a[28:31], a[172:175], v[124:127]
 ds_read_b64_tr_b16 a[16:17], v200 offset:0
 ds_read_b64_tr_b16 a[18:19], v200 offset:512
 v_mfma_f32_16x16x32_bf16 v[120:123], a[28:31], a[168:171], v[120:123]
 s_waitcnt lgkmcnt(8)
 v_accvgpr_write_b32 a69, v5
 v_accvgpr_write_b32 a70, v12
 v_mfma_f32_16x16x32_bf16 v[64:67], a[0:3], a[176:179], v[64:67]
 ds_read_b64_tr_b16 a[20:21], v200 offset:8192
 ds_read_b64_tr_b16 a[22:23], v200 offset:8704
 v_mfma_f32_16x16x32_bf16 v[68:71], a[0:3], a[180:183], v[68:71]
 s_waitcnt vmcnt(11) lgkmcnt(8)
 v_accvgpr_write_b32 a71, v13
 v_mul_f32 v17, s61, v17
 v_mfma_f32_16x16x32_bf16 v[68:71], a[4:7], a[188:191], v[68:71]
 s_barrier
 ds_read_b64_tr_b16 a[24:25], v201 offset:0
 ds_read_b64_tr_b16 a[26:27], v201 offset:512
 v_mfma_f32_16x16x32_bf16 v[64:67], a[4:7], a[184:187], v[64:67]
 s_waitcnt lgkmcnt(8)
 v_mul_f32 v18, s61, v18
 v_mul_f32 v19, s61, v19
 v_mfma_f32_16x16x32_bf16 v[72:75], a[8:11], a[176:179], v[72:75]
 ds_read_b64_tr_b16 a[28:29], v201 offset:8192
 ds_read_b64_tr_b16 a[30:31], v201 offset:8704
 v_mfma_f32_16x16x32_bf16 v[76:79], a[8:11], a[180:183], v[76:79]
 s_waitcnt lgkmcnt(8)
 buffer_load_dwordx4 v213, s[8:11], s34 offen offset:3072 nt lds
 v_mul_f32 v24, s61, v24
 v_mfma_f32_16x16x32_bf16 v[76:79], a[12:15], a[188:191], v[76:79]
 s_add_u32 m0, s33, 98304
 ds_read_b64_tr_b16 a[0:1], v198 offset:4096
 ds_read_b64_tr_b16 a[2:3], v198 offset:4608
 v_mfma_f32_16x16x32_bf16 v[72:75], a[12:15], a[184:187], v[72:75]
 s_waitcnt lgkmcnt(8)
 s_mov_b32 s34, 0
 v_mul_f32 v25, s61, v25
 v_mfma_f32_16x16x32_bf16 v[80:83], a[16:19], a[176:179], v[80:83]
 ds_read_b64_tr_b16 a[4:5], v198 offset:12288
 ds_read_b64_tr_b16 a[6:7], v198 offset:12800
 v_mfma_f32_16x16x32_bf16 v[84:87], a[16:19], a[180:183], v[84:87]
 s_waitcnt lgkmcnt(8)
 v_mul_f32 v26, s61, v26
 v_mul_f32 v27, s61, v27
 v_mfma_f32_16x16x32_bf16 v[84:87], a[20:23], a[188:191], v[84:87]
 ds_read_b64_tr_b16 a[8:9], v199 offset:4096
 ds_read_b64_tr_b16 a[10:11], v199 offset:4608
 v_mfma_f32_16x16x32_bf16 v[80:83], a[20:23], a[184:187], v[80:83]
 s_waitcnt lgkmcnt(8)
 v_cvt_pk_bf16_f32 v16, v16, v17
 v_cvt_pk_bf16_f32 v17, v18, v19
 v_mfma_f32_16x16x32_bf16 v[88:91], a[24:27], a[176:179], v[88:91]
 ds_read_b64_tr_b16 a[12:13], v199 offset:12288
 ds_read_b64_tr_b16 a[14:15], v199 offset:12800
 v_mfma_f32_16x16x32_bf16 v[92:95], a[24:27], a[180:183], v[92:95]
 s_waitcnt lgkmcnt(8)
 buffer_load_dwordx4 v210, s[12:15], s34 offen nt lds
 v_cvt_pk_bf16_f32 v24, v24, v25
 v_mfma_f32_16x16x32_bf16 v[92:95], a[28:31], a[188:191], v[92:95]
 ds_read_b64_tr_b16 a[16:17], v200 offset:4096
 ds_read_b64_tr_b16 a[18:19], v200 offset:4608
 v_mfma_f32_16x16x32_bf16 v[88:91], a[28:31], a[184:187], v[88:91]
 s_waitcnt lgkmcnt(8)
 v_permlane32_swap_b32 v16, v24
 v_mfma_f32_16x16x32_bf16 v[96:99], a[0:3], a[176:179], v[96:99]
 ds_read_b64_tr_b16 a[20:21], v200 offset:12288
 ds_read_b64_tr_b16 a[22:23], v200 offset:12800
 v_mfma_f32_16x16x32_bf16 v[100:103], a[0:3], a[180:183], v[100:103]
 s_waitcnt lgkmcnt(8)
 v_permlane16_swap_b32 v16, v24
 v_mfma_f32_16x16x32_bf16 v[100:103], a[4:7], a[188:191], v[100:103]
 ds_read_b64_tr_b16 a[24:25], v201 offset:4096
 ds_read_b64_tr_b16 a[26:27], v201 offset:4608
 v_mfma_f32_16x16x32_bf16 v[96:99], a[4:7], a[184:187], v[96:99]
 s_waitcnt lgkmcnt(8)
 v_cvt_pk_bf16_f32 v25, v26, v27
 v_accvgpr_write_b32 a72, v16
 v_mfma_f32_16x16x32_bf16 v[104:107], a[8:11], a[176:179], v[104:107]
 ds_read_b64_tr_b16 a[28:29], v201 offset:12288
 ds_read_b64_tr_b16 a[30:31], v201 offset:12800
 v_mfma_f32_16x16x32_bf16 v[108:111], a[8:11], a[180:183], v[108:111]
 s_waitcnt lgkmcnt(8)
 buffer_load_dwordx4 v211, s[12:15], s34 offen offset:1024 nt lds
 v_accvgpr_write_b32 a74, v24
 v_mfma_f32_16x16x32_bf16 v[108:111], a[12:15], a[188:191], v[108:111]
 ds_read_b64_tr_b16 a[0:1], v198 offset:16384
 ds_read_b64_tr_b16 a[2:3], v198 offset:16896
 v_mfma_f32_16x16x32_bf16 v[104:107], a[12:15], a[184:187], v[104:107]
 s_waitcnt lgkmcnt(8)
 v_permlane32_swap_b32 v17, v25
 v_mfma_f32_16x16x32_bf16 v[112:115], a[16:19], a[176:179], v[112:115]
 ds_read_b64_tr_b16 a[4:5], v198 offset:24576
 ds_read_b64_tr_b16 a[6:7], v198 offset:25088
 v_mfma_f32_16x16x32_bf16 v[116:119], a[16:19], a[180:183], v[116:119]
 s_waitcnt lgkmcnt(8)
 v_permlane16_swap_b32 v17, v25
 v_mfma_f32_16x16x32_bf16 v[116:119], a[20:23], a[188:191], v[116:119]
 ds_read_b64_tr_b16 a[8:9], v199 offset:16384
 ds_read_b64_tr_b16 a[10:11], v199 offset:16896
 v_mfma_f32_16x16x32_bf16 v[112:115], a[20:23], a[184:187], v[112:115]
 s_waitcnt lgkmcnt(8)
 v_accvgpr_write_b32 a73, v17
 v_accvgpr_write_b32 a75, v25
 v_mfma_f32_16x16x32_bf16 v[120:123], a[24:27], a[176:179], v[120:123]
 ds_read_b64_tr_b16 a[12:13], v199 offset:24576
 ds_read_b64_tr_b16 a[14:15], v199 offset:25088
 v_mfma_f32_16x16x32_bf16 v[124:127], a[24:27], a[180:183], v[124:127]
 s_waitcnt lgkmcnt(8)
 buffer_load_dwordx4 v212, s[12:15], s34 offen offset:2048 nt lds
 v_mul_f32 v20, s61, v20
 v_mfma_f32_16x16x32_bf16 v[124:127], a[28:31], a[188:191], v[124:127]
 ds_read_b64_tr_b16 a[16:17], v200 offset:16384
 ds_read_b64_tr_b16 a[18:19], v200 offset:16896
 v_mfma_f32_16x16x32_bf16 v[120:123], a[28:31], a[184:187], v[120:123]
 s_waitcnt lgkmcnt(8)
 v_mul_f32 v21, s61, v21
 v_mul_f32 v22, s61, v22
 v_mfma_f32_16x16x32_bf16 v[64:67], a[0:3], a[192:195], v[64:67]
 ds_read_b64_tr_b16 a[20:21], v200 offset:24576
 ds_read_b64_tr_b16 a[22:23], v200 offset:25088
 v_mfma_f32_16x16x32_bf16 v[68:71], a[0:3], a[196:199], v[68:71]
 s_waitcnt lgkmcnt(8)
 v_mul_f32 v23, s61, v23
 v_mul_f32 v28, s61, v28
 v_mfma_f32_16x16x32_bf16 v[68:71], a[4:7], a[204:207], v[68:71]
 ds_read_b64_tr_b16 a[24:25], v201 offset:16384
 ds_read_b64_tr_b16 a[26:27], v201 offset:16896
 v_mfma_f32_16x16x32_bf16 v[64:67], a[4:7], a[200:203], v[64:67]
 s_waitcnt lgkmcnt(8)
 v_mul_f32 v29, s61, v29
 v_mul_f32 v30, s61, v30
 v_mfma_f32_16x16x32_bf16 v[72:75], a[8:11], a[192:195], v[72:75]
 ds_read_b64_tr_b16 a[28:29], v201 offset:24576
 ds_read_b64_tr_b16 a[30:31], v201 offset:25088
 v_mfma_f32_16x16x32_bf16 v[76:79], a[8:11], a[196:199], v[76:79]
 s_waitcnt lgkmcnt(8)
 buffer_load_dwordx4 v213, s[12:15], s34 offen offset:3072 nt lds
 v_mul_f32 v31, s61, v31
 v_mfma_f32_16x16x32_bf16 v[76:79], a[12:15], a[204:207], v[76:79]
 s_add_u32 m0, s33, 114688
 ds_read_b64_tr_b16 a[0:1], v198 offset:20480
 ds_read_b64_tr_b16 a[2:3], v198 offset:20992
 v_mfma_f32_16x16x32_bf16 v[72:75], a[12:15], a[200:203], v[72:75]
 s_waitcnt lgkmcnt(8)
 s_mov_b32 s34, 32768
 v_cvt_pk_bf16_f32 v20, v20, v21
 v_mfma_f32_16x16x32_bf16 v[80:83], a[16:19], a[192:195], v[80:83]
 ds_read_b64_tr_b16 a[4:5], v198 offset:28672
 ds_read_b64_tr_b16 a[6:7], v198 offset:29184
 v_mfma_f32_16x16x32_bf16 v[84:87], a[16:19], a[196:199], v[84:87]
 s_waitcnt lgkmcnt(8)
 v_cvt_pk_bf16_f32 v21, v22, v23
 v_cvt_pk_bf16_f32 v28, v28, v29
 v_mfma_f32_16x16x32_bf16 v[84:87], a[20:23], a[204:207], v[84:87]
 ds_read_b64_tr_b16 a[8:9], v199 offset:20480
 ds_read_b64_tr_b16 a[10:11], v199 offset:20992
 v_mfma_f32_16x16x32_bf16 v[80:83], a[20:23], a[200:203], v[80:83]
 s_waitcnt lgkmcnt(8)
 v_permlane32_swap_b32 v20, v28
 v_mfma_f32_16x16x32_bf16 v[88:91], a[24:27], a[192:195], v[88:91]
 ds_read_b64_tr_b16 a[12:13], v199 offset:28672
 ds_read_b64_tr_b16 a[14:15], v199 offset:29184
 v_mfma_f32_16x16x32_bf16 v[92:95], a[24:27], a[196:199], v[92:95]
 s_waitcnt lgkmcnt(8)
 buffer_load_dwordx4 v210, s[8:11], s34 offen nt lds
 v_cvt_pk_bf16_f32 v29, v30, v31
 v_mfma_f32_16x16x32_bf16 v[92:95], a[28:31], a[204:207], v[92:95]
 ds_read_b64_tr_b16 a[16:17], v200 offset:20480
 ds_read_b64_tr_b16 a[18:19], v200 offset:20992
 v_mfma_f32_16x16x32_bf16 v[88:91], a[28:31], a[200:203], v[88:91]
 s_waitcnt lgkmcnt(8)
 v_permlane32_swap_b32 v21, v29
 v_mfma_f32_16x16x32_bf16 v[96:99], a[0:3], a[192:195], v[96:99]
 ds_read_b64_tr_b16 a[20:21], v200 offset:28672
 ds_read_b64_tr_b16 a[22:23], v200 offset:29184
 v_mfma_f32_16x16x32_bf16 v[100:103], a[0:3], a[196:199], v[100:103]
 s_waitcnt lgkmcnt(8)
 v_permlane16_swap_b32 v20, v28
 v_mfma_f32_16x16x32_bf16 v[100:103], a[4:7], a[204:207], v[100:103]
 ds_read_b64_tr_b16 a[24:25], v201 offset:20480
 ds_read_b64_tr_b16 a[26:27], v201 offset:20992
 v_mfma_f32_16x16x32_bf16 v[96:99], a[4:7], a[200:203], v[96:99]
 s_waitcnt lgkmcnt(8)
 v_permlane16_swap_b32 v21, v29
 v_mfma_f32_16x16x32_bf16 v[104:107], a[8:11], a[192:195], v[104:107]
 ds_read_b64_tr_b16 a[28:29], v201 offset:28672
 ds_read_b64_tr_b16 a[30:31], v201 offset:29184
 v_mfma_f32_16x16x32_bf16 v[108:111], a[8:11], a[196:199], v[108:111]
 s_waitcnt lgkmcnt(8)
 buffer_load_dwordx4 v211, s[8:11], s34 offen offset:1024 nt lds
 v_accvgpr_write_b32 a76, v20
 v_mfma_f32_16x16x32_bf16 v[108:111], a[12:15], a[204:207], v[108:111]
 ds_read_b64_tr_b16 a[0:1], v198 offset:32768
 ds_read_b64_tr_b16 a[2:3], v198 offset:33280
 v_mfma_f32_16x16x32_bf16 v[104:107], a[12:15], a[200:203], v[104:107]
 s_waitcnt lgkmcnt(8)
 v_accvgpr_write_b32 a77, v21
 v_accvgpr_write_b32 a78, v28
 v_mfma_f32_16x16x32_bf16 v[112:115], a[16:19], a[192:195], v[112:115]
 ds_read_b64_tr_b16 a[4:5], v198 offset:40960
 ds_read_b64_tr_b16 a[6:7], v198 offset:41472
 v_mfma_f32_16x16x32_bf16 v[116:119], a[16:19], a[196:199], v[116:119]
 s_waitcnt lgkmcnt(8)
 v_accvgpr_write_b32 a79, v29
 v_mul_f32 v32, s61, v32
 v_mfma_f32_16x16x32_bf16 v[116:119], a[20:23], a[204:207], v[116:119]
 ds_read_b64_tr_b16 a[8:9], v199 offset:32768
 ds_read_b64_tr_b16 a[10:11], v199 offset:33280
 v_mfma_f32_16x16x32_bf16 v[112:115], a[20:23], a[200:203], v[112:115]
 s_waitcnt lgkmcnt(8)
 v_mul_f32 v33, s61, v33
 v_mul_f32 v34, s61, v34
 v_mfma_f32_16x16x32_bf16 v[120:123], a[24:27], a[192:195], v[120:123]
 ds_read_b64_tr_b16 a[12:13], v199 offset:40960
 ds_read_b64_tr_b16 a[14:15], v199 offset:41472
 v_mfma_f32_16x16x32_bf16 v[124:127], a[24:27], a[196:199], v[124:127]
 s_waitcnt lgkmcnt(8)
 buffer_load_dwordx4 v212, s[8:11], s34 offen offset:2048 nt lds
 v_mul_f32 v35, s61, v35
 v_mfma_f32_16x16x32_bf16 v[124:127], a[28:31], a[204:207], v[124:127]
 ds_read_b64_tr_b16 a[16:17], v200 offset:32768
 ds_read_b64_tr_b16 a[18:19], v200 offset:33280
 v_mfma_f32_16x16x32_bf16 v[120:123], a[28:31], a[200:203], v[120:123]
 s_waitcnt lgkmcnt(8)
 v_mul_f32 v40, s61, v40
 v_mul_f32 v41, s61, v41
 v_mfma_f32_16x16x32_bf16 v[64:67], a[0:3], a[208:211], v[64:67]
 s_add_u32 s92, s54, 20480
 s_addc_u32 s93, s55, 0
 ds_read_b64_tr_b16 a[20:21], v200 offset:40960
 ds_read_b64_tr_b16 a[22:23], v200 offset:41472
 v_mfma_f32_16x16x32_bf16 v[68:71], a[0:3], a[212:215], v[68:71]
 s_waitcnt vmcnt(11) lgkmcnt(8)
 global_load_dword v252, v245, s[92:93]
 v_mul_f32 v42, s61, v42
 v_mfma_f32_16x16x32_bf16 v[68:71], a[4:7], a[220:223], v[68:71]
 s_barrier
 ds_read_b64_tr_b16 a[24:25], v201 offset:32768
 ds_read_b64_tr_b16 a[26:27], v201 offset:33280
 v_mfma_f32_16x16x32_bf16 v[64:67], a[4:7], a[216:219], v[64:67]
 s_waitcnt lgkmcnt(8)
 v_mul_f32 v43, s61, v43
 v_cvt_pk_bf16_f32 v32, v32, v33
 v_mfma_f32_16x16x32_bf16 v[72:75], a[8:11], a[208:211], v[72:75]
 ds_read_b64_tr_b16 a[28:29], v201 offset:40960
 ds_read_b64_tr_b16 a[30:31], v201 offset:41472
 v_mfma_f32_16x16x32_bf16 v[76:79], a[8:11], a[212:215], v[76:79]
 s_waitcnt lgkmcnt(8)
 buffer_load_dwordx4 v213, s[8:11], s34 offen offset:3072 nt lds
 v_cvt_pk_bf16_f32 v33, v34, v35
 v_mfma_f32_16x16x32_bf16 v[76:79], a[12:15], a[220:223], v[76:79]
 s_add_u32 m0, s33, 131072
 ds_read_b64_tr_b16 a[0:1], v198 offset:36864
 ds_read_b64_tr_b16 a[2:3], v198 offset:37376
 v_mfma_f32_16x16x32_bf16 v[72:75], a[12:15], a[216:219], v[72:75]
 s_waitcnt lgkmcnt(8)
 v_cvt_pk_bf16_f32 v40, v40, v41
 v_cvt_pk_bf16_f32 v41, v42, v43
 v_mfma_f32_16x16x32_bf16 v[80:83], a[16:19], a[208:211], v[80:83]
 s_mov_b32 s34, 16384
 ds_read_b64_tr_b16 a[4:5], v198 offset:45056
 ds_read_b64_tr_b16 a[6:7], v198 offset:45568
 v_mfma_f32_16x16x32_bf16 v[84:87], a[16:19], a[212:215], v[84:87]
 s_waitcnt lgkmcnt(8)
 v_permlane32_swap_b32 v32, v40
 v_mfma_f32_16x16x32_bf16 v[84:87], a[20:23], a[220:223], v[84:87]
 ds_read_b64_tr_b16 a[8:9], v199 offset:36864
 ds_read_b64_tr_b16 a[10:11], v199 offset:37376
 v_mfma_f32_16x16x32_bf16 v[80:83], a[20:23], a[216:219], v[80:83]
 s_waitcnt lgkmcnt(8)
 v_permlane32_swap_b32 v33, v41
 v_mfma_f32_16x16x32_bf16 v[88:91], a[24:27], a[208:211], v[88:91]
 ds_read_b64_tr_b16 a[12:13], v199 offset:45056
 ds_read_b64_tr_b16 a[14:15], v199 offset:45568
 v_mfma_f32_16x16x32_bf16 v[92:95], a[24:27], a[212:215], v[92:95]
 s_waitcnt lgkmcnt(8)
 buffer_load_dwordx4 v210, s[12:15], s34 offen nt lds
 v_mul_f32 v36, s61, v36
 v_mfma_f32_16x16x32_bf16 v[92:95], a[28:31], a[220:223], v[92:95]
 ds_read_b64_tr_b16 a[16:17], v200 offset:36864
 ds_read_b64_tr_b16 a[18:19], v200 offset:37376
 v_mfma_f32_16x16x32_bf16 v[88:91], a[28:31], a[216:219], v[88:91]
 s_waitcnt lgkmcnt(8)
 v_permlane16_swap_b32 v32, v40
 v_mfma_f32_16x16x32_bf16 v[96:99], a[0:3], a[208:211], v[96:99]
 ds_read_b64_tr_b16 a[20:21], v200 offset:45056
 ds_read_b64_tr_b16 a[22:23], v200 offset:45568
 v_mfma_f32_16x16x32_bf16 v[100:103], a[0:3], a[212:215], v[100:103]
 s_waitcnt lgkmcnt(8)
 v_permlane16_swap_b32 v33, v41
 v_mfma_f32_16x16x32_bf16 v[100:103], a[4:7], a[220:223], v[100:103]
 ds_read_b64_tr_b16 a[24:25], v201 offset:36864
 ds_read_b64_tr_b16 a[26:27], v201 offset:37376
 v_mfma_f32_16x16x32_bf16 v[96:99], a[4:7], a[216:219], v[96:99]
 s_waitcnt lgkmcnt(8)
 v_accvgpr_write_b32 a80, v32
 v_accvgpr_write_b32 a81, v33
 v_mfma_f32_16x16x32_bf16 v[104:107], a[8:11], a[208:211], v[104:107]
 ds_read_b64_tr_b16 a[28:29], v201 offset:45056
 ds_read_b64_tr_b16 a[30:31], v201 offset:45568
 v_mfma_f32_16x16x32_bf16 v[108:111], a[8:11], a[212:215], v[108:111]
 s_waitcnt lgkmcnt(8)
 buffer_load_dwordx4 v211, s[12:15], s34 offen offset:1024 nt lds
 v_accvgpr_write_b32 a82, v40
 v_mfma_f32_16x16x32_bf16 v[108:111], a[12:15], a[220:223], v[108:111]
 ds_read_b64_tr_b16 a[0:1], v198 offset:49152
 ds_read_b64_tr_b16 a[2:3], v198 offset:49664
 v_mfma_f32_16x16x32_bf16 v[104:107], a[12:15], a[216:219], v[104:107]
 s_waitcnt lgkmcnt(8)
 v_accvgpr_write_b32 a83, v41
 v_mul_f32 v37, s61, v37
 v_mfma_f32_16x16x32_bf16 v[112:115], a[16:19], a[208:211], v[112:115]
 ds_read_b64_tr_b16 a[4:5], v198 offset:57344
 ds_read_b64_tr_b16 a[6:7], v198 offset:57856
 v_mfma_f32_16x16x32_bf16 v[116:119], a[16:19], a[212:215], v[116:119]
 s_waitcnt lgkmcnt(8)
 v_mul_f32 v38, s61, v38
 v_mul_f32 v39, s61, v39
 v_mfma_f32_16x16x32_bf16 v[116:119], a[20:23], a[220:223], v[116:119]
 ds_read_b64_tr_b16 a[8:9], v199 offset:49152
 ds_read_b64_tr_b16 a[10:11], v199 offset:49664
 v_mfma_f32_16x16x32_bf16 v[112:115], a[20:23], a[216:219], v[112:115]
 s_waitcnt lgkmcnt(8)
 v_mul_f32 v44, s61, v44
 v_mul_f32 v45, s61, v45
 v_mfma_f32_16x16x32_bf16 v[120:123], a[24:27], a[208:211], v[120:123]
 ds_read_b64_tr_b16 a[12:13], v199 offset:57344
 ds_read_b64_tr_b16 a[14:15], v199 offset:57856
 v_mfma_f32_16x16x32_bf16 v[124:127], a[24:27], a[212:215], v[124:127]
 s_waitcnt lgkmcnt(8)
 buffer_load_dwordx4 v212, s[12:15], s34 offen offset:2048 nt lds
 v_mul_f32 v46, s61, v46
 v_mfma_f32_16x16x32_bf16 v[124:127], a[28:31], a[220:223], v[124:127]
 ds_read_b64_tr_b16 a[16:17], v200 offset:49152
 ds_read_b64_tr_b16 a[18:19], v200 offset:49664
 v_mfma_f32_16x16x32_bf16 v[120:123], a[28:31], a[216:219], v[120:123]
 s_waitcnt lgkmcnt(8)
 v_mul_f32 v47, s61, v47
 v_cvt_pk_bf16_f32 v36, v36, v37
 v_mfma_f32_16x16x32_bf16 v[64:67], a[0:3], a[224:227], v[64:67]
 ds_read_b64_tr_b16 a[20:21], v200 offset:57344
 ds_read_b64_tr_b16 a[22:23], v200 offset:57856
 v_mfma_f32_16x16x32_bf16 v[68:71], a[0:3], a[228:231], v[68:71]
 s_waitcnt lgkmcnt(8)
 v_cvt_pk_bf16_f32 v37, v38, v39
 v_cvt_pk_bf16_f32 v44, v44, v45
 v_mfma_f32_16x16x32_bf16 v[68:71], a[4:7], a[236:239], v[68:71]
 ds_read_b64_tr_b16 a[24:25], v201 offset:49152
 ds_read_b64_tr_b16 a[26:27], v201 offset:49664
 v_mfma_f32_16x16x32_bf16 v[64:67], a[4:7], a[232:235], v[64:67]
 s_waitcnt lgkmcnt(8)
 v_permlane32_swap_b32 v36, v44
 v_mfma_f32_16x16x32_bf16 v[72:75], a[8:11], a[224:227], v[72:75]
 ds_read_b64_tr_b16 a[28:29], v201 offset:57344
 ds_read_b64_tr_b16 a[30:31], v201 offset:57856
 v_mfma_f32_16x16x32_bf16 v[76:79], a[8:11], a[228:231], v[76:79]
 s_waitcnt lgkmcnt(8)
 buffer_load_dwordx4 v213, s[12:15], s34 offen offset:3072 nt lds
 v_cvt_pk_bf16_f32 v45, v46, v47
 v_mfma_f32_16x16x32_bf16 v[76:79], a[12:15], a[236:239], v[76:79]
 s_add_u32 m0, s33, 147456
 ds_read_b64_tr_b16 a[0:1], v198 offset:53248
 ds_read_b64_tr_b16 a[2:3], v198 offset:53760
 v_mfma_f32_16x16x32_bf16 v[72:75], a[12:15], a[232:235], v[72:75]
 s_waitcnt lgkmcnt(8)
 v_permlane32_swap_b32 v37, v45
 v_mfma_f32_16x16x32_bf16 v[80:83], a[16:19], a[224:227], v[80:83]
 s_mov_b32 s34, 49152
 ds_read_b64_tr_b16 a[4:5], v198 offset:61440
 ds_read_b64_tr_b16 a[6:7], v198 offset:61952
 v_mfma_f32_16x16x32_bf16 v[84:87], a[16:19], a[228:231], v[84:87]
 s_waitcnt lgkmcnt(8)
 v_permlane16_swap_b32 v36, v44
 v_mfma_f32_16x16x32_bf16 v[84:87], a[20:23], a[236:239], v[84:87]
 ds_read_b64_tr_b16 a[8:9], v199 offset:53248
 ds_read_b64_tr_b16 a[10:11], v199 offset:53760
 v_mfma_f32_16x16x32_bf16 v[80:83], a[20:23], a[232:235], v[80:83]
 s_waitcnt lgkmcnt(8)
 v_permlane16_swap_b32 v37, v45
 v_mfma_f32_16x16x32_bf16 v[88:91], a[24:27], a[224:227], v[88:91]
 ds_read_b64_tr_b16 a[12:13], v199 offset:61440
 ds_read_b64_tr_b16 a[14:15], v199 offset:61952
 v_mfma_f32_16x16x32_bf16 v[92:95], a[24:27], a[228:231], v[92:95]
 s_waitcnt lgkmcnt(8)
 buffer_load_dwordx4 v210, s[8:11], s34 offen nt lds
 v_accvgpr_write_b32 a84, v36
 v_mfma_f32_16x16x32_bf16 v[92:95], a[28:31], a[236:239], v[92:95]
 ds_read_b64_tr_b16 a[16:17], v200 offset:53248
 ds_read_b64_tr_b16 a[18:19], v200 offset:53760
 v_mfma_f32_16x16x32_bf16 v[88:91], a[28:31], a[232:235], v[88:91]
 s_waitcnt lgkmcnt(8)
 v_accvgpr_write_b32 a85, v37
 v_accvgpr_write_b32 a86, v44
 v_mfma_f32_16x16x32_bf16 v[96:99], a[0:3], a[224:227], v[96:99]
 ds_read_b64_tr_b16 a[20:21], v200 offset:61440
 ds_read_b64_tr_b16 a[22:23], v200 offset:61952
 v_mfma_f32_16x16x32_bf16 v[100:103], a[0:3], a[228:231], v[100:103]
 s_waitcnt lgkmcnt(8)
 v_accvgpr_write_b32 a87, v45
 v_mul_f32 v48, s61, v48
 v_mfma_f32_16x16x32_bf16 v[100:103], a[4:7], a[236:239], v[100:103]
 ds_read_b64_tr_b16 a[24:25], v201 offset:53248
 ds_read_b64_tr_b16 a[26:27], v201 offset:53760
 v_mfma_f32_16x16x32_bf16 v[96:99], a[4:7], a[232:235], v[96:99]
 s_waitcnt lgkmcnt(8)
 v_mul_f32 v49, s61, v49
 v_mul_f32 v50, s61, v50
 v_mfma_f32_16x16x32_bf16 v[104:107], a[8:11], a[224:227], v[104:107]
 ds_read_b64_tr_b16 a[28:29], v201 offset:61440
 ds_read_b64_tr_b16 a[30:31], v201 offset:61952
 v_mfma_f32_16x16x32_bf16 v[108:111], a[8:11], a[228:231], v[108:111]
 s_waitcnt lgkmcnt(8)
 buffer_load_dwordx4 v211, s[8:11], s34 offen offset:1024 nt lds
 v_mul_f32 v51, s61, v51
 v_mfma_f32_16x16x32_bf16 v[108:111], a[12:15], a[236:239], v[108:111]
 ds_read_b128 a[0:3], v194 offset:0
 v_mul_f32 v56, s61, v56
 v_mfma_f32_16x16x32_bf16 v[104:107], a[12:15], a[232:235], v[104:107]
 s_waitcnt lgkmcnt(7)
 v_mul_f32 v57, s61, v57
 v_mul_f32 v58, s61, v58
 v_mfma_f32_16x16x32_bf16 v[112:115], a[16:19], a[224:227], v[112:115]
 ds_read_b128 a[4:7], v194 offset:512
 v_mul_f32 v59, s61, v59
 v_mfma_f32_16x16x32_bf16 v[116:119], a[16:19], a[228:231], v[116:119]
 s_waitcnt lgkmcnt(6)
 v_cvt_pk_bf16_f32 v48, v48, v49
 v_cvt_pk_bf16_f32 v49, v50, v51
 v_mfma_f32_16x16x32_bf16 v[116:119], a[20:23], a[236:239], v[116:119]
 ds_read_b128 a[8:11], v195 offset:0
 v_cvt_pk_bf16_f32 v56, v56, v57
 v_mfma_f32_16x16x32_bf16 v[112:115], a[20:23], a[232:235], v[112:115]
 s_waitcnt lgkmcnt(5)
 v_permlane32_swap_b32 v48, v56
 v_mfma_f32_16x16x32_bf16 v[120:123], a[24:27], a[224:227], v[120:123]
 ds_read_b128 a[12:15], v195 offset:512
 buffer_load_dwordx4 v212, s[8:11], s34 offen offset:2048 nt lds
 v_mfma_f32_16x16x32_bf16 v[124:127], a[24:27], a[228:231], v[124:127]
 s_waitcnt lgkmcnt(4)
 v_permlane16_swap_b32 v48, v56
 v_mfma_f32_16x16x32_bf16 v[124:127], a[28:31], a[236:239], v[124:127]
 ds_read_b128 a[16:19], v194 offset:4096
 v_cvt_pk_bf16_f32 v57, v58, v59
 v_mfma_f32_16x16x32_bf16 v[120:123], a[28:31], a[232:235], v[120:123]
 s_waitcnt lgkmcnt(4)
 v_permlane32_swap_b32 v49, v57
 v_mfma_f32_16x16x32_bf16 v[128:131], a[0:3], a[64:67], 0
 ds_read_b128 a[20:23], v194 offset:4608
 v_accvgpr_write_b32 a88, v48
 v_mfma_f32_16x16x32_bf16 v[132:135], a[0:3], a[68:71], 0
 s_waitcnt vmcnt(12) lgkmcnt(4)
 v_permlane16_swap_b32 v49, v57
 v_mfma_f32_16x16x32_bf16 v[140:143], a[4:7], a[68:71], 0
 s_barrier
 ds_read_b128 a[24:27], v195 offset:4096
 v_accvgpr_write_b32 a89, v49
 v_mfma_f32_16x16x32_bf16 v[136:139], a[4:7], a[64:67], 0
 s_waitcnt lgkmcnt(4)
 buffer_load_dwordx4 v213, s[8:11], s34 offen offset:3072 nt lds
 v_accvgpr_write_b32 a90, v56
 v_mfma_f32_16x16x32_bf16 v[128:131], a[8:11], a[72:75], v[128:131]
 s_add_u32 m0, s33, 0
 ds_read_b128 a[28:31], v195 offset:4608
 v_accvgpr_write_b32 a91, v57
 v_mfma_f32_16x16x32_bf16 v[132:135], a[8:11], a[76:79], v[132:135]
 s_waitcnt lgkmcnt(4)
 v_mul_f32 v52, s61, v52
 v_mul_f32 v53, s61, v53
 v_mfma_f32_16x16x32_bf16 v[140:143], a[12:15], a[76:79], v[140:143]
 s_mov_b32 s34, 32768
 ds_read_b128 a[0:3], v194 offset:8192
 v_mul_f32 v54, s61, v54
 v_mfma_f32_16x16x32_bf16 v[136:139], a[12:15], a[72:75], v[136:139]
 s_waitcnt lgkmcnt(4)
 v_mul_f32 v55, s61, v55
 v_mul_f32 v60, s61, v60
 v_mfma_f32_16x16x32_bf16 v[128:131], a[16:19], a[80:83], v[128:131]
 ds_read_b128 a[4:7], v194 offset:8704
 v_mul_f32 v61, s61, v61
 v_mfma_f32_16x16x32_bf16 v[132:135], a[16:19], a[84:87], v[132:135]
 s_waitcnt lgkmcnt(4)
 v_mul_f32 v62, s61, v62
 v_mul_f32 v63, s61, v63
 v_mfma_f32_16x16x32_bf16 v[140:143], a[20:23], a[84:87], v[140:143]
 ds_read_b128 a[8:11], v195 offset:8192
 buffer_load_dwordx4 v210, s[12:15], s34 offen nt lds
 v_mfma_f32_16x16x32_bf16 v[136:139], a[20:23], a[80:83], v[136:139]
 s_waitcnt lgkmcnt(4)
 v_cvt_pk_bf16_f32 v52, v52, v53
 v_cvt_pk_bf16_f32 v53, v54, v55
 v_cvt_pk_bf16_f32 v60, v60, v61
 v_cvt_pk_bf16_f32 v61, v62, v63
 s_nop 0
 v_permlane32_swap_b32 v52, v60
 v_permlane32_swap_b32 v53, v61
 s_nop 0
 v_permlane16_swap_b32 v52, v60
 v_permlane16_swap_b32 v53, v61
 v_accvgpr_write_b32 a92, v52
 v_accvgpr_write_b32 a93, v53
 v_accvgpr_write_b32 a94, v60
 v_accvgpr_write_b32 a95, v61
 v_mfma_f32_16x16x32_bf16 v[128:131], a[24:27], a[88:91], v[128:131]
 ds_read_b128 a[12:15], v195 offset:8704
 v_mul_f32 v64, s61, v64
 v_mfma_f32_16x16x32_bf16 v[132:135], a[24:27], a[92:95], v[132:135]
 s_waitcnt lgkmcnt(4)
 v_mul_f32 v65, s61, v65
 v_mul_f32 v66, s61, v66
 v_mfma_f32_16x16x32_bf16 v[140:143], a[28:31], a[92:95], v[140:143]
 ds_read_b128 a[16:19], v194 offset:12288
 v_mul_f32 v67, s61, v67
 v_mfma_f32_16x16x32_bf16 v[136:139], a[28:31], a[88:91], v[136:139]
 s_waitcnt lgkmcnt(4)
 v_mul_f32 v72, s61, v72
 v_mul_f32 v73, s61, v73
 v_mul_f32 v74, s61, v74
 v_mul_f32 v75, s61, v75
 v_cvt_pk_bf16_f32 v64, v64, v65
 v_cvt_pk_bf16_f32 v72, v72, v73
 v_cvt_pk_bf16_f32 v65, v66, v67
 v_cvt_pk_bf16_f32 v73, v74, v75
 v_permlane32_swap_b32 v64, v72
 v_mul_f32 v68, s61, v68
 v_permlane32_swap_b32 v65, v73
 v_permlane16_swap_b32 v64, v72
 v_accvgpr_write_b32 a96, v64
 v_permlane16_swap_b32 v65, v73
 v_accvgpr_write_b32 a97, v65
 v_accvgpr_write_b32 a98, v72
 v_accvgpr_write_b32 a99, v73
 v_mul_f32 v69, s61, v69
 v_mul_f32 v76, s61, v76
 v_mul_f32 v77, s61, v77
 v_mul_f32 v70, s61, v70
 v_mul_f32 v71, s61, v71
 v_mul_f32 v78, s61, v78
 v_mul_f32 v79, s61, v79
 v_cvt_pk_bf16_f32 v68, v68, v69
 v_cvt_pk_bf16_f32 v76, v76, v77
 v_cvt_pk_bf16_f32 v69, v70, v71
 v_cvt_pk_bf16_f32 v77, v78, v79
 v_permlane32_swap_b32 v68, v76
 s_nop 0
 v_permlane32_swap_b32 v69, v77
 v_permlane16_swap_b32 v68, v76
 v_accvgpr_write_b32 a100, v68
 v_permlane16_swap_b32 v69, v77
 v_accvgpr_write_b32 a101, v69
 v_accvgpr_write_b32 a102, v76
 v_accvgpr_write_b32 a103, v77
 v_mfma_f32_16x16x32_bf16 v[128:131], a[0:3], a[96:99], v[128:131]
 ds_read_b128 a[20:23], v194 offset:12800
 v_mul_f32 v80, s61, v80
 v_mfma_f32_16x16x32_bf16 v[132:135], a[0:3], a[100:103], v[132:135]
 s_waitcnt lgkmcnt(4)
 buffer_load_dwordx4 v211, s[12:15], s34 offen offset:1024 nt lds
 v_mul_f32 v81, s61, v81
 v_mfma_f32_16x16x32_bf16 v[140:143], a[4:7], a[100:103], v[140:143]
 ds_read_b128 a[24:27], v195 offset:12288
 v_mul_f32 v82, s61, v82
 v_mfma_f32_16x16x32_bf16 v[136:139], a[4:7], a[96:99], v[136:139]
 s_waitcnt lgkmcnt(4)
 v_mul_f32 v83, s61, v83
 v_mul_f32 v88, s61, v88
 v_mul_f32 v89, s61, v89
 v_mul_f32 v90, s61, v90
 v_mul_f32 v91, s61, v91
 v_cvt_pk_bf16_f32 v80, v80, v81
 v_cvt_pk_bf16_f32 v88, v88, v89
 v_cvt_pk_bf16_f32 v81, v82, v83
 v_cvt_pk_bf16_f32 v89, v90, v91
 v_permlane32_swap_b32 v80, v88
 v_mul_f32 v84, s61, v84
 v_permlane32_swap_b32 v81, v89
 v_permlane16_swap_b32 v80, v88
 v_accvgpr_write_b32 a104, v80
 v_permlane16_swap_b32 v81, v89
 v_accvgpr_write_b32 a105, v81
 v_accvgpr_write_b32 a106, v88
 v_accvgpr_write_b32 a107, v89
 v_mul_f32 v85, s61, v85
 v_mul_f32 v92, s61, v92
 v_mul_f32 v93, s61, v93
 v_mul_f32 v86, s61, v86
 v_mul_f32 v87, s61, v87
 v_mul_f32 v94, s61, v94
 v_mul_f32 v95, s61, v95
 v_cvt_pk_bf16_f32 v84, v84, v85
 v_cvt_pk_bf16_f32 v92, v92, v93
 v_cvt_pk_bf16_f32 v85, v86, v87
 v_cvt_pk_bf16_f32 v93, v94, v95
 v_permlane32_swap_b32 v84, v92
 s_nop 0
 v_permlane32_swap_b32 v85, v93
 v_permlane16_swap_b32 v84, v92
 v_accvgpr_write_b32 a108, v84
 v_permlane16_swap_b32 v85, v93
 v_accvgpr_write_b32 a109, v85
 v_accvgpr_write_b32 a110, v92
 v_accvgpr_write_b32 a111, v93
 v_mfma_f32_16x16x32_bf16 v[128:131], a[8:11], a[104:107], v[128:131]
 ds_read_b128 a[28:31], v195 offset:12800
 v_mul_f32 v96, s61, v96
 v_mfma_f32_16x16x32_bf16 v[132:135], a[8:11], a[108:111], v[132:135]
 s_waitcnt lgkmcnt(4)
 v_mul_f32 v97, s61, v97
 v_mul_f32 v98, s61, v98
 v_mfma_f32_16x16x32_bf16 v[140:143], a[12:15], a[108:111], v[140:143]
 ds_read_b128 a[0:3], v194 offset:16384
 v_mul_f32 v99, s61, v99
 v_mfma_f32_16x16x32_bf16 v[136:139], a[12:15], a[104:107], v[136:139]
 s_waitcnt lgkmcnt(4)
 v_mul_f32 v104, s61, v104
 v_mul_f32 v105, s61, v105
 v_mul_f32 v106, s61, v106
 v_mul_f32 v107, s61, v107
 v_cvt_pk_bf16_f32 v96, v96, v97
 v_cvt_pk_bf16_f32 v104, v104, v105
 v_cvt_pk_bf16_f32 v97, v98, v99
 v_cvt_pk_bf16_f32 v105, v106, v107
 v_permlane32_swap_b32 v96, v104
 v_mul_f32 v100, s61, v100
 v_permlane32_swap_b32 v97, v105
 v_permlane16_swap_b32 v96, v104
 v_accvgpr_write_b32 a112, v96
 v_permlane16_swap_b32 v97, v105
 v_accvgpr_write_b32 a113, v97
 v_accvgpr_write_b32 a114, v104
 v_accvgpr_write_b32 a115, v105
 v_mul_f32 v101, s61, v101
 v_mul_f32 v108, s61, v108
 v_mul_f32 v109, s61, v109
 v_mul_f32 v102, s61, v102
 v_mul_f32 v103, s61, v103
 v_mul_f32 v110, s61, v110
 v_mul_f32 v111, s61, v111
 v_cvt_pk_bf16_f32 v100, v100, v101
 v_cvt_pk_bf16_f32 v108, v108, v109
 v_cvt_pk_bf16_f32 v101, v102, v103
 v_cvt_pk_bf16_f32 v109, v110, v111
 v_permlane32_swap_b32 v100, v108
 s_nop 0
 v_permlane32_swap_b32 v101, v109
 v_permlane16_swap_b32 v100, v108
 v_accvgpr_write_b32 a116, v100
 v_permlane16_swap_b32 v101, v109
 v_accvgpr_write_b32 a117, v101
 v_accvgpr_write_b32 a118, v108
 v_accvgpr_write_b32 a119, v109
 v_mfma_f32_16x16x32_bf16 v[128:131], a[16:19], a[112:115], v[128:131]
 ds_read_b128 a[4:7], v194 offset:16896
 buffer_load_dwordx4 v212, s[12:15], s34 offen offset:2048 nt lds
 v_mfma_f32_16x16x32_bf16 v[132:135], a[16:19], a[116:119], v[132:135]
 s_waitcnt lgkmcnt(4)
 v_mul_f32 v112, s61, v112
 v_mul_f32 v113, s61, v113
 v_mfma_f32_16x16x32_bf16 v[140:143], a[20:23], a[116:119], v[140:143]
 ds_read_b128 a[8:11], v195 offset:16384
 v_mul_f32 v114, s61, v114
 v_mfma_f32_16x16x32_bf16 v[136:139], a[20:23], a[112:115], v[136:139]
 s_waitcnt lgkmcnt(4)
 v_mul_f32 v115, s61, v115
 v_mul_f32 v120, s61, v120
 v_mul_f32 v121, s61, v121
 v_mul_f32 v122, s61, v122
 v_mul_f32 v123, s61, v123
 v_cvt_pk_bf16_f32 v112, v112, v113
 v_cvt_pk_bf16_f32 v120, v120, v121
 v_cvt_pk_bf16_f32 v113, v114, v115
 v_cvt_pk_bf16_f32 v121, v122, v123
 v_permlane32_swap_b32 v112, v120
 v_mul_f32 v116, s61, v116
 v_permlane32_swap_b32 v113, v121
 v_permlane16_swap_b32 v112, v120
 v_accvgpr_write_b32 a120, v112
 v_permlane16_swap_b32 v113, v121
 v_accvgpr_write_b32 a121, v113
 v_accvgpr_write_b32 a122, v120
 v_accvgpr_write_b32 a123, v121
 v_mul_f32 v117, s61, v117
 v_mul_f32 v124, s61, v124
 v_mul_f32 v125, s61, v125
 v_mul_f32 v118, s61, v118
 v_mul_f32 v119, s61, v119
 v_mul_f32 v126, s61, v126
 v_mul_f32 v127, s61, v127
 v_cvt_pk_bf16_f32 v116, v116, v117
 v_cvt_pk_bf16_f32 v124, v124, v125
 v_cvt_pk_bf16_f32 v117, v118, v119
 v_cvt_pk_bf16_f32 v125, v126, v127
 v_permlane32_swap_b32 v116, v124
 s_nop 0
 v_permlane32_swap_b32 v117, v125
 v_permlane16_swap_b32 v116, v124
 v_accvgpr_write_b32 a124, v116
 v_permlane16_swap_b32 v117, v125
 v_accvgpr_write_b32 a125, v117
 v_accvgpr_write_b32 a126, v124
 v_accvgpr_write_b32 a127, v125
 v_mfma_f32_16x16x32_bf16 v[128:131], a[24:27], a[120:123], v[128:131]
 ds_read_b128 a[12:15], v195 offset:16896
 v_mfma_f32_16x16x32_bf16 v[132:135], a[24:27], a[124:127], v[132:135]
 s_waitcnt lgkmcnt(4)
 v_mfma_f32_16x16x32_bf16 v[140:143], a[28:31], a[124:127], v[140:143]
 ds_read_b128 a[16:19], v194 offset:20480
 v_mfma_f32_16x16x32_bf16 v[136:139], a[28:31], a[120:123], v[136:139]
 s_waitcnt lgkmcnt(4)
 buffer_load_dwordx4 v213, s[12:15], s34 offen offset:3072 nt lds
 v_max3_f32 v224, v128, v129, v130
 s_nop 4
 v_max3_f32 v224, v131, v136, v224
 v_max3_f32 v224, v137, v138, v224
 v_max_f32 v224, v139, v224
 v_mov_b32 v225, v224
 s_nop 1
 v_permlane32_swap_b32 v224, v225
 v_max_f32 v224, v224, v225
 v_mov_b32 v225, v224
 s_nop 1
 v_permlane16_swap_b32 v224, v225
 v_max_f32 v224, v224, v225
 v_sub_f32 v168, 0, v224
 v_sub_f32 v169, 0, v224
 v_sub_f32 v170, 0, v224
 v_sub_f32 v171, 0, v224
 v_max3_f32 v226, v132, v133, v134
 v_max3_f32 v226, v135, v140, v226
 v_max3_f32 v226, v141, v142, v226
 v_max_f32 v226, v143, v226
 v_mov_b32 v227, v226
 s_nop 1
 v_permlane32_swap_b32 v226, v227
 v_max_f32 v226, v226, v227
 v_mov_b32 v227, v226
 s_nop 1
 v_permlane16_swap_b32 v226, v227
 v_max_f32 v226, v226, v227
 v_sub_f32 v172, 0, v226
 v_sub_f32 v173, 0, v226
 v_sub_f32 v174, 0, v226
 v_sub_f32 v175, 0, v226
 v_mfma_f32_16x16x32_bf16 v[144:147], a[0:3], a[64:67], v[168:171]
 s_add_u32 m0, s33, 16384
 ds_read_b128 a[20:23], v194 offset:20992
 v_sub_f32 v128, v128, v224
 v_mfma_f32_16x16x32_bf16 v[148:151], a[0:3], a[68:71], v[172:175]
 s_waitcnt lgkmcnt(4)
 v_exp_f32 v128, v128
 v_mfma_f32_16x16x32_bf16 v[156:159], a[4:7], a[68:71], v[172:175]
 s_mov_b32 s34, 65536
 ds_read_b128 a[24:27], v195 offset:20480
 v_sub_f32 v129, v129, v224
 v_mfma_f32_16x16x32_bf16 v[152:155], a[4:7], a[64:67], v[168:171]
 s_waitcnt lgkmcnt(4)
 v_exp_f32 v129, v129
 v_mfma_f32_16x16x32_bf16 v[144:147], a[8:11], a[72:75], v[144:147]
 ds_read_b128 a[28:31], v195 offset:20992
 v_sub_f32 v130, v130, v224
 v_mfma_f32_16x16x32_bf16 v[148:151], a[8:11], a[76:79], v[148:151]
 s_waitcnt lgkmcnt(4)
 v_exp_f32 v130, v130
 v_mfma_f32_16x16x32_bf16 v[156:159], a[12:15], a[76:79], v[156:159]
 ds_read_b128 a[0:3], v194 offset:24576
 buffer_load_dwordx4 v210, s[8:11], s34 offen nt lds
 v_mfma_f32_16x16x32_bf16 v[152:155], a[12:15], a[72:75], v[152:155]
 s_waitcnt lgkmcnt(4)
 v_sub_f32 v131, v131, v224
 v_sub_f32 v136, v136, v224
 v_mfma_f32_16x16x32_bf16 v[144:147], a[16:19], a[80:83], v[144:147]
 ds_read_b128 a[4:7], v194 offset:25088
 v_sub_f32 v137, v137, v224
 v_mfma_f32_16x16x32_bf16 v[148:151], a[16:19], a[84:87], v[148:151]
 s_waitcnt lgkmcnt(4)
 v_exp_f32 v131, v131
 v_mfma_f32_16x16x32_bf16 v[156:159], a[20:23], a[84:87], v[156:159]
 ds_read_b128 a[8:11], v195 offset:24576
 v_sub_f32 v138, v138, v224
 v_mfma_f32_16x16x32_bf16 v[152:155], a[20:23], a[80:83], v[152:155]
 s_waitcnt lgkmcnt(4)
 v_exp_f32 v136, v136
 v_mfma_f32_16x16x32_bf16 v[144:147], a[24:27], a[88:91], v[144:147]
 ds_read_b128 a[12:15], v195 offset:25088
 v_sub_f32 v139, v139, v224
 v_mfma_f32_16x16x32_bf16 v[148:151], a[24:27], a[92:95], v[148:151]
 s_waitcnt lgkmcnt(4)
 buffer_load_dwordx4 v211, s[8:11], s34 offen offset:1024 nt lds
 v_sub_f32 v132, v132, v226
 v_mfma_f32_16x16x32_bf16 v[156:159], a[28:31], a[92:95], v[156:159]
 ds_read_b128 a[16:19], v194 offset:28672
 v_sub_f32 v133, v133, v226
 v_mfma_f32_16x16x32_bf16 v[152:155], a[28:31], a[88:91], v[152:155]
 s_waitcnt lgkmcnt(4)
 v_exp_f32 v137, v137
 v_mfma_f32_16x16x32_bf16 v[144:147], a[0:3], a[96:99], v[144:147]
 ds_read_b128 a[20:23], v194 offset:29184
 v_sub_f32 v134, v134, v226
 v_mfma_f32_16x16x32_bf16 v[148:151], a[0:3], a[100:103], v[148:151]
 s_waitcnt lgkmcnt(4)
 v_exp_f32 v138, v138
 v_mfma_f32_16x16x32_bf16 v[156:159], a[4:7], a[100:103], v[156:159]
 ds_read_b128 a[24:27], v195 offset:28672
 v_cvt_pk_bf16_f32 v160, v128, v129
 v_mfma_f32_16x16x32_bf16 v[152:155], a[4:7], a[96:99], v[152:155]
 s_waitcnt lgkmcnt(4)
 v_exp_f32 v139, v139
 v_mfma_f32_16x16x32_bf16 v[144:147], a[8:11], a[104:107], v[144:147]
 ds_read_b128 a[28:31], v195 offset:29184
 buffer_load_dwordx4 v212, s[8:11], s34 offen offset:2048 nt lds
 v_mfma_f32_16x16x32_bf16 v[148:151], a[8:11], a[108:111], v[148:151]
 s_waitcnt lgkmcnt(4)
 v_exp_f32 v132, v132
 v_mfma_f32_16x16x32_bf16 v[156:159], a[12:15], a[108:111], v[156:159]
 ds_read_b64_tr_b16 a[0:1], v202 offset:32768
 ds_read_b64_tr_b16 a[2:3], v202 offset:33280
 v_mfma_f32_16x16x32_bf16 v[152:155], a[12:15], a[104:107], v[152:155]
 s_waitcnt lgkmcnt(5)
 v_exp_f32 v133, v133
 v_mfma_f32_16x16x32_bf16 v[144:147], a[16:19], a[112:115], v[144:147]
 ds_read_b64_tr_b16 a[4:5], v203 offset:32768
 ds_read_b64_tr_b16 a[6:7], v203 offset:33280
 v_mfma_f32_16x16x32_bf16 v[148:151], a[16:19], a[116:119], v[148:151]
 s_waitcnt lgkmcnt(6)
 v_exp_f32 v134, v134
 v_mfma_f32_16x16x32_bf16 v[156:159], a[20:23], a[116:119], v[156:159]
 ds_read_b64_tr_b16 a[8:9], v204 offset:32768
 ds_read_b64_tr_b16 a[10:11], v204 offset:33280
 v_mfma_f32_16x16x32_bf16 v[152:155], a[20:23], a[112:115], v[152:155]
 s_waitcnt lgkmcnt(7)
 buffer_load_dwordx4 v213, s[8:11], s34 offen offset:3072 nt lds
 v_sub_f32 v135, v135, v226
 v_mfma_f32_16x16x32_bf16 v[144:147], a[24:27], a[120:123], v[144:147]
 s_add_u32 m0, s33, 32768
 ds_read_b64_tr_b16 a[12:13], v205 offset:32768
 ds_read_b64_tr_b16 a[14:15], v205 offset:33280
 v_mfma_f32_16x16x32_bf16 v[148:151], a[24:27], a[124:127], v[148:151]
 s_waitcnt lgkmcnt(8)
 v_exp_f32 v135, v135
 v_mfma_f32_16x16x32_bf16 v[156:159], a[28:31], a[124:127], v[156:159]
 s_mov_b32 s34, 49152
 ds_read_b64_tr_b16 a[16:17], v202 offset:36864
 ds_read_b64_tr_b16 a[18:19], v202 offset:37376
 v_mfma_f32_16x16x32_bf16 v[152:155], a[28:31], a[120:123], v[152:155]
 s_waitcnt lgkmcnt(8)
 v_cvt_pk_bf16_f32 v161, v130, v131
 v_sub_f32 v140, v140, v226
 v_cvt_pk_bf16_f32 v162, v136, v137
 v_cvt_pk_bf16_f32 v163, v138, v139
 s_nop 1
 v_mfma_f32_16x16x32_bf16 v[0:3], a[0:3], v[160:163], 0
 ds_read_b64_tr_b16 a[20:21], v203 offset:36864
 ds_read_b64_tr_b16 a[22:23], v203 offset:37376
 v_sub_f32 v141, v141, v226
 v_cvt_pk_bf16_f32 v164, v132, v133
 v_sub_f32 v142, v142, v226
 v_cvt_pk_bf16_f32 v165, v134, v135
 v_sub_f32 v143, v143, v226
 v_exp_f32 v140, v140
 v_exp_f32 v141, v141
 v_exp_f32 v142, v142
 v_cvt_pk_bf16_f32 v166, v140, v141
 v_exp_f32 v143, v143
 s_nop 0
 v_cvt_pk_bf16_f32 v167, v142, v143
 s_nop 1
 v_mfma_f32_16x16x32_bf16 v[4:7], a[0:3], v[164:167], 0
 s_waitcnt vmcnt(12) lgkmcnt(8)
 v_max3_f32 v224, v144, v145, v146
 v_max3_f32 v224, v147, v148, v224
 v_mfma_f32_16x16x32_bf16 v[12:15], a[4:7], v[164:167], 0
 s_barrier
 ds_read_b64_tr_b16 a[24:25], v204 offset:36864
 ds_read_b64_tr_b16 a[26:27], v204 offset:37376
 v_mfma_f32_16x16x32_bf16 v[8:11], a[4:7], v[160:163], 0
 s_waitcnt lgkmcnt(8)
 buffer_load_dwordx4 v210, s[12:15], s34 offen nt lds
 v_max3_f32 v224, v149, v150, v224
 v_mfma_f32_16x16x32_bf16 v[16:19], a[8:11], v[160:163], 0
 ds_read_b64_tr_b16 a[28:29], v205 offset:36864
 ds_read_b64_tr_b16 a[30:31], v205 offset:37376
 v_mfma_f32_16x16x32_bf16 v[20:23], a[8:11], v[164:167], 0
 s_waitcnt lgkmcnt(8)
 v_max3_f32 v224, v151, v152, v224
 v_max3_f32 v224, v153, v154, v224
 v_mfma_f32_16x16x32_bf16 v[28:31], a[12:15], v[164:167], 0
 ds_read_b64_tr_b16 a[0:1], v202 offset:40960
 ds_read_b64_tr_b16 a[2:3], v202 offset:41472
 v_mfma_f32_16x16x32_bf16 v[24:27], a[12:15], v[160:163], 0
 s_waitcnt lgkmcnt(8)
 v_max3_f32 v224, v155, v156, v224
 v_max3_f32 v224, v157, v158, v224
 v_mfma_f32_16x16x32_bf16 v[32:35], a[16:19], v[160:163], 0
 ds_read_b64_tr_b16 a[4:5], v203 offset:40960
 ds_read_b64_tr_b16 a[6:7], v203 offset:41472
 v_mfma_f32_16x16x32_bf16 v[36:39], a[16:19], v[164:167], 0
 s_waitcnt lgkmcnt(8)
 v_max_f32 v224, v159, v224
 v_cmp_lt_f32 vcc, s35, v224
 v_mfma_f32_16x16x32_bf16 v[44:47], a[20:23], v[164:167], 0
 ds_read_b64_tr_b16 a[8:9], v204 offset:40960
 ds_read_b64_tr_b16 a[10:11], v204 offset:41472
 v_mfma_f32_16x16x32_bf16 v[40:43], a[20:23], v[160:163], 0
 s_waitcnt lgkmcnt(8)
 buffer_load_dwordx4 v211, s[12:15], s34 offen offset:1024 nt lds
 v_add_f32 v222, v128, v222
 v_mfma_f32_16x16x32_bf16 v[48:51], a[24:27], v[160:163], 0
 ds_read_b64_tr_b16 a[12:13], v205 offset:40960
 ds_read_b64_tr_b16 a[14:15], v205 offset:41472
 v_mfma_f32_16x16x32_bf16 v[52:55], a[24:27], v[164:167], 0
 s_waitcnt lgkmcnt(8)
 v_add_f32 v222, v129, v222
 v_add_f32 v222, v130, v222
 v_mfma_f32_16x16x32_bf16 v[60:63], a[28:31], v[164:167], 0
 ds_read_b64_tr_b16 a[16:17], v202 offset:45056
 ds_read_b64_tr_b16 a[18:19], v202 offset:45568
 v_mfma_f32_16x16x32_bf16 v[56:59], a[28:31], v[160:163], 0
 s_waitcnt lgkmcnt(8)
 v_add_f32 v222, v131, v222
 v_add_f32 v222, v136, v222
 v_mfma_f32_16x16x32_bf16 v[64:67], a[0:3], v[160:163], 0
 ds_read_b64_tr_b16 a[20:21], v203 offset:45056
 ds_read_b64_tr_b16 a[22:23], v203 offset:45568
 v_mfma_f32_16x16x32_bf16 v[68:71], a[0:3], v[164:167], 0
 s_waitcnt lgkmcnt(8)
 v_add_f32 v222, v137, v222
 v_add_f32 v222, v138, v222
 v_mfma_f32_16x16x32_bf16 v[76:79], a[4:7], v[164:167], 0
 ds_read_b64_tr_b16 a[24:25], v204 offset:45056
 ds_read_b64_tr_b16 a[26:27], v204 offset:45568
 v_mfma_f32_16x16x32_bf16 v[72:75], a[4:7], v[160:163], 0
 s_waitcnt lgkmcnt(8)
 buffer_load_dwordx4 v212, s[12:15], s34 offen offset:2048 nt lds
 v_add_f32 v222, v139, v222
 v_mfma_f32_16x16x32_bf16 v[80:83], a[8:11], v[160:163], 0
 ds_read_b64_tr_b16 a[28:29], v205 offset:45056
 ds_read_b64_tr_b16 a[30:31], v205 offset:45568
 v_mfma_f32_16x16x32_bf16 v[84:87], a[8:11], v[164:167], 0
 s_waitcnt lgkmcnt(8)
 v_add_f32 v223, v132, v223
 v_add_f32 v223, v133, v223
 v_mfma_f32_16x16x32_bf16 v[92:95], a[12:15], v[164:167], 0
 ds_read_b128 a[0:3], v194 offset:49152
 v_add_f32 v223, v134, v223
 v_mfma_f32_16x16x32_bf16 v[88:91], a[12:15], v[160:163], 0
 s_waitcnt lgkmcnt(7)
 v_add_f32 v223, v135, v223
 v_add_f32 v223, v140, v223
 v_mfma_f32_16x16x32_bf16 v[96:99], a[16:19], v[160:163], 0
 ds_read_b128 a[4:7], v194 offset:49664
 v_add_f32 v223, v141, v223
 v_mfma_f32_16x16x32_bf16 v[100:103], a[16:19], v[164:167], 0
 s_waitcnt lgkmcnt(6)
 v_add_f32 v223, v142, v223
 v_add_f32 v223, v143, v223
 v_mfma_f32_16x16x32_bf16 v[108:111], a[20:23], v[164:167], 0
 s_cbranch_vccnz L_stub0
L_ret0:
 ds_read_b128 a[8:11], v195 offset:49152
 buffer_load_dwordx4 v213, s[12:15], s34 offen offset:3072 nt lds
 v_mfma_f32_16x16x32_bf16 v[104:107], a[20:23], v[160:163], 0
 s_waitcnt lgkmcnt(5)
 v_exp_f32 v144, v144
 v_mfma_f32_16x16x32_bf16 v[112:115], a[24:27], v[160:163], 0
 s_add_u32 m0, s33, 49152
 ds_read_b128 a[12:15], v195 offset:49664
 v_add_f32 v222, v144, v222
 v_mfma_f32_16x16x32_bf16 v[116:119], a[24:27], v[164:167], 0
 s_waitcnt lgkmcnt(4)
 v_exp_f32 v145, v145
 v_mfma_f32_16x16x32_bf16 v[124:127], a[28:31], v[164:167], 0
 s_mov_b32 s34, 81920
 ds_read_b128 a[16:19], v194 offset:53248
 v_add_f32 v222, v145, v222
 v_mfma_f32_16x16x32_bf16 v[120:123], a[28:31], v[160:163], 0
 s_waitcnt lgkmcnt(4)
 v_exp_f32 v146, v146
 v_mfma_f32_16x16x32_bf16 v[128:131], a[0:3], a[64:67], v[168:171]
 s_add_u32 s92, s54, 24576
 s_addc_u32 s93, s55, 0
 ds_read_b128 a[20:23], v194 offset:53760
 global_load_dword v252, v245, s[92:93]
 v_mfma_f32_16x16x32_bf16 v[132:135], a[0:3], a[68:71], v[172:175]
 s_waitcnt lgkmcnt(4)
 buffer_load_dwordx4 v210, s[8:11], s34 offen nt lds
 v_cvt_pk_bf16_f32 v160, v144, v145
 v_mfma_f32_16x16x32_bf16 v[140:143], a[4:7], a[68:71], v[172:175]
 ds_read_b128 a[24:27], v195 offset:53248
 v_add_f32 v222, v146, v222
 v_mfma_f32_16x16x32_bf16 v[136:139], a[4:7], a[64:67], v[168:171]
 s_waitcnt lgkmcnt(4)
 v_exp_f32 v147, v147
 v_mfma_f32_16x16x32_bf16 v[128:131], a[8:11], a[72:75], v[128:131]
 ds_read_b128 a[28:31], v195 offset:53760
 v_cvt_pk_bf16_f32 v161, v146, v147
 v_mfma_f32_16x16x32_bf16 v[132:135], a[8:11], a[76:79], v[132:135]
 s_waitcnt lgkmcnt(4)
 v_exp_f32 v152, v152
 v_mfma_f32_16x16x32_bf16 v[140:143], a[12:15], a[76:79], v[140:143]
 ds_read_b128 a[0:3], v194 offset:57344
 v_add_f32 v222, v147, v222
 v_mfma_f32_16x16x32_bf16 v[136:139], a[12:15], a[72:75], v[136:139]
 s_waitcnt lgkmcnt(4)
 v_exp_f32 v153, v153
 v_mfma_f32_16x16x32_bf16 v[128:131], a[16:19], a[80:83], v[128:131]
 ds_read_b128 a[4:7], v194 offset:57856
 buffer_load_dwordx4 v211, s[8:11], s34 offen offset:1024 nt lds
 v_mfma_f32_16x16x32_bf16 v[132:135], a[16:19], a[84:87], v[132:135]
 s_waitcnt lgkmcnt(4)
 v_exp_f32 v154, v154
 v_mfma_f32_16x16x32_bf16 v[140:143], a[20:23], a[84:87], v[140:143]
 ds_read_b128 a[8:11], v195 offset:57344
 v_cvt_pk_bf16_f32 v162, v152, v153
 v_mfma_f32_16x16x32_bf16 v[136:139], a[20:23], a[80:83], v[136:139]
 s_waitcnt lgkmcnt(4)
 v_exp_f32 v155, v155
 v_mfma_f32_16x16x32_bf16 v[128:131], a[24:27], a[88:91], v[128:131]
 ds_read_b128 a[12:15], v195 offset:57856
 v_cvt_pk_bf16_f32 v163, v154, v155
 v_mfma_f32_16x16x32_bf16 v[132:135], a[24:27], a[92:95], v[132:135]
 s_waitcnt lgkmcnt(4)
 v_exp_f32 v148, v148
 v_mfma_f32_16x16x32_bf16 v[140:143], a[28:31], a[92:95], v[140:143]
 ds_read_b128 a[16:19], v194 offset:61440
 v_add_f32 v222, v152, v222
 v_mfma_f32_16x16x32_bf16 v[136:139], a[28:31], a[88:91], v[136:139]
 s_waitcnt lgkmcnt(4)
 buffer_load_dwordx4 v212, s[8:11], s34 offen offset:2048 nt lds
 v_add_f32 v222, v153, v222
 v_mfma_f32_16x16x32_bf16 v[128:131], a[0:3], a[96:99], v[128:131]
 ds_read_b128 a[20:23], v194 offset:61952
 v_add_f32 v222, v154, v222
 v_mfma_f32_16x16x32_bf16 v[132:135], a[0:3], a[100:103], v[132:135]
 s_waitcnt lgkmcnt(4)
 v_exp_f32 v149, v149
 v_mfma_f32_16x16x32_bf16 v[140:143], a[4:7], a[100:103], v[140:143]
 ds_read_b128 a[24:27], v195 offset:61440
 v_cvt_pk_bf16_f32 v164, v148, v149
 v_mfma_f32_16x16x32_bf16 v[136:139], a[4:7], a[96:99], v[136:139]
 s_waitcnt lgkmcnt(4)
 v_exp_f32 v150, v150
 v_mfma_f32_16x16x32_bf16 v[128:131], a[8:11], a[104:107], v[128:131]
 ds_read_b128 a[28:31], v195 offset:61952
 v_add_f32 v222, v155, v222
 v_mfma_f32_16x16x32_bf16 v[132:135], a[8:11], a[108:111], v[132:135]
 s_waitcnt lgkmcnt(4)
 v_exp_f32 v151, v151
 v_mfma_f32_16x16x32_bf16 v[140:143], a[12:15], a[108:111], v[140:143]
 ds_read_b64_tr_b16 a[0:1], v206 offset:0
 ds_read_b64_tr_b16 a[2:3], v206 offset:512
 v_mfma_f32_16x16x32_bf16 v[136:139], a[12:15], a[104:107], v[136:139]
 s_waitcnt lgkmcnt(5)
 buffer_load_dwordx4 v213, s[8:11], s34 offen offset:3072 nt lds
 v_cvt_pk_bf16_f32 v165, v150, v151
 v_mfma_f32_16x16x32_bf16 v[128:131], a[16:19], a[112:115], v[128:131]
 s_add_u32 m0, s33, 65536
 ds_read_b64_tr_b16 a[4:5], v207 offset:0
 ds_read_b64_tr_b16 a[6:7], v207 offset:512
 v_mfma_f32_16x16x32_bf16 v[132:135], a[16:19], a[116:119], v[132:135]
 s_waitcnt lgkmcnt(6)
 v_exp_f32 v156, v156
 v_mfma_f32_16x16x32_bf16 v[140:143], a[20:23], a[116:119], v[140:143]
 s_mov_b32 s34, 65536
 ds_read_b64_tr_b16 a[8:9], v208 offset:0
 ds_read_b64_tr_b16 a[10:11], v208 offset:512
 v_mfma_f32_16x16x32_bf16 v[136:139], a[20:23], a[112:115], v[136:139]
 s_waitcnt lgkmcnt(7)
 v_exp_f32 v157, v157
 v_mfma_f32_16x16x32_bf16 v[128:131], a[24:27], a[120:123], v[128:131]
 ds_read_b64_tr_b16 a[12:13], v209 offset:0
 ds_read_b64_tr_b16 a[14:15], v209 offset:512
 v_mfma_f32_16x16x32_bf16 v[132:135], a[24:27], a[124:127], v[132:135]
 s_waitcnt lgkmcnt(8)
 v_exp_f32 v158, v158
 v_mfma_f32_16x16x32_bf16 v[140:143], a[28:31], a[124:127], v[140:143]
 ds_read_b64_tr_b16 a[16:17], v206 offset:4096
 ds_read_b64_tr_b16 a[18:19], v206 offset:4608
 v_mfma_f32_16x16x32_bf16 v[136:139], a[28:31], a[120:123], v[136:139]
 s_waitcnt lgkmcnt(8)
 buffer_load_dwordx4 v210, s[12:15], s34 offen nt lds
 v_cvt_pk_bf16_f32 v166, v156, v157
 v_mfma_f32_16x16x32_bf16 v[0:3], a[0:3], v[160:163], v[0:3]
 ds_read_b64_tr_b16 a[20:21], v207 offset:4096
 ds_read_b64_tr_b16 a[22:23], v207 offset:4608
 v_exp_f32 v159, v159
 s_nop 0
 v_cvt_pk_bf16_f32 v167, v158, v159
 s_nop 1
 v_mfma_f32_16x16x32_bf16 v[4:7], a[0:3], v[164:167], v[4:7]
 s_waitcnt vmcnt(14) lgkmcnt(8)
 v_max3_f32 v224, v128, v129, v130
 v_max3_f32 v224, v131, v132, v224
 v_mfma_f32_16x16x32_bf16 v[12:15], a[4:7], v[164:167], v[12:15]
 s_barrier
 ds_read_b64_tr_b16 a[24:25], v208 offset:4096
 ds_read_b64_tr_b16 a[26:27], v208 offset:4608
 v_mfma_f32_16x16x32_bf16 v[8:11], a[4:7], v[160:163], v[8:11]
 s_waitcnt lgkmcnt(8)
 v_max3_f32 v224, v133, v134, v224
 v_max3_f32 v224, v135, v136, v224
 v_mfma_f32_16x16x32_bf16 v[16:19], a[8:11], v[160:163], v[16:19]
 ds_read_b64_tr_b16 a[28:29], v209 offset:4096
 ds_read_b64_tr_b16 a[30:31], v209 offset:4608
 v_mfma_f32_16x16x32_bf16 v[20:23], a[8:11], v[164:167], v[20:23]
 s_waitcnt lgkmcnt(8)
 v_max3_f32 v224, v137, v138, v224
 v_max3_f32 v224, v139, v140, v224
 v_mfma_f32_16x16x32_bf16 v[28:31], a[12:15], v[164:167], v[28:31]
 ds_read_b64_tr_b16 a[0:1], v206 offset:8192
 ds_read_b64_tr_b16 a[2:3], v206 offset:8704
 v_mfma_f32_16x16x32_bf16 v[24:27], a[12:15], v[160:163], v[24:27]
 s_waitcnt lgkmcnt(8)
 buffer_load_dwordx4 v211, s[12:15], s34 offen offset:1024 nt lds
 v_max3_f32 v224, v141, v142, v224
 v_mfma_f32_16x16x32_bf16 v[32:35], a[16:19], v[160:163], v[32:35]
 ds_read_b64_tr_b16 a[4:5], v207 offset:8192
 ds_read_b64_tr_b16 a[6:7], v207 offset:8704
 v_mfma_f32_16x16x32_bf16 v[36:39], a[16:19], v[164:167], v[36:39]
 s_waitcnt lgkmcnt(8)
 v_max_f32 v224, v143, v224
 v_cmp_lt_f32 vcc, s35, v224
 v_mfma_f32_16x16x32_bf16 v[44:47], a[20:23], v[164:167], v[44:47]
 ds_read_b64_tr_b16 a[8:9], v208 offset:8192
 ds_read_b64_tr_b16 a[10:11], v208 offset:8704
 v_mfma_f32_16x16x32_bf16 v[40:43], a[20:23], v[160:163], v[40:43]
 s_waitcnt lgkmcnt(8)
 v_add_f32 v223, v148, v223
 v_add_f32 v223, v149, v223
 v_mfma_f32_16x16x32_bf16 v[48:51], a[24:27], v[160:163], v[48:51]
 ds_read_b64_tr_b16 a[12:13], v209 offset:8192
 ds_read_b64_tr_b16 a[14:15], v209 offset:8704
 v_mfma_f32_16x16x32_bf16 v[52:55], a[24:27], v[164:167], v[52:55]
 s_waitcnt lgkmcnt(8)
 v_add_f32 v223, v150, v223
 v_add_f32 v223, v151, v223
 v_mfma_f32_16x16x32_bf16 v[60:63], a[28:31], v[164:167], v[60:63]
 ds_read_b64_tr_b16 a[16:17], v206 offset:12288
 ds_read_b64_tr_b16 a[18:19], v206 offset:12800
 v_mfma_f32_16x16x32_bf16 v[56:59], a[28:31], v[160:163], v[56:59]
 s_waitcnt lgkmcnt(8)
 buffer_load_dwordx4 v212, s[12:15], s34 offen offset:2048 nt lds
 v_add_f32 v223, v156, v223
 v_mfma_f32_16x16x32_bf16 v[64:67], a[0:3], v[160:163], v[64:67]
 ds_read_b64_tr_b16 a[20:21], v207 offset:12288
 ds_read_b64_tr_b16 a[22:23], v207 offset:12800
 v_mfma_f32_16x16x32_bf16 v[68:71], a[0:3], v[164:167], v[68:71]
 s_waitcnt lgkmcnt(8)
 v_add_f32 v223, v157, v223
 v_add_f32 v223, v158, v223
 v_mfma_f32_16x16x32_bf16 v[76:79], a[4:7], v[164:167], v[76:79]
 ds_read_b64_tr_b16 a[24:25], v208 offset:12288
 ds_read_b64_tr_b16 a[26:27], v208 offset:12800
 v_mfma_f32_16x16x32_bf16 v[72:75], a[4:7], v[160:163], v[72:75]
 s_waitcnt lgkmcnt(8)
 v_add_f32 v223, v159, v223
 v_mfma_f32_16x16x32_bf16 v[80:83], a[8:11], v[160:163], v[80:83]
 s_cbranch_vccnz L_stub1
L_ret1:
 ds_read_b64_tr_b16 a[28:29], v209 offset:12288
 ds_read_b64_tr_b16 a[30:31], v209 offset:12800
 v_mfma_f32_16x16x32_bf16 v[84:87], a[8:11], v[164:167], v[84:87]
 s_waitcnt lgkmcnt(8)
 v_exp_f32 v128, v128
 v_mfma_f32_16x16x32_bf16 v[92:95], a[12:15], v[164:167], v[92:95]
 ds_read_b128 a[0:3], v196 offset:16384
 buffer_load_dwordx4 v213, s[12:15], s34 offen offset:3072 nt lds
 v_mfma_f32_16x16x32_bf16 v[88:91], a[12:15], v[160:163], v[88:91]
 s_waitcnt lgkmcnt(7)
 v_exp_f32 v129, v129
 v_mfma_f32_16x16x32_bf16 v[96:99], a[16:19], v[160:163], v[96:99]
 s_add_u32 m0, s33, 81920
 ds_read_b128 a[4:7], v196 offset:16896
 v_add_f32 v222, v128, v222
 v_mfma_f32_16x16x32_bf16 v[100:103], a[16:19], v[164:167], v[100:103]
 s_waitcnt lgkmcnt(6)
 v_exp_f32 v130, v130
 v_mfma_f32_16x16x32_bf16 v[108:111], a[20:23], v[164:167], v[108:111]
 s_mov_b32 s34, 98304
 ds_read_b128 a[8:11], v197 offset:16384
 v_add_f32 v222, v129, v222
 v_mfma_f32_16x16x32_bf16 v[104:107], a[20:23], v[160:163], v[104:107]
 s_waitcnt lgkmcnt(5)
 v_exp_f32 v131, v131
 v_mfma_f32_16x16x32_bf16 v[112:115], a[24:27], v[160:163], v[112:115]
 ds_read_b128 a[12:15], v197 offset:16896
 v_add_f32 v222, v130, v222
 v_mfma_f32_16x16x32_bf16 v[116:119], a[24:27], v[164:167], v[116:119]
 s_waitcnt lgkmcnt(4)
 buffer_load_dwordx4 v210, s[8:11], s34 offen nt lds
 v_add_f32 v222, v131, v222
 v_mfma_f32_16x16x32_bf16 v[124:127], a[28:31], v[164:167], v[124:127]
 ds_read_b128 a[16:19], v196 offset:20480
 v_mfma_f32_16x16x32_bf16 v[120:123], a[28:31], v[160:163], v[120:123]
 s_waitcnt lgkmcnt(4)
 v_exp_f32 v136, v136
 v_mfma_f32_16x16x32_bf16 v[144:147], a[0:3], a[64:67], v[168:171]
 ds_read_b128 a[20:23], v196 offset:20992
 v_cvt_pk_bf16_f32 v160, v128, v129
 v_mfma_f32_16x16x32_bf16 v[148:151], a[0:3], a[68:71], v[172:175]
 s_waitcnt lgkmcnt(4)
 v_exp_f32 v137, v137
 v_mfma_f32_16x16x32_bf16 v[156:159], a[4:7], a[68:71], v[172:175]
 ds_read_b128 a[24:27], v197 offset:20480
 v_cvt_pk_bf16_f32 v161, v130, v131
 v_mfma_f32_16x16x32_bf16 v[152:155], a[4:7], a[64:67], v[168:171]
 s_waitcnt lgkmcnt(4)
 v_exp_f32 v138, v138
 v_mfma_f32_16x16x32_bf16 v[144:147], a[8:11], a[72:75], v[144:147]
 ds_read_b128 a[28:31], v197 offset:20992
 buffer_load_dwordx4 v211, s[8:11], s34 offen offset:1024 nt lds
 v_mfma_f32_16x16x32_bf16 v[148:151], a[8:11], a[76:79], v[148:151]
 s_waitcnt lgkmcnt(4)
 v_exp_f32 v139, v139
 v_mfma_f32_16x16x32_bf16 v[156:159], a[12:15], a[76:79], v[156:159]
 ds_read_b128 a[0:3], v196 offset:24576
 v_cvt_pk_bf16_f32 v162, v136, v137
 v_mfma_f32_16x16x32_bf16 v[152:155], a[12:15], a[72:75], v[152:155]
 s_waitcnt lgkmcnt(4)
 v_exp_f32 v132, v132
 v_mfma_f32_16x16x32_bf16 v[144:147], a[16:19], a[80:83], v[144:147]
 ds_read_b128 a[4:7], v196 offset:25088
 v_cvt_pk_bf16_f32 v163, v138, v139
 v_mfma_f32_16x16x32_bf16 v[148:151], a[16:19], a[84:87], v[148:151]
 s_waitcnt lgkmcnt(4)
 v_exp_f32 v133, v133
 v_mfma_f32_16x16x32_bf16 v[156:159], a[20:23], a[84:87], v[156:159]
 ds_read_b128 a[8:11], v197 offset:24576
 v_cvt_pk_bf16_f32 v164, v132, v133
 v_mfma_f32_16x16x32_bf16 v[152:155], a[20:23], a[80:83], v[152:155]
 s_waitcnt lgkmcnt(4)
 buffer_load_dwordx4 v212, s[8:11], s34 offen offset:2048 nt lds
 v_add_f32 v222, v136, v222
 v_mfma_f32_16x16x32_bf16 v[144:147], a[24:27], a[88:91], v[144:147]
 ds_read_b128 a[12:15], v197 offset:25088
 v_add_f32 v222, v137, v222
 v_mfma_f32_16x16x32_bf16 v[148:151], a[24:27], a[92:95], v[148:151]
 s_waitcnt lgkmcnt(4)
 v_exp_f32 v134, v134
 v_mfma_f32_16x16x32_bf16 v[156:159], a[28:31], a[92:95], v[156:159]
 ds_read_b128 a[16:19], v196 offset:28672
 v_add_f32 v222, v138, v222
 v_mfma_f32_16x16x32_bf16 v[152:155], a[28:31], a[88:91], v[152:155]
 s_waitcnt lgkmcnt(4)
 v_exp_f32 v135, v135
 v_mfma_f32_16x16x32_bf16 v[144:147], a[0:3], a[96:99], v[144:147]
 ds_read_b128 a[20:23], v196 offset:29184
 v_cvt_pk_bf16_f32 v165, v134, v135
 v_mfma_f32_16x16x32_bf16 v[148:151], a[0:3], a[100:103], v[148:151]
 s_waitcnt lgkmcnt(4)
 v_exp_f32 v140, v140
 v_mfma_f32_16x16x32_bf16 v[156:159], a[4:7], a[100:103], v[156:159]
 ds_read_b128 a[24:27], v197 offset:28672
 buffer_load_dwordx4 v213, s[8:11], s34 offen offset:3072 nt lds
 v_mfma_f32_16x16x32_bf16 v[152:155], a[4:7], a[96:99], v[152:155]
 s_waitcnt lgkmcnt(4)
 v_exp_f32 v141, v141
 v_mfma_f32_16x16x32_bf16 v[144:147], a[8:11], a[104:107], v[144:147]
 s_add_u32 m0, s33, 98304
 ds_read_b128 a[28:31], v197 offset:29184
 v_cvt_pk_bf16_f32 v166, v140, v141
 v_mfma_f32_16x16x32_bf16 v[148:151], a[8:11], a[108:111], v[148:151]
 s_waitcnt lgkmcnt(4)
 v_exp_f32 v142, v142
 v_mfma_f32_16x16x32_bf16 v[156:159], a[12:15], a[108:111], v[156:159]
 s_mov_b32 s34, 81920
 ds_read_b64_tr_b16 a[0:1], v198 offset:0
 ds_read_b64_tr_b16 a[2:3], v198 offset:512
 v_mfma_f32_16x16x32_bf16 v[152:155], a[12:15], a[104:107], v[152:155]
 s_waitcnt lgkmcnt(5)
 v_exp_f32 v143, v143
 v_mfma_f32_16x16x32_bf16 v[144:147], a[16:19], a[112:115], v[144:147]
 ds_read_b64_tr_b16 a[4:5], v199 offset:0
 ds_read_b64_tr_b16 a[6:7], v199 offset:512
 v_mfma_f32_16x16x32_bf16 v[148:151], a[16:19], a[116:119], v[148:151]
 s_waitcnt lgkmcnt(6)
 buffer_load_dwordx4 v210, s[12:15], s34 offen nt lds
 v_cvt_pk_bf16_f32 v167, v142, v143
 v_mfma_f32_16x16x32_bf16 v[156:159], a[20:23], a[116:119], v[156:159]
 ds_read_b64_tr_b16 a[8:9], v200 offset:0
 ds_read_b64_tr_b16 a[10:11], v200 offset:512
 v_mfma_f32_16x16x32_bf16 v[152:155], a[20:23], a[112:115], v[152:155]
 s_waitcnt lgkmcnt(7)
 v_add_f32 v222, v139, v222
 v_add_f32 v223, v132, v223
 v_mfma_f32_16x16x32_bf16 v[144:147], a[24:27], a[120:123], v[144:147]
 ds_read_b64_tr_b16 a[12:13], v201 offset:0
 ds_read_b64_tr_b16 a[14:15], v201 offset:512
 v_mfma_f32_16x16x32_bf16 v[148:151], a[24:27], a[124:127], v[148:151]
 s_waitcnt lgkmcnt(8)
 v_add_f32 v223, v133, v223
 v_add_f32 v223, v134, v223
 v_mfma_f32_16x16x32_bf16 v[156:159], a[28:31], a[124:127], v[156:159]
 ds_read_b64_tr_b16 a[16:17], v198 offset:4096
 ds_read_b64_tr_b16 a[18:19], v198 offset:4608
 v_mfma_f32_16x16x32_bf16 v[152:155], a[28:31], a[120:123], v[152:155]
 s_waitcnt lgkmcnt(8)
 v_add_f32 v223, v135, v223
 v_add_f32 v223, v140, v223
 v_mfma_f32_16x16x32_bf16 v[0:3], a[0:3], v[160:163], v[0:3]
 ds_read_b64_tr_b16 a[20:21], v199 offset:4096
 ds_read_b64_tr_b16 a[22:23], v199 offset:4608
 v_mfma_f32_16x16x32_bf16 v[4:7], a[0:3], v[164:167], v[4:7]
 s_waitcnt vmcnt(14) lgkmcnt(8)
 buffer_load_dwordx4 v211, s[12:15], s34 offen offset:1024 nt lds
 v_max3_f32 v224, v144, v145, v146
 v_mfma_f32_16x16x32_bf16 v[12:15], a[4:7], v[164:167], v[12:15]
 s_barrier
 ds_read_b64_tr_b16 a[24:25], v200 offset:4096
 ds_read_b64_tr_b16 a[26:27], v200 offset:4608
 v_mfma_f32_16x16x32_bf16 v[8:11], a[4:7], v[160:163], v[8:11]
 s_waitcnt lgkmcnt(8)
 v_max3_f32 v224, v147, v148, v224
 v_max3_f32 v224, v149, v150, v224
 v_mfma_f32_16x16x32_bf16 v[16:19], a[8:11], v[160:163], v[16:19]
 ds_read_b64_tr_b16 a[28:29], v201 offset:4096
 ds_read_b64_tr_b16 a[30:31], v201 offset:4608
 v_mfma_f32_16x16x32_bf16 v[20:23], a[8:11], v[164:167], v[20:23]
 s_waitcnt lgkmcnt(8)
 v_max3_f32 v224, v151, v152, v224
 v_max3_f32 v224, v153, v154, v224
 v_mfma_f32_16x16x32_bf16 v[28:31], a[12:15], v[164:167], v[28:31]
 ds_read_b64_tr_b16 a[0:1], v198 offset:8192
 ds_read_b64_tr_b16 a[2:3], v198 offset:8704
 v_mfma_f32_16x16x32_bf16 v[24:27], a[12:15], v[160:163], v[24:27]
 s_waitcnt lgkmcnt(8)
 v_max3_f32 v224, v155, v156, v224
 v_max3_f32 v224, v157, v158, v224
 v_mfma_f32_16x16x32_bf16 v[32:35], a[16:19], v[160:163], v[32:35]
 ds_read_b64_tr_b16 a[4:5], v199 offset:8192
 ds_read_b64_tr_b16 a[6:7], v199 offset:8704
 v_mfma_f32_16x16x32_bf16 v[36:39], a[16:19], v[164:167], v[36:39]
 s_waitcnt lgkmcnt(8)
 buffer_load_dwordx4 v212, s[12:15], s34 offen offset:2048 nt lds
 buffer_store_byte v236, v238, s[48:51], s100 offen sc1
 v_mfma_f32_16x16x32_bf16 v[44:47], a[20:23], v[164:167], v[44:47]
 ds_read_b64_tr_b16 a[8:9], v200 offset:8192
 ds_read_b64_tr_b16 a[10:11], v200 offset:8704
 v_mfma_f32_16x16x32_bf16 v[40:43], a[20:23], v[160:163], v[40:43]
 s_waitcnt lgkmcnt(8)
 v_max_f32 v224, v159, v224
 v_cmp_lt_f32 vcc, s35, v224
 v_mfma_f32_16x16x32_bf16 v[48:51], a[24:27], v[160:163], v[48:51]
 ds_read_b64_tr_b16 a[12:13], v201 offset:8192
 ds_read_b64_tr_b16 a[14:15], v201 offset:8704
 v_mfma_f32_16x16x32_bf16 v[52:55], a[24:27], v[164:167], v[52:55]
 s_waitcnt lgkmcnt(8)
 v_add_f32 v223, v141, v223
 v_add_f32 v223, v142, v223
 v_mfma_f32_16x16x32_bf16 v[60:63], a[28:31], v[164:167], v[60:63]
 ds_read_b64_tr_b16 a[16:17], v198 offset:12288
 ds_read_b64_tr_b16 a[18:19], v198 offset:12800
 v_mfma_f32_16x16x32_bf16 v[56:59], a[28:31], v[160:163], v[56:59]
 s_waitcnt lgkmcnt(8)
 v_add_f32 v223, v143, v223
 v_mfma_f32_16x16x32_bf16 v[64:67], a[0:3], v[160:163], v[64:67]
 s_cbranch_vccnz L_stub2
L_ret2:
 ds_read_b64_tr_b16 a[20:21], v199 offset:12288
 ds_read_b64_tr_b16 a[22:23], v199 offset:12800
 v_mfma_f32_16x16x32_bf16 v[68:71], a[0:3], v[164:167], v[68:71]
 s_waitcnt lgkmcnt(8)
 buffer_load_dwordx4 v213, s[12:15], s34 offen offset:3072 nt lds
 v_mfma_f32_16x16x32_bf16 v[76:79], a[4:7], v[164:167], v[76:79]
 s_add_u32 m0, s33, 114688
 ds_read_b64_tr_b16 a[24:25], v200 offset:12288
 ds_read_b64_tr_b16 a[26:27], v200 offset:12800
 v_mfma_f32_16x16x32_bf16 v[72:75], a[4:7], v[160:163], v[72:75]
 s_waitcnt lgkmcnt(8)
 v_exp_f32 v144, v144
 v_mfma_f32_16x16x32_bf16 v[80:83], a[8:11], v[160:163], v[80:83]
 s_mov_b32 s34, 114688
 ds_read_b64_tr_b16 a[28:29], v201 offset:12288
 ds_read_b64_tr_b16 a[30:31], v201 offset:12800
 v_mfma_f32_16x16x32_bf16 v[84:87], a[8:11], v[164:167], v[84:87]
 s_waitcnt lgkmcnt(8)
 v_exp_f32 v145, v145
 v_mfma_f32_16x16x32_bf16 v[92:95], a[12:15], v[164:167], v[92:95]
 ds_read_b128 a[0:3], v192 offset:16384
 v_add_f32 v222, v144, v222
 v_mfma_f32_16x16x32_bf16 v[88:91], a[12:15], v[160:163], v[88:91]
 s_waitcnt lgkmcnt(7)
 v_exp_f32 v146, v146
 v_mfma_f32_16x16x32_bf16 v[96:99], a[16:19], v[160:163], v[96:99]
 ds_read_b128 a[4:7], v192 offset:16896
 buffer_load_dwordx4 v210, s[8:11], s34 offen nt lds
 v_mfma_f32_16x16x32_bf16 v[100:103], a[16:19], v[164:167], v[100:103]
 s_waitcnt lgkmcnt(6)
 v_exp_f32 v147, v147
 v_mfma_f32_16x16x32_bf16 v[108:111], a[20:23], v[164:167], v[108:111]
 ds_read_b128 a[8:11], v193 offset:16384
 v_add_f32 v222, v145, v222
 v_mfma_f32_16x16x32_bf16 v[104:107], a[20:23], v[160:163], v[104:107]
 s_waitcnt lgkmcnt(5)
 v_exp_f32 v152, v152
 v_mfma_f32_16x16x32_bf16 v[112:115], a[24:27], v[160:163], v[112:115]
 ds_read_b128 a[12:15], v193 offset:16896
 v_add_f32 v222, v146, v222
 v_mfma_f32_16x16x32_bf16 v[116:119], a[24:27], v[164:167], v[116:119]
 s_waitcnt lgkmcnt(4)
 v_exp_f32 v153, v153
 v_mfma_f32_16x16x32_bf16 v[124:127], a[28:31], v[164:167], v[124:127]
 ds_read_b128 a[16:19], v192 offset:20480
 v_add_f32 v222, v147, v222
 v_mfma_f32_16x16x32_bf16 v[120:123], a[28:31], v[160:163], v[120:123]
 s_waitcnt lgkmcnt(4)
 buffer_load_dwordx4 v211, s[8:11], s34 offen offset:1024 nt lds
 v_add_f32 v222, v152, v222
 v_mfma_f32_16x16x32_bf16 v[128:131], a[0:3], a[64:67], v[168:171]
 ds_read_b128 a[20:23], v192 offset:20992
 v_cvt_pk_bf16_f32 v160, v144, v145
 v_mfma_f32_16x16x32_bf16 v[132:135], a[0:3], a[68:71], v[172:175]
 s_waitcnt lgkmcnt(4)
 v_exp_f32 v154, v154
 v_mfma_f32_16x16x32_bf16 v[140:143], a[4:7], a[68:71], v[172:175]
 ds_read_b128 a[24:27], v193 offset:20480
 v_cvt_pk_bf16_f32 v161, v146, v147
 v_mfma_f32_16x16x32_bf16 v[136:139], a[4:7], a[64:67], v[168:171]
 s_waitcnt lgkmcnt(4)
 v_exp_f32 v155, v155
 v_mfma_f32_16x16x32_bf16 v[128:131], a[8:11], a[72:75], v[128:131]
 ds_read_b128 a[28:31], v193 offset:20992
 v_cvt_pk_bf16_f32 v162, v152, v153
 v_mfma_f32_16x16x32_bf16 v[132:135], a[8:11], a[76:79], v[132:135]
 s_waitcnt lgkmcnt(4)
 v_exp_f32 v148, v148
 v_mfma_f32_16x16x32_bf16 v[140:143], a[12:15], a[76:79], v[140:143]
 ds_read_b128 a[0:3], v192 offset:24576
 buffer_load_dwordx4 v212, s[8:11], s34 offen offset:2048 nt lds
 v_mfma_f32_16x16x32_bf16 v[136:139], a[12:15], a[72:75], v[136:139]
 s_waitcnt lgkmcnt(4)
 v_exp_f32 v149, v149
 v_mfma_f32_16x16x32_bf16 v[128:131], a[16:19], a[80:83], v[128:131]
 ds_read_b128 a[4:7], v192 offset:25088
 v_cvt_pk_bf16_f32 v163, v154, v155
 v_mfma_f32_16x16x32_bf16 v[132:135], a[16:19], a[84:87], v[132:135]
 s_waitcnt lgkmcnt(4)
 v_exp_f32 v150, v150
 v_mfma_f32_16x16x32_bf16 v[140:143], a[20:23], a[84:87], v[140:143]
 ds_read_b128 a[8:11], v193 offset:24576
 v_cvt_pk_bf16_f32 v164, v148, v149
 v_mfma_f32_16x16x32_bf16 v[136:139], a[20:23], a[80:83], v[136:139]
 s_waitcnt lgkmcnt(4)
 v_exp_f32 v151, v151
 v_mfma_f32_16x16x32_bf16 v[128:131], a[24:27], a[88:91], v[128:131]
 ds_read_b128 a[12:15], v193 offset:25088
 v_cvt_pk_bf16_f32 v165, v150, v151
 v_mfma_f32_16x16x32_bf16 v[132:135], a[24:27], a[92:95], v[132:135]
 s_waitcnt lgkmcnt(4)
 buffer_load_dwordx4 v213, s[8:11], s34 offen offset:3072 nt lds
 v_add_f32 v222, v153, v222
 v_mfma_f32_16x16x32_bf16 v[140:143], a[28:31], a[92:95], v[140:143]
 s_add_u32 m0, s33, 131072
 ds_read_b128 a[16:19], v192 offset:28672
 v_add_f32 v222, v154, v222
 v_mfma_f32_16x16x32_bf16 v[136:139], a[28:31], a[88:91], v[136:139]
 s_waitcnt lgkmcnt(4)
 v_exp_f32 v156, v156
 v_mfma_f32_16x16x32_bf16 v[128:131], a[0:3], a[96:99], v[128:131]
 s_mov_b32 s34, 98304
 ds_read_b128 a[20:23], v192 offset:29184
 v_add_f32 v222, v155, v222
 v_mfma_f32_16x16x32_bf16 v[132:135], a[0:3], a[100:103], v[132:135]
 s_waitcnt lgkmcnt(4)
 v_exp_f32 v157, v157
 v_mfma_f32_16x16x32_bf16 v[140:143], a[4:7], a[100:103], v[140:143]
 ds_read_b128 a[24:27], v193 offset:28672
 v_cvt_pk_bf16_f32 v166, v156, v157
 v_mfma_f32_16x16x32_bf16 v[136:139], a[4:7], a[96:99], v[136:139]
 s_waitcnt lgkmcnt(4)
 v_exp_f32 v158, v158
 v_mfma_f32_16x16x32_bf16 v[128:131], a[8:11], a[104:107], v[128:131]
 ds_read_b128 a[28:31], v193 offset:29184
 buffer_load_dwordx4 v210, s[12:15], s34 offen nt lds
 v_mfma_f32_16x16x32_bf16 v[132:135], a[8:11], a[108:111], v[132:135]
 s_waitcnt lgkmcnt(4)
 v_exp_f32 v159, v159
 v_mfma_f32_16x16x32_bf16 v[140:143], a[12:15], a[108:111], v[140:143]
 ds_read_b64_tr_b16 a[0:1], v198 offset:32768
 ds_read_b64_tr_b16 a[2:3], v198 offset:33280
 v_mfma_f32_16x16x32_bf16 v[136:139], a[12:15], a[104:107], v[136:139]
 s_waitcnt lgkmcnt(5)
 v_cvt_pk_bf16_f32 v167, v158, v159
 v_add_f32 v223, v148, v223
 v_mfma_f32_16x16x32_bf16 v[128:131], a[16:19], a[112:115], v[128:131]
 ds_read_b64_tr_b16 a[4:5], v199 offset:32768
 ds_read_b64_tr_b16 a[6:7], v199 offset:33280
 v_mfma_f32_16x16x32_bf16 v[132:135], a[16:19], a[116:119], v[132:135]
 s_waitcnt lgkmcnt(6)
 v_add_f32 v223, v149, v223
 v_add_f32 v223, v150, v223
 v_mfma_f32_16x16x32_bf16 v[140:143], a[20:23], a[116:119], v[140:143]
 ds_read_b64_tr_b16 a[8:9], v200 offset:32768
 ds_read_b64_tr_b16 a[10:11], v200 offset:33280
 v_mfma_f32_16x16x32_bf16 v[136:139], a[20:23], a[112:115], v[136:139]
 s_waitcnt lgkmcnt(7)
 buffer_load_dwordx4 v211, s[12:15], s34 offen offset:1024 nt lds
 v_add_f32 v223, v151, v223
 v_mfma_f32_16x16x32_bf16 v[128:131], a[24:27], a[120:123], v[128:131]
 ds_read_b64_tr_b16 a[12:13], v201 offset:32768
 ds_read_b64_tr_b16 a[14:15], v201 offset:33280
 v_mfma_f32_16x16x32_bf16 v[132:135], a[24:27], a[124:127], v[132:135]
 s_waitcnt lgkmcnt(8)
 v_add_f32 v223, v156, v223
 v_add_f32 v223, v157, v223
 v_mfma_f32_16x16x32_bf16 v[140:143], a[28:31], a[124:127], v[140:143]
 ds_read_b64_tr_b16 a[16:17], v198 offset:36864
 ds_read_b64_tr_b16 a[18:19], v198 offset:37376
 v_mfma_f32_16x16x32_bf16 v[136:139], a[28:31], a[120:123], v[136:139]
 s_waitcnt lgkmcnt(8)
 v_add_f32 v223, v158, v223
 v_add_f32 v223, v159, v223
 v_mfma_f32_16x16x32_bf16 v[0:3], a[0:3], v[160:163], v[0:3]
 s_add_u32 s92, s54, 28672
 s_addc_u32 s93, s55, 0
 ds_read_b64_tr_b16 a[20:21], v199 offset:36864
 ds_read_b64_tr_b16 a[22:23], v199 offset:37376
 v_mfma_f32_16x16x32_bf16 v[4:7], a[0:3], v[164:167], v[4:7]
 s_waitcnt vmcnt(15) lgkmcnt(8)
 global_load_dword v252, v245, s[92:93]
 v_max3_f32 v224, v128, v129, v130
 v_mfma_f32_16x16x32_bf16 v[12:15], a[4:7], v[164:167], v[12:15]
 s_barrier
 ds_read_b64_tr_b16 a[24:25], v200 offset:36864
 ds_read_b64_tr_b16 a[26:27], v200 offset:37376
 v_mfma_f32_16x16x32_bf16 v[8:11], a[4:7], v[160:163], v[8:11]
 s_waitcnt lgkmcnt(8)
 buffer_load_dwordx4 v212, s[12:15], s34 offen offset:2048 nt lds
 v_max3_f32 v224, v131, v132, v224
 v_mfma_f32_16x16x32_bf16 v[16:19], a[8:11], v[160:163], v[16:19]
 ds_read_b64_tr_b16 a[28:29], v201 offset:36864
 ds_read_b64_tr_b16 a[30:31], v201 offset:37376
 v_mfma_f32_16x16x32_bf16 v[20:23], a[8:11], v[164:167], v[20:23]
 s_waitcnt lgkmcnt(8)
 v_max3_f32 v224, v133, v134, v224
 v_max3_f32 v224, v135, v136, v224
 v_mfma_f32_16x16x32_bf16 v[28:31], a[12:15], v[164:167], v[28:31]
 ds_read_b64_tr_b16 a[0:1], v198 offset:40960
 ds_read_b64_tr_b16 a[2:3], v198 offset:41472
 v_mfma_f32_16x16x32_bf16 v[24:27], a[12:15], v[160:163], v[24:27]
 s_waitcnt lgkmcnt(8)
 v_max3_f32 v224, v137, v138, v224
 v_max3_f32 v224, v139, v140, v224
 v_mfma_f32_16x16x32_bf16 v[32:35], a[16:19], v[160:163], v[32:35]
 ds_read_b64_tr_b16 a[4:5], v199 offset:40960
 ds_read_b64_tr_b16 a[6:7], v199 offset:41472
 v_mfma_f32_16x16x32_bf16 v[36:39], a[16:19], v[164:167], v[36:39]
 s_waitcnt lgkmcnt(8)
 buffer_store_byte v236, v238, s[48:51], s101 offen sc1
 v_max3_f32 v224, v141, v142, v224
 v_mfma_f32_16x16x32_bf16 v[44:47], a[20:23], v[164:167], v[44:47]
 ds_read_b64_tr_b16 a[8:9], v200 offset:40960
 ds_read_b64_tr_b16 a[10:11], v200 offset:41472
 v_mfma_f32_16x16x32_bf16 v[40:43], a[20:23], v[160:163], v[40:43]
 s_waitcnt lgkmcnt(8)
 buffer_load_dwordx4 v213, s[12:15], s34 offen offset:3072 nt lds
 v_max_f32 v224, v143, v224
 v_mfma_f32_16x16x32_bf16 v[48:51], a[24:27], v[160:163], v[48:51]
 s_add_u32 m0, s33, 147456
 ds_read_b64_tr_b16 a[12:13], v201 offset:40960
 ds_read_b64_tr_b16 a[14:15], v201 offset:41472
 v_mfma_f32_16x16x32_bf16 v[52:55], a[24:27], v[164:167], v[52:55]
 s_waitcnt lgkmcnt(8)
 v_cmp_lt_f32 vcc, s35, v224
 v_mfma_f32_16x16x32_bf16 v[60:63], a[28:31], v[164:167], v[60:63]
 s_cbranch_vccnz L_stub3
L_ret3:
 ds_read_b64_tr_b16 a[16:17], v198 offset:45056
 ds_read_b64_tr_b16 a[18:19], v198 offset:45568
 v_mfma_f32_16x16x32_bf16 v[56:59], a[28:31], v[160:163], v[56:59]
 s_waitcnt lgkmcnt(8)
 v_exp_f32 v128, v128
 v_mfma_f32_16x16x32_bf16 v[64:67], a[0:3], v[160:163], v[64:67]
 s_mov_b32 s34, 131072
 ds_read_b64_tr_b16 a[20:21], v199 offset:45056
 ds_read_b64_tr_b16 a[22:23], v199 offset:45568
 v_mfma_f32_16x16x32_bf16 v[68:71], a[0:3], v[164:167], v[68:71]
 s_waitcnt lgkmcnt(8)
 v_exp_f32 v129, v129
 v_mfma_f32_16x16x32_bf16 v[76:79], a[4:7], v[164:167], v[76:79]
 ds_read_b64_tr_b16 a[24:25], v200 offset:45056
 ds_read_b64_tr_b16 a[26:27], v200 offset:45568
 v_mfma_f32_16x16x32_bf16 v[72:75], a[4:7], v[160:163], v[72:75]
 s_waitcnt lgkmcnt(8)
 buffer_load_dwordx4 v210, s[8:11], s34 offen nt lds
 v_add_f32 v222, v128, v222
 v_mfma_f32_16x16x32_bf16 v[80:83], a[8:11], v[160:163], v[80:83]
 ds_read_b64_tr_b16 a[28:29], v201 offset:45056
 ds_read_b64_tr_b16 a[30:31], v201 offset:45568
 v_mfma_f32_16x16x32_bf16 v[84:87], a[8:11], v[164:167], v[84:87]
 s_waitcnt lgkmcnt(8)
 v_exp_f32 v130, v130
 v_mfma_f32_16x16x32_bf16 v[92:95], a[12:15], v[164:167], v[92:95]
 ds_read_b128 a[0:3], v192 offset:49152
 v_add_f32 v222, v129, v222
 v_mfma_f32_16x16x32_bf16 v[88:91], a[12:15], v[160:163], v[88:91]
 s_waitcnt lgkmcnt(7)
 v_exp_f32 v131, v131
 v_mfma_f32_16x16x32_bf16 v[96:99], a[16:19], v[160:163], v[96:99]
 ds_read_b128 a[4:7], v192 offset:49664
 v_add_f32 v222, v130, v222
 v_mfma_f32_16x16x32_bf16 v[100:103], a[16:19], v[164:167], v[100:103]
 s_waitcnt lgkmcnt(6)
 v_exp_f32 v136, v136
 v_mfma_f32_16x16x32_bf16 v[108:111], a[20:23], v[164:167], v[108:111]
 ds_read_b128 a[8:11], v193 offset:49152
 buffer_load_dwordx4 v211, s[8:11], s34 offen offset:1024 nt lds
 v_mfma_f32_16x16x32_bf16 v[104:107], a[20:23], v[160:163], v[104:107]
 s_waitcnt lgkmcnt(5)
 v_exp_f32 v137, v137
 v_mfma_f32_16x16x32_bf16 v[112:115], a[24:27], v[160:163], v[112:115]
 ds_read_b128 a[12:15], v193 offset:49664
 v_add_f32 v222, v131, v222
 v_mfma_f32_16x16x32_bf16 v[116:119], a[24:27], v[164:167], v[116:119]
 s_waitcnt lgkmcnt(4)
 v_exp_f32 v138, v138
 v_mfma_f32_16x16x32_bf16 v[124:127], a[28:31], v[164:167], v[124:127]
 ds_read_b128 a[16:19], v192 offset:53248
 v_add_f32 v222, v136, v222
 v_mfma_f32_16x16x32_bf16 v[120:123], a[28:31], v[160:163], v[120:123]
 s_waitcnt lgkmcnt(4)
 v_exp_f32 v139, v139
 v_mfma_f32_16x16x32_bf16 v[144:147], a[0:3], a[64:67], v[168:171]
 ds_read_b128 a[20:23], v192 offset:53760
 v_cvt_pk_bf16_f32 v160, v128, v129
 v_mfma_f32_16x16x32_bf16 v[148:151], a[0:3], a[68:71], v[172:175]
 s_waitcnt lgkmcnt(4)
 buffer_load_dwordx4 v212, s[8:11], s34 offen offset:2048 nt lds
 v_cvt_pk_bf16_f32 v161, v130, v131
 v_mfma_f32_16x16x32_bf16 v[156:159], a[4:7], a[68:71], v[172:175]
 ds_read_b128 a[24:27], v193 offset:53248
 v_cvt_pk_bf16_f32 v162, v136, v137
 v_mfma_f32_16x16x32_bf16 v[152:155], a[4:7], a[64:67], v[168:171]
 s_waitcnt lgkmcnt(4)
 v_exp_f32 v132, v132
 v_mfma_f32_16x16x32_bf16 v[144:147], a[8:11], a[72:75], v[144:147]
 ds_read_b128 a[28:31], v193 offset:53760
 v_cvt_pk_bf16_f32 v163, v138, v139
 v_mfma_f32_16x16x32_bf16 v[148:151], a[8:11], a[76:79], v[148:151]
 s_waitcnt lgkmcnt(4)
 v_exp_f32 v133, v133
 v_mfma_f32_16x16x32_bf16 v[156:159], a[12:15], a[76:79], v[156:159]
 ds_read_b128 a[0:3], v192 offset:57344
 v_cvt_pk_bf16_f32 v164, v132, v133
 v_mfma_f32_16x16x32_bf16 v[152:155], a[12:15], a[72:75], v[152:155]
 s_waitcnt lgkmcnt(4)
 v_exp_f32 v134, v134
 v_mfma_f32_16x16x32_bf16 v[144:147], a[16:19], a[80:83], v[144:147]
 ds_read_b128 a[4:7], v192 offset:57856
 buffer_load_dwordx4 v213, s[8:11], s34 offen offset:3072 nt lds
 v_mfma_f32_16x16x32_bf16 v[148:151], a[16:19], a[84:87], v[148:151]
 s_waitcnt lgkmcnt(4)
 v_exp_f32 v135, v135
 v_mfma_f32_16x16x32_bf16 v[156:159], a[20:23], a[84:87], v[156:159]
 s_add_u32 m0, s33, 0
 ds_read_b128 a[8:11], v193 offset:57344
 v_cvt_pk_bf16_f32 v165, v134, v135
 v_mfma_f32_16x16x32_bf16 v[152:155], a[20:23], a[80:83], v[152:155]
 s_waitcnt lgkmcnt(4)
 v_exp_f32 v140, v140
 v_mfma_f32_16x16x32_bf16 v[144:147], a[24:27], a[88:91], v[144:147]
 s_mov_b32 s34, 114688
 ds_read_b128 a[12:15], v193 offset:57856
 v_add_f32 v222, v137, v222
 v_mfma_f32_16x16x32_bf16 v[148:151], a[24:27], a[92:95], v[148:151]
 s_waitcnt lgkmcnt(4)
 v_exp_f32 v141, v141
 v_mfma_f32_16x16x32_bf16 v[156:159], a[28:31], a[92:95], v[156:159]
 ds_read_b128 a[16:19], v192 offset:61440
 v_cvt_pk_bf16_f32 v166, v140, v141
 v_mfma_f32_16x16x32_bf16 v[152:155], a[28:31], a[88:91], v[152:155]
 s_waitcnt lgkmcnt(4)
 buffer_load_dwordx4 v210, s[12:15], s34 offen nt lds
 v_add_f32 v222, v138, v222
 v_mfma_f32_16x16x32_bf16 v[144:147], a[0:3], a[96:99], v[144:147]
 ds_read_b128 a[20:23], v192 offset:61952
 v_add_f32 v222, v139, v222
 v_mfma_f32_16x16x32_bf16 v[148:151], a[0:3], a[100:103], v[148:151]
 s_waitcnt lgkmcnt(4)
 v_exp_f32 v142, v142
 v_mfma_f32_16x16x32_bf16 v[156:159], a[4:7], a[100:103], v[156:159]
 ds_read_b128 a[24:27], v193 offset:61440
 v_add_f32 v223, v132, v223
 v_mfma_f32_16x16x32_bf16 v[152:155], a[4:7], a[96:99], v[152:155]
 s_waitcnt lgkmcnt(4)
 v_exp_f32 v143, v143
 v_mfma_f32_16x16x32_bf16 v[144:147], a[8:11], a[104:107], v[144:147]
 ds_read_b128 a[28:31], v193 offset:61952
 v_cvt_pk_bf16_f32 v167, v142, v143
 v_mfma_f32_16x16x32_bf16 v[148:151], a[8:11], a[108:111], v[148:151]
 s_waitcnt lgkmcnt(4)
 v_add_f32 v223, v133, v223
 v_add_f32 v223, v134, v223
 v_mfma_f32_16x16x32_bf16 v[156:159], a[12:15], a[108:111], v[156:159]
 ds_read_b64_tr_b16 a[0:1], v202 offset:0
 ds_read_b64_tr_b16 a[2:3], v202 offset:512
 v_mfma_f32_16x16x32_bf16 v[152:155], a[12:15], a[104:107], v[152:155]
 s_waitcnt lgkmcnt(5)
 buffer_load_dwordx4 v211, s[12:15], s34 offen offset:1024 nt lds
 v_add_f32 v223, v135, v223
 v_mfma_f32_16x16x32_bf16 v[144:147], a[16:19], a[112:115], v[144:147]
 ds_read_b64_tr_b16 a[4:5], v203 offset:0
 ds_read_b64_tr_b16 a[6:7], v203 offset:512
 v_mfma_f32_16x16x32_bf16 v[148:151], a[16:19], a[116:119], v[148:151]
 s_waitcnt lgkmcnt(6)
 v_add_f32 v223, v140, v223
 v_add_f32 v223, v141, v223
 v_mfma_f32_16x16x32_bf16 v[156:159], a[20:23], a[116:119], v[156:159]
 ds_read_b64_tr_b16 a[8:9], v204 offset:0
 ds_read_b64_tr_b16 a[10:11], v204 offset:512
 v_mfma_f32_16x16x32_bf16 v[152:155], a[20:23], a[112:115], v[152:155]
 s_waitcnt lgkmcnt(7)
 v_add_f32 v223, v142, v223
 v_add_f32 v223, v143, v223
 v_mfma_f32_16x16x32_bf16 v[144:147], a[24:27], a[120:123], v[144:147]
 ds_read_b64_tr_b16 a[12:13], v205 offset:0
 ds_read_b64_tr_b16 a[14:15], v205 offset:512
 v_mfma_f32_16x16x32_bf16 v[148:151], a[24:27], a[124:127], v[148:151]
 s_waitcnt lgkmcnt(8)
 v_mfma_f32_16x16x32_bf16 v[156:159], a[28:31], a[124:127], v[156:159]
 ds_read_b64_tr_b16 a[16:17], v202 offset:4096
 ds_read_b64_tr_b16 a[18:19], v202 offset:4608
 v_mfma_f32_16x16x32_bf16 v[152:155], a[28:31], a[120:123], v[152:155]
 s_waitcnt lgkmcnt(8)
 buffer_load_dwordx4 v212, s[12:15], s34 offen offset:2048 nt lds
 v_mfma_f32_16x16x32_bf16 v[0:3], a[0:3], v[160:163], v[0:3]
 ds_read_b64_tr_b16 a[20:21], v203 offset:4096
 ds_read_b64_tr_b16 a[22:23], v203 offset:4608
 v_mfma_f32_16x16x32_bf16 v[4:7], a[0:3], v[164:167], v[4:7]
 s_waitcnt vmcnt(17) lgkmcnt(8)
 v_max3_f32 v224, v144, v145, v146
 v_max3_f32 v224, v147, v148, v224
 v_mfma_f32_16x16x32_bf16 v[12:15], a[4:7], v[164:167], v[12:15]
 s_barrier
 ds_read_b64_tr_b16 a[24:25], v204 offset:4096
 ds_read_b64_tr_b16 a[26:27], v204 offset:4608
 v_mfma_f32_16x16x32_bf16 v[8:11], a[4:7], v[160:163], v[8:11]
 s_waitcnt lgkmcnt(8)
 v_max3_f32 v224, v149, v150, v224
 v_max3_f32 v224, v151, v152, v224
 v_mfma_f32_16x16x32_bf16 v[16:19], a[8:11], v[160:163], v[16:19]
 ds_read_b64_tr_b16 a[28:29], v205 offset:4096
 ds_read_b64_tr_b16 a[30:31], v205 offset:4608
 v_mfma_f32_16x16x32_bf16 v[20:23], a[8:11], v[164:167], v[20:23]
 s_waitcnt lgkmcnt(8)
 v_max3_f32 v224, v153, v154, v224
 v_max3_f32 v224, v155, v156, v224
 v_mfma_f32_16x16x32_bf16 v[28:31], a[12:15], v[164:167], v[28:31]
 ds_read_b64_tr_b16 a[0:1], v202 offset:8192
 ds_read_b64_tr_b16 a[2:3], v202 offset:8704
 v_mfma_f32_16x16x32_bf16 v[24:27], a[12:15], v[160:163], v[24:27]
 s_waitcnt lgkmcnt(8)
 buffer_load_dwordx4 v213, s[12:15], s34 offen offset:3072 nt lds
 v_max3_f32 v224, v157, v158, v224
 v_mfma_f32_16x16x32_bf16 v[32:35], a[16:19], v[160:163], v[32:35]
 s_add_u32 m0, s33, 16384
 ds_read_b64_tr_b16 a[4:5], v203 offset:8192
 ds_read_b64_tr_b16 a[6:7], v203 offset:8704
 v_mfma_f32_16x16x32_bf16 v[36:39], a[16:19], v[164:167], v[36:39]
 s_waitcnt lgkmcnt(8)
 buffer_store_byte v236, v238, s[48:51], s39 offen sc1
 v_max_f32 v224, v159, v224
 v_mfma_f32_16x16x32_bf16 v[44:47], a[20:23], v[164:167], v[44:47]
 s_mov_b32 s34, 147456
 ds_read_b64_tr_b16 a[8:9], v204 offset:8192
 ds_read_b64_tr_b16 a[10:11], v204 offset:8704
 v_mfma_f32_16x16x32_bf16 v[40:43], a[20:23], v[160:163], v[40:43]
 s_waitcnt lgkmcnt(8)
 v_cmp_lt_f32 vcc, s35, v224
 v_mfma_f32_16x16x32_bf16 v[48:51], a[24:27], v[160:163], v[48:51]
 s_cbranch_vccnz L_stub4
L_ret4:
 ds_read_b64_tr_b16 a[12:13], v205 offset:8192
 ds_read_b64_tr_b16 a[14:15], v205 offset:8704
 v_mfma_f32_16x16x32_bf16 v[52:55], a[24:27], v[164:167], v[52:55]
 s_waitcnt lgkmcnt(8)
 v_exp_f32 v144, v144
 v_mfma_f32_16x16x32_bf16 v[60:63], a[28:31], v[164:167], v[60:63]
 ds_read_b64_tr_b16 a[16:17], v202 offset:12288
 ds_read_b64_tr_b16 a[18:19], v202 offset:12800
 v_mfma_f32_16x16x32_bf16 v[56:59], a[28:31], v[160:163], v[56:59]
 s_waitcnt lgkmcnt(8)
 buffer_load_dwordx4 v210, s[8:11], s34 offen nt lds
 v_add_f32 v222, v144, v222
 v_mfma_f32_16x16x32_bf16 v[64:67], a[0:3], v[160:163], v[64:67]
 ds_read_b64_tr_b16 a[20:21], v203 offset:12288
 ds_read_b64_tr_b16 a[22:23], v203 offset:12800
 v_mfma_f32_16x16x32_bf16 v[68:71], a[0:3], v[164:167], v[68:71]
 s_waitcnt lgkmcnt(8)
 v_exp_f32 v145, v145
 v_mfma_f32_16x16x32_bf16 v[76:79], a[4:7], v[164:167], v[76:79]
 ds_read_b64_tr_b16 a[24:25], v204 offset:12288
 ds_read_b64_tr_b16 a[26:27], v204 offset:12800
 v_mfma_f32_16x16x32_bf16 v[72:75], a[4:7], v[160:163], v[72:75]
 s_waitcnt lgkmcnt(8)
 v_exp_f32 v146, v146
 v_mfma_f32_16x16x32_bf16 v[80:83], a[8:11], v[160:163], v[80:83]
 ds_read_b64_tr_b16 a[28:29], v205 offset:12288
 ds_read_b64_tr_b16 a[30:31], v205 offset:12800
 v_mfma_f32_16x16x32_bf16 v[84:87], a[8:11], v[164:167], v[84:87]
 s_waitcnt lgkmcnt(8)
 v_exp_f32 v147, v147
 v_mfma_f32_16x16x32_bf16 v[92:95], a[12:15], v[164:167], v[92:95]
 ds_read_b128 a[0:3], v194 offset:16384
 buffer_load_dwordx4 v211, s[8:11], s34 offen offset:1024 nt lds
 v_mfma_f32_16x16x32_bf16 v[88:91], a[12:15], v[160:163], v[88:91]
 s_waitcnt lgkmcnt(7)
 v_exp_f32 v152, v152
 v_mfma_f32_16x16x32_bf16 v[96:99], a[16:19], v[160:163], v[96:99]
 ds_read_b128 a[4:7], v194 offset:16896
 v_add_f32 v222, v145, v222
 v_mfma_f32_16x16x32_bf16 v[100:103], a[16:19], v[164:167], v[100:103]
 s_waitcnt lgkmcnt(6)
 v_exp_f32 v153, v153
 v_mfma_f32_16x16x32_bf16 v[108:111], a[20:23], v[164:167], v[108:111]
 ds_read_b128 a[8:11], v195 offset:16384
 v_add_f32 v222, v146, v222
 v_mfma_f32_16x16x32_bf16 v[104:107], a[20:23], v[160:163], v[104:107]
 s_waitcnt lgkmcnt(5)
 v_exp_f32 v154, v154
 v_mfma_f32_16x16x32_bf16 v[112:115], a[24:27], v[160:163], v[112:115]
 ds_read_b128 a[12:15], v195 offset:16896
 v_add_f32 v222, v147, v222
 v_mfma_f32_16x16x32_bf16 v[116:119], a[24:27], v[164:167], v[116:119]
 s_waitcnt lgkmcnt(4)
 buffer_load_dwordx4 v212, s[8:11], s34 offen offset:2048 nt lds
 v_add_f32 v222, v152, v222
 v_mfma_f32_16x16x32_bf16 v[124:127], a[28:31], v[164:167], v[124:127]
 ds_read_b128 a[16:19], v194 offset:20480
 v_add_f32 v222, v153, v222
 v_mfma_f32_16x16x32_bf16 v[120:123], a[28:31], v[160:163], v[120:123]
 s_waitcnt lgkmcnt(4)
 v_exp_f32 v155, v155
 v_mfma_f32_16x16x32_bf16 v[128:131], a[0:3], a[64:67], v[168:171]
 ds_read_b128 a[20:23], v194 offset:20992
 v_cvt_pk_bf16_f32 v160, v144, v145
 v_mfma_f32_16x16x32_bf16 v[132:135], a[0:3], a[68:71], v[172:175]
 s_waitcnt lgkmcnt(4)
 v_exp_f32 v148, v148
 v_mfma_f32_16x16x32_bf16 v[140:143], a[4:7], a[68:71], v[172:175]
 ds_read_b128 a[24:27], v195 offset:20480
 v_cvt_pk_bf16_f32 v161, v146, v147
 v_mfma_f32_16x16x32_bf16 v[136:139], a[4:7], a[64:67], v[168:171]
 s_waitcnt lgkmcnt(4)
 v_exp_f32 v149, v149
 v_mfma_f32_16x16x32_bf16 v[128:131], a[8:11], a[72:75], v[128:131]
 ds_read_b128 a[28:31], v195 offset:20992
 buffer_load_dwordx4 v213, s[8:11], s34 offen offset:3072 nt lds
 v_mfma_f32_16x16x32_bf16 v[132:135], a[8:11], a[76:79], v[132:135]
 s_waitcnt lgkmcnt(4)
 v_exp_f32 v150, v150
 v_mfma_f32_16x16x32_bf16 v[140:143], a[12:15], a[76:79], v[140:143]
 s_add_u32 m0, s33, 32768
 ds_read_b128 a[0:3], v194 offset:24576
 v_cvt_pk_bf16_f32 v162, v152, v153
 v_mfma_f32_16x16x32_bf16 v[136:139], a[12:15], a[72:75], v[136:139]
 s_waitcnt lgkmcnt(4)
 v_exp_f32 v151, v151
 v_mfma_f32_16x16x32_bf16 v[128:131], a[16:19], a[80:83], v[128:131]
 s_mov_b32 s34, 131072
 ds_read_b128 a[4:7], v194 offset:25088
 v_cvt_pk_bf16_f32 v163, v154, v155
 v_mfma_f32_16x16x32_bf16 v[132:135], a[16:19], a[84:87], v[132:135]
 s_waitcnt lgkmcnt(4)
 v_exp_f32 v156, v156
 v_mfma_f32_16x16x32_bf16 v[140:143], a[20:23], a[84:87], v[140:143]
 ds_read_b128 a[8:11], v195 offset:24576
 v_cvt_pk_bf16_f32 v164, v148, v149
 v_mfma_f32_16x16x32_bf16 v[136:139], a[20:23], a[80:83], v[136:139]
 s_waitcnt lgkmcnt(4)
 buffer_load_dwordx4 v210, s[12:15], s34 offen nt lds
 v_cvt_pk_bf16_f32 v165, v150, v151
 v_mfma_f32_16x16x32_bf16 v[128:131], a[24:27], a[88:91], v[128:131]
 ds_read_b128 a[12:15], v195 offset:25088
 v_add_f32 v222, v154, v222
 v_mfma_f32_16x16x32_bf16 v[132:135], a[24:27], a[92:95], v[132:135]
 s_waitcnt lgkmcnt(4)
 v_exp_f32 v157, v157
 v_mfma_f32_16x16x32_bf16 v[140:143], a[28:31], a[92:95], v[140:143]
 ds_read_b128 a[16:19], v194 offset:28672
 v_cvt_pk_bf16_f32 v166, v156, v157
 v_mfma_f32_16x16x32_bf16 v[136:139], a[28:31], a[88:91], v[136:139]
 s_waitcnt lgkmcnt(4)
 v_exp_f32 v158, v158
 v_mfma_f32_16x16x32_bf16 v[128:131], a[0:3], a[96:99], v[128:131]
 ds_read_b128 a[20:23], v194 offset:29184
 v_add_f32 v222, v155, v222
 v_mfma_f32_16x16x32_bf16 v[132:135], a[0:3], a[100:103], v[132:135]
 s_waitcnt lgkmcnt(4)
 v_exp_f32 v159, v159
 v_mfma_f32_16x16x32_bf16 v[140:143], a[4:7], a[100:103], v[140:143]
 ds_read_b128 a[24:27], v195 offset:28672
 buffer_load_dwordx4 v211, s[12:15], s34 offen offset:1024 nt lds
 v_mfma_f32_16x16x32_bf16 v[136:139], a[4:7], a[96:99], v[136:139]
 s_waitcnt lgkmcnt(4)
 v_cvt_pk_bf16_f32 v167, v158, v159
 v_add_f32 v223, v148, v223
 v_mfma_f32_16x16x32_bf16 v[128:131], a[8:11], a[104:107], v[128:131]
 ds_read_b128 a[28:31], v195 offset:29184
 v_add_f32 v223, v149, v223
 v_mfma_f32_16x16x32_bf16 v[132:135], a[8:11], a[108:111], v[132:135]
 s_waitcnt lgkmcnt(4)
 v_add_f32 v223, v150, v223
 v_add_f32 v223, v151, v223
 v_mfma_f32_16x16x32_bf16 v[140:143], a[12:15], a[108:111], v[140:143]
 ds_read_b64_tr_b16 a[0:1], v202 offset:32768
 ds_read_b64_tr_b16 a[2:3], v202 offset:33280
 v_mfma_f32_16x16x32_bf16 v[136:139], a[12:15], a[104:107], v[136:139]
 s_waitcnt lgkmcnt(5)
 v_add_f32 v223, v156, v223
 v_add_f32 v223, v157, v223
 v_mfma_f32_16x16x32_bf16 v[128:131], a[16:19], a[112:115], v[128:131]
 ds_read_b64_tr_b16 a[4:5], v203 offset:32768
 ds_read_b64_tr_b16 a[6:7], v203 offset:33280
 v_mfma_f32_16x16x32_bf16 v[132:135], a[16:19], a[116:119], v[132:135]
 s_waitcnt lgkmcnt(6)
 buffer_load_dwordx4 v212, s[12:15], s34 offen offset:2048 nt lds
 v_add_f32 v223, v158, v223
 v_mfma_f32_16x16x32_bf16 v[140:143], a[20:23], a[116:119], v[140:143]
 ds_read_b64_tr_b16 a[8:9], v204 offset:32768
 ds_read_b64_tr_b16 a[10:11], v204 offset:33280
 v_mfma_f32_16x16x32_bf16 v[136:139], a[20:23], a[112:115], v[136:139]
 s_waitcnt lgkmcnt(7)
 v_add_f32 v223, v159, v223
 v_mfma_f32_16x16x32_bf16 v[128:131], a[24:27], a[120:123], v[128:131]
 ds_read_b64_tr_b16 a[12:13], v205 offset:32768
 ds_read_b64_tr_b16 a[14:15], v205 offset:33280
 v_mfma_f32_16x16x32_bf16 v[132:135], a[24:27], a[124:127], v[132:135]
 s_waitcnt lgkmcnt(8)
 v_mfma_f32_16x16x32_bf16 v[140:143], a[28:31], a[124:127], v[140:143]
 ds_read_b64_tr_b16 a[16:17], v202 offset:36864
 ds_read_b64_tr_b16 a[18:19], v202 offset:37376
 v_mfma_f32_16x16x32_bf16 v[136:139], a[28:31], a[120:123], v[136:139]
 s_waitcnt lgkmcnt(8)
 v_mfma_f32_16x16x32_bf16 v[0:3], a[0:3], v[160:163], v[0:3]
 ds_read_b64_tr_b16 a[20:21], v203 offset:36864
 ds_read_b64_tr_b16 a[22:23], v203 offset:37376
 v_mfma_f32_16x16x32_bf16 v[4:7], a[0:3], v[164:167], v[4:7]
 s_waitcnt vmcnt(16) lgkmcnt(8)
 buffer_load_dwordx4 v213, s[12:15], s34 offen offset:3072 nt lds
 v_max3_f32 v224, v128, v129, v130
 v_mfma_f32_16x16x32_bf16 v[12:15], a[4:7], v[164:167], v[12:15]
 s_barrier
 ds_read_b64_tr_b16 a[24:25], v204 offset:36864
 ds_read_b64_tr_b16 a[26:27], v204 offset:37376
 v_mfma_f32_16x16x32_bf16 v[8:11], a[4:7], v[160:163], v[8:11]
 s_waitcnt lgkmcnt(8)
 v_max3_f32 v224, v131, v132, v224
 v_max3_f32 v224, v133, v134, v224
 v_mfma_f32_16x16x32_bf16 v[16:19], a[8:11], v[160:163], v[16:19]
 s_add_u32 m0, s33, 49152
 ds_read_b64_tr_b16 a[28:29], v205 offset:36864
 ds_read_b64_tr_b16 a[30:31], v205 offset:37376
 v_mfma_f32_16x16x32_bf16 v[20:23], a[8:11], v[164:167], v[20:23]
 s_waitcnt lgkmcnt(8)
 v_max3_f32 v224, v135, v136, v224
 v_max3_f32 v224, v137, v138, v224
 v_mfma_f32_16x16x32_bf16 v[28:31], a[12:15], v[164:167], v[28:31]
 s_mov_b32 s34, 163840
 ds_read_b64_tr_b16 a[0:1], v202 offset:40960
 ds_read_b64_tr_b16 a[2:3], v202 offset:41472
 v_mfma_f32_16x16x32_bf16 v[24:27], a[12:15], v[160:163], v[24:27]
 s_waitcnt lgkmcnt(8)
 v_max3_f32 v224, v139, v140, v224
 v_max3_f32 v224, v141, v142, v224
 v_mfma_f32_16x16x32_bf16 v[32:35], a[16:19], v[160:163], v[32:35]
 ds_read_b64_tr_b16 a[4:5], v203 offset:40960
 ds_read_b64_tr_b16 a[6:7], v203 offset:41472
 v_mfma_f32_16x16x32_bf16 v[36:39], a[16:19], v[164:167], v[36:39]
 s_waitcnt lgkmcnt(8)
 buffer_load_dwordx4 v210, s[8:11], s34 offen nt lds
 buffer_store_byte v236, v238, s[48:51], s38 offen sc1
 v_mfma_f32_16x16x32_bf16 v[44:47], a[20:23], v[164:167], v[44:47]
 ds_read_b64_tr_b16 a[8:9], v204 offset:40960
 ds_read_b64_tr_b16 a[10:11], v204 offset:41472
 v_mfma_f32_16x16x32_bf16 v[40:43], a[20:23], v[160:163], v[40:43]
 s_waitcnt lgkmcnt(8)
 v_max_f32 v224, v143, v224
 v_cmp_lt_f32 vcc, s35, v224
 v_mfma_f32_16x16x32_bf16 v[48:51], a[24:27], v[160:163], v[48:51]
 s_cbranch_vccnz L_stub5
L_ret5:
 ds_read_b64_tr_b16 a[12:13], v205 offset:40960
 ds_read_b64_tr_b16 a[14:15], v205 offset:41472
 v_mfma_f32_16x16x32_bf16 v[52:55], a[24:27], v[164:167], v[52:55]
 s_waitcnt lgkmcnt(8)
 v_exp_f32 v128, v128
 v_mfma_f32_16x16x32_bf16 v[60:63], a[28:31], v[164:167], v[60:63]
 ds_read_b64_tr_b16 a[16:17], v202 offset:45056
 ds_read_b64_tr_b16 a[18:19], v202 offset:45568
 v_mfma_f32_16x16x32_bf16 v[56:59], a[28:31], v[160:163], v[56:59]
 s_waitcnt lgkmcnt(8)
 v_exp_f32 v129, v129
 v_mfma_f32_16x16x32_bf16 v[64:67], a[0:3], v[160:163], v[64:67]
 ds_read_b64_tr_b16 a[20:21], v203 offset:45056
 ds_read_b64_tr_b16 a[22:23], v203 offset:45568
 v_mfma_f32_16x16x32_bf16 v[68:71], a[0:3], v[164:167], v[68:71]
 s_waitcnt lgkmcnt(8)
 buffer_load_dwordx4 v211, s[8:11], s34 offen offset:1024 nt lds
 v_add_f32 v222, v128, v222
 v_mfma_f32_16x16x32_bf16 v[76:79], a[4:7], v[164:167], v[76:79]
 ds_read_b64_tr_b16 a[24:25], v204 offset:45056
 ds_read_b64_tr_b16 a[26:27], v204 offset:45568
 v_mfma_f32_16x16x32_bf16 v[72:75], a[4:7], v[160:163], v[72:75]
 s_waitcnt lgkmcnt(8)
 v_exp_f32 v130, v130
 v_mfma_f32_16x16x32_bf16 v[80:83], a[8:11], v[160:163], v[80:83]
 ds_read_b64_tr_b16 a[28:29], v205 offset:45056
 ds_read_b64_tr_b16 a[30:31], v205 offset:45568
 v_mfma_f32_16x16x32_bf16 v[84:87], a[8:11], v[164:167], v[84:87]
 s_waitcnt lgkmcnt(8)
 v_exp_f32 v131, v131
 v_mfma_f32_16x16x32_bf16 v[92:95], a[12:15], v[164:167], v[92:95]
 ds_read_b128 a[0:3], v194 offset:49152
 v_add_f32 v222, v129, v222
 v_mfma_f32_16x16x32_bf16 v[88:91], a[12:15], v[160:163], v[88:91]
 s_waitcnt lgkmcnt(7)
 v_exp_f32 v136, v136
 v_mfma_f32_16x16x32_bf16 v[96:99], a[16:19], v[160:163], v[96:99]
 ds_read_b128 a[4:7], v194 offset:49664
 buffer_load_dwordx4 v212, s[8:11], s34 offen offset:2048 nt lds
 v_mfma_f32_16x16x32_bf16 v[100:103], a[16:19], v[164:167], v[100:103]
 s_waitcnt lgkmcnt(6)
 v_exp_f32 v137, v137
 v_mfma_f32_16x16x32_bf16 v[108:111], a[20:23], v[164:167], v[108:111]
 ds_read_b128 a[8:11], v195 offset:49152
 v_add_f32 v222, v130, v222
 v_mfma_f32_16x16x32_bf16 v[104:107], a[20:23], v[160:163], v[104:107]
 s_waitcnt lgkmcnt(5)
 v_exp_f32 v138, v138
 v_mfma_f32_16x16x32_bf16 v[112:115], a[24:27], v[160:163], v[112:115]
 ds_read_b128 a[12:15], v195 offset:49664
 v_add_f32 v222, v131, v222
 v_mfma_f32_16x16x32_bf16 v[116:119], a[24:27], v[164:167], v[116:119]
 s_waitcnt lgkmcnt(4)
 v_exp_f32 v139, v139
 v_mfma_f32_16x16x32_bf16 v[124:127], a[28:31], v[164:167], v[124:127]
 ds_read_b128 a[16:19], v194 offset:53248
 v_add_f32 v222, v136, v222
 v_mfma_f32_16x16x32_bf16 v[120:123], a[28:31], v[160:163], v[120:123]
 s_waitcnt lgkmcnt(4)
 buffer_load_dwordx4 v213, s[8:11], s34 offen offset:3072 nt lds
 v_add_f32 v222, v137, v222
 v_mfma_f32_16x16x32_bf16 v[144:147], a[0:3], a[64:67], v[168:171]
 s_add_u32 m0, s33, 65536
 ds_read_b128 a[20:23], v194 offset:53760
 v_cvt_pk_bf16_f32 v160, v128, v129
 v_mfma_f32_16x16x32_bf16 v[148:151], a[0:3], a[68:71], v[172:175]
 s_waitcnt lgkmcnt(4)
 v_exp_f32 v132, v132
 v_mfma_f32_16x16x32_bf16 v[156:159], a[4:7], a[68:71], v[172:175]
 s_mov_b32 s34, 147456
 ds_read_b128 a[24:27], v195 offset:53248
 v_cvt_pk_bf16_f32 v161, v130, v131
 v_mfma_f32_16x16x32_bf16 v[152:155], a[4:7], a[64:67], v[168:171]
 s_waitcnt lgkmcnt(4)
 v_exp_f32 v133, v133
 v_mfma_f32_16x16x32_bf16 v[144:147], a[8:11], a[72:75], v[144:147]
 ds_read_b128 a[28:31], v195 offset:53760
 v_cvt_pk_bf16_f32 v162, v136, v137
 v_mfma_f32_16x16x32_bf16 v[148:151], a[8:11], a[76:79], v[148:151]
 s_waitcnt lgkmcnt(4)
 v_exp_f32 v134, v134
 v_mfma_f32_16x16x32_bf16 v[156:159], a[12:15], a[76:79], v[156:159]
 ds_read_b128 a[0:3], v194 offset:57344
 buffer_load_dwordx4 v210, s[12:15], s34 offen nt lds
 v_mfma_f32_16x16x32_bf16 v[152:155], a[12:15], a[72:75], v[152:155]
 s_waitcnt lgkmcnt(4)
 v_exp_f32 v135, v135
 v_mfma_f32_16x16x32_bf16 v[144:147], a[16:19], a[80:83], v[144:147]
 ds_read_b128 a[4:7], v194 offset:57856
 v_cvt_pk_bf16_f32 v163, v138, v139
 v_mfma_f32_16x16x32_bf16 v[148:151], a[16:19], a[84:87], v[148:151]
 s_waitcnt lgkmcnt(4)
 v_exp_f32 v140, v140
 v_mfma_f32_16x16x32_bf16 v[156:159], a[20:23], a[84:87], v[156:159]
 ds_read_b128 a[8:11], v195 offset:57344
 v_cvt_pk_bf16_f32 v164, v132, v133
 v_mfma_f32_16x16x32_bf16 v[152:155], a[20:23], a[80:83], v[152:155]
 s_waitcnt lgkmcnt(4)
 v_exp_f32 v141, v141
 v_mfma_f32_16x16x32_bf16 v[144:147], a[24:27], a[88:91], v[144:147]
 ds_read_b128 a[12:15], v195 offset:57856
 v_cvt_pk_bf16_f32 v165, v134, v135
 v_mfma_f32_16x16x32_bf16 v[148:151], a[24:27], a[92:95], v[148:151]
 s_waitcnt lgkmcnt(4)
 buffer_load_dwordx4 v211, s[12:15], s34 offen offset:1024 nt lds
 v_cvt_pk_bf16_f32 v166, v140, v141
 v_mfma_f32_16x16x32_bf16 v[156:159], a[28:31], a[92:95], v[156:159]
 ds_read_b128 a[16:19], v194 offset:61440
 v_add_f32 v222, v138, v222
 v_mfma_f32_16x16x32_bf16 v[152:155], a[28:31], a[88:91], v[152:155]
 s_waitcnt lgkmcnt(4)
 v_exp_f32 v142, v142
 v_mfma_f32_16x16x32_bf16 v[144:147], a[0:3], a[96:99], v[144:147]
 ds_read_b128 a[20:23], v194 offset:61952
 v_add_f32 v222, v139, v222
 v_mfma_f32_16x16x32_bf16 v[148:151], a[0:3], a[100:103], v[148:151]
 s_waitcnt lgkmcnt(4)
 v_exp_f32 v143, v143
 v_mfma_f32_16x16x32_bf16 v[156:159], a[4:7], a[100:103], v[156:159]
 ds_read_b128 a[24:27], v195 offset:61440
 v_cvt_pk_bf16_f32 v167, v142, v143
 v_mfma_f32_16x16x32_bf16 v[152:155], a[4:7], a[96:99], v[152:155]
 s_waitcnt lgkmcnt(4)
 v_add_f32 v223, v132, v223
 v_add_f32 v223, v133, v223
 v_mfma_f32_16x16x32_bf16 v[144:147], a[8:11], a[104:107], v[144:147]
 ds_read_b128 a[28:31], v195 offset:61952
 buffer_load_dwordx4 v212, s[12:15], s34 offen offset:2048 nt lds
 v_mfma_f32_16x16x32_bf16 v[148:151], a[8:11], a[108:111], v[148:151]
 s_waitcnt lgkmcnt(4)
 v_add_f32 v223, v134, v223
 v_add_f32 v223, v135, v223
 v_mfma_f32_16x16x32_bf16 v[156:159], a[12:15], a[108:111], v[156:159]
 ds_read_b64_tr_b16 a[0:1], v206 offset:0
 ds_read_b64_tr_b16 a[2:3], v206 offset:512
 v_mfma_f32_16x16x32_bf16 v[152:155], a[12:15], a[104:107], v[152:155]
 s_waitcnt lgkmcnt(5)
 v_add_f32 v223, v140, v223
 v_add_f32 v223, v141, v223
 v_mfma_f32_16x16x32_bf16 v[144:147], a[16:19], a[112:115], v[144:147]
 ds_read_b64_tr_b16 a[4:5], v207 offset:0
 ds_read_b64_tr_b16 a[6:7], v207 offset:512
 v_mfma_f32_16x16x32_bf16 v[148:151], a[16:19], a[116:119], v[148:151]
 s_waitcnt lgkmcnt(6)
 v_add_f32 v223, v142, v223
 v_add_f32 v223, v143, v223
 v_mfma_f32_16x16x32_bf16 v[156:159], a[20:23], a[116:119], v[156:159]
 ds_read_b64_tr_b16 a[8:9], v208 offset:0
 ds_read_b64_tr_b16 a[10:11], v208 offset:512
 v_mfma_f32_16x16x32_bf16 v[152:155], a[20:23], a[112:115], v[152:155]
 s_waitcnt lgkmcnt(7)
 buffer_load_dwordx4 v213, s[12:15], s34 offen offset:3072 nt lds
 v_mfma_f32_16x16x32_bf16 v[144:147], a[24:27], a[120:123], v[144:147]
 s_add_u32 m0, s33, 81920
 ds_read_b64_tr_b16 a[12:13], v209 offset:0
 ds_read_b64_tr_b16 a[14:15], v209 offset:512
 v_mfma_f32_16x16x32_bf16 v[148:151], a[24:27], a[124:127], v[148:151]
 s_waitcnt lgkmcnt(8)
 v_mfma_f32_16x16x32_bf16 v[156:159], a[28:31], a[124:127], v[156:159]
 s_mov_b32 s34, 180224
 ds_read_b64_tr_b16 a[16:17], v206 offset:4096
 ds_read_b64_tr_b16 a[18:19], v206 offset:4608
 v_mfma_f32_16x16x32_bf16 v[152:155], a[28:31], a[120:123], v[152:155]
 s_waitcnt lgkmcnt(8)
 v_mfma_f32_16x16x32_bf16 v[0:3], a[0:3], v[160:163], v[0:3]
 s_add_u32 s92, s54, 32768
 s_addc_u32 s93, s55, 0
 ds_read_b64_tr_b16 a[20:21], v207 offset:4096
 ds_read_b64_tr_b16 a[22:23], v207 offset:4608
 v_mfma_f32_16x16x32_bf16 v[4:7], a[0:3], v[164:167], v[4:7]
 s_waitcnt vmcnt(18) lgkmcnt(8)
 global_load_dword v252, v245, s[92:93]
 v_max3_f32 v224, v144, v145, v146
 v_mfma_f32_16x16x32_bf16 v[12:15], a[4:7], v[164:167], v[12:15]
 s_barrier
 ds_read_b64_tr_b16 a[24:25], v208 offset:4096
 ds_read_b64_tr_b16 a[26:27], v208 offset:4608
 v_mfma_f32_16x16x32_bf16 v[8:11], a[4:7], v[160:163], v[8:11]
 s_waitcnt lgkmcnt(8)
 buffer_load_dwordx4 v210, s[8:11], s34 offen nt lds
 v_max3_f32 v224, v147, v148, v224
 v_mfma_f32_16x16x32_bf16 v[16:19], a[8:11], v[160:163], v[16:19]
 ds_read_b64_tr_b16 a[28:29], v209 offset:4096
 ds_read_b64_tr_b16 a[30:31], v209 offset:4608
 v_mfma_f32_16x16x32_bf16 v[20:23], a[8:11], v[164:167], v[20:23]
 s_waitcnt lgkmcnt(8)
 v_max3_f32 v224, v149, v150, v224
 v_max3_f32 v224, v151, v152, v224
 v_mfma_f32_16x16x32_bf16 v[28:31], a[12:15], v[164:167], v[28:31]
 ds_read_b64_tr_b16 a[0:1], v206 offset:8192
 ds_read_b64_tr_b16 a[2:3], v206 offset:8704
 v_mfma_f32_16x16x32_bf16 v[24:27], a[12:15], v[160:163], v[24:27]
 s_waitcnt lgkmcnt(8)
 v_max3_f32 v224, v153, v154, v224
 v_max3_f32 v224, v155, v156, v224
 v_mfma_f32_16x16x32_bf16 v[32:35], a[16:19], v[160:163], v[32:35]
 ds_read_b64_tr_b16 a[4:5], v207 offset:8192
 ds_read_b64_tr_b16 a[6:7], v207 offset:8704
 v_mfma_f32_16x16x32_bf16 v[36:39], a[16:19], v[164:167], v[36:39]
 s_waitcnt lgkmcnt(8)
 v_max3_f32 v224, v157, v158, v224
 v_max_f32 v224, v159, v224
 v_mfma_f32_16x16x32_bf16 v[44:47], a[20:23], v[164:167], v[44:47]
 ds_read_b64_tr_b16 a[8:9], v208 offset:8192
 ds_read_b64_tr_b16 a[10:11], v208 offset:8704
 v_mfma_f32_16x16x32_bf16 v[40:43], a[20:23], v[160:163], v[40:43]
 s_waitcnt lgkmcnt(8)
 buffer_load_dwordx4 v211, s[8:11], s34 offen offset:1024 nt lds
 v_cmp_lt_f32 vcc, s35, v224
 v_mfma_f32_16x16x32_bf16 v[48:51], a[24:27], v[160:163], v[48:51]
 s_cbranch_vccnz L_stub6
L_ret6:
 ds_read_b64_tr_b16 a[12:13], v209 offset:8192
 ds_read_b64_tr_b16 a[14:15], v209 offset:8704
 v_mfma_f32_16x16x32_bf16 v[52:55], a[24:27], v[164:167], v[52:55]
 s_waitcnt lgkmcnt(8)
 v_exp_f32 v144, v144
 v_mfma_f32_16x16x32_bf16 v[60:63], a[28:31], v[164:167], v[60:63]
 ds_read_b64_tr_b16 a[16:17], v206 offset:12288
 ds_read_b64_tr_b16 a[18:19], v206 offset:12800
 v_mfma_f32_16x16x32_bf16 v[56:59], a[28:31], v[160:163], v[56:59]
 s_waitcnt lgkmcnt(8)
 v_exp_f32 v145, v145
 v_mfma_f32_16x16x32_bf16 v[64:67], a[0:3], v[160:163], v[64:67]
 ds_read_b64_tr_b16 a[20:21], v207 offset:12288
 ds_read_b64_tr_b16 a[22:23], v207 offset:12800
 v_mfma_f32_16x16x32_bf16 v[68:71], a[0:3], v[164:167], v[68:71]
 s_waitcnt lgkmcnt(8)
 v_exp_f32 v146, v146
 v_mfma_f32_16x16x32_bf16 v[76:79], a[4:7], v[164:167], v[76:79]
 ds_read_b64_tr_b16 a[24:25], v208 offset:12288
 ds_read_b64_tr_b16 a[26:27], v208 offset:12800
 v_mfma_f32_16x16x32_bf16 v[72:75], a[4:7], v[160:163], v[72:75]
 s_waitcnt lgkmcnt(8)
 buffer_load_dwordx4 v212, s[8:11], s34 offen offset:2048 nt lds
 v_add_f32 v222, v144, v222
 v_mfma_f32_16x16x32_bf16 v[80:83], a[8:11], v[160:163], v[80:83]
 ds_read_b64_tr_b16 a[28:29], v209 offset:12288
 ds_read_b64_tr_b16 a[30:31], v209 offset:12800
 v_mfma_f32_16x16x32_bf16 v[84:87], a[8:11], v[164:167], v[84:87]
 s_waitcnt lgkmcnt(8)
 v_exp_f32 v147, v147
 v_mfma_f32_16x16x32_bf16 v[92:95], a[12:15], v[164:167], v[92:95]
 ds_read_b128 a[0:3], v196 offset:16384
 v_add_f32 v222, v145, v222
 v_mfma_f32_16x16x32_bf16 v[88:91], a[12:15], v[160:163], v[88:91]
 s_waitcnt lgkmcnt(7)
 v_exp_f32 v152, v152
 v_mfma_f32_16x16x32_bf16 v[96:99], a[16:19], v[160:163], v[96:99]
 ds_read_b128 a[4:7], v196 offset:16896
 v_add_f32 v222, v146, v222
 v_mfma_f32_16x16x32_bf16 v[100:103], a[16:19], v[164:167], v[100:103]
 s_waitcnt lgkmcnt(6)
 v_exp_f32 v153, v153
 v_mfma_f32_16x16x32_bf16 v[108:111], a[20:23], v[164:167], v[108:111]
 ds_read_b128 a[8:11], v197 offset:16384
 buffer_load_dwordx4 v213, s[8:11], s34 offen offset:3072 nt lds
 v_mfma_f32_16x16x32_bf16 v[104:107], a[20:23], v[160:163], v[104:107]
 s_waitcnt lgkmcnt(5)
 v_exp_f32 v154, v154
 v_mfma_f32_16x16x32_bf16 v[112:115], a[24:27], v[160:163], v[112:115]
 s_add_u32 m0, s33, 98304
 ds_read_b128 a[12:15], v197 offset:16896
 v_add_f32 v222, v147, v222
 v_mfma_f32_16x16x32_bf16 v[116:119], a[24:27], v[164:167], v[116:119]
 s_waitcnt lgkmcnt(4)
 v_exp_f32 v155, v155
 v_mfma_f32_16x16x32_bf16 v[124:127], a[28:31], v[164:167], v[124:127]
 s_mov_b32 s34, 163840
 ds_read_b128 a[16:19], v196 offset:20480
 v_add_f32 v222, v152, v222
 v_mfma_f32_16x16x32_bf16 v[120:123], a[28:31], v[160:163], v[120:123]
 s_waitcnt lgkmcnt(4)
 v_exp_f32 v148, v148
 v_mfma_f32_16x16x32_bf16 v[128:131], a[0:3], a[64:67], v[168:171]
 ds_read_b128 a[20:23], v196 offset:20992
 v_cvt_pk_bf16_f32 v160, v144, v145
 v_mfma_f32_16x16x32_bf16 v[132:135], a[0:3], a[68:71], v[172:175]
 s_waitcnt lgkmcnt(4)
 buffer_load_dwordx4 v210, s[12:15], s34 offen nt lds
 v_cvt_pk_bf16_f32 v161, v146, v147
 v_mfma_f32_16x16x32_bf16 v[140:143], a[4:7], a[68:71], v[172:175]
 ds_read_b128 a[24:27], v197 offset:20480
 v_cvt_pk_bf16_f32 v162, v152, v153
 v_mfma_f32_16x16x32_bf16 v[136:139], a[4:7], a[64:67], v[168:171]
 s_waitcnt lgkmcnt(4)
 v_exp_f32 v149, v149
 v_mfma_f32_16x16x32_bf16 v[128:131], a[8:11], a[72:75], v[128:131]
 ds_read_b128 a[28:31], v197 offset:20992
 v_cvt_pk_bf16_f32 v163, v154, v155
 v_mfma_f32_16x16x32_bf16 v[132:135], a[8:11], a[76:79], v[132:135]
 s_waitcnt lgkmcnt(4)
 v_exp_f32 v150, v150
 v_mfma_f32_16x16x32_bf16 v[140:143], a[12:15], a[76:79], v[140:143]
 ds_read_b128 a[0:3], v196 offset:24576
 v_cvt_pk_bf16_f32 v164, v148, v149
 v_mfma_f32_16x16x32_bf16 v[136:139], a[12:15], a[72:75], v[136:139]
 s_waitcnt lgkmcnt(4)
 v_exp_f32 v151, v151
 v_mfma_f32_16x16x32_bf16 v[128:131], a[16:19], a[80:83], v[128:131]
 ds_read_b128 a[4:7], v196 offset:25088
 buffer_load_dwordx4 v211, s[12:15], s34 offen offset:1024 nt lds
 v_mfma_f32_16x16x32_bf16 v[132:135], a[16:19], a[84:87], v[132:135]
 s_waitcnt lgkmcnt(4)
 v_exp_f32 v156, v156
 v_mfma_f32_16x16x32_bf16 v[140:143], a[20:23], a[84:87], v[140:143]
 ds_read_b128 a[8:11], v197 offset:24576
 v_cvt_pk_bf16_f32 v165, v150, v151
 v_mfma_f32_16x16x32_bf16 v[136:139], a[20:23], a[80:83], v[136:139]
 s_waitcnt lgkmcnt(4)
 v_exp_f32 v157, v157
 v_mfma_f32_16x16x32_bf16 v[128:131], a[24:27], a[88:91], v[128:131]
 ds_read_b128 a[12:15], v197 offset:25088
 v_cvt_pk_bf16_f32 v166, v156, v157
 v_mfma_f32_16x16x32_bf16 v[132:135], a[24:27], a[92:95], v[132:135]
 s_waitcnt lgkmcnt(4)
 v_exp_f32 v158, v158
 v_mfma_f32_16x16x32_bf16 v[140:143], a[28:31], a[92:95], v[140:143]
 ds_read_b128 a[16:19], v196 offset:28672
 v_add_f32 v222, v153, v222
 v_mfma_f32_16x16x32_bf16 v[136:139], a[28:31], a[88:91], v[136:139]
 s_waitcnt lgkmcnt(4)
 buffer_load_dwordx4 v212, s[12:15], s34 offen offset:2048 nt lds
 v_add_f32 v222, v154, v222
 v_mfma_f32_16x16x32_bf16 v[128:131], a[0:3], a[96:99], v[128:131]
 ds_read_b128 a[20:23], v196 offset:29184
 v_add_f32 v222, v155, v222
 v_mfma_f32_16x16x32_bf16 v[132:135], a[0:3], a[100:103], v[132:135]
 s_waitcnt lgkmcnt(4)
 v_exp_f32 v159, v159
 v_mfma_f32_16x16x32_bf16 v[140:143], a[4:7], a[100:103], v[140:143]
 ds_read_b128 a[24:27], v197 offset:28672
 v_cvt_pk_bf16_f32 v167, v158, v159
 v_mfma_f32_16x16x32_bf16 v[136:139], a[4:7], a[96:99], v[136:139]
 s_waitcnt lgkmcnt(4)
 v_add_f32 v223, v148, v223
 v_add_f32 v223, v149, v223
 v_mfma_f32_16x16x32_bf16 v[128:131], a[8:11], a[104:107], v[128:131]
 ds_read_b128 a[28:31], v197 offset:29184
 v_add_f32 v223, v150, v223
 v_mfma_f32_16x16x32_bf16 v[132:135], a[8:11], a[108:111], v[132:135]
 s_waitcnt lgkmcnt(4)
 v_add_f32 v223, v151, v223
 v_add_f32 v223, v156, v223
 v_mfma_f32_16x16x32_bf16 v[140:143], a[12:15], a[108:111], v[140:143]
 ds_read_b64_tr_b16 a[0:1], v198 offset:0
 ds_read_b64_tr_b16 a[2:3], v198 offset:512
 v_mfma_f32_16x16x32_bf16 v[136:139], a[12:15], a[104:107], v[136:139]
 s_waitcnt lgkmcnt(5)
 buffer_load_dwordx4 v213, s[12:15], s34 offen offset:3072 nt lds
 v_add_f32 v223, v157, v223
 v_mfma_f32_16x16x32_bf16 v[128:131], a[16:19], a[112:115], v[128:131]
 s_add_u32 m0, s33, 114688
 ds_read_b64_tr_b16 a[4:5], v199 offset:0
 ds_read_b64_tr_b16 a[6:7], v199 offset:512
 v_mfma_f32_16x16x32_bf16 v[132:135], a[16:19], a[116:119], v[132:135]
 s_waitcnt lgkmcnt(6)
 v_add_f32 v223, v158, v223
 v_add_f32 v223, v159, v223
 v_mfma_f32_16x16x32_bf16 v[140:143], a[20:23], a[116:119], v[140:143]
 s_mov_b32 s34, 196608
 ds_read_b64_tr_b16 a[8:9], v200 offset:0
 ds_read_b64_tr_b16 a[10:11], v200 offset:512
 v_mfma_f32_16x16x32_bf16 v[136:139], a[20:23], a[112:115], v[136:139]
 s_waitcnt lgkmcnt(7)
 v_mfma_f32_16x16x32_bf16 v[128:131], a[24:27], a[120:123], v[128:131]
 ds_read_b64_tr_b16 a[12:13], v201 offset:0
 ds_read_b64_tr_b16 a[14:15], v201 offset:512
 v_mfma_f32_16x16x32_bf16 v[132:135], a[24:27], a[124:127], v[132:135]
 s_waitcnt lgkmcnt(8)
 v_mfma_f32_16x16x32_bf16 v[140:143], a[28:31], a[124:127], v[140:143]
 ds_read_b64_tr_b16 a[16:17], v198 offset:4096
 ds_read_b64_tr_b16 a[18:19], v198 offset:4608
 v_mfma_f32_16x16x32_bf16 v[136:139], a[28:31], a[120:123], v[136:139]
 s_waitcnt lgkmcnt(8)
 buffer_load_dwordx4 v210, s[8:11], s34 offen nt lds
 v_mfma_f32_16x16x32_bf16 v[0:3], a[0:3], v[160:163], v[0:3]
 ds_read_b64_tr_b16 a[20:21], v199 offset:4096
 ds_read_b64_tr_b16 a[22:23], v199 offset:4608
 v_mfma_f32_16x16x32_bf16 v[4:7], a[0:3], v[164:167], v[4:7]
 s_waitcnt vmcnt(19) lgkmcnt(8)
 v_max3_f32 v224, v128, v129, v130
 v_max3_f32 v224, v131, v132, v224
 v_mfma_f32_16x16x32_bf16 v[12:15], a[4:7], v[164:167], v[12:15]
 s_barrier
 ds_read_b64_tr_b16 a[24:25], v200 offset:4096
 ds_read_b64_tr_b16 a[26:27], v200 offset:4608
 v_mfma_f32_16x16x32_bf16 v[8:11], a[4:7], v[160:163], v[8:11]
 s_waitcnt lgkmcnt(8)
 v_max3_f32 v224, v133, v134, v224
 v_max3_f32 v224, v135, v136, v224
 v_mfma_f32_16x16x32_bf16 v[16:19], a[8:11], v[160:163], v[16:19]
 ds_read_b64_tr_b16 a[28:29], v201 offset:4096
 ds_read_b64_tr_b16 a[30:31], v201 offset:4608
 v_mfma_f32_16x16x32_bf16 v[20:23], a[8:11], v[164:167], v[20:23]
 s_waitcnt lgkmcnt(8)
 v_max3_f32 v224, v137, v138, v224
 v_max3_f32 v224, v139, v140, v224
 v_mfma_f32_16x16x32_bf16 v[28:31], a[12:15], v[164:167], v[28:31]
 ds_read_b64_tr_b16 a[0:1], v198 offset:8192
 ds_read_b64_tr_b16 a[2:3], v198 offset:8704
 v_mfma_f32_16x16x32_bf16 v[24:27], a[12:15], v[160:163], v[24:27]
 s_waitcnt lgkmcnt(8)
 buffer_load_dwordx4 v211, s[8:11], s34 offen offset:1024 nt lds
 v_max3_f32 v224, v141, v142, v224
 v_mfma_f32_16x16x32_bf16 v[32:35], a[16:19], v[160:163], v[32:35]
 ds_read_b64_tr_b16 a[4:5], v199 offset:8192
 ds_read_b64_tr_b16 a[6:7], v199 offset:8704
 v_mfma_f32_16x16x32_bf16 v[36:39], a[16:19], v[164:167], v[36:39]
 s_waitcnt lgkmcnt(8)
 v_max_f32 v224, v143, v224
 v_cmp_lt_f32 vcc, s35, v224
 v_mfma_f32_16x16x32_bf16 v[44:47], a[20:23], v[164:167], v[44:47]
 s_cbranch_vccnz L_stub7
L_ret7:
 ds_read_b64_tr_b16 a[8:9], v200 offset:8192
 ds_read_b64_tr_b16 a[10:11], v200 offset:8704
 v_mfma_f32_16x16x32_bf16 v[40:43], a[20:23], v[160:163], v[40:43]
 s_waitcnt lgkmcnt(8)
 v_exp_f32 v128, v128
 v_mfma_f32_16x16x32_bf16 v[48:51], a[24:27], v[160:163], v[48:51]
 ds_read_b64_tr_b16 a[12:13], v201 offset:8192
 ds_read_b64_tr_b16 a[14:15], v201 offset:8704
 v_mfma_f32_16x16x32_bf16 v[52:55], a[24:27], v[164:167], v[52:55]
 s_waitcnt lgkmcnt(8)
 v_exp_f32 v129, v129
 v_mfma_f32_16x16x32_bf16 v[60:63], a[28:31], v[164:167], v[60:63]
 ds_read_b64_tr_b16 a[16:17], v198 offset:12288
 ds_read_b64_tr_b16 a[18:19], v198 offset:12800
 v_mfma_f32_16x16x32_bf16 v[56:59], a[28:31], v[160:163], v[56:59]
 s_waitcnt lgkmcnt(8)
 buffer_load_dwordx4 v212, s[8:11], s34 offen offset:2048 nt lds
 v_add_f32 v222, v128, v222
 v_mfma_f32_16x16x32_bf16 v[64:67], a[0:3], v[160:163], v[64:67]
 ds_read_b64_tr_b16 a[20:21], v199 offset:12288
 ds_read_b64_tr_b16 a[22:23], v199 offset:12800
 v_mfma_f32_16x16x32_bf16 v[68:71], a[0:3], v[164:167], v[68:71]
 s_waitcnt lgkmcnt(8)
 v_exp_f32 v130, v130
 v_mfma_f32_16x16x32_bf16 v[76:79], a[4:7], v[164:167], v[76:79]
 ds_read_b64_tr_b16 a[24:25], v200 offset:12288
 ds_read_b64_tr_b16 a[26:27], v200 offset:12800
 v_mfma_f32_16x16x32_bf16 v[72:75], a[4:7], v[160:163], v[72:75]
 s_waitcnt lgkmcnt(8)
 v_exp_f32 v131, v131
 v_mfma_f32_16x16x32_bf16 v[80:83], a[8:11], v[160:163], v[80:83]
 ds_read_b64_tr_b16 a[28:29], v201 offset:12288
 ds_read_b64_tr_b16 a[30:31], v201 offset:12800
 v_mfma_f32_16x16x32_bf16 v[84:87], a[8:11], v[164:167], v[84:87]
 s_waitcnt lgkmcnt(8)
 v_exp_f32 v136, v136
 v_mfma_f32_16x16x32_bf16 v[92:95], a[12:15], v[164:167], v[92:95]
 ds_read_b128 a[0:3], v192 offset:16384
 buffer_load_dwordx4 v213, s[8:11], s34 offen offset:3072 nt lds
 v_mfma_f32_16x16x32_bf16 v[88:91], a[12:15], v[160:163], v[88:91]
 s_waitcnt lgkmcnt(7)
 v_exp_f32 v137, v137
 v_mfma_f32_16x16x32_bf16 v[96:99], a[16:19], v[160:163], v[96:99]
 s_add_u32 m0, s33, 131072
 ds_read_b128 a[4:7], v192 offset:16896
 v_add_f32 v222, v129, v222
 v_mfma_f32_16x16x32_bf16 v[100:103], a[16:19], v[164:167], v[100:103]
 s_waitcnt lgkmcnt(6)
 v_exp_f32 v138, v138
 v_mfma_f32_16x16x32_bf16 v[108:111], a[20:23], v[164:167], v[108:111]
 s_mov_b32 s34, 180224
 ds_read_b128 a[8:11], v193 offset:16384
 v_add_f32 v222, v130, v222
 v_mfma_f32_16x16x32_bf16 v[104:107], a[20:23], v[160:163], v[104:107]
 s_waitcnt lgkmcnt(5)
 v_exp_f32 v139, v139
 v_mfma_f32_16x16x32_bf16 v[112:115], a[24:27], v[160:163], v[112:115]
 ds_read_b128 a[12:15], v193 offset:16896
 v_add_f32 v222, v131, v222
 v_mfma_f32_16x16x32_bf16 v[116:119], a[24:27], v[164:167], v[116:119]
 s_waitcnt lgkmcnt(4)
 buffer_load_dwordx4 v210, s[12:15], s34 offen nt lds
 v_add_f32 v222, v136, v222
 v_mfma_f32_16x16x32_bf16 v[124:127], a[28:31], v[164:167], v[124:127]
 ds_read_b128 a[16:19], v192 offset:20480
 v_add_f32 v222, v137, v222
 v_mfma_f32_16x16x32_bf16 v[120:123], a[28:31], v[160:163], v[120:123]
 s_waitcnt lgkmcnt(4)
 v_exp_f32 v132, v132
 v_mfma_f32_16x16x32_bf16 v[144:147], a[0:3], a[64:67], v[168:171]
 ds_read_b128 a[20:23], v192 offset:20992
 v_cvt_pk_bf16_f32 v160, v128, v129
 v_mfma_f32_16x16x32_bf16 v[148:151], a[0:3], a[68:71], v[172:175]
 s_waitcnt lgkmcnt(4)
 v_exp_f32 v133, v133
 v_mfma_f32_16x16x32_bf16 v[156:159], a[4:7], a[68:71], v[172:175]
 ds_read_b128 a[24:27], v193 offset:20480
 v_cvt_pk_bf16_f32 v161, v130, v131
 v_mfma_f32_16x16x32_bf16 v[152:155], a[4:7], a[64:67], v[168:171]
 s_waitcnt lgkmcnt(4)
 v_exp_f32 v134, v134
 v_mfma_f32_16x16x32_bf16 v[144:147], a[8:11], a[72:75], v[144:147]
 ds_read_b128 a[28:31], v193 offset:20992
 buffer_load_dwordx4 v211, s[12:15], s34 offen offset:1024 nt lds
 v_mfma_f32_16x16x32_bf16 v[148:151], a[8:11], a[76:79], v[148:151]
 s_waitcnt lgkmcnt(4)
 v_exp_f32 v135, v135
 v_mfma_f32_16x16x32_bf16 v[156:159], a[12:15], a[76:79], v[156:159]
 ds_read_b128 a[0:3], v192 offset:24576
 v_cvt_pk_bf16_f32 v162, v136, v137
 v_mfma_f32_16x16x32_bf16 v[152:155], a[12:15], a[72:75], v[152:155]
 s_waitcnt lgkmcnt(4)
 v_exp_f32 v140, v140
 v_mfma_f32_16x16x32_bf16 v[144:147], a[16:19], a[80:83], v[144:147]
 ds_read_b128 a[4:7], v192 offset:25088
 v_cvt_pk_bf16_f32 v163, v138, v139
 v_mfma_f32_16x16x32_bf16 v[148:151], a[16:19], a[84:87], v[148:151]
 s_waitcnt lgkmcnt(4)
 v_exp_f32 v141, v141
 v_mfma_f32_16x16x32_bf16 v[156:159], a[20:23], a[84:87], v[156:159]
 ds_read_b128 a[8:11], v193 offset:24576
 v_cvt_pk_bf16_f32 v164, v132, v133
 v_mfma_f32_16x16x32_bf16 v[152:155], a[20:23], a[80:83], v[152:155]
 s_waitcnt lgkmcnt(4)
 buffer_load_dwordx4 v212, s[12:15], s34 offen offset:2048 nt lds
 v_cvt_pk_bf16_f32 v165, v134, v135
 v_mfma_f32_16x16x32_bf16 v[144:147], a[24:27], a[88:91], v[144:147]
 ds_read_b128 a[12:15], v193 offset:25088
 v_cvt_pk_bf16_f32 v166, v140, v141
 v_mfma_f32_16x16x32_bf16 v[148:151], a[24:27], a[92:95], v[148:151]
 s_waitcnt lgkmcnt(4)
 v_exp_f32 v142, v142
 v_mfma_f32_16x16x32_bf16 v[156:159], a[28:31], a[92:95], v[156:159]
 ds_read_b128 a[16:19], v192 offset:28672
 v_add_f32 v222, v138, v222
 v_mfma_f32_16x16x32_bf16 v[152:155], a[28:31], a[88:91], v[152:155]
 s_waitcnt lgkmcnt(4)
 v_exp_f32 v143, v143
 v_mfma_f32_16x16x32_bf16 v[144:147], a[0:3], a[96:99], v[144:147]
 ds_read_b128 a[20:23], v192 offset:29184
 v_cvt_pk_bf16_f32 v167, v142, v143
 v_mfma_f32_16x16x32_bf16 v[148:151], a[0:3], a[100:103], v[148:151]
 s_waitcnt lgkmcnt(4)
 v_add_f32 v222, v139, v222
 v_add_f32 v223, v132, v223
 v_mfma_f32_16x16x32_bf16 v[156:159], a[4:7], a[100:103], v[156:159]
 ds_read_b128 a[24:27], v193 offset:28672
 buffer_load_dwordx4 v213, s[12:15], s34 offen offset:3072 nt lds
 v_mfma_f32_16x16x32_bf16 v[152:155], a[4:7], a[96:99], v[152:155]
 s_waitcnt lgkmcnt(4)
 v_add_f32 v223, v133, v223
 v_add_f32 v223, v134, v223
 v_mfma_f32_16x16x32_bf16 v[144:147], a[8:11], a[104:107], v[144:147]
 s_add_u32 m0, s33, 147456
 ds_read_b128 a[28:31], v193 offset:29184
 v_add_f32 v223, v135, v223
 v_mfma_f32_16x16x32_bf16 v[148:151], a[8:11], a[108:111], v[148:151]
 s_waitcnt lgkmcnt(4)
 v_add_f32 v223, v140, v223
 v_add_f32 v223, v141, v223
 v_mfma_f32_16x16x32_bf16 v[156:159], a[12:15], a[108:111], v[156:159]
 s_mov_b32 s34, 212992
 ds_read_b64_tr_b16 a[0:1], v198 offset:32768
 ds_read_b64_tr_b16 a[2:3], v198 offset:33280
 v_mfma_f32_16x16x32_bf16 v[152:155], a[12:15], a[104:107], v[152:155]
 s_waitcnt lgkmcnt(5)
 v_add_f32 v223, v142, v223
 v_add_f32 v223, v143, v223
 v_mfma_f32_16x16x32_bf16 v[144:147], a[16:19], a[112:115], v[144:147]
 ds_read_b64_tr_b16 a[4:5], v199 offset:32768
 ds_read_b64_tr_b16 a[6:7], v199 offset:33280
 v_mfma_f32_16x16x32_bf16 v[148:151], a[16:19], a[116:119], v[148:151]
 s_waitcnt lgkmcnt(6)
 buffer_load_dwordx4 v210, s[8:11], s34 offen nt lds
 v_mfma_f32_16x16x32_bf16 v[156:159], a[20:23], a[116:119], v[156:159]
 ds_read_b64_tr_b16 a[8:9], v200 offset:32768
 ds_read_b64_tr_b16 a[10:11], v200 offset:33280
 v_mfma_f32_16x16x32_bf16 v[152:155], a[20:23], a[112:115], v[152:155]
 s_waitcnt lgkmcnt(7)
 v_mfma_f32_16x16x32_bf16 v[144:147], a[24:27], a[120:123], v[144:147]
 ds_read_b64_tr_b16 a[12:13], v201 offset:32768
 ds_read_b64_tr_b16 a[14:15], v201 offset:33280
 v_mfma_f32_16x16x32_bf16 v[148:151], a[24:27], a[124:127], v[148:151]
 s_waitcnt lgkmcnt(8)
 v_mfma_f32_16x16x32_bf16 v[156:159], a[28:31], a[124:127], v[156:159]
 ds_read_b64_tr_b16 a[16:17], v198 offset:36864
 ds_read_b64_tr_b16 a[18:19], v198 offset:37376
 v_mfma_f32_16x16x32_bf16 v[152:155], a[28:31], a[120:123], v[152:155]
 s_waitcnt lgkmcnt(8)
 v_mfma_f32_16x16x32_bf16 v[0:3], a[0:3], v[160:163], v[0:3]
 ds_read_b64_tr_b16 a[20:21], v199 offset:36864
 ds_read_b64_tr_b16 a[22:23], v199 offset:37376
 v_mfma_f32_16x16x32_bf16 v[4:7], a[0:3], v[164:167], v[4:7]
 s_waitcnt vmcnt(18) lgkmcnt(8)
 buffer_load_dwordx4 v211, s[8:11], s34 offen offset:1024 nt lds
 v_max3_f32 v224, v144, v145, v146
 v_mfma_f32_16x16x32_bf16 v[12:15], a[4:7], v[164:167], v[12:15]
 s_barrier
 ds_read_b64_tr_b16 a[24:25], v200 offset:36864
 ds_read_b64_tr_b16 a[26:27], v200 offset:37376
 v_mfma_f32_16x16x32_bf16 v[8:11], a[4:7], v[160:163], v[8:11]
 s_waitcnt lgkmcnt(8)
 v_max3_f32 v224, v147, v148, v224
 v_max3_f32 v224, v149, v150, v224
 v_mfma_f32_16x16x32_bf16 v[16:19], a[8:11], v[160:163], v[16:19]
 ds_read_b64_tr_b16 a[28:29], v201 offset:36864
 ds_read_b64_tr_b16 a[30:31], v201 offset:37376
 v_mfma_f32_16x16x32_bf16 v[20:23], a[8:11], v[164:167], v[20:23]
 s_waitcnt lgkmcnt(8)
 v_max3_f32 v224, v151, v152, v224
 v_max3_f32 v224, v153, v154, v224
 v_mfma_f32_16x16x32_bf16 v[28:31], a[12:15], v[164:167], v[28:31]
 ds_read_b64_tr_b16 a[0:1], v198 offset:40960
 ds_read_b64_tr_b16 a[2:3], v198 offset:41472
 v_mfma_f32_16x16x32_bf16 v[24:27], a[12:15], v[160:163], v[24:27]
 s_waitcnt lgkmcnt(8)
 v_max3_f32 v224, v155, v156, v224
 v_max3_f32 v224, v157, v158, v224
 v_mfma_f32_16x16x32_bf16 v[32:35], a[16:19], v[160:163], v[32:35]
 ds_read_b64_tr_b16 a[4:5], v199 offset:40960
 ds_read_b64_tr_b16 a[6:7], v199 offset:41472
 v_mfma_f32_16x16x32_bf16 v[36:39], a[16:19], v[164:167], v[36:39]
 s_waitcnt lgkmcnt(8)
 buffer_load_dwordx4 v212, s[8:11], s34 offen offset:2048 nt lds
 v_max_f32 v224, v159, v224
 v_mfma_f32_16x16x32_bf16 v[44:47], a[20:23], v[164:167], v[44:47]
 ds_read_b64_tr_b16 a[8:9], v200 offset:40960
 ds_read_b64_tr_b16 a[10:11], v200 offset:41472
 v_mfma_f32_16x16x32_bf16 v[40:43], a[20:23], v[160:163], v[40:43]
 s_waitcnt lgkmcnt(8)
 v_cmp_lt_f32 vcc, s35, v224
 v_mfma_f32_16x16x32_bf16 v[48:51], a[24:27], v[160:163], v[48:51]
 s_cbranch_vccnz L_stub8
L_ret8:
 ds_read_b64_tr_b16 a[12:13], v201 offset:40960
 ds_read_b64_tr_b16 a[14:15], v201 offset:41472
 v_mfma_f32_16x16x32_bf16 v[52:55], a[24:27], v[164:167], v[52:55]
 s_waitcnt lgkmcnt(8)
 v_exp_f32 v144, v144
 v_mfma_f32_16x16x32_bf16 v[60:63], a[28:31], v[164:167], v[60:63]
 ds_read_b64_tr_b16 a[16:17], v198 offset:45056
 ds_read_b64_tr_b16 a[18:19], v198 offset:45568
 v_mfma_f32_16x16x32_bf16 v[56:59], a[28:31], v[160:163], v[56:59]
 s_waitcnt lgkmcnt(8)
 v_exp_f32 v145, v145
 v_mfma_f32_16x16x32_bf16 v[64:67], a[0:3], v[160:163], v[64:67]
 ds_read_b64_tr_b16 a[20:21], v199 offset:45056
 ds_read_b64_tr_b16 a[22:23], v199 offset:45568
 v_mfma_f32_16x16x32_bf16 v[68:71], a[0:3], v[164:167], v[68:71]
 s_waitcnt lgkmcnt(8)
 buffer_load_dwordx4 v213, s[8:11], s34 offen offset:3072 nt lds
 v_add_f32 v222, v144, v222
 v_mfma_f32_16x16x32_bf16 v[76:79], a[4:7], v[164:167], v[76:79]
 s_add_u32 m0, s33, 0
 ds_read_b64_tr_b16 a[24:25], v200 offset:45056
 ds_read_b64_tr_b16 a[26:27], v200 offset:45568
 v_mfma_f32_16x16x32_bf16 v[72:75], a[4:7], v[160:163], v[72:75]
 s_waitcnt lgkmcnt(8)
 v_exp_f32 v146, v146
 v_mfma_f32_16x16x32_bf16 v[80:83], a[8:11], v[160:163], v[80:83]
 s_mov_b32 s34, 196608
 ds_read_b64_tr_b16 a[28:29], v201 offset:45056
 ds_read_b64_tr_b16 a[30:31], v201 offset:45568
 v_mfma_f32_16x16x32_bf16 v[84:87], a[8:11], v[164:167], v[84:87]
 s_waitcnt lgkmcnt(8)
 v_exp_f32 v147, v147
 v_mfma_f32_16x16x32_bf16 v[92:95], a[12:15], v[164:167], v[92:95]
 ds_read_b128 a[0:3], v192 offset:49152
 v_add_f32 v222, v145, v222
 v_mfma_f32_16x16x32_bf16 v[88:91], a[12:15], v[160:163], v[88:91]
 s_waitcnt lgkmcnt(7)
 v_exp_f32 v152, v152
 v_mfma_f32_16x16x32_bf16 v[96:99], a[16:19], v[160:163], v[96:99]
 ds_read_b128 a[4:7], v192 offset:49664
 buffer_load_dwordx4 v210, s[12:15], s34 offen nt lds
 v_mfma_f32_16x16x32_bf16 v[100:103], a[16:19], v[164:167], v[100:103]
 s_waitcnt lgkmcnt(6)
 v_exp_f32 v153, v153
 v_mfma_f32_16x16x32_bf16 v[108:111], a[20:23], v[164:167], v[108:111]
 ds_read_b128 a[8:11], v193 offset:49152
 v_add_f32 v222, v146, v222
 v_mfma_f32_16x16x32_bf16 v[104:107], a[20:23], v[160:163], v[104:107]
 s_waitcnt lgkmcnt(5)
 v_exp_f32 v154, v154
 v_mfma_f32_16x16x32_bf16 v[112:115], a[24:27], v[160:163], v[112:115]
 ds_read_b128 a[12:15], v193 offset:49664
 v_add_f32 v222, v147, v222
 v_mfma_f32_16x16x32_bf16 v[116:119], a[24:27], v[164:167], v[116:119]
 s_waitcnt lgkmcnt(4)
 v_exp_f32 v155, v155
 v_mfma_f32_16x16x32_bf16 v[124:127], a[28:31], v[164:167], v[124:127]
 ds_read_b128 a[16:19], v192 offset:53248
 v_add_f32 v222, v152, v222
 v_mfma_f32_16x16x32_bf16 v[120:123], a[28:31], v[160:163], v[120:123]
 s_waitcnt lgkmcnt(4)
 buffer_load_dwordx4 v211, s[12:15], s34 offen offset:1024 nt lds
 v_add_f32 v222, v153, v222
 v_mfma_f32_16x16x32_bf16 v[128:131], a[0:3], a[64:67], v[168:171]
 ds_read_b128 a[20:23], v192 offset:53760
 v_cvt_pk_bf16_f32 v160, v144, v145
 v_mfma_f32_16x16x32_bf16 v[132:135], a[0:3], a[68:71], v[172:175]
 s_waitcnt lgkmcnt(4)
 v_exp_f32 v148, v148
 v_mfma_f32_16x16x32_bf16 v[140:143], a[4:7], a[68:71], v[172:175]
 ds_read_b128 a[24:27], v193 offset:53248
 v_cvt_pk_bf16_f32 v161, v146, v147
 v_mfma_f32_16x16x32_bf16 v[136:139], a[4:7], a[64:67], v[168:171]
 s_waitcnt lgkmcnt(4)
 v_exp_f32 v149, v149
 v_mfma_f32_16x16x32_bf16 v[128:131], a[8:11], a[72:75], v[128:131]
 ds_read_b128 a[28:31], v193 offset:53760
 v_cvt_pk_bf16_f32 v162, v152, v153
 v_mfma_f32_16x16x32_bf16 v[132:135], a[8:11], a[76:79], v[132:135]
 s_waitcnt lgkmcnt(4)
 v_exp_f32 v150, v150
 v_mfma_f32_16x16x32_bf16 v[140:143], a[12:15], a[76:79], v[140:143]
 ds_read_b128 a[0:3], v192 offset:57344
 buffer_load_dwordx4 v212, s[12:15], s34 offen offset:2048 nt lds
 v_mfma_f32_16x16x32_bf16 v[136:139], a[12:15], a[72:75], v[136:139]
 s_waitcnt lgkmcnt(4)
 v_exp_f32 v151, v151
 v_mfma_f32_16x16x32_bf16 v[128:131], a[16:19], a[80:83], v[128:131]
 ds_read_b128 a[4:7], v192 offset:57856
 v_cvt_pk_bf16_f32 v163, v154, v155
 v_mfma_f32_16x16x32_bf16 v[132:135], a[16:19], a[84:87], v[132:135]
 s_waitcnt lgkmcnt(4)
 v_exp_f32 v156, v156
 v_mfma_f32_16x16x32_bf16 v[140:143], a[20:23], a[84:87], v[140:143]
 ds_read_b128 a[8:11], v193 offset:57344
 v_cvt_pk_bf16_f32 v164, v148, v149
 v_mfma_f32_16x16x32_bf16 v[136:139], a[20:23], a[80:83], v[136:139]
 s_waitcnt lgkmcnt(4)
 v_exp_f32 v157, v157
 v_mfma_f32_16x16x32_bf16 v[128:131], a[24:27], a[88:91], v[128:131]
 ds_read_b128 a[12:15], v193 offset:57856
 v_cvt_pk_bf16_f32 v165, v150, v151
 v_mfma_f32_16x16x32_bf16 v[132:135], a[24:27], a[92:95], v[132:135]
 s_waitcnt lgkmcnt(4)
 buffer_load_dwordx4 v213, s[12:15], s34 offen offset:3072 nt lds
 v_cvt_pk_bf16_f32 v166, v156, v157
 v_mfma_f32_16x16x32_bf16 v[140:143], a[28:31], a[92:95], v[140:143]
 s_add_u32 m0, s33, 16384
 ds_read_b128 a[16:19], v192 offset:61440
 v_add_f32 v222, v154, v222
 v_mfma_f32_16x16x32_bf16 v[136:139], a[28:31], a[88:91], v[136:139]
 s_waitcnt lgkmcnt(4)
 v_exp_f32 v158, v158
 v_mfma_f32_16x16x32_bf16 v[128:131], a[0:3], a[96:99], v[128:131]
 s_mov_b32 s34, 229376
 ds_read_b128 a[20:23], v192 offset:61952
 v_add_f32 v222, v155, v222
 v_mfma_f32_16x16x32_bf16 v[132:135], a[0:3], a[100:103], v[132:135]
 s_waitcnt lgkmcnt(4)
 v_exp_f32 v159, v159
 v_mfma_f32_16x16x32_bf16 v[140:143], a[4:7], a[100:103], v[140:143]
 ds_read_b128 a[24:27], v193 offset:61440
 v_cvt_pk_bf16_f32 v167, v158, v159
 v_mfma_f32_16x16x32_bf16 v[136:139], a[4:7], a[96:99], v[136:139]
 s_waitcnt lgkmcnt(4)
 v_add_f32 v223, v148, v223
 v_add_f32 v223, v149, v223
 v_mfma_f32_16x16x32_bf16 v[128:131], a[8:11], a[104:107], v[128:131]
 ds_read_b128 a[28:31], v193 offset:61952
 buffer_load_dwordx4 v210, s[8:11], s34 offen nt lds
 v_mfma_f32_16x16x32_bf16 v[132:135], a[8:11], a[108:111], v[132:135]
 s_waitcnt lgkmcnt(4)
 v_add_f32 v223, v150, v223
 v_add_f32 v223, v151, v223
 v_mfma_f32_16x16x32_bf16 v[140:143], a[12:15], a[108:111], v[140:143]
 ds_read_b64_tr_b16 a[0:1], v202 offset:0
 ds_read_b64_tr_b16 a[2:3], v202 offset:512
 v_mfma_f32_16x16x32_bf16 v[136:139], a[12:15], a[104:107], v[136:139]
 s_waitcnt lgkmcnt(5)
 v_add_f32 v223, v156, v223
 v_add_f32 v223, v157, v223
 v_mfma_f32_16x16x32_bf16 v[128:131], a[16:19], a[112:115], v[128:131]
 ds_read_b64_tr_b16 a[4:5], v203 offset:0
 ds_read_b64_tr_b16 a[6:7], v203 offset:512
 v_mfma_f32_16x16x32_bf16 v[132:135], a[16:19], a[116:119], v[132:135]
 s_waitcnt lgkmcnt(6)
 v_add_f32 v223, v158, v223
 v_add_f32 v223, v159, v223
 v_mfma_f32_16x16x32_bf16 v[140:143], a[20:23], a[116:119], v[140:143]
 ds_read_b64_tr_b16 a[8:9], v204 offset:0
 ds_read_b64_tr_b16 a[10:11], v204 offset:512
 v_mfma_f32_16x16x32_bf16 v[136:139], a[20:23], a[112:115], v[136:139]
 s_waitcnt lgkmcnt(7)
 buffer_load_dwordx4 v211, s[8:11], s34 offen offset:1024 nt lds
 v_mfma_f32_16x16x32_bf16 v[128:131], a[24:27], a[120:123], v[128:131]
 ds_read_b64_tr_b16 a[12:13], v205 offset:0
 ds_read_b64_tr_b16 a[14:15], v205 offset:512
 v_mfma_f32_16x16x32_bf16 v[132:135], a[24:27], a[124:127], v[132:135]
 s_waitcnt lgkmcnt(8)
 v_mfma_f32_16x16x32_bf16 v[140:143], a[28:31], a[124:127], v[140:143]
 ds_read_b64_tr_b16 a[16:17], v202 offset:4096
 ds_read_b64_tr_b16 a[18:19], v202 offset:4608
 v_mfma_f32_16x16x32_bf16 v[136:139], a[28:31], a[120:123], v[136:139]
 s_waitcnt lgkmcnt(8)
 v_mfma_f32_16x16x32_bf16 v[0:3], a[0:3], v[160:163], v[0:3]
 s_add_u32 s92, s54, 36864
 s_addc_u32 s93, s55, 0
 ds_read_b64_tr_b16 a[20:21], v203 offset:4096
 ds_read_b64_tr_b16 a[22:23], v203 offset:4608
 v_mfma_f32_16x16x32_bf16 v[4:7], a[0:3], v[164:167], v[4:7]
 s_waitcnt vmcnt(18) lgkmcnt(8)
 global_load_dword v252, v245, s[92:93]
 v_max3_f32 v224, v128, v129, v130
 v_mfma_f32_16x16x32_bf16 v[12:15], a[4:7], v[164:167], v[12:15]
 s_barrier
 ds_read_b64_tr_b16 a[24:25], v204 offset:4096
 ds_read_b64_tr_b16 a[26:27], v204 offset:4608
 v_mfma_f32_16x16x32_bf16 v[8:11], a[4:7], v[160:163], v[8:11]
 s_waitcnt lgkmcnt(8)
 buffer_load_dwordx4 v212, s[8:11], s34 offen offset:2048 nt lds
 v_max3_f32 v224, v131, v132, v224
 v_mfma_f32_16x16x32_bf16 v[16:19], a[8:11], v[160:163], v[16:19]
 ds_read_b64_tr_b16 a[28:29], v205 offset:4096
 ds_read_b64_tr_b16 a[30:31], v205 offset:4608
 v_mfma_f32_16x16x32_bf16 v[20:23], a[8:11], v[164:167], v[20:23]
 s_waitcnt lgkmcnt(8)
 v_max3_f32 v224, v133, v134, v224
 v_max3_f32 v224, v135, v136, v224
 v_mfma_f32_16x16x32_bf16 v[28:31], a[12:15], v[164:167], v[28:31]
 ds_read_b64_tr_b16 a[0:1], v202 offset:8192
 ds_read_b64_tr_b16 a[2:3], v202 offset:8704
 v_mfma_f32_16x16x32_bf16 v[24:27], a[12:15], v[160:163], v[24:27]
 s_waitcnt lgkmcnt(8)
 v_max3_f32 v224, v137, v138, v224
 v_max3_f32 v224, v139, v140, v224
 v_mfma_f32_16x16x32_bf16 v[32:35], a[16:19], v[160:163], v[32:35]
 ds_read_b64_tr_b16 a[4:5], v203 offset:8192
 ds_read_b64_tr_b16 a[6:7], v203 offset:8704
 v_mfma_f32_16x16x32_bf16 v[36:39], a[16:19], v[164:167], v[36:39]
 s_waitcnt lgkmcnt(8)
 v_max3_f32 v224, v141, v142, v224
 v_max_f32 v224, v143, v224
 v_mfma_f32_16x16x32_bf16 v[44:47], a[20:23], v[164:167], v[44:47]
 ds_read_b64_tr_b16 a[8:9], v204 offset:8192
 ds_read_b64_tr_b16 a[10:11], v204 offset:8704
 v_mfma_f32_16x16x32_bf16 v[40:43], a[20:23], v[160:163], v[40:43]
 s_waitcnt lgkmcnt(8)
 buffer_load_dwordx4 v213, s[8:11], s34 offen offset:3072 nt lds
 v_cmp_lt_f32 vcc, s35, v224
 v_mfma_f32_16x16x32_bf16 v[48:51], a[24:27], v[160:163], v[48:51]
 s_cbranch_vccnz L_stub9
L_ret9:
 ds_read_b64_tr_b16 a[12:13], v205 offset:8192
 ds_read_b64_tr_b16 a[14:15], v205 offset:8704
 v_mfma_f32_16x16x32_bf16 v[52:55], a[24:27], v[164:167], v[52:55]
 s_waitcnt lgkmcnt(8)
 v_exp_f32 v128, v128
 v_mfma_f32_16x16x32_bf16 v[60:63], a[28:31], v[164:167], v[60:63]
 s_add_u32 m0, s33, 32768
 ds_read_b64_tr_b16 a[16:17], v202 offset:12288
 ds_read_b64_tr_b16 a[18:19], v202 offset:12800
 v_mfma_f32_16x16x32_bf16 v[56:59], a[28:31], v[160:163], v[56:59]
 s_waitcnt lgkmcnt(8)
 v_exp_f32 v129, v129
 v_mfma_f32_16x16x32_bf16 v[64:67], a[0:3], v[160:163], v[64:67]
 s_mov_b32 s34, 212992
 ds_read_b64_tr_b16 a[20:21], v203 offset:12288
 ds_read_b64_tr_b16 a[22:23], v203 offset:12800
 v_mfma_f32_16x16x32_bf16 v[68:71], a[0:3], v[164:167], v[68:71]
 s_waitcnt lgkmcnt(8)
 v_exp_f32 v130, v130
 v_mfma_f32_16x16x32_bf16 v[76:79], a[4:7], v[164:167], v[76:79]
 ds_read_b64_tr_b16 a[24:25], v204 offset:12288
 ds_read_b64_tr_b16 a[26:27], v204 offset:12800
 v_mfma_f32_16x16x32_bf16 v[72:75], a[4:7], v[160:163], v[72:75]
 s_waitcnt lgkmcnt(8)
 buffer_load_dwordx4 v210, s[12:15], s34 offen nt lds
 v_add_f32 v222, v128, v222
 v_mfma_f32_16x16x32_bf16 v[80:83], a[8:11], v[160:163], v[80:83]
 ds_read_b64_tr_b16 a[28:29], v205 offset:12288
 ds_read_b64_tr_b16 a[30:31], v205 offset:12800
 v_mfma_f32_16x16x32_bf16 v[84:87], a[8:11], v[164:167], v[84:87]
 s_waitcnt lgkmcnt(8)
 v_exp_f32 v131, v131
 v_mfma_f32_16x16x32_bf16 v[92:95], a[12:15], v[164:167], v[92:95]
 ds_read_b128 a[0:3], v194 offset:16384
 v_add_f32 v222, v129, v222
 v_mfma_f32_16x16x32_bf16 v[88:91], a[12:15], v[160:163], v[88:91]
 s_waitcnt lgkmcnt(7)
 v_exp_f32 v136, v136
 v_mfma_f32_16x16x32_bf16 v[96:99], a[16:19], v[160:163], v[96:99]
 ds_read_b128 a[4:7], v194 offset:16896
 v_add_f32 v222, v130, v222
 v_mfma_f32_16x16x32_bf16 v[100:103], a[16:19], v[164:167], v[100:103]
 s_waitcnt lgkmcnt(6)
 v_exp_f32 v137, v137
 v_mfma_f32_16x16x32_bf16 v[108:111], a[20:23], v[164:167], v[108:111]
 ds_read_b128 a[8:11], v195 offset:16384
 buffer_load_dwordx4 v211, s[12:15], s34 offen offset:1024 nt lds
 v_mfma_f32_16x16x32_bf16 v[104:107], a[20:23], v[160:163], v[104:107]
 s_waitcnt lgkmcnt(5)
 v_exp_f32 v138, v138
 v_mfma_f32_16x16x32_bf16 v[112:115], a[24:27], v[160:163], v[112:115]
 ds_read_b128 a[12:15], v195 offset:16896
 v_add_f32 v222, v131, v222
 v_mfma_f32_16x16x32_bf16 v[116:119], a[24:27], v[164:167], v[116:119]
 s_waitcnt lgkmcnt(4)
 v_exp_f32 v139, v139
 v_mfma_f32_16x16x32_bf16 v[124:127], a[28:31], v[164:167], v[124:127]
 ds_read_b128 a[16:19], v194 offset:20480
 v_add_f32 v222, v136, v222
 v_mfma_f32_16x16x32_bf16 v[120:123], a[28:31], v[160:163], v[120:123]
 s_waitcnt lgkmcnt(4)
 v_exp_f32 v132, v132
 v_mfma_f32_16x16x32_bf16 v[144:147], a[0:3], a[64:67], v[168:171]
 ds_read_b128 a[20:23], v194 offset:20992
 v_cvt_pk_bf16_f32 v160, v128, v129
 v_mfma_f32_16x16x32_bf16 v[148:151], a[0:3], a[68:71], v[172:175]
 s_waitcnt lgkmcnt(4)
 buffer_load_dwordx4 v212, s[12:15], s34 offen offset:2048 nt lds
 v_cvt_pk_bf16_f32 v161, v130, v131
 v_mfma_f32_16x16x32_bf16 v[156:159], a[4:7], a[68:71], v[172:175]
 ds_read_b128 a[24:27], v195 offset:20480
 v_cvt_pk_bf16_f32 v162, v136, v137
 v_mfma_f32_16x16x32_bf16 v[152:155], a[4:7], a[64:67], v[168:171]
 s_waitcnt lgkmcnt(4)
 v_exp_f32 v133, v133
 v_mfma_f32_16x16x32_bf16 v[144:147], a[8:11], a[72:75], v[144:147]
 ds_read_b128 a[28:31], v195 offset:20992
 v_cvt_pk_bf16_f32 v163, v138, v139
 v_mfma_f32_16x16x32_bf16 v[148:151], a[8:11], a[76:79], v[148:151]
 s_waitcnt lgkmcnt(4)
 v_exp_f32 v134, v134
 v_mfma_f32_16x16x32_bf16 v[156:159], a[12:15], a[76:79], v[156:159]
 ds_read_b128 a[0:3], v194 offset:24576
 v_cvt_pk_bf16_f32 v164, v132, v133
 v_mfma_f32_16x16x32_bf16 v[152:155], a[12:15], a[72:75], v[152:155]
 s_waitcnt lgkmcnt(4)
 v_exp_f32 v135, v135
 v_mfma_f32_16x16x32_bf16 v[144:147], a[16:19], a[80:83], v[144:147]
 ds_read_b128 a[4:7], v194 offset:25088
 buffer_load_dwordx4 v213, s[12:15], s34 offen offset:3072 nt lds
 v_mfma_f32_16x16x32_bf16 v[148:151], a[16:19], a[84:87], v[148:151]
 s_waitcnt lgkmcnt(4)
 v_exp_f32 v140, v140
 v_mfma_f32_16x16x32_bf16 v[156:159], a[20:23], a[84:87], v[156:159]
 s_add_u32 m0, s33, 49152
 ds_read_b128 a[8:11], v195 offset:24576
 v_cvt_pk_bf16_f32 v165, v134, v135
 v_mfma_f32_16x16x32_bf16 v[152:155], a[20:23], a[80:83], v[152:155]
 s_waitcnt lgkmcnt(4)
 v_exp_f32 v141, v141
 v_mfma_f32_16x16x32_bf16 v[144:147], a[24:27], a[88:91], v[144:147]
 s_mov_b32 s34, 245760
 ds_read_b128 a[12:15], v195 offset:25088
 v_cvt_pk_bf16_f32 v166, v140, v141
 v_mfma_f32_16x16x32_bf16 v[148:151], a[24:27], a[92:95], v[148:151]
 s_waitcnt lgkmcnt(4)
 v_exp_f32 v142, v142
 v_mfma_f32_16x16x32_bf16 v[156:159], a[28:31], a[92:95], v[156:159]
 ds_read_b128 a[16:19], v194 offset:28672
 v_add_f32 v222, v137, v222
 v_mfma_f32_16x16x32_bf16 v[152:155], a[28:31], a[88:91], v[152:155]
 s_waitcnt lgkmcnt(4)
 buffer_load_dwordx4 v210, s[8:11], s34 offen nt lds
 v_add_f32 v222, v138, v222
 v_mfma_f32_16x16x32_bf16 v[144:147], a[0:3], a[96:99], v[144:147]
 ds_read_b128 a[20:23], v194 offset:29184
 v_add_f32 v222, v139, v222
 v_mfma_f32_16x16x32_bf16 v[148:151], a[0:3], a[100:103], v[148:151]
 s_waitcnt lgkmcnt(4)
 v_exp_f32 v143, v143
 v_mfma_f32_16x16x32_bf16 v[156:159], a[4:7], a[100:103], v[156:159]
 ds_read_b128 a[24:27], v195 offset:28672
 v_cvt_pk_bf16_f32 v167, v142, v143
 v_mfma_f32_16x16x32_bf16 v[152:155], a[4:7], a[96:99], v[152:155]
 s_waitcnt lgkmcnt(4)
 v_add_f32 v223, v132, v223
 v_add_f32 v223, v133, v223
 v_mfma_f32_16x16x32_bf16 v[144:147], a[8:11], a[104:107], v[144:147]
 ds_read_b128 a[28:31], v195 offset:29184
 v_add_f32 v223, v134, v223
 v_mfma_f32_16x16x32_bf16 v[148:151], a[8:11], a[108:111], v[148:151]
 s_waitcnt lgkmcnt(4)
 v_add_f32 v223, v135, v223
 v_add_f32 v223, v140, v223
 v_mfma_f32_16x16x32_bf16 v[156:159], a[12:15], a[108:111], v[156:159]
 ds_read_b64_tr_b16 a[0:1], v202 offset:32768
 ds_read_b64_tr_b16 a[2:3], v202 offset:33280
 v_mfma_f32_16x16x32_bf16 v[152:155], a[12:15], a[104:107], v[152:155]
 s_waitcnt lgkmcnt(5)
 buffer_load_dwordx4 v211, s[8:11], s34 offen offset:1024 nt lds
 v_add_f32 v223, v141, v223
 v_mfma_f32_16x16x32_bf16 v[144:147], a[16:19], a[112:115], v[144:147]
 ds_read_b64_tr_b16 a[4:5], v203 offset:32768
 ds_read_b64_tr_b16 a[6:7], v203 offset:33280
 v_mfma_f32_16x16x32_bf16 v[148:151], a[16:19], a[116:119], v[148:151]
 s_waitcnt lgkmcnt(6)
 v_add_f32 v223, v142, v223
 v_add_f32 v223, v143, v223
 v_mfma_f32_16x16x32_bf16 v[156:159], a[20:23], a[116:119], v[156:159]
 ds_read_b64_tr_b16 a[8:9], v204 offset:32768
 ds_read_b64_tr_b16 a[10:11], v204 offset:33280
 v_mfma_f32_16x16x32_bf16 v[152:155], a[20:23], a[112:115], v[152:155]
 s_waitcnt lgkmcnt(7)
 v_mfma_f32_16x16x32_bf16 v[144:147], a[24:27], a[120:123], v[144:147]
 ds_read_b64_tr_b16 a[12:13], v205 offset:32768
 ds_read_b64_tr_b16 a[14:15], v205 offset:33280
 v_mfma_f32_16x16x32_bf16 v[148:151], a[24:27], a[124:127], v[148:151]
 s_waitcnt lgkmcnt(8)
 v_mfma_f32_16x16x32_bf16 v[156:159], a[28:31], a[124:127], v[156:159]
 ds_read_b64_tr_b16 a[16:17], v202 offset:36864
 ds_read_b64_tr_b16 a[18:19], v202 offset:37376
 v_mfma_f32_16x16x32_bf16 v[152:155], a[28:31], a[120:123], v[152:155]
 s_waitcnt lgkmcnt(8)
 buffer_load_dwordx4 v212, s[8:11], s34 offen offset:2048 nt lds
 v_mfma_f32_16x16x32_bf16 v[0:3], a[0:3], v[160:163], v[0:3]
 ds_read_b64_tr_b16 a[20:21], v203 offset:36864
 ds_read_b64_tr_b16 a[22:23], v203 offset:37376
 v_mfma_f32_16x16x32_bf16 v[4:7], a[0:3], v[164:167], v[4:7]
 s_waitcnt vmcnt(20) lgkmcnt(8)
 v_max3_f32 v224, v144, v145, v146
 v_max3_f32 v224, v147, v148, v224
 v_mfma_f32_16x16x32_bf16 v[12:15], a[4:7], v[164:167], v[12:15]
 s_barrier
 ds_read_b64_tr_b16 a[24:25], v204 offset:36864
 ds_read_b64_tr_b16 a[26:27], v204 offset:37376
 v_mfma_f32_16x16x32_bf16 v[8:11], a[4:7], v[160:163], v[8:11]
 s_waitcnt lgkmcnt(8)
 v_max3_f32 v224, v149, v150, v224
 v_max3_f32 v224, v151, v152, v224
 v_mfma_f32_16x16x32_bf16 v[16:19], a[8:11], v[160:163], v[16:19]
 ds_read_b64_tr_b16 a[28:29], v205 offset:36864
 ds_read_b64_tr_b16 a[30:31], v205 offset:37376
 v_mfma_f32_16x16x32_bf16 v[20:23], a[8:11], v[164:167], v[20:23]
 s_waitcnt lgkmcnt(8)
 v_max3_f32 v224, v153, v154, v224
 v_max3_f32 v224, v155, v156, v224
 v_mfma_f32_16x16x32_bf16 v[28:31], a[12:15], v[164:167], v[28:31]
 ds_read_b64_tr_b16 a[0:1], v202 offset:40960
 ds_read_b64_tr_b16 a[2:3], v202 offset:41472
 v_mfma_f32_16x16x32_bf16 v[24:27], a[12:15], v[160:163], v[24:27]
 s_waitcnt lgkmcnt(8)
 buffer_load_dwordx4 v213, s[8:11], s34 offen offset:3072 nt lds
 v_max3_f32 v224, v157, v158, v224
 v_mfma_f32_16x16x32_bf16 v[32:35], a[16:19], v[160:163], v[32:35]
 s_add_u32 m0, s33, 65536
 ds_read_b64_tr_b16 a[4:5], v203 offset:40960
 ds_read_b64_tr_b16 a[6:7], v203 offset:41472
 v_mfma_f32_16x16x32_bf16 v[36:39], a[16:19], v[164:167], v[36:39]
 s_waitcnt lgkmcnt(8)
 v_max_f32 v224, v159, v224
 v_cmp_lt_f32 vcc, s35, v224
 v_mfma_f32_16x16x32_bf16 v[44:47], a[20:23], v[164:167], v[44:47]
 s_cbranch_vccnz L_stub10
L_ret10:
 ds_read_b64_tr_b16 a[8:9], v204 offset:40960
 ds_read_b64_tr_b16 a[10:11], v204 offset:41472
 v_mfma_f32_16x16x32_bf16 v[40:43], a[20:23], v[160:163], v[40:43]
 s_waitcnt lgkmcnt(8)
 v_exp_f32 v144, v144
 v_mfma_f32_16x16x32_bf16 v[48:51], a[24:27], v[160:163], v[48:51]
 s_mov_b32 s34, 229376
 ds_read_b64_tr_b16 a[12:13], v205 offset:40960
 ds_read_b64_tr_b16 a[14:15], v205 offset:41472
 v_mfma_f32_16x16x32_bf16 v[52:55], a[24:27], v[164:167], v[52:55]
 s_waitcnt lgkmcnt(8)
 v_exp_f32 v145, v145
 v_mfma_f32_16x16x32_bf16 v[60:63], a[28:31], v[164:167], v[60:63]
 ds_read_b64_tr_b16 a[16:17], v202 offset:45056
 ds_read_b64_tr_b16 a[18:19], v202 offset:45568
 v_mfma_f32_16x16x32_bf16 v[56:59], a[28:31], v[160:163], v[56:59]
 s_waitcnt lgkmcnt(8)
 buffer_load_dwordx4 v210, s[12:15], s34 offen nt lds
 v_add_f32 v222, v144, v222
 v_mfma_f32_16x16x32_bf16 v[64:67], a[0:3], v[160:163], v[64:67]
 ds_read_b64_tr_b16 a[20:21], v203 offset:45056
 ds_read_b64_tr_b16 a[22:23], v203 offset:45568
 v_mfma_f32_16x16x32_bf16 v[68:71], a[0:3], v[164:167], v[68:71]
 s_waitcnt lgkmcnt(8)
 v_exp_f32 v146, v146
 v_mfma_f32_16x16x32_bf16 v[76:79], a[4:7], v[164:167], v[76:79]
 ds_read_b64_tr_b16 a[24:25], v204 offset:45056
 ds_read_b64_tr_b16 a[26:27], v204 offset:45568
 v_mfma_f32_16x16x32_bf16 v[72:75], a[4:7], v[160:163], v[72:75]
 s_waitcnt lgkmcnt(8)
 v_exp_f32 v147, v147
 v_mfma_f32_16x16x32_bf16 v[80:83], a[8:11], v[160:163], v[80:83]
 ds_read_b64_tr_b16 a[28:29], v205 offset:45056
 ds_read_b64_tr_b16 a[30:31], v205 offset:45568
 v_mfma_f32_16x16x32_bf16 v[84:87], a[8:11], v[164:167], v[84:87]
 s_waitcnt lgkmcnt(8)
 v_exp_f32 v152, v152
 v_mfma_f32_16x16x32_bf16 v[92:95], a[12:15], v[164:167], v[92:95]
 ds_read_b128 a[0:3], v194 offset:49152
 buffer_load_dwordx4 v211, s[12:15], s34 offen offset:1024 nt lds
 v_mfma_f32_16x16x32_bf16 v[88:91], a[12:15], v[160:163], v[88:91]
 s_waitcnt lgkmcnt(7)
 v_exp_f32 v153, v153
 v_mfma_f32_16x16x32_bf16 v[96:99], a[16:19], v[160:163], v[96:99]
 ds_read_b128 a[4:7], v194 offset:49664
 v_add_f32 v222, v145, v222
 v_mfma_f32_16x16x32_bf16 v[100:103], a[16:19], v[164:167], v[100:103]
 s_waitcnt lgkmcnt(6)
 v_exp_f32 v154, v154
 v_mfma_f32_16x16x32_bf16 v[108:111], a[20:23], v[164:167], v[108:111]
 ds_read_b128 a[8:11], v195 offset:49152
 v_add_f32 v222, v146, v222
 v_mfma_f32_16x16x32_bf16 v[104:107], a[20:23], v[160:163], v[104:107]
 s_waitcnt lgkmcnt(5)
 v_exp_f32 v155, v155
 v_mfma_f32_16x16x32_bf16 v[112:115], a[24:27], v[160:163], v[112:115]
 ds_read_b128 a[12:15], v195 offset:49664
 v_add_f32 v222, v147, v222
 v_mfma_f32_16x16x32_bf16 v[116:119], a[24:27], v[164:167], v[116:119]
 s_waitcnt lgkmcnt(4)
 buffer_load_dwordx4 v212, s[12:15], s34 offen offset:2048 nt lds
 v_add_f32 v222, v152, v222
 v_mfma_f32_16x16x32_bf16 v[124:127], a[28:31], v[164:167], v[124:127]
 ds_read_b128 a[16:19], v194 offset:53248
 v_add_f32 v222, v153, v222
 v_mfma_f32_16x16x32_bf16 v[120:123], a[28:31], v[160:163], v[120:123]
 s_waitcnt lgkmcnt(4)
 v_exp_f32 v148, v148
 v_mfma_f32_16x16x32_bf16 v[128:131], a[0:3], a[64:67], v[168:171]
 ds_read_b128 a[20:23], v194 offset:53760
 v_cvt_pk_bf16_f32 v160, v144, v145
 v_mfma_f32_16x16x32_bf16 v[132:135], a[0:3], a[68:71], v[172:175]
 s_waitcnt lgkmcnt(4)
 v_exp_f32 v149, v149
 v_mfma_f32_16x16x32_bf16 v[140:143], a[4:7], a[68:71], v[172:175]
 ds_read_b128 a[24:27], v195 offset:53248
 v_cvt_pk_bf16_f32 v161, v146, v147
 v_mfma_f32_16x16x32_bf16 v[136:139], a[4:7], a[64:67], v[168:171]
 s_waitcnt lgkmcnt(4)
 v_exp_f32 v150, v150
 v_mfma_f32_16x16x32_bf16 v[128:131], a[8:11], a[72:75], v[128:131]
 ds_read_b128 a[28:31], v195 offset:53760
 buffer_load_dwordx4 v213, s[12:15], s34 offen offset:3072 nt lds
 v_mfma_f32_16x16x32_bf16 v[132:135], a[8:11], a[76:79], v[132:135]
 s_waitcnt lgkmcnt(4)
 v_exp_f32 v151, v151
 v_mfma_f32_16x16x32_bf16 v[140:143], a[12:15], a[76:79], v[140:143]
 s_add_u32 m0, s33, 81920
 ds_read_b128 a[0:3], v194 offset:57344
 v_cvt_pk_bf16_f32 v162, v152, v153
 v_mfma_f32_16x16x32_bf16 v[136:139], a[12:15], a[72:75], v[136:139]
 s_waitcnt lgkmcnt(4)
 v_exp_f32 v156, v156
 v_mfma_f32_16x16x32_bf16 v[128:131], a[16:19], a[80:83], v[128:131]
 s_mov_b32 s34, 262144
 ds_read_b128 a[4:7], v194 offset:57856
 v_cvt_pk_bf16_f32 v163, v154, v155
 v_mfma_f32_16x16x32_bf16 v[132:135], a[16:19], a[84:87], v[132:135]
 s_waitcnt lgkmcnt(4)
 v_exp_f32 v157, v157
 v_mfma_f32_16x16x32_bf16 v[140:143], a[20:23], a[84:87], v[140:143]
 ds_read_b128 a[8:11], v195 offset:57344
 v_cvt_pk_bf16_f32 v164, v148, v149
 v_mfma_f32_16x16x32_bf16 v[136:139], a[20:23], a[80:83], v[136:139]
 s_waitcnt lgkmcnt(4)
 buffer_load_dwordx4 v210, s[8:11], s34 offen nt lds
 v_cvt_pk_bf16_f32 v165, v150, v151
 v_mfma_f32_16x16x32_bf16 v[128:131], a[24:27], a[88:91], v[128:131]
 ds_read_b128 a[12:15], v195 offset:57856
 v_cvt_pk_bf16_f32 v166, v156, v157
 v_mfma_f32_16x16x32_bf16 v[132:135], a[24:27], a[92:95], v[132:135]
 s_waitcnt lgkmcnt(4)
 v_exp_f32 v158, v158
 v_mfma_f32_16x16x32_bf16 v[140:143], a[28:31], a[92:95], v[140:143]
 ds_read_b128 a[16:19], v194 offset:61440
 v_add_f32 v222, v154, v222
 v_mfma_f32_16x16x32_bf16 v[136:139], a[28:31], a[88:91], v[136:139]
 s_waitcnt lgkmcnt(4)
 v_exp_f32 v159, v159
 v_mfma_f32_16x16x32_bf16 v[128:131], a[0:3], a[96:99], v[128:131]
 ds_read_b128 a[20:23], v194 offset:61952
 v_cvt_pk_bf16_f32 v167, v158, v159
 v_mfma_f32_16x16x32_bf16 v[132:135], a[0:3], a[100:103], v[132:135]
 s_waitcnt lgkmcnt(4)
 v_add_f32 v222, v155, v222
 v_add_f32 v223, v148, v223
 v_mfma_f32_16x16x32_bf16 v[140:143], a[4:7], a[100:103], v[140:143]
 ds_read_b128 a[24:27], v195 offset:61440
 buffer_load_dwordx4 v211, s[8:11], s34 offen offset:1024 nt lds
 v_mfma_f32_16x16x32_bf16 v[136:139], a[4:7], a[96:99], v[136:139]
 s_waitcnt lgkmcnt(4)
 v_add_f32 v223, v149, v223
 v_add_f32 v223, v150, v223
 v_mfma_f32_16x16x32_bf16 v[128:131], a[8:11], a[104:107], v[128:131]
 ds_read_b128 a[28:31], v195 offset:61952
 v_add_f32 v223, v151, v223
 v_mfma_f32_16x16x32_bf16 v[132:135], a[8:11], a[108:111], v[132:135]
 s_waitcnt lgkmcnt(4)
 v_add_f32 v223, v156, v223
 v_add_f32 v223, v157, v223
 v_mfma_f32_16x16x32_bf16 v[140:143], a[12:15], a[108:111], v[140:143]
 ds_read_b64_tr_b16 a[0:1], v206 offset:0
 ds_read_b64_tr_b16 a[2:3], v206 offset:512
 v_mfma_f32_16x16x32_bf16 v[136:139], a[12:15], a[104:107], v[136:139]
 s_waitcnt lgkmcnt(5)
 v_add_f32 v223, v158, v223
 v_add_f32 v223, v159, v223
 v_mfma_f32_16x16x32_bf16 v[128:131], a[16:19], a[112:115], v[128:131]
 ds_read_b64_tr_b16 a[4:5], v207 offset:0
 ds_read_b64_tr_b16 a[6:7], v207 offset:512
 v_mfma_f32_16x16x32_bf16 v[132:135], a[16:19], a[116:119], v[132:135]
 s_waitcnt lgkmcnt(6)
 buffer_load_dwordx4 v212, s[8:11], s34 offen offset:2048 nt lds
 v_mfma_f32_16x16x32_bf16 v[140:143], a[20:23], a[116:119], v[140:143]
 ds_read_b64_tr_b16 a[8:9], v208 offset:0
 ds_read_b64_tr_b16 a[10:11], v208 offset:512
 v_mfma_f32_16x16x32_bf16 v[136:139], a[20:23], a[112:115], v[136:139]
 s_waitcnt lgkmcnt(7)
 v_mfma_f32_16x16x32_bf16 v[128:131], a[24:27], a[120:123], v[128:131]
 ds_read_b64_tr_b16 a[12:13], v209 offset:0
 ds_read_b64_tr_b16 a[14:15], v209 offset:512
 v_mfma_f32_16x16x32_bf16 v[132:135], a[24:27], a[124:127], v[132:135]
 s_waitcnt lgkmcnt(8)
 v_mfma_f32_16x16x32_bf16 v[140:143], a[28:31], a[124:127], v[140:143]
 ds_read_b64_tr_b16 a[16:17], v206 offset:4096
 ds_read_b64_tr_b16 a[18:19], v206 offset:4608
 v_mfma_f32_16x16x32_bf16 v[136:139], a[28:31], a[120:123], v[136:139]
 s_waitcnt lgkmcnt(8)
 v_mfma_f32_16x16x32_bf16 v[0:3], a[0:3], v[160:163], v[0:3]
 ds_read_b64_tr_b16 a[20:21], v207 offset:4096
 ds_read_b64_tr_b16 a[22:23], v207 offset:4608
 v_mfma_f32_16x16x32_bf16 v[4:7], a[0:3], v[164:167], v[4:7]
 s_waitcnt vmcnt(20) lgkmcnt(8)
 buffer_load_dwordx4 v213, s[8:11], s34 offen offset:3072 nt lds
 v_max3_f32 v224, v128, v129, v130
 v_mfma_f32_16x16x32_bf16 v[12:15], a[4:7], v[164:167], v[12:15]
 s_barrier
 ds_read_b64_tr_b16 a[24:25], v208 offset:4096
 ds_read_b64_tr_b16 a[26:27], v208 offset:4608
 v_mfma_f32_16x16x32_bf16 v[8:11], a[4:7], v[160:163], v[8:11]
 s_waitcnt lgkmcnt(8)
 v_max3_f32 v224, v131, v132, v224
 v_max3_f32 v224, v133, v134, v224
 v_mfma_f32_16x16x32_bf16 v[16:19], a[8:11], v[160:163], v[16:19]
 s_add_u32 m0, s33, 98304
 ds_read_b64_tr_b16 a[28:29], v209 offset:4096
 ds_read_b64_tr_b16 a[30:31], v209 offset:4608
 v_mfma_f32_16x16x32_bf16 v[20:23], a[8:11], v[164:167], v[20:23]
 s_waitcnt lgkmcnt(8)
 v_max3_f32 v224, v135, v136, v224
 v_max3_f32 v224, v137, v138, v224
 v_mfma_f32_16x16x32_bf16 v[28:31], a[12:15], v[164:167], v[28:31]
 s_mov_b32 s34, 245760
 ds_read_b64_tr_b16 a[0:1], v206 offset:8192
 ds_read_b64_tr_b16 a[2:3], v206 offset:8704
 v_mfma_f32_16x16x32_bf16 v[24:27], a[12:15], v[160:163], v[24:27]
 s_waitcnt lgkmcnt(8)
 v_max3_f32 v224, v139, v140, v224
 v_max3_f32 v224, v141, v142, v224
 v_mfma_f32_16x16x32_bf16 v[32:35], a[16:19], v[160:163], v[32:35]
 ds_read_b64_tr_b16 a[4:5], v207 offset:8192
 ds_read_b64_tr_b16 a[6:7], v207 offset:8704
 v_mfma_f32_16x16x32_bf16 v[36:39], a[16:19], v[164:167], v[36:39]
 s_waitcnt lgkmcnt(8)
 buffer_load_dwordx4 v210, s[12:15], s34 offen nt lds
 v_max_f32 v224, v143, v224
 v_mfma_f32_16x16x32_bf16 v[44:47], a[20:23], v[164:167], v[44:47]
 ds_read_b64_tr_b16 a[8:9], v208 offset:8192
 ds_read_b64_tr_b16 a[10:11], v208 offset:8704
 v_mfma_f32_16x16x32_bf16 v[40:43], a[20:23], v[160:163], v[40:43]
 s_waitcnt lgkmcnt(8)
 v_cmp_lt_f32 vcc, s35, v224
 v_mfma_f32_16x16x32_bf16 v[48:51], a[24:27], v[160:163], v[48:51]
 s_cbranch_vccnz L_stub11
L_ret11:
 ds_read_b64_tr_b16 a[12:13], v209 offset:8192
 ds_read_b64_tr_b16 a[14:15], v209 offset:8704
 v_mfma_f32_16x16x32_bf16 v[52:55], a[24:27], v[164:167], v[52:55]
 s_waitcnt lgkmcnt(8)
 v_exp_f32 v128, v128
 v_mfma_f32_16x16x32_bf16 v[60:63], a[28:31], v[164:167], v[60:63]
 ds_read_b64_tr_b16 a[16:17], v206 offset:12288
 ds_read_b64_tr_b16 a[18:19], v206 offset:12800
 v_mfma_f32_16x16x32_bf16 v[56:59], a[28:31], v[160:163], v[56:59]
 s_waitcnt lgkmcnt(8)
 v_exp_f32 v129, v129
 v_mfma_f32_16x16x32_bf16 v[64:67], a[0:3], v[160:163], v[64:67]
 ds_read_b64_tr_b16 a[20:21], v207 offset:12288
 ds_read_b64_tr_b16 a[22:23], v207 offset:12800
 v_mfma_f32_16x16x32_bf16 v[68:71], a[0:3], v[164:167], v[68:71]
 s_waitcnt lgkmcnt(8)
 buffer_load_dwordx4 v211, s[12:15], s34 offen offset:1024 nt lds
 v_add_f32 v222, v128, v222
 v_mfma_f32_16x16x32_bf16 v[76:79], a[4:7], v[164:167], v[76:79]
 ds_read_b64_tr_b16 a[24:25], v208 offset:12288
 ds_read_b64_tr_b16 a[26:27], v208 offset:12800
 v_mfma_f32_16x16x32_bf16 v[72:75], a[4:7], v[160:163], v[72:75]
 s_waitcnt lgkmcnt(8)
 v_exp_f32 v130, v130
 v_mfma_f32_16x16x32_bf16 v[80:83], a[8:11], v[160:163], v[80:83]
 ds_read_b64_tr_b16 a[28:29], v209 offset:12288
 ds_read_b64_tr_b16 a[30:31], v209 offset:12800
 v_mfma_f32_16x16x32_bf16 v[84:87], a[8:11], v[164:167], v[84:87]
 s_waitcnt lgkmcnt(8)
 v_exp_f32 v131, v131
 v_mfma_f32_16x16x32_bf16 v[92:95], a[12:15], v[164:167], v[92:95]
 ds_read_b128 a[0:3], v196 offset:16384
 v_add_f32 v222, v129, v222
 v_mfma_f32_16x16x32_bf16 v[88:91], a[12:15], v[160:163], v[88:91]
 s_waitcnt lgkmcnt(7)
 v_exp_f32 v136, v136
 v_mfma_f32_16x16x32_bf16 v[96:99], a[16:19], v[160:163], v[96:99]
 ds_read_b128 a[4:7], v196 offset:16896
 buffer_load_dwordx4 v212, s[12:15], s34 offen offset:2048 nt lds
 v_mfma_f32_16x16x32_bf16 v[100:103], a[16:19], v[164:167], v[100:103]
 s_waitcnt lgkmcnt(6)
 v_exp_f32 v137, v137
 v_mfma_f32_16x16x32_bf16 v[108:111], a[20:23], v[164:167], v[108:111]
 ds_read_b128 a[8:11], v197 offset:16384
 v_add_f32 v222, v130, v222
 v_mfma_f32_16x16x32_bf16 v[104:107], a[20:23], v[160:163], v[104:107]
 s_waitcnt lgkmcnt(5)
 v_exp_f32 v138, v138
 v_mfma_f32_16x16x32_bf16 v[112:115], a[24:27], v[160:163], v[112:115]
 ds_read_b128 a[12:15], v197 offset:16896
 v_add_f32 v222, v131, v222
 v_mfma_f32_16x16x32_bf16 v[116:119], a[24:27], v[164:167], v[116:119]
 s_waitcnt lgkmcnt(4)
 v_exp_f32 v139, v139
 v_mfma_f32_16x16x32_bf16 v[124:127], a[28:31], v[164:167], v[124:127]
 ds_read_b128 a[16:19], v196 offset:20480
 v_add_f32 v222, v136, v222
 v_mfma_f32_16x16x32_bf16 v[120:123], a[28:31], v[160:163], v[120:123]
 s_waitcnt lgkmcnt(4)
 buffer_load_dwordx4 v213, s[12:15], s34 offen offset:3072 nt lds
 v_add_f32 v222, v137, v222
 v_mfma_f32_16x16x32_bf16 v[144:147], a[0:3], a[64:67], v[168:171]
 s_add_u32 m0, s33, 114688
 ds_read_b128 a[20:23], v196 offset:20992
 v_cvt_pk_bf16_f32 v160, v128, v129
 v_mfma_f32_16x16x32_bf16 v[148:151], a[0:3], a[68:71], v[172:175]
 s_waitcnt lgkmcnt(4)
 v_exp_f32 v132, v132
 v_mfma_f32_16x16x32_bf16 v[156:159], a[4:7], a[68:71], v[172:175]
 s_mov_b32 s34, 278528
 ds_read_b128 a[24:27], v197 offset:20480
 v_cvt_pk_bf16_f32 v161, v130, v131
 v_mfma_f32_16x16x32_bf16 v[152:155], a[4:7], a[64:67], v[168:171]
 s_waitcnt lgkmcnt(4)
 v_exp_f32 v133, v133
 v_mfma_f32_16x16x32_bf16 v[144:147], a[8:11], a[72:75], v[144:147]
 ds_read_b128 a[28:31], v197 offset:20992
 v_cvt_pk_bf16_f32 v162, v136, v137
 v_mfma_f32_16x16x32_bf16 v[148:151], a[8:11], a[76:79], v[148:151]
 s_waitcnt lgkmcnt(4)
 v_exp_f32 v134, v134
 v_mfma_f32_16x16x32_bf16 v[156:159], a[12:15], a[76:79], v[156:159]
 ds_read_b128 a[0:3], v196 offset:24576
 buffer_load_dwordx4 v210, s[8:11], s34 offen nt lds
 v_mfma_f32_16x16x32_bf16 v[152:155], a[12:15], a[72:75], v[152:155]
 s_waitcnt lgkmcnt(4)
 v_exp_f32 v135, v135
 v_mfma_f32_16x16x32_bf16 v[144:147], a[16:19], a[80:83], v[144:147]
 ds_read_b128 a[4:7], v196 offset:25088
 v_cvt_pk_bf16_f32 v163, v138, v139
 v_mfma_f32_16x16x32_bf16 v[148:151], a[16:19], a[84:87], v[148:151]
 s_waitcnt lgkmcnt(4)
 v_exp_f32 v140, v140
 v_mfma_f32_16x16x32_bf16 v[156:159], a[20:23], a[84:87], v[156:159]
 ds_read_b128 a[8:11], v197 offset:24576
 v_cvt_pk_bf16_f32 v164, v132, v133
 v_mfma_f32_16x16x32_bf16 v[152:155], a[20:23], a[80:83], v[152:155]
 s_waitcnt lgkmcnt(4)
 v_exp_f32 v141, v141
 v_mfma_f32_16x16x32_bf16 v[144:147], a[24:27], a[88:91], v[144:147]
 ds_read_b128 a[12:15], v197 offset:25088
 v_cvt_pk_bf16_f32 v165, v134, v135
 v_mfma_f32_16x16x32_bf16 v[148:151], a[24:27], a[92:95], v[148:151]
 s_waitcnt lgkmcnt(4)
 buffer_load_dwordx4 v211, s[8:11], s34 offen offset:1024 nt lds
 v_cvt_pk_bf16_f32 v166, v140, v141
 v_mfma_f32_16x16x32_bf16 v[156:159], a[28:31], a[92:95], v[156:159]
 ds_read_b128 a[16:19], v196 offset:28672
 v_add_f32 v222, v138, v222
 v_mfma_f32_16x16x32_bf16 v[152:155], a[28:31], a[88:91], v[152:155]
 s_waitcnt lgkmcnt(4)
 v_exp_f32 v142, v142
 v_mfma_f32_16x16x32_bf16 v[144:147], a[0:3], a[96:99], v[144:147]
 ds_read_b128 a[20:23], v196 offset:29184
 v_add_f32 v222, v139, v222
 v_mfma_f32_16x16x32_bf16 v[148:151], a[0:3], a[100:103], v[148:151]
 s_waitcnt lgkmcnt(4)
 v_exp_f32 v143, v143
 v_mfma_f32_16x16x32_bf16 v[156:159], a[4:7], a[100:103], v[156:159]
 ds_read_b128 a[24:27], v197 offset:28672
 v_cvt_pk_bf16_f32 v167, v142, v143
 v_mfma_f32_16x16x32_bf16 v[152:155], a[4:7], a[96:99], v[152:155]
 s_waitcnt lgkmcnt(4)
 v_add_f32 v223, v132, v223
 v_add_f32 v223, v133, v223
 v_mfma_f32_16x16x32_bf16 v[144:147], a[8:11], a[104:107], v[144:147]
 ds_read_b128 a[28:31], v197 offset:29184
 buffer_load_dwordx4 v212, s[8:11], s34 offen offset:2048 nt lds
 v_mfma_f32_16x16x32_bf16 v[148:151], a[8:11], a[108:111], v[148:151]
 s_waitcnt lgkmcnt(4)
 v_add_f32 v223, v134, v223
 v_add_f32 v223, v135, v223
 v_mfma_f32_16x16x32_bf16 v[156:159], a[12:15], a[108:111], v[156:159]
 ds_read_b64_tr_b16 a[0:1], v198 offset:0
 ds_read_b64_tr_b16 a[2:3], v198 offset:512
 v_mfma_f32_16x16x32_bf16 v[152:155], a[12:15], a[104:107], v[152:155]
 s_waitcnt lgkmcnt(5)
 v_add_f32 v223, v140, v223
 v_add_f32 v223, v141, v223
 v_mfma_f32_16x16x32_bf16 v[144:147], a[16:19], a[112:115], v[144:147]
 ds_read_b64_tr_b16 a[4:5], v199 offset:0
 ds_read_b64_tr_b16 a[6:7], v199 offset:512
 v_mfma_f32_16x16x32_bf16 v[148:151], a[16:19], a[116:119], v[148:151]
 s_waitcnt lgkmcnt(6)
 v_add_f32 v223, v142, v223
 v_add_f32 v223, v143, v223
 v_mfma_f32_16x16x32_bf16 v[156:159], a[20:23], a[116:119], v[156:159]
 ds_read_b64_tr_b16 a[8:9], v200 offset:0
 ds_read_b64_tr_b16 a[10:11], v200 offset:512
 v_mfma_f32_16x16x32_bf16 v[152:155], a[20:23], a[112:115], v[152:155]
 s_waitcnt lgkmcnt(7)
 buffer_load_dwordx4 v213, s[8:11], s34 offen offset:3072 nt lds
 v_mfma_f32_16x16x32_bf16 v[144:147], a[24:27], a[120:123], v[144:147]
 ds_read_b64_tr_b16 a[12:13], v201 offset:0
 ds_read_b64_tr_b16 a[14:15], v201 offset:512
 v_mfma_f32_16x16x32_bf16 v[148:151], a[24:27], a[124:127], v[148:151]
 s_waitcnt lgkmcnt(8)
 v_mfma_f32_16x16x32_bf16 v[156:159], a[28:31], a[124:127], v[156:159]
 ds_read_b64_tr_b16 a[16:17], v198 offset:4096
 ds_read_b64_tr_b16 a[18:19], v198 offset:4608
 v_mfma_f32_16x16x32_bf16 v[152:155], a[28:31], a[120:123], v[152:155]
 s_waitcnt lgkmcnt(8)
 v_mfma_f32_16x16x32_bf16 v[0:3], a[0:3], v[160:163], v[0:3]
 s_add_u32 s92, s54, 40960
 s_addc_u32 s93, s55, 0
 ds_read_b64_tr_b16 a[20:21], v199 offset:4096
 ds_read_b64_tr_b16 a[22:23], v199 offset:4608
 v_mfma_f32_16x16x32_bf16 v[4:7], a[0:3], v[164:167], v[4:7]
 s_waitcnt vmcnt(20) lgkmcnt(8)
 global_load_dword v252, v245, s[92:93]
 v_max3_f32 v224, v144, v145, v146
 v_mfma_f32_16x16x32_bf16 v[12:15], a[4:7], v[164:167], v[12:15]
 s_barrier
 ds_read_b64_tr_b16 a[24:25], v200 offset:4096
 ds_read_b64_tr_b16 a[26:27], v200 offset:4608
 v_mfma_f32_16x16x32_bf16 v[8:11], a[4:7], v[160:163], v[8:11]
 s_waitcnt lgkmcnt(8)
 v_max3_f32 v224, v147, v148, v224
 v_max3_f32 v224, v149, v150, v224
 v_mfma_f32_16x16x32_bf16 v[16:19], a[8:11], v[160:163], v[16:19]
 s_add_u32 m0, s33, 131072
 ds_read_b64_tr_b16 a[28:29], v201 offset:4096
 ds_read_b64_tr_b16 a[30:31], v201 offset:4608
 v_mfma_f32_16x16x32_bf16 v[20:23], a[8:11], v[164:167], v[20:23]
 s_waitcnt lgkmcnt(8)
 v_max3_f32 v224, v151, v152, v224
 v_max3_f32 v224, v153, v154, v224
 v_mfma_f32_16x16x32_bf16 v[28:31], a[12:15], v[164:167], v[28:31]
 s_mov_b32 s34, 262144
 ds_read_b64_tr_b16 a[0:1], v198 offset:8192
 ds_read_b64_tr_b16 a[2:3], v198 offset:8704
 v_mfma_f32_16x16x32_bf16 v[24:27], a[12:15], v[160:163], v[24:27]
 s_waitcnt lgkmcnt(8)
 buffer_load_dwordx4 v210, s[12:15], s34 offen nt lds
 v_max3_f32 v224, v155, v156, v224
 v_mfma_f32_16x16x32_bf16 v[32:35], a[16:19], v[160:163], v[32:35]
 ds_read_b64_tr_b16 a[4:5], v199 offset:8192
 ds_read_b64_tr_b16 a[6:7], v199 offset:8704
 v_mfma_f32_16x16x32_bf16 v[36:39], a[16:19], v[164:167], v[36:39]
 s_waitcnt lgkmcnt(8)
 v_max3_f32 v224, v157, v158, v224
 v_max_f32 v224, v159, v224
 v_mfma_f32_16x16x32_bf16 v[44:47], a[20:23], v[164:167], v[44:47]
 ds_read_b64_tr_b16 a[8:9], v200 offset:8192
 ds_read_b64_tr_b16 a[10:11], v200 offset:8704
 v_mfma_f32_16x16x32_bf16 v[40:43], a[20:23], v[160:163], v[40:43]
 s_waitcnt lgkmcnt(8)
 v_cmp_lt_f32 vcc, s35, v224
 v_mfma_f32_16x16x32_bf16 v[48:51], a[24:27], v[160:163], v[48:51]
 s_cbranch_vccnz L_stub12
L_ret12:
 ds_read_b64_tr_b16 a[12:13], v201 offset:8192
 ds_read_b64_tr_b16 a[14:15], v201 offset:8704
 v_mfma_f32_16x16x32_bf16 v[52:55], a[24:27], v[164:167], v[52:55]
 s_waitcnt lgkmcnt(8)
 v_exp_f32 v144, v144
 v_mfma_f32_16x16x32_bf16 v[60:63], a[28:31], v[164:167], v[60:63]
 ds_read_b64_tr_b16 a[16:17], v198 offset:12288
 ds_read_b64_tr_b16 a[18:19], v198 offset:12800
 v_mfma_f32_16x16x32_bf16 v[56:59], a[28:31], v[160:163], v[56:59]
 s_waitcnt lgkmcnt(8)
 buffer_load_dwordx4 v211, s[12:15], s34 offen offset:1024 nt lds
 v_add_f32 v222, v144, v222
 v_mfma_f32_16x16x32_bf16 v[64:67], a[0:3], v[160:163], v[64:67]
 ds_read_b64_tr_b16 a[20:21], v199 offset:12288
 ds_read_b64_tr_b16 a[22:23], v199 offset:12800
 v_mfma_f32_16x16x32_bf16 v[68:71], a[0:3], v[164:167], v[68:71]
 s_waitcnt lgkmcnt(8)
 v_exp_f32 v145, v145
 v_mfma_f32_16x16x32_bf16 v[76:79], a[4:7], v[164:167], v[76:79]
 ds_read_b64_tr_b16 a[24:25], v200 offset:12288
 ds_read_b64_tr_b16 a[26:27], v200 offset:12800
 v_mfma_f32_16x16x32_bf16 v[72:75], a[4:7], v[160:163], v[72:75]
 s_waitcnt lgkmcnt(8)
 v_exp_f32 v146, v146
 v_mfma_f32_16x16x32_bf16 v[80:83], a[8:11], v[160:163], v[80:83]
 ds_read_b64_tr_b16 a[28:29], v201 offset:12288
 ds_read_b64_tr_b16 a[30:31], v201 offset:12800
 v_mfma_f32_16x16x32_bf16 v[84:87], a[8:11], v[164:167], v[84:87]
 s_waitcnt lgkmcnt(8)
 v_exp_f32 v147, v147
 v_mfma_f32_16x16x32_bf16 v[92:95], a[12:15], v[164:167], v[92:95]
 ds_read_b128 a[0:3], v192 offset:16384
 buffer_load_dwordx4 v212, s[12:15], s34 offen offset:2048 nt lds
 v_mfma_f32_16x16x32_bf16 v[88:91], a[12:15], v[160:163], v[88:91]
 s_waitcnt lgkmcnt(7)
 v_exp_f32 v152, v152
 v_mfma_f32_16x16x32_bf16 v[96:99], a[16:19], v[160:163], v[96:99]
 ds_read_b128 a[4:7], v192 offset:16896
 v_add_f32 v222, v145, v222
 v_mfma_f32_16x16x32_bf16 v[100:103], a[16:19], v[164:167], v[100:103]
 s_waitcnt lgkmcnt(6)
 v_exp_f32 v153, v153
 v_mfma_f32_16x16x32_bf16 v[108:111], a[20:23], v[164:167], v[108:111]
 ds_read_b128 a[8:11], v193 offset:16384
 v_add_f32 v222, v146, v222
 v_mfma_f32_16x16x32_bf16 v[104:107], a[20:23], v[160:163], v[104:107]
 s_waitcnt lgkmcnt(5)
 v_exp_f32 v154, v154
 v_mfma_f32_16x16x32_bf16 v[112:115], a[24:27], v[160:163], v[112:115]
 ds_read_b128 a[12:15], v193 offset:16896
 v_add_f32 v222, v147, v222
 v_mfma_f32_16x16x32_bf16 v[116:119], a[24:27], v[164:167], v[116:119]
 s_waitcnt lgkmcnt(4)
 buffer_load_dwordx4 v213, s[12:15], s34 offen offset:3072 nt lds
 v_add_f32 v222, v152, v222
 v_mfma_f32_16x16x32_bf16 v[124:127], a[28:31], v[164:167], v[124:127]
 s_add_u32 m0, s33, 147456
 ds_read_b128 a[16:19], v192 offset:20480
 v_add_f32 v222, v153, v222
 v_mfma_f32_16x16x32_bf16 v[120:123], a[28:31], v[160:163], v[120:123]
 s_waitcnt lgkmcnt(4)
 v_exp_f32 v155, v155
 v_mfma_f32_16x16x32_bf16 v[128:131], a[0:3], a[64:67], v[168:171]
 s_mov_b32 s34, 294912
 ds_read_b128 a[20:23], v192 offset:20992
 v_cvt_pk_bf16_f32 v160, v144, v145
 v_mfma_f32_16x16x32_bf16 v[132:135], a[0:3], a[68:71], v[172:175]
 s_waitcnt lgkmcnt(4)
 v_exp_f32 v148, v148
 v_mfma_f32_16x16x32_bf16 v[140:143], a[4:7], a[68:71], v[172:175]
 ds_read_b128 a[24:27], v193 offset:20480
 v_cvt_pk_bf16_f32 v161, v146, v147
 v_mfma_f32_16x16x32_bf16 v[136:139], a[4:7], a[64:67], v[168:171]
 s_waitcnt lgkmcnt(4)
 v_exp_f32 v149, v149
 v_mfma_f32_16x16x32_bf16 v[128:131], a[8:11], a[72:75], v[128:131]
 ds_read_b128 a[28:31], v193 offset:20992
 buffer_load_dwordx4 v210, s[8:11], s34 offen nt lds
 v_mfma_f32_16x16x32_bf16 v[132:135], a[8:11], a[76:79], v[132:135]
 s_waitcnt lgkmcnt(4)
 v_exp_f32 v150, v150
 v_mfma_f32_16x16x32_bf16 v[140:143], a[12:15], a[76:79], v[140:143]
 ds_read_b128 a[0:3], v192 offset:24576
 v_cvt_pk_bf16_f32 v162, v152, v153
 v_mfma_f32_16x16x32_bf16 v[136:139], a[12:15], a[72:75], v[136:139]
 s_waitcnt lgkmcnt(4)
 v_exp_f32 v151, v151
 v_mfma_f32_16x16x32_bf16 v[128:131], a[16:19], a[80:83], v[128:131]
 ds_read_b128 a[4:7], v192 offset:25088
 v_cvt_pk_bf16_f32 v163, v154, v155
 v_mfma_f32_16x16x32_bf16 v[132:135], a[16:19], a[84:87], v[132:135]
 s_waitcnt lgkmcnt(4)
 v_exp_f32 v156, v156
 v_mfma_f32_16x16x32_bf16 v[140:143], a[20:23], a[84:87], v[140:143]
 ds_read_b128 a[8:11], v193 offset:24576
 v_cvt_pk_bf16_f32 v164, v148, v149
 v_mfma_f32_16x16x32_bf16 v[136:139], a[20:23], a[80:83], v[136:139]
 s_waitcnt lgkmcnt(4)
 buffer_load_dwordx4 v211, s[8:11], s34 offen offset:1024 nt lds
 v_cvt_pk_bf16_f32 v165, v150, v151
 v_mfma_f32_16x16x32_bf16 v[128:131], a[24:27], a[88:91], v[128:131]
 ds_read_b128 a[12:15], v193 offset:25088
 v_add_f32 v222, v154, v222
 v_mfma_f32_16x16x32_bf16 v[132:135], a[24:27], a[92:95], v[132:135]
 s_waitcnt lgkmcnt(4)
 v_exp_f32 v157, v157
 v_mfma_f32_16x16x32_bf16 v[140:143], a[28:31], a[92:95], v[140:143]
 ds_read_b128 a[16:19], v192 offset:28672
 v_cvt_pk_bf16_f32 v166, v156, v157
 v_mfma_f32_16x16x32_bf16 v[136:139], a[28:31], a[88:91], v[136:139]
 s_waitcnt lgkmcnt(4)
 v_exp_f32 v158, v158
 v_mfma_f32_16x16x32_bf16 v[128:131], a[0:3], a[96:99], v[128:131]
 ds_read_b128 a[20:23], v192 offset:29184
 v_add_f32 v222, v155, v222
 v_mfma_f32_16x16x32_bf16 v[132:135], a[0:3], a[100:103], v[132:135]
 s_waitcnt lgkmcnt(4)
 v_exp_f32 v159, v159
 v_mfma_f32_16x16x32_bf16 v[140:143], a[4:7], a[100:103], v[140:143]
 ds_read_b128 a[24:27], v193 offset:28672
 buffer_load_dwordx4 v212, s[8:11], s34 offen offset:2048 nt lds
 v_mfma_f32_16x16x32_bf16 v[136:139], a[4:7], a[96:99], v[136:139]
 s_waitcnt lgkmcnt(4)
 v_cvt_pk_bf16_f32 v167, v158, v159
 v_add_f32 v223, v148, v223
 v_mfma_f32_16x16x32_bf16 v[128:131], a[8:11], a[104:107], v[128:131]
 ds_read_b128 a[28:31], v193 offset:29184
 v_add_f32 v223, v149, v223
 v_mfma_f32_16x16x32_bf16 v[132:135], a[8:11], a[108:111], v[132:135]
 s_waitcnt lgkmcnt(4)
 v_add_f32 v223, v150, v223
 v_add_f32 v223, v151, v223
 v_mfma_f32_16x16x32_bf16 v[140:143], a[12:15], a[108:111], v[140:143]
 ds_read_b64_tr_b16 a[0:1], v198 offset:32768
 ds_read_b64_tr_b16 a[2:3], v198 offset:33280
 v_mfma_f32_16x16x32_bf16 v[136:139], a[12:15], a[104:107], v[136:139]
 s_waitcnt lgkmcnt(5)
 v_add_f32 v223, v156, v223
 v_add_f32 v223, v157, v223
 v_mfma_f32_16x16x32_bf16 v[128:131], a[16:19], a[112:115], v[128:131]
 ds_read_b64_tr_b16 a[4:5], v199 offset:32768
 ds_read_b64_tr_b16 a[6:7], v199 offset:33280
 v_mfma_f32_16x16x32_bf16 v[132:135], a[16:19], a[116:119], v[132:135]
 s_waitcnt lgkmcnt(6)
 buffer_load_dwordx4 v213, s[8:11], s34 offen offset:3072 nt lds
 v_add_f32 v223, v158, v223
 v_mfma_f32_16x16x32_bf16 v[140:143], a[20:23], a[116:119], v[140:143]
 ds_read_b64_tr_b16 a[8:9], v200 offset:32768
 ds_read_b64_tr_b16 a[10:11], v200 offset:33280
 v_mfma_f32_16x16x32_bf16 v[136:139], a[20:23], a[112:115], v[136:139]
 s_waitcnt lgkmcnt(7)
 v_add_f32 v223, v159, v223
 v_mfma_f32_16x16x32_bf16 v[128:131], a[24:27], a[120:123], v[128:131]
 ds_read_b64_tr_b16 a[12:13], v201 offset:32768
 ds_read_b64_tr_b16 a[14:15], v201 offset:33280
 v_mfma_f32_16x16x32_bf16 v[132:135], a[24:27], a[124:127], v[132:135]
 s_waitcnt lgkmcnt(8)
 v_mfma_f32_16x16x32_bf16 v[140:143], a[28:31], a[124:127], v[140:143]
 ds_read_b64_tr_b16 a[16:17], v198 offset:36864
 ds_read_b64_tr_b16 a[18:19], v198 offset:37376
 v_mfma_f32_16x16x32_bf16 v[136:139], a[28:31], a[120:123], v[136:139]
 s_waitcnt lgkmcnt(8)
 v_mfma_f32_16x16x32_bf16 v[0:3], a[0:3], v[160:163], v[0:3]
 ds_read_b64_tr_b16 a[20:21], v199 offset:36864
 ds_read_b64_tr_b16 a[22:23], v199 offset:37376
 v_mfma_f32_16x16x32_bf16 v[4:7], a[0:3], v[164:167], v[4:7]
 s_waitcnt vmcnt(21) lgkmcnt(8)
 v_max3_f32 v224, v128, v129, v130
 v_max3_f32 v224, v131, v132, v224
 v_mfma_f32_16x16x32_bf16 v[12:15], a[4:7], v[164:167], v[12:15]
 s_barrier
 ds_read_b64_tr_b16 a[24:25], v200 offset:36864
 ds_read_b64_tr_b16 a[26:27], v200 offset:37376
 v_mfma_f32_16x16x32_bf16 v[8:11], a[4:7], v[160:163], v[8:11]
 s_waitcnt lgkmcnt(8)
 v_max3_f32 v224, v133, v134, v224
 v_max3_f32 v224, v135, v136, v224
 v_mfma_f32_16x16x32_bf16 v[16:19], a[8:11], v[160:163], v[16:19]
 s_add_u32 m0, s33, 0
 ds_read_b64_tr_b16 a[28:29], v201 offset:36864
 ds_read_b64_tr_b16 a[30:31], v201 offset:37376
 v_mfma_f32_16x16x32_bf16 v[20:23], a[8:11], v[164:167], v[20:23]
 s_waitcnt lgkmcnt(8)
 v_max3_f32 v224, v137, v138, v224
 v_max3_f32 v224, v139, v140, v224
 v_mfma_f32_16x16x32_bf16 v[28:31], a[12:15], v[164:167], v[28:31]
 s_mov_b32 s34, 278528
 ds_read_b64_tr_b16 a[0:1], v198 offset:40960
 ds_read_b64_tr_b16 a[2:3], v198 offset:41472
 v_mfma_f32_16x16x32_bf16 v[24:27], a[12:15], v[160:163], v[24:27]
 s_waitcnt lgkmcnt(8)
 buffer_load_dwordx4 v210, s[12:15], s34 offen nt lds
 v_max3_f32 v224, v141, v142, v224
 v_mfma_f32_16x16x32_bf16 v[32:35], a[16:19], v[160:163], v[32:35]
 ds_read_b64_tr_b16 a[4:5], v199 offset:40960
 ds_read_b64_tr_b16 a[6:7], v199 offset:41472
 v_mfma_f32_16x16x32_bf16 v[36:39], a[16:19], v[164:167], v[36:39]
 s_waitcnt lgkmcnt(8)
 v_max_f32 v224, v143, v224
 v_cmp_lt_f32 vcc, s35, v224
 v_mfma_f32_16x16x32_bf16 v[44:47], a[20:23], v[164:167], v[44:47]
 s_cbranch_vccnz L_stub13
L_ret13:
 ds_read_b64_tr_b16 a[8:9], v200 offset:40960
 ds_read_b64_tr_b16 a[10:11], v200 offset:41472
 v_mfma_f32_16x16x32_bf16 v[40:43], a[20:23], v[160:163], v[40:43]
 s_waitcnt lgkmcnt(8)
 v_exp_f32 v128, v128
 v_mfma_f32_16x16x32_bf16 v[48:51], a[24:27], v[160:163], v[48:51]
 ds_read_b64_tr_b16 a[12:13], v201 offset:40960
 ds_read_b64_tr_b16 a[14:15], v201 offset:41472
 v_mfma_f32_16x16x32_bf16 v[52:55], a[24:27], v[164:167], v[52:55]
 s_waitcnt lgkmcnt(8)
 v_exp_f32 v129, v129
 v_mfma_f32_16x16x32_bf16 v[60:63], a[28:31], v[164:167], v[60:63]
 ds_read_b64_tr_b16 a[16:17], v198 offset:45056
 ds_read_b64_tr_b16 a[18:19], v198 offset:45568
 v_mfma_f32_16x16x32_bf16 v[56:59], a[28:31], v[160:163], v[56:59]
 s_waitcnt lgkmcnt(8)
 buffer_load_dwordx4 v211, s[12:15], s34 offen offset:1024 nt lds
 v_add_f32 v222, v128, v222
 v_mfma_f32_16x16x32_bf16 v[64:67], a[0:3], v[160:163], v[64:67]
 ds_read_b64_tr_b16 a[20:21], v199 offset:45056
 ds_read_b64_tr_b16 a[22:23], v199 offset:45568
 v_mfma_f32_16x16x32_bf16 v[68:71], a[0:3], v[164:167], v[68:71]
 s_waitcnt lgkmcnt(8)
 v_exp_f32 v130, v130
 v_mfma_f32_16x16x32_bf16 v[76:79], a[4:7], v[164:167], v[76:79]
 ds_read_b64_tr_b16 a[24:25], v200 offset:45056
 ds_read_b64_tr_b16 a[26:27], v200 offset:45568
 v_mfma_f32_16x16x32_bf16 v[72:75], a[4:7], v[160:163], v[72:75]
 s_waitcnt lgkmcnt(8)
 v_exp_f32 v131, v131
 v_mfma_f32_16x16x32_bf16 v[80:83], a[8:11], v[160:163], v[80:83]
 ds_read_b64_tr_b16 a[28:29], v201 offset:45056
 ds_read_b64_tr_b16 a[30:31], v201 offset:45568
 v_mfma_f32_16x16x32_bf16 v[84:87], a[8:11], v[164:167], v[84:87]
 s_waitcnt lgkmcnt(8)
 v_exp_f32 v136, v136
 v_mfma_f32_16x16x32_bf16 v[92:95], a[12:15], v[164:167], v[92:95]
 ds_read_b128 a[0:3], v192 offset:49152
 buffer_load_dwordx4 v212, s[12:15], s34 offen offset:2048 nt lds
 v_mfma_f32_16x16x32_bf16 v[88:91], a[12:15], v[160:163], v[88:91]
 s_waitcnt lgkmcnt(7)
 v_exp_f32 v137, v137
 v_mfma_f32_16x16x32_bf16 v[96:99], a[16:19], v[160:163], v[96:99]
 ds_read_b128 a[4:7], v192 offset:49664
 v_add_f32 v222, v129, v222
 v_mfma_f32_16x16x32_bf16 v[100:103], a[16:19], v[164:167], v[100:103]
 s_waitcnt lgkmcnt(6)
 v_exp_f32 v138, v138
 v_mfma_f32_16x16x32_bf16 v[108:111], a[20:23], v[164:167], v[108:111]
 ds_read_b128 a[8:11], v193 offset:49152
 v_add_f32 v222, v130, v222
 v_mfma_f32_16x16x32_bf16 v[104:107], a[20:23], v[160:163], v[104:107]
 s_waitcnt lgkmcnt(5)
 v_exp_f32 v139, v139
 v_mfma_f32_16x16x32_bf16 v[112:115], a[24:27], v[160:163], v[112:115]
 ds_read_b128 a[12:15], v193 offset:49664
 v_add_f32 v222, v131, v222
 v_mfma_f32_16x16x32_bf16 v[116:119], a[24:27], v[164:167], v[116:119]
 s_waitcnt lgkmcnt(4)
 buffer_load_dwordx4 v213, s[12:15], s34 offen offset:3072 nt lds
 v_add_f32 v222, v136, v222
 v_mfma_f32_16x16x32_bf16 v[124:127], a[28:31], v[164:167], v[124:127]
 s_add_u32 m0, s33, 16384
 ds_read_b128 a[16:19], v192 offset:53248
 v_add_f32 v222, v137, v222
 v_mfma_f32_16x16x32_bf16 v[120:123], a[28:31], v[160:163], v[120:123]
 s_waitcnt lgkmcnt(4)
 v_exp_f32 v132, v132
 v_mfma_f32_16x16x32_bf16 v[144:147], a[0:3], a[64:67], v[168:171]
 s_mov_b32 s34, 311296
 ds_read_b128 a[20:23], v192 offset:53760
 v_cvt_pk_bf16_f32 v160, v128, v129
 v_mfma_f32_16x16x32_bf16 v[148:151], a[0:3], a[68:71], v[172:175]
 s_waitcnt lgkmcnt(4)
 v_exp_f32 v133, v133
 v_mfma_f32_16x16x32_bf16 v[156:159], a[4:7], a[68:71], v[172:175]
 ds_read_b128 a[24:27], v193 offset:53248
 v_cvt_pk_bf16_f32 v161, v130, v131
 v_mfma_f32_16x16x32_bf16 v[152:155], a[4:7], a[64:67], v[168:171]
 s_waitcnt lgkmcnt(4)
 v_exp_f32 v134, v134
 v_mfma_f32_16x16x32_bf16 v[144:147], a[8:11], a[72:75], v[144:147]
 ds_read_b128 a[28:31], v193 offset:53760
 buffer_load_dwordx4 v210, s[8:11], s34 offen nt lds
 v_mfma_f32_16x16x32_bf16 v[148:151], a[8:11], a[76:79], v[148:151]
 s_waitcnt lgkmcnt(4)
 v_exp_f32 v135, v135
 v_mfma_f32_16x16x32_bf16 v[156:159], a[12:15], a[76:79], v[156:159]
 ds_read_b128 a[0:3], v192 offset:57344
 v_cvt_pk_bf16_f32 v162, v136, v137
 v_mfma_f32_16x16x32_bf16 v[152:155], a[12:15], a[72:75], v[152:155]
 s_waitcnt lgkmcnt(4)
 v_exp_f32 v140, v140
 v_mfma_f32_16x16x32_bf16 v[144:147], a[16:19], a[80:83], v[144:147]
 ds_read_b128 a[4:7], v192 offset:57856
 v_cvt_pk_bf16_f32 v163, v138, v139
 v_mfma_f32_16x16x32_bf16 v[148:151], a[16:19], a[84:87], v[148:151]
 s_waitcnt lgkmcnt(4)
 v_exp_f32 v141, v141
 v_mfma_f32_16x16x32_bf16 v[156:159], a[20:23], a[84:87], v[156:159]
 ds_read_b128 a[8:11], v193 offset:57344
 v_cvt_pk_bf16_f32 v164, v132, v133
 v_mfma_f32_16x16x32_bf16 v[152:155], a[20:23], a[80:83], v[152:155]
 s_waitcnt lgkmcnt(4)
 buffer_load_dwordx4 v211, s[8:11], s34 offen offset:1024 nt lds
 v_cvt_pk_bf16_f32 v165, v134, v135
 v_mfma_f32_16x16x32_bf16 v[144:147], a[24:27], a[88:91], v[144:147]
 ds_read_b128 a[12:15], v193 offset:57856
 v_cvt_pk_bf16_f32 v166, v140, v141
 v_mfma_f32_16x16x32_bf16 v[148:151], a[24:27], a[92:95], v[148:151]
 s_waitcnt lgkmcnt(4)
 v_exp_f32 v142, v142
 v_mfma_f32_16x16x32_bf16 v[156:159], a[28:31], a[92:95], v[156:159]
 ds_read_b128 a[16:19], v192 offset:61440
 v_add_f32 v222, v138, v222
 v_mfma_f32_16x16x32_bf16 v[152:155], a[28:31], a[88:91], v[152:155]
 s_waitcnt lgkmcnt(4)
 v_exp_f32 v143, v143
 v_mfma_f32_16x16x32_bf16 v[144:147], a[0:3], a[96:99], v[144:147]
 ds_read_b128 a[20:23], v192 offset:61952
 v_cvt_pk_bf16_f32 v167, v142, v143
 v_mfma_f32_16x16x32_bf16 v[148:151], a[0:3], a[100:103], v[148:151]
 s_waitcnt lgkmcnt(4)
 v_add_f32 v222, v139, v222
 v_add_f32 v223, v132, v223
 v_mfma_f32_16x16x32_bf16 v[156:159], a[4:7], a[100:103], v[156:159]
 ds_read_b128 a[24:27], v193 offset:61440
 buffer_load_dwordx4 v212, s[8:11], s34 offen offset:2048 nt lds
 v_mfma_f32_16x16x32_bf16 v[152:155], a[4:7], a[96:99], v[152:155]
 s_waitcnt lgkmcnt(4)
 v_add_f32 v223, v133, v223
 v_add_f32 v223, v134, v223
 v_mfma_f32_16x16x32_bf16 v[144:147], a[8:11], a[104:107], v[144:147]
 ds_read_b128 a[28:31], v193 offset:61952
 v_add_f32 v223, v135, v223
 v_mfma_f32_16x16x32_bf16 v[148:151], a[8:11], a[108:111], v[148:151]
 s_waitcnt lgkmcnt(4)
 v_add_f32 v223, v140, v223
 v_add_f32 v223, v141, v223
 v_mfma_f32_16x16x32_bf16 v[156:159], a[12:15], a[108:111], v[156:159]
 ds_read_b64_tr_b16 a[0:1], v202 offset:0
 ds_read_b64_tr_b16 a[2:3], v202 offset:512
 v_mfma_f32_16x16x32_bf16 v[152:155], a[12:15], a[104:107], v[152:155]
 s_waitcnt lgkmcnt(5)
 v_add_f32 v223, v142, v223
 v_add_f32 v223, v143, v223
 v_mfma_f32_16x16x32_bf16 v[144:147], a[16:19], a[112:115], v[144:147]
 ds_read_b64_tr_b16 a[4:5], v203 offset:0
 ds_read_b64_tr_b16 a[6:7], v203 offset:512
 v_mfma_f32_16x16x32_bf16 v[148:151], a[16:19], a[116:119], v[148:151]
 s_waitcnt lgkmcnt(6)
 buffer_load_dwordx4 v213, s[8:11], s34 offen offset:3072 nt lds
 v_mfma_f32_16x16x32_bf16 v[156:159], a[20:23], a[116:119], v[156:159]
 ds_read_b64_tr_b16 a[8:9], v204 offset:0
 ds_read_b64_tr_b16 a[10:11], v204 offset:512
 v_mfma_f32_16x16x32_bf16 v[152:155], a[20:23], a[112:115], v[152:155]
 s_waitcnt lgkmcnt(7)
 v_mfma_f32_16x16x32_bf16 v[144:147], a[24:27], a[120:123], v[144:147]
 ds_read_b64_tr_b16 a[12:13], v205 offset:0
 ds_read_b64_tr_b16 a[14:15], v205 offset:512
 v_mfma_f32_16x16x32_bf16 v[148:151], a[24:27], a[124:127], v[148:151]
 s_waitcnt lgkmcnt(8)
 v_mfma_f32_16x16x32_bf16 v[156:159], a[28:31], a[124:127], v[156:159]
 ds_read_b64_tr_b16 a[16:17], v202 offset:4096
 ds_read_b64_tr_b16 a[18:19], v202 offset:4608
 v_mfma_f32_16x16x32_bf16 v[152:155], a[28:31], a[120:123], v[152:155]
 s_waitcnt lgkmcnt(8)
 v_mfma_f32_16x16x32_bf16 v[0:3], a[0:3], v[160:163], v[0:3]
 ds_read_b64_tr_b16 a[20:21], v203 offset:4096
 ds_read_b64_tr_b16 a[22:23], v203 offset:4608
 v_mfma_f32_16x16x32_bf16 v[4:7], a[0:3], v[164:167], v[4:7]
 s_waitcnt vmcnt(21) lgkmcnt(8)
 v_max3_f32 v224, v144, v145, v146
 v_max3_f32 v224, v147, v148, v224
 v_mfma_f32_16x16x32_bf16 v[12:15], a[4:7], v[164:167], v[12:15]
 s_barrier
 ds_read_b64_tr_b16 a[24:25], v204 offset:4096
 ds_read_b64_tr_b16 a[26:27], v204 offset:4608
 v_mfma_f32_16x16x32_bf16 v[8:11], a[4:7], v[160:163], v[8:11]
 s_waitcnt lgkmcnt(8)
 v_max3_f32 v224, v149, v150, v224
 v_max3_f32 v224, v151, v152, v224
 v_mfma_f32_16x16x32_bf16 v[16:19], a[8:11], v[160:163], v[16:19]
 s_add_u32 m0, s33, 32768
 ds_read_b64_tr_b16 a[28:29], v205 offset:4096
 ds_read_b64_tr_b16 a[30:31], v205 offset:4608
 v_mfma_f32_16x16x32_bf16 v[20:23], a[8:11], v[164:167], v[20:23]
 s_waitcnt lgkmcnt(8)
 v_max3_f32 v224, v153, v154, v224
 v_max3_f32 v224, v155, v156, v224
 v_mfma_f32_16x16x32_bf16 v[28:31], a[12:15], v[164:167], v[28:31]
 s_mov_b32 s34, 294912
 ds_read_b64_tr_b16 a[0:1], v202 offset:8192
 ds_read_b64_tr_b16 a[2:3], v202 offset:8704
 v_mfma_f32_16x16x32_bf16 v[24:27], a[12:15], v[160:163], v[24:27]
 s_waitcnt lgkmcnt(8)
 buffer_load_dwordx4 v210, s[12:15], s34 offen nt lds
 v_max3_f32 v224, v157, v158, v224
 v_mfma_f32_16x16x32_bf16 v[32:35], a[16:19], v[160:163], v[32:35]
 ds_read_b64_tr_b16 a[4:5], v203 offset:8192
 ds_read_b64_tr_b16 a[6:7], v203 offset:8704
 v_mfma_f32_16x16x32_bf16 v[36:39], a[16:19], v[164:167], v[36:39]
 s_waitcnt lgkmcnt(8)
 v_max_f32 v224, v159, v224
 v_cmp_lt_f32 vcc, s35, v224
 v_mfma_f32_16x16x32_bf16 v[44:47], a[20:23], v[164:167], v[44:47]
 s_cbranch_vccnz L_stub14
L_ret14:
 ds_read_b64_tr_b16 a[8:9], v204 offset:8192
 ds_read_b64_tr_b16 a[10:11], v204 offset:8704
 v_mfma_f32_16x16x32_bf16 v[40:43], a[20:23], v[160:163], v[40:43]
 s_waitcnt lgkmcnt(8)
 v_exp_f32 v144, v144
 v_mfma_f32_16x16x32_bf16 v[48:51], a[24:27], v[160:163], v[48:51]
 ds_read_b64_tr_b16 a[12:13], v205 offset:8192
 ds_read_b64_tr_b16 a[14:15], v205 offset:8704
 v_mfma_f32_16x16x32_bf16 v[52:55], a[24:27], v[164:167], v[52:55]
 s_waitcnt lgkmcnt(8)
 v_exp_f32 v145, v145
 v_mfma_f32_16x16x32_bf16 v[60:63], a[28:31], v[164:167], v[60:63]
 ds_read_b64_tr_b16 a[16:17], v202 offset:12288
 ds_read_b64_tr_b16 a[18:19], v202 offset:12800
 v_mfma_f32_16x16x32_bf16 v[56:59], a[28:31], v[160:163], v[56:59]
 s_waitcnt lgkmcnt(8)
 buffer_load_dwordx4 v211, s[12:15], s34 offen offset:1024 nt lds
 v_add_f32 v222, v144, v222
 v_mfma_f32_16x16x32_bf16 v[64:67], a[0:3], v[160:163], v[64:67]
 ds_read_b64_tr_b16 a[20:21], v203 offset:12288
 ds_read_b64_tr_b16 a[22:23], v203 offset:12800
 v_mfma_f32_16x16x32_bf16 v[68:71], a[0:3], v[164:167], v[68:71]
 s_waitcnt lgkmcnt(8)
 v_exp_f32 v146, v146
 v_mfma_f32_16x16x32_bf16 v[76:79], a[4:7], v[164:167], v[76:79]
 ds_read_b64_tr_b16 a[24:25], v204 offset:12288
 ds_read_b64_tr_b16 a[26:27], v204 offset:12800
 v_mfma_f32_16x16x32_bf16 v[72:75], a[4:7], v[160:163], v[72:75]
 s_waitcnt lgkmcnt(8)
 v_exp_f32 v147, v147
 v_mfma_f32_16x16x32_bf16 v[80:83], a[8:11], v[160:163], v[80:83]
 ds_read_b64_tr_b16 a[28:29], v205 offset:12288
 ds_read_b64_tr_b16 a[30:31], v205 offset:12800
 v_mfma_f32_16x16x32_bf16 v[84:87], a[8:11], v[164:167], v[84:87]
 s_waitcnt lgkmcnt(8)
 v_exp_f32 v152, v152
 v_mfma_f32_16x16x32_bf16 v[92:95], a[12:15], v[164:167], v[92:95]
 ds_read_b128 a[0:3], v194 offset:16384
 buffer_load_dwordx4 v212, s[12:15], s34 offen offset:2048 nt lds
 v_mfma_f32_16x16x32_bf16 v[88:91], a[12:15], v[160:163], v[88:91]
 s_waitcnt lgkmcnt(7)
 v_exp_f32 v153, v153
 v_mfma_f32_16x16x32_bf16 v[96:99], a[16:19], v[160:163], v[96:99]
 ds_read_b128 a[4:7], v194 offset:16896
 v_add_f32 v222, v145, v222
 v_mfma_f32_16x16x32_bf16 v[100:103], a[16:19], v[164:167], v[100:103]
 s_waitcnt lgkmcnt(6)
 v_exp_f32 v154, v154
 v_mfma_f32_16x16x32_bf16 v[108:111], a[20:23], v[164:167], v[108:111]
 ds_read_b128 a[8:11], v195 offset:16384
 v_add_f32 v222, v146, v222
 v_mfma_f32_16x16x32_bf16 v[104:107], a[20:23], v[160:163], v[104:107]
 s_waitcnt lgkmcnt(5)
 v_exp_f32 v155, v155
 v_mfma_f32_16x16x32_bf16 v[112:115], a[24:27], v[160:163], v[112:115]
 ds_read_b128 a[12:15], v195 offset:16896
 v_add_f32 v222, v147, v222
 v_mfma_f32_16x16x32_bf16 v[116:119], a[24:27], v[164:167], v[116:119]
 s_waitcnt lgkmcnt(4)
 buffer_load_dwordx4 v213, s[12:15], s34 offen offset:3072 nt lds
 v_add_f32 v222, v152, v222
 v_mfma_f32_16x16x32_bf16 v[124:127], a[28:31], v[164:167], v[124:127]
 s_add_u32 m0, s33, 49152
 ds_read_b128 a[16:19], v194 offset:20480
 v_add_f32 v222, v153, v222
 v_mfma_f32_16x16x32_bf16 v[120:123], a[28:31], v[160:163], v[120:123]
 s_waitcnt lgkmcnt(4)
 v_exp_f32 v148, v148
 v_mfma_f32_16x16x32_bf16 v[128:131], a[0:3], a[64:67], v[168:171]
 s_mov_b32 s34, 327680
 ds_read_b128 a[20:23], v194 offset:20992
 v_cvt_pk_bf16_f32 v160, v144, v145
 v_mfma_f32_16x16x32_bf16 v[132:135], a[0:3], a[68:71], v[172:175]
 s_waitcnt lgkmcnt(4)
 v_exp_f32 v149, v149
 v_mfma_f32_16x16x32_bf16 v[140:143], a[4:7], a[68:71], v[172:175]
 ds_read_b128 a[24:27], v195 offset:20480
 v_cvt_pk_bf16_f32 v161, v146, v147
 v_mfma_f32_16x16x32_bf16 v[136:139], a[4:7], a[64:67], v[168:171]
 s_waitcnt lgkmcnt(4)
 v_exp_f32 v150, v150
 v_mfma_f32_16x16x32_bf16 v[128:131], a[8:11], a[72:75], v[128:131]
 ds_read_b128 a[28:31], v195 offset:20992
 buffer_load_dwordx4 v210, s[8:11], s34 offen nt lds
 v_mfma_f32_16x16x32_bf16 v[132:135], a[8:11], a[76:79], v[132:135]
 s_waitcnt lgkmcnt(4)
 v_exp_f32 v151, v151
 v_mfma_f32_16x16x32_bf16 v[140:143], a[12:15], a[76:79], v[140:143]
 ds_read_b128 a[0:3], v194 offset:24576
 v_cvt_pk_bf16_f32 v162, v152, v153
 v_mfma_f32_16x16x32_bf16 v[136:139], a[12:15], a[72:75], v[136:139]
 s_waitcnt lgkmcnt(4)
 v_exp_f32 v156, v156
 v_mfma_f32_16x16x32_bf16 v[128:131], a[16:19], a[80:83], v[128:131]
 ds_read_b128 a[4:7], v194 offset:25088
 v_cvt_pk_bf16_f32 v163, v154, v155
 v_mfma_f32_16x16x32_bf16 v[132:135], a[16:19], a[84:87], v[132:135]
 s_waitcnt lgkmcnt(4)
 v_exp_f32 v157, v157
 v_mfma_f32_16x16x32_bf16 v[140:143], a[20:23], a[84:87], v[140:143]
 ds_read_b128 a[8:11], v195 offset:24576
 v_cvt_pk_bf16_f32 v164, v148, v149
 v_mfma_f32_16x16x32_bf16 v[136:139], a[20:23], a[80:83], v[136:139]
 s_waitcnt lgkmcnt(4)
 buffer_load_dwordx4 v211, s[8:11], s34 offen offset:1024 nt lds
 v_cvt_pk_bf16_f32 v165, v150, v151
 v_mfma_f32_16x16x32_bf16 v[128:131], a[24:27], a[88:91], v[128:131]
 ds_read_b128 a[12:15], v195 offset:25088
 v_cvt_pk_bf16_f32 v166, v156, v157
 v_mfma_f32_16x16x32_bf16 v[132:135], a[24:27], a[92:95], v[132:135]
 s_waitcnt lgkmcnt(4)
 v_exp_f32 v158, v158
 v_mfma_f32_16x16x32_bf16 v[140:143], a[28:31], a[92:95], v[140:143]
 ds_read_b128 a[16:19], v194 offset:28672
 v_add_f32 v222, v154, v222
 v_mfma_f32_16x16x32_bf16 v[136:139], a[28:31], a[88:91], v[136:139]
 s_waitcnt lgkmcnt(4)
 v_exp_f32 v159, v159
 v_mfma_f32_16x16x32_bf16 v[128:131], a[0:3], a[96:99], v[128:131]
 ds_read_b128 a[20:23], v194 offset:29184
 v_cvt_pk_bf16_f32 v167, v158, v159
 v_mfma_f32_16x16x32_bf16 v[132:135], a[0:3], a[100:103], v[132:135]
 s_waitcnt lgkmcnt(4)
 v_add_f32 v222, v155, v222
 v_add_f32 v223, v148, v223
 v_mfma_f32_16x16x32_bf16 v[140:143], a[4:7], a[100:103], v[140:143]
 ds_read_b128 a[24:27], v195 offset:28672
 buffer_load_dwordx4 v212, s[8:11], s34 offen offset:2048 nt lds
 v_mfma_f32_16x16x32_bf16 v[136:139], a[4:7], a[96:99], v[136:139]
 s_waitcnt lgkmcnt(4)
 v_add_f32 v223, v149, v223
 v_add_f32 v223, v150, v223
 v_mfma_f32_16x16x32_bf16 v[128:131], a[8:11], a[104:107], v[128:131]
 ds_read_b128 a[28:31], v195 offset:29184
 v_add_f32 v223, v151, v223
 v_mfma_f32_16x16x32_bf16 v[132:135], a[8:11], a[108:111], v[132:135]
 s_waitcnt lgkmcnt(4)
 v_add_f32 v223, v156, v223
 v_add_f32 v223, v157, v223
 v_mfma_f32_16x16x32_bf16 v[140:143], a[12:15], a[108:111], v[140:143]
 ds_read_b64_tr_b16 a[0:1], v202 offset:32768
 ds_read_b64_tr_b16 a[2:3], v202 offset:33280
 v_mfma_f32_16x16x32_bf16 v[136:139], a[12:15], a[104:107], v[136:139]
 s_waitcnt lgkmcnt(5)
 v_add_f32 v223, v158, v223
 v_add_f32 v223, v159, v223
 v_mfma_f32_16x16x32_bf16 v[128:131], a[16:19], a[112:115], v[128:131]
 ds_read_b64_tr_b16 a[4:5], v203 offset:32768
 ds_read_b64_tr_b16 a[6:7], v203 offset:33280
 v_mfma_f32_16x16x32_bf16 v[132:135], a[16:19], a[116:119], v[132:135]
 s_waitcnt lgkmcnt(6)
 buffer_load_dwordx4 v213, s[8:11], s34 offen offset:3072 nt lds
 v_mfma_f32_16x16x32_bf16 v[140:143], a[20:23], a[116:119], v[140:143]
 ds_read_b64_tr_b16 a[8:9], v204 offset:32768
 ds_read_b64_tr_b16 a[10:11], v204 offset:33280
 v_mfma_f32_16x16x32_bf16 v[136:139], a[20:23], a[112:115], v[136:139]
 s_waitcnt lgkmcnt(7)
 v_mfma_f32_16x16x32_bf16 v[128:131], a[24:27], a[120:123], v[128:131]
 ds_read_b64_tr_b16 a[12:13], v205 offset:32768
 ds_read_b64_tr_b16 a[14:15], v205 offset:33280
 v_mfma_f32_16x16x32_bf16 v[132:135], a[24:27], a[124:127], v[132:135]
 s_waitcnt lgkmcnt(8)
 v_mfma_f32_16x16x32_bf16 v[140:143], a[28:31], a[124:127], v[140:143]
 ds_read_b64_tr_b16 a[16:17], v202 offset:36864
 ds_read_b64_tr_b16 a[18:19], v202 offset:37376
 v_mfma_f32_16x16x32_bf16 v[136:139], a[28:31], a[120:123], v[136:139]
 s_waitcnt lgkmcnt(8)
 v_mfma_f32_16x16x32_bf16 v[0:3], a[0:3], v[160:163], v[0:3]
 s_add_u32 s92, s54, 45056
 s_addc_u32 s93, s55, 0
 ds_read_b64_tr_b16 a[20:21], v203 offset:36864
 ds_read_b64_tr_b16 a[22:23], v203 offset:37376
 v_mfma_f32_16x16x32_bf16 v[4:7], a[0:3], v[164:167], v[4:7]
 s_waitcnt vmcnt(20) lgkmcnt(8)
 global_load_dword v252, v245, s[92:93]
 v_max3_f32 v224, v128, v129, v130
 v_mfma_f32_16x16x32_bf16 v[12:15], a[4:7], v[164:167], v[12:15]
 s_barrier
 ds_read_b64_tr_b16 a[24:25], v204 offset:36864
 ds_read_b64_tr_b16 a[26:27], v204 offset:37376
 v_mfma_f32_16x16x32_bf16 v[8:11], a[4:7], v[160:163], v[8:11]
 s_waitcnt lgkmcnt(8)
 v_max3_f32 v224, v131, v132, v224
 v_max3_f32 v224, v133, v134, v224
 v_mfma_f32_16x16x32_bf16 v[16:19], a[8:11], v[160:163], v[16:19]
 s_add_u32 m0, s33, 65536
 ds_read_b64_tr_b16 a[28:29], v205 offset:36864
 ds_read_b64_tr_b16 a[30:31], v205 offset:37376
 v_mfma_f32_16x16x32_bf16 v[20:23], a[8:11], v[164:167], v[20:23]
 s_waitcnt lgkmcnt(8)
 v_max3_f32 v224, v135, v136, v224
 v_max3_f32 v224, v137, v138, v224
 v_mfma_f32_16x16x32_bf16 v[28:31], a[12:15], v[164:167], v[28:31]
 s_mov_b32 s34, 311296
 ds_read_b64_tr_b16 a[0:1], v202 offset:40960
 ds_read_b64_tr_b16 a[2:3], v202 offset:41472
 v_mfma_f32_16x16x32_bf16 v[24:27], a[12:15], v[160:163], v[24:27]
 s_waitcnt lgkmcnt(8)
 buffer_load_dwordx4 v210, s[12:15], s34 offen nt lds
 v_max3_f32 v224, v139, v140, v224
 v_mfma_f32_16x16x32_bf16 v[32:35], a[16:19], v[160:163], v[32:35]
 ds_read_b64_tr_b16 a[4:5], v203 offset:40960
 ds_read_b64_tr_b16 a[6:7], v203 offset:41472
 v_mfma_f32_16x16x32_bf16 v[36:39], a[16:19], v[164:167], v[36:39]
 s_waitcnt lgkmcnt(8)
 v_max3_f32 v224, v141, v142, v224
 v_max_f32 v224, v143, v224
 v_mfma_f32_16x16x32_bf16 v[44:47], a[20:23], v[164:167], v[44:47]
 ds_read_b64_tr_b16 a[8:9], v204 offset:40960
 ds_read_b64_tr_b16 a[10:11], v204 offset:41472
 v_mfma_f32_16x16x32_bf16 v[40:43], a[20:23], v[160:163], v[40:43]
 s_waitcnt lgkmcnt(8)
 v_cmp_lt_f32 vcc, s35, v224
 v_mfma_f32_16x16x32_bf16 v[48:51], a[24:27], v[160:163], v[48:51]
 s_cbranch_vccnz L_stub15
L_ret15:
 ds_read_b64_tr_b16 a[12:13], v205 offset:40960
 ds_read_b64_tr_b16 a[14:15], v205 offset:41472
 v_mfma_f32_16x16x32_bf16 v[52:55], a[24:27], v[164:167], v[52:55]
 s_waitcnt lgkmcnt(8)
 v_exp_f32 v128, v128
 v_mfma_f32_16x16x32_bf16 v[60:63], a[28:31], v[164:167], v[60:63]
 ds_read_b64_tr_b16 a[16:17], v202 offset:45056
 ds_read_b64_tr_b16 a[18:19], v202 offset:45568
 v_mfma_f32_16x16x32_bf16 v[56:59], a[28:31], v[160:163], v[56:59]
 s_waitcnt lgkmcnt(8)
 buffer_load_dwordx4 v211, s[12:15], s34 offen offset:1024 nt lds
 v_add_f32 v222, v128, v222
 v_mfma_f32_16x16x32_bf16 v[64:67], a[0:3], v[160:163], v[64:67]
 ds_read_b64_tr_b16 a[20:21], v203 offset:45056
 ds_read_b64_tr_b16 a[22:23], v203 offset:45568
 v_mfma_f32_16x16x32_bf16 v[68:71], a[0:3], v[164:167], v[68:71]
 s_waitcnt lgkmcnt(8)
 v_exp_f32 v129, v129
 v_mfma_f32_16x16x32_bf16 v[76:79], a[4:7], v[164:167], v[76:79]
 ds_read_b64_tr_b16 a[24:25], v204 offset:45056
 ds_read_b64_tr_b16 a[26:27], v204 offset:45568
 v_mfma_f32_16x16x32_bf16 v[72:75], a[4:7], v[160:163], v[72:75]
 s_waitcnt lgkmcnt(8)
 v_exp_f32 v130, v130
 v_mfma_f32_16x16x32_bf16 v[80:83], a[8:11], v[160:163], v[80:83]
 ds_read_b64_tr_b16 a[28:29], v205 offset:45056
 ds_read_b64_tr_b16 a[30:31], v205 offset:45568
 v_mfma_f32_16x16x32_bf16 v[84:87], a[8:11], v[164:167], v[84:87]
 s_waitcnt lgkmcnt(8)
 v_exp_f32 v131, v131
 v_mfma_f32_16x16x32_bf16 v[92:95], a[12:15], v[164:167], v[92:95]
 ds_read_b128 a[0:3], v194 offset:49152
 buffer_load_dwordx4 v212, s[12:15], s34 offen offset:2048 nt lds
 v_mfma_f32_16x16x32_bf16 v[88:91], a[12:15], v[160:163], v[88:91]
 s_waitcnt lgkmcnt(7)
 v_exp_f32 v136, v136
 v_mfma_f32_16x16x32_bf16 v[96:99], a[16:19], v[160:163], v[96:99]
 ds_read_b128 a[4:7], v194 offset:49664
 v_add_f32 v222, v129, v222
 v_mfma_f32_16x16x32_bf16 v[100:103], a[16:19], v[164:167], v[100:103]
 s_waitcnt lgkmcnt(6)
 v_exp_f32 v137, v137
 v_mfma_f32_16x16x32_bf16 v[108:111], a[20:23], v[164:167], v[108:111]
 ds_read_b128 a[8:11], v195 offset:49152
 v_add_f32 v222, v130, v222
 v_mfma_f32_16x16x32_bf16 v[104:107], a[20:23], v[160:163], v[104:107]
 s_waitcnt lgkmcnt(5)
 v_exp_f32 v138, v138
 v_mfma_f32_16x16x32_bf16 v[112:115], a[24:27], v[160:163], v[112:115]
 ds_read_b128 a[12:15], v195 offset:49664
 v_add_f32 v222, v131, v222
 v_mfma_f32_16x16x32_bf16 v[116:119], a[24:27], v[164:167], v[116:119]
 s_waitcnt lgkmcnt(4)
 buffer_load_dwordx4 v213, s[12:15], s34 offen offset:3072 nt lds
 v_add_f32 v222, v136, v222
 v_mfma_f32_16x16x32_bf16 v[124:127], a[28:31], v[164:167], v[124:127]
 s_add_u32 m0, s33, 81920
 ds_read_b128 a[16:19], v194 offset:53248
 v_add_f32 v222, v137, v222
 v_mfma_f32_16x16x32_bf16 v[120:123], a[28:31], v[160:163], v[120:123]
 s_waitcnt lgkmcnt(4)
 v_exp_f32 v139, v139
 v_mfma_f32_16x16x32_bf16 v[144:147], a[0:3], a[64:67], v[168:171]
 s_mov_b32 s34, 344064
 ds_read_b128 a[20:23], v194 offset:53760
 v_cvt_pk_bf16_f32 v160, v128, v129
 v_mfma_f32_16x16x32_bf16 v[148:151], a[0:3], a[68:71], v[172:175]
 s_waitcnt lgkmcnt(4)
 v_exp_f32 v132, v132
 v_mfma_f32_16x16x32_bf16 v[156:159], a[4:7], a[68:71], v[172:175]
 ds_read_b128 a[24:27], v195 offset:53248
 v_cvt_pk_bf16_f32 v161, v130, v131
 v_mfma_f32_16x16x32_bf16 v[152:155], a[4:7], a[64:67], v[168:171]
 s_waitcnt lgkmcnt(4)
 v_exp_f32 v133, v133
 v_mfma_f32_16x16x32_bf16 v[144:147], a[8:11], a[72:75], v[144:147]
 ds_read_b128 a[28:31], v195 offset:53760
 buffer_load_dwordx4 v210, s[8:11], s34 offen nt lds
 v_mfma_f32_16x16x32_bf16 v[148:151], a[8:11], a[76:79], v[148:151]
 s_waitcnt lgkmcnt(4)
 v_exp_f32 v134, v134
 v_mfma_f32_16x16x32_bf16 v[156:159], a[12:15], a[76:79], v[156:159]
 ds_read_b128 a[0:3], v194 offset:57344
 v_cvt_pk_bf16_f32 v162, v136, v137
 v_mfma_f32_16x16x32_bf16 v[152:155], a[12:15], a[72:75], v[152:155]
 s_waitcnt lgkmcnt(4)
 v_exp_f32 v135, v135
 v_mfma_f32_16x16x32_bf16 v[144:147], a[16:19], a[80:83], v[144:147]
 ds_read_b128 a[4:7], v194 offset:57856
 v_cvt_pk_bf16_f32 v163, v138, v139
 v_mfma_f32_16x16x32_bf16 v[148:151], a[16:19], a[84:87], v[148:151]
 s_waitcnt lgkmcnt(4)
 v_exp_f32 v140, v140
 v_mfma_f32_16x16x32_bf16 v[156:159], a[20:23], a[84:87], v[156:159]
 ds_read_b128 a[8:11], v195 offset:57344
 v_cvt_pk_bf16_f32 v164, v132, v133
 v_mfma_f32_16x16x32_bf16 v[152:155], a[20:23], a[80:83], v[152:155]
 s_waitcnt lgkmcnt(4)
 buffer_load_dwordx4 v211, s[8:11], s34 offen offset:1024 nt lds
 v_cvt_pk_bf16_f32 v165, v134, v135
 v_mfma_f32_16x16x32_bf16 v[144:147], a[24:27], a[88:91], v[144:147]
 ds_read_b128 a[12:15], v195 offset:57856
 v_add_f32 v222, v138, v222
 v_mfma_f32_16x16x32_bf16 v[148:151], a[24:27], a[92:95], v[148:151]
 s_waitcnt lgkmcnt(4)
 v_exp_f32 v141, v141
 v_mfma_f32_16x16x32_bf16 v[156:159], a[28:31], a[92:95], v[156:159]
 ds_read_b128 a[16:19], v194 offset:61440
 v_cvt_pk_bf16_f32 v166, v140, v141
 v_mfma_f32_16x16x32_bf16 v[152:155], a[28:31], a[88:91], v[152:155]
 s_waitcnt lgkmcnt(4)
 v_exp_f32 v142, v142
 v_mfma_f32_16x16x32_bf16 v[144:147], a[0:3], a[96:99], v[144:147]
 ds_read_b128 a[20:23], v194 offset:61952
 v_add_f32 v222, v139, v222
 v_mfma_f32_16x16x32_bf16 v[148:151], a[0:3], a[100:103], v[148:151]
 s_waitcnt lgkmcnt(4)
 v_exp_f32 v143, v143
 v_mfma_f32_16x16x32_bf16 v[156:159], a[4:7], a[100:103], v[156:159]
 ds_read_b128 a[24:27], v195 offset:61440
 buffer_load_dwordx4 v212, s[8:11], s34 offen offset:2048 nt lds
 v_mfma_f32_16x16x32_bf16 v[152:155], a[4:7], a[96:99], v[152:155]
 s_waitcnt lgkmcnt(4)
 v_cvt_pk_bf16_f32 v167, v142, v143
 v_add_f32 v223, v132, v223
 v_mfma_f32_16x16x32_bf16 v[144:147], a[8:11], a[104:107], v[144:147]
 ds_read_b128 a[28:31], v195 offset:61952
 v_add_f32 v223, v133, v223
 v_mfma_f32_16x16x32_bf16 v[148:151], a[8:11], a[108:111], v[148:151]
 s_waitcnt lgkmcnt(4)
 v_add_f32 v223, v134, v223
 v_add_f32 v223, v135, v223
 v_mfma_f32_16x16x32_bf16 v[156:159], a[12:15], a[108:111], v[156:159]
 ds_read_b64_tr_b16 a[0:1], v206 offset:0
 ds_read_b64_tr_b16 a[2:3], v206 offset:512
 v_mfma_f32_16x16x32_bf16 v[152:155], a[12:15], a[104:107], v[152:155]
 s_waitcnt lgkmcnt(5)
 v_add_f32 v223, v140, v223
 v_add_f32 v223, v141, v223
 v_mfma_f32_16x16x32_bf16 v[144:147], a[16:19], a[112:115], v[144:147]
 ds_read_b64_tr_b16 a[4:5], v207 offset:0
 ds_read_b64_tr_b16 a[6:7], v207 offset:512
 v_mfma_f32_16x16x32_bf16 v[148:151], a[16:19], a[116:119], v[148:151]
 s_waitcnt lgkmcnt(6)
 buffer_load_dwordx4 v213, s[8:11], s34 offen offset:3072 nt lds
 v_add_f32 v223, v142, v223
 v_mfma_f32_16x16x32_bf16 v[156:159], a[20:23], a[116:119], v[156:159]
 ds_read_b64_tr_b16 a[8:9], v208 offset:0
 ds_read_b64_tr_b16 a[10:11], v208 offset:512
 v_mfma_f32_16x16x32_bf16 v[152:155], a[20:23], a[112:115], v[152:155]
 s_waitcnt lgkmcnt(7)
 v_add_f32 v223, v143, v223
 v_mfma_f32_16x16x32_bf16 v[144:147], a[24:27], a[120:123], v[144:147]
 ds_read_b64_tr_b16 a[12:13], v209 offset:0
 ds_read_b64_tr_b16 a[14:15], v209 offset:512
 v_mfma_f32_16x16x32_bf16 v[148:151], a[24:27], a[124:127], v[148:151]
 s_waitcnt lgkmcnt(8)
 v_mfma_f32_16x16x32_bf16 v[156:159], a[28:31], a[124:127], v[156:159]
 ds_read_b64_tr_b16 a[16:17], v206 offset:4096
 ds_read_b64_tr_b16 a[18:19], v206 offset:4608
 v_mfma_f32_16x16x32_bf16 v[152:155], a[28:31], a[120:123], v[152:155]
 s_waitcnt lgkmcnt(8)
 v_mfma_f32_16x16x32_bf16 v[0:3], a[0:3], v[160:163], v[0:3]
 ds_read_b64_tr_b16 a[20:21], v207 offset:4096
 ds_read_b64_tr_b16 a[22:23], v207 offset:4608
 v_mfma_f32_16x16x32_bf16 v[4:7], a[0:3], v[164:167], v[4:7]
 s_waitcnt vmcnt(21) lgkmcnt(8)
 v_max3_f32 v224, v144, v145, v146
 v_max3_f32 v224, v147, v148, v224
 v_mfma_f32_16x16x32_bf16 v[12:15], a[4:7], v[164:167], v[12:15]
 s_barrier
 ds_read_b64_tr_b16 a[24:25], v208 offset:4096
 ds_read_b64_tr_b16 a[26:27], v208 offset:4608
 v_mfma_f32_16x16x32_bf16 v[8:11], a[4:7], v[160:163], v[8:11]
 s_waitcnt lgkmcnt(8)
 v_max3_f32 v224, v149, v150, v224
 v_max3_f32 v224, v151, v152, v224
 v_mfma_f32_16x16x32_bf16 v[16:19], a[8:11], v[160:163], v[16:19]
 s_add_u32 m0, s33, 98304
 ds_read_b64_tr_b16 a[28:29], v209 offset:4096
 ds_read_b64_tr_b16 a[30:31], v209 offset:4608
 v_mfma_f32_16x16x32_bf16 v[20:23], a[8:11], v[164:167], v[20:23]
 s_waitcnt lgkmcnt(8)
 v_max3_f32 v224, v153, v154, v224
 v_max3_f32 v224, v155, v156, v224
 v_mfma_f32_16x16x32_bf16 v[28:31], a[12:15], v[164:167], v[28:31]
 s_mov_b32 s34, 327680
 ds_read_b64_tr_b16 a[0:1], v206 offset:8192
 ds_read_b64_tr_b16 a[2:3], v206 offset:8704
 v_mfma_f32_16x16x32_bf16 v[24:27], a[12:15], v[160:163], v[24:27]
 s_waitcnt lgkmcnt(8)
 buffer_load_dwordx4 v210, s[12:15], s34 offen nt lds
 v_max3_f32 v224, v157, v158, v224
 v_mfma_f32_16x16x32_bf16 v[32:35], a[16:19], v[160:163], v[32:35]
 ds_read_b64_tr_b16 a[4:5], v207 offset:8192
 ds_read_b64_tr_b16 a[6:7], v207 offset:8704
 v_mfma_f32_16x16x32_bf16 v[36:39], a[16:19], v[164:167], v[36:39]
 s_waitcnt lgkmcnt(8)
 v_max_f32 v224, v159, v224
 v_cmp_lt_f32 vcc, s35, v224
 v_mfma_f32_16x16x32_bf16 v[44:47], a[20:23], v[164:167], v[44:47]
 s_cbranch_vccnz L_stub16
L_ret16:
 ds_read_b64_tr_b16 a[8:9], v208 offset:8192
 ds_read_b64_tr_b16 a[10:11], v208 offset:8704
 v_mfma_f32_16x16x32_bf16 v[40:43], a[20:23], v[160:163], v[40:43]
 s_waitcnt lgkmcnt(8)
 v_exp_f32 v144, v144
 v_mfma_f32_16x16x32_bf16 v[48:51], a[24:27], v[160:163], v[48:51]
 ds_read_b64_tr_b16 a[12:13], v209 offset:8192
 ds_read_b64_tr_b16 a[14:15], v209 offset:8704
 v_mfma_f32_16x16x32_bf16 v[52:55], a[24:27], v[164:167], v[52:55]
 s_waitcnt lgkmcnt(8)
 v_exp_f32 v145, v145
 v_mfma_f32_16x16x32_bf16 v[60:63], a[28:31], v[164:167], v[60:63]
 ds_read_b64_tr_b16 a[16:17], v206 offset:12288
 ds_read_b64_tr_b16 a[18:19], v206 offset:12800
 v_mfma_f32_16x16x32_bf16 v[56:59], a[28:31], v[160:163], v[56:59]
 s_waitcnt lgkmcnt(8)
 buffer_load_dwordx4 v211, s[12:15], s34 offen offset:1024 nt lds
 v_add_f32 v222, v144, v222
 v_mfma_f32_16x16x32_bf16 v[64:67], a[0:3], v[160:163], v[64:67]
 ds_read_b64_tr_b16 a[20:21], v207 offset:12288
 ds_read_b64_tr_b16 a[22:23], v207 offset:12800
 v_mfma_f32_16x16x32_bf16 v[68:71], a[0:3], v[164:167], v[68:71]
 s_waitcnt lgkmcnt(8)
 v_exp_f32 v146, v146
 v_mfma_f32_16x16x32_bf16 v[76:79], a[4:7], v[164:167], v[76:79]
 ds_read_b64_tr_b16 a[24:25], v208 offset:12288
 ds_read_b64_tr_b16 a[26:27], v208 offset:12800
 v_mfma_f32_16x16x32_bf16 v[72:75], a[4:7], v[160:163], v[72:75]
 s_waitcnt lgkmcnt(8)
 v_exp_f32 v147, v147
 v_mfma_f32_16x16x32_bf16 v[80:83], a[8:11], v[160:163], v[80:83]
 ds_read_b64_tr_b16 a[28:29], v209 offset:12288
 ds_read_b64_tr_b16 a[30:31], v209 offset:12800
 v_mfma_f32_16x16x32_bf16 v[84:87], a[8:11], v[164:167], v[84:87]
 s_waitcnt lgkmcnt(8)
 v_exp_f32 v152, v152
 v_mfma_f32_16x16x32_bf16 v[92:95], a[12:15], v[164:167], v[92:95]
 ds_read_b128 a[0:3], v196 offset:16384
 buffer_load_dwordx4 v212, s[12:15], s34 offen offset:2048 nt lds
 v_mfma_f32_16x16x32_bf16 v[88:91], a[12:15], v[160:163], v[88:91]
 s_waitcnt lgkmcnt(7)
 v_exp_f32 v153, v153
 v_mfma_f32_16x16x32_bf16 v[96:99], a[16:19], v[160:163], v[96:99]
 ds_read_b128 a[4:7], v196 offset:16896
 v_add_f32 v222, v145, v222
 v_mfma_f32_16x16x32_bf16 v[100:103], a[16:19], v[164:167], v[100:103]
 s_waitcnt lgkmcnt(6)
 v_exp_f32 v154, v154
 v_mfma_f32_16x16x32_bf16 v[108:111], a[20:23], v[164:167], v[108:111]
 ds_read_b128 a[8:11], v197 offset:16384
 v_add_f32 v222, v146, v222
 v_mfma_f32_16x16x32_bf16 v[104:107], a[20:23], v[160:163], v[104:107]
 s_waitcnt lgkmcnt(5)
 v_exp_f32 v155, v155
 v_mfma_f32_16x16x32_bf16 v[112:115], a[24:27], v[160:163], v[112:115]
 ds_read_b128 a[12:15], v197 offset:16896
 v_add_f32 v222, v147, v222
 v_mfma_f32_16x16x32_bf16 v[116:119], a[24:27], v[164:167], v[116:119]
 s_waitcnt lgkmcnt(4)
 buffer_load_dwordx4 v213, s[12:15], s34 offen offset:3072 nt lds
 v_add_f32 v222, v152, v222
 v_mfma_f32_16x16x32_bf16 v[124:127], a[28:31], v[164:167], v[124:127]
 s_add_u32 m0, s33, 114688
 ds_read_b128 a[16:19], v196 offset:20480
 v_add_f32 v222, v153, v222
 v_mfma_f32_16x16x32_bf16 v[120:123], a[28:31], v[160:163], v[120:123]
 s_waitcnt lgkmcnt(4)
 v_exp_f32 v148, v148
 v_mfma_f32_16x16x32_bf16 v[128:131], a[0:3], a[64:67], v[168:171]
 s_mov_b32 s34, 360448
 ds_read_b128 a[20:23], v196 offset:20992
 v_cvt_pk_bf16_f32 v160, v144, v145
 v_mfma_f32_16x16x32_bf16 v[132:135], a[0:3], a[68:71], v[172:175]
 s_waitcnt lgkmcnt(4)
 v_exp_f32 v149, v149
 v_mfma_f32_16x16x32_bf16 v[140:143], a[4:7], a[68:71], v[172:175]
 ds_read_b128 a[24:27], v197 offset:20480
 v_cvt_pk_bf16_f32 v161, v146, v147
 v_mfma_f32_16x16x32_bf16 v[136:139], a[4:7], a[64:67], v[168:171]
 s_waitcnt lgkmcnt(4)
 v_exp_f32 v150, v150
 v_mfma_f32_16x16x32_bf16 v[128:131], a[8:11], a[72:75], v[128:131]
 ds_read_b128 a[28:31], v197 offset:20992
 buffer_load_dwordx4 v210, s[8:11], s34 offen nt lds
 v_mfma_f32_16x16x32_bf16 v[132:135], a[8:11], a[76:79], v[132:135]
 s_waitcnt lgkmcnt(4)
 v_exp_f32 v151, v151
 v_mfma_f32_16x16x32_bf16 v[140:143], a[12:15], a[76:79], v[140:143]
 ds_read_b128 a[0:3], v196 offset:24576
 v_cvt_pk_bf16_f32 v162, v152, v153
 v_mfma_f32_16x16x32_bf16 v[136:139], a[12:15], a[72:75], v[136:139]
 s_waitcnt lgkmcnt(4)
 v_exp_f32 v156, v156
 v_mfma_f32_16x16x32_bf16 v[128:131], a[16:19], a[80:83], v[128:131]
 ds_read_b128 a[4:7], v196 offset:25088
 v_cvt_pk_bf16_f32 v163, v154, v155
 v_mfma_f32_16x16x32_bf16 v[132:135], a[16:19], a[84:87], v[132:135]
 s_waitcnt lgkmcnt(4)
 v_exp_f32 v157, v157
 v_mfma_f32_16x16x32_bf16 v[140:143], a[20:23], a[84:87], v[140:143]
 ds_read_b128 a[8:11], v197 offset:24576
 v_cvt_pk_bf16_f32 v164, v148, v149
 v_mfma_f32_16x16x32_bf16 v[136:139], a[20:23], a[80:83], v[136:139]
 s_waitcnt lgkmcnt(4)
 buffer_load_dwordx4 v211, s[8:11], s34 offen offset:1024 nt lds
 v_cvt_pk_bf16_f32 v165, v150, v151
 v_mfma_f32_16x16x32_bf16 v[128:131], a[24:27], a[88:91], v[128:131]
 ds_read_b128 a[12:15], v197 offset:25088
 v_cvt_pk_bf16_f32 v166, v156, v157
 v_mfma_f32_16x16x32_bf16 v[132:135], a[24:27], a[92:95], v[132:135]
 s_waitcnt lgkmcnt(4)
 v_exp_f32 v158, v158
 v_mfma_f32_16x16x32_bf16 v[140:143], a[28:31], a[92:95], v[140:143]
 ds_read_b128 a[16:19], v196 offset:28672
 v_add_f32 v222, v154, v222
 v_mfma_f32_16x16x32_bf16 v[136:139], a[28:31], a[88:91], v[136:139]
 s_waitcnt lgkmcnt(4)
 v_exp_f32 v159, v159
 v_mfma_f32_16x16x32_bf16 v[128:131], a[0:3], a[96:99], v[128:131]
 ds_read_b128 a[20:23], v196 offset:29184
 v_cvt_pk_bf16_f32 v167, v158, v159
 v_mfma_f32_16x16x32_bf16 v[132:135], a[0:3], a[100:103], v[132:135]
 s_waitcnt lgkmcnt(4)
 v_add_f32 v222, v155, v222
 v_add_f32 v223, v148, v223
 v_mfma_f32_16x16x32_bf16 v[140:143], a[4:7], a[100:103], v[140:143]
 ds_read_b128 a[24:27], v197 offset:28672
 buffer_load_dwordx4 v212, s[8:11], s34 offen offset:2048 nt lds
 v_mfma_f32_16x16x32_bf16 v[136:139], a[4:7], a[96:99], v[136:139]
 s_waitcnt lgkmcnt(4)
 v_add_f32 v223, v149, v223
 v_add_f32 v223, v150, v223
 v_mfma_f32_16x16x32_bf16 v[128:131], a[8:11], a[104:107], v[128:131]
 ds_read_b128 a[28:31], v197 offset:29184
 v_add_f32 v223, v151, v223
 v_mfma_f32_16x16x32_bf16 v[132:135], a[8:11], a[108:111], v[132:135]
 s_waitcnt lgkmcnt(4)
 v_add_f32 v223, v156, v223
 v_add_f32 v223, v157, v223
 v_mfma_f32_16x16x32_bf16 v[140:143], a[12:15], a[108:111], v[140:143]
 ds_read_b64_tr_b16 a[0:1], v198 offset:0
 ds_read_b64_tr_b16 a[2:3], v198 offset:512
 v_mfma_f32_16x16x32_bf16 v[136:139], a[12:15], a[104:107], v[136:139]
 s_waitcnt lgkmcnt(5)
 v_add_f32 v223, v158, v223
 v_add_f32 v223, v159, v223
 v_mfma_f32_16x16x32_bf16 v[128:131], a[16:19], a[112:115], v[128:131]
 ds_read_b64_tr_b16 a[4:5], v199 offset:0
 ds_read_b64_tr_b16 a[6:7], v199 offset:512
 v_mfma_f32_16x16x32_bf16 v[132:135], a[16:19], a[116:119], v[132:135]
 s_waitcnt lgkmcnt(6)
 buffer_load_dwordx4 v213, s[8:11], s34 offen offset:3072 nt lds
 v_mfma_f32_16x16x32_bf16 v[140:143], a[20:23], a[116:119], v[140:143]
 ds_read_b64_tr_b16 a[8:9], v200 offset:0
 ds_read_b64_tr_b16 a[10:11], v200 offset:512
 v_mfma_f32_16x16x32_bf16 v[136:139], a[20:23], a[112:115], v[136:139]
 s_waitcnt lgkmcnt(7)
 v_mfma_f32_16x16x32_bf16 v[128:131], a[24:27], a[120:123], v[128:131]
 ds_read_b64_tr_b16 a[12:13], v201 offset:0
 ds_read_b64_tr_b16 a[14:15], v201 offset:512
 v_mfma_f32_16x16x32_bf16 v[132:135], a[24:27], a[124:127], v[132:135]
 s_waitcnt lgkmcnt(8)
 v_mfma_f32_16x16x32_bf16 v[140:143], a[28:31], a[124:127], v[140:143]
 ds_read_b64_tr_b16 a[16:17], v198 offset:4096
 ds_read_b64_tr_b16 a[18:19], v198 offset:4608
 v_mfma_f32_16x16x32_bf16 v[136:139], a[28:31], a[120:123], v[136:139]
 s_waitcnt lgkmcnt(8)
 v_mfma_f32_16x16x32_bf16 v[0:3], a[0:3], v[160:163], v[0:3]
 ds_read_b64_tr_b16 a[20:21], v199 offset:4096
 ds_read_b64_tr_b16 a[22:23], v199 offset:4608
 v_mfma_f32_16x16x32_bf16 v[4:7], a[0:3], v[164:167], v[4:7]
 s_waitcnt vmcnt(21) lgkmcnt(8)
 v_max3_f32 v224, v128, v129, v130
 v_max3_f32 v224, v131, v132, v224
 v_mfma_f32_16x16x32_bf16 v[12:15], a[4:7], v[164:167], v[12:15]
 s_barrier
 ds_read_b64_tr_b16 a[24:25], v200 offset:4096
 ds_read_b64_tr_b16 a[26:27], v200 offset:4608
 v_mfma_f32_16x16x32_bf16 v[8:11], a[4:7], v[160:163], v[8:11]
 s_waitcnt lgkmcnt(8)
 v_max3_f32 v224, v133, v134, v224
 v_max3_f32 v224, v135, v136, v224
 v_mfma_f32_16x16x32_bf16 v[16:19], a[8:11], v[160:163], v[16:19]
 s_add_u32 m0, s33, 131072
 ds_read_b64_tr_b16 a[28:29], v201 offset:4096
 ds_read_b64_tr_b16 a[30:31], v201 offset:4608
 v_mfma_f32_16x16x32_bf16 v[20:23], a[8:11], v[164:167], v[20:23]
 s_waitcnt lgkmcnt(8)
 v_max3_f32 v224, v137, v138, v224
 v_max3_f32 v224, v139, v140, v224
 v_mfma_f32_16x16x32_bf16 v[28:31], a[12:15], v[164:167], v[28:31]
 s_mov_b32 s34, 344064
 ds_read_b64_tr_b16 a[0:1], v198 offset:8192
 ds_read_b64_tr_b16 a[2:3], v198 offset:8704
 v_mfma_f32_16x16x32_bf16 v[24:27], a[12:15], v[160:163], v[24:27]
 s_waitcnt lgkmcnt(8)
 buffer_load_dwordx4 v210, s[12:15], s34 offen nt lds
 v_max3_f32 v224, v141, v142, v224
 v_mfma_f32_16x16x32_bf16 v[32:35], a[16:19], v[160:163], v[32:35]
 ds_read_b64_tr_b16 a[4:5], v199 offset:8192
 ds_read_b64_tr_b16 a[6:7], v199 offset:8704
 v_mfma_f32_16x16x32_bf16 v[36:39], a[16:19], v[164:167], v[36:39]
 s_waitcnt lgkmcnt(8)
 v_max_f32 v224, v143, v224
 v_cmp_lt_f32 vcc, s35, v224
 v_mfma_f32_16x16x32_bf16 v[44:47], a[20:23], v[164:167], v[44:47]
 s_cbranch_vccnz L_stub17
L_ret17:
 ds_read_b64_tr_b16 a[8:9], v200 offset:8192
 ds_read_b64_tr_b16 a[10:11], v200 offset:8704
 v_mfma_f32_16x16x32_bf16 v[40:43], a[20:23], v[160:163], v[40:43]
 s_waitcnt lgkmcnt(8)
 v_exp_f32 v128, v128
 v_mfma_f32_16x16x32_bf16 v[48:51], a[24:27], v[160:163], v[48:51]
 ds_read_b64_tr_b16 a[12:13], v201 offset:8192
 ds_read_b64_tr_b16 a[14:15], v201 offset:8704
 v_mfma_f32_16x16x32_bf16 v[52:55], a[24:27], v[164:167], v[52:55]
 s_waitcnt lgkmcnt(8)
 v_exp_f32 v129, v129
 v_mfma_f32_16x16x32_bf16 v[60:63], a[28:31], v[164:167], v[60:63]
 ds_read_b64_tr_b16 a[16:17], v198 offset:12288
 ds_read_b64_tr_b16 a[18:19], v198 offset:12800
 v_mfma_f32_16x16x32_bf16 v[56:59], a[28:31], v[160:163], v[56:59]
 s_waitcnt lgkmcnt(8)
 buffer_load_dwordx4 v211, s[12:15], s34 offen offset:1024 nt lds
 v_add_f32 v222, v128, v222
 v_mfma_f32_16x16x32_bf16 v[64:67], a[0:3], v[160:163], v[64:67]
 ds_read_b64_tr_b16 a[20:21], v199 offset:12288
 ds_read_b64_tr_b16 a[22:23], v199 offset:12800
 v_mfma_f32_16x16x32_bf16 v[68:71], a[0:3], v[164:167], v[68:71]
 s_waitcnt lgkmcnt(8)
 v_exp_f32 v130, v130
 v_mfma_f32_16x16x32_bf16 v[76:79], a[4:7], v[164:167], v[76:79]
 ds_read_b64_tr_b16 a[24:25], v200 offset:12288
 ds_read_b64_tr_b16 a[26:27], v200 offset:12800
 v_mfma_f32_16x16x32_bf16 v[72:75], a[4:7], v[160:163], v[72:75]
 s_waitcnt lgkmcnt(8)
 v_exp_f32 v131, v131
 v_mfma_f32_16x16x32_bf16 v[80:83], a[8:11], v[160:163], v[80:83]
 ds_read_b64_tr_b16 a[28:29], v201 offset:12288
 ds_read_b64_tr_b16 a[30:31], v201 offset:12800
 v_mfma_f32_16x16x32_bf16 v[84:87], a[8:11], v[164:167], v[84:87]
 s_waitcnt lgkmcnt(8)
 v_exp_f32 v136, v136
 v_mfma_f32_16x16x32_bf16 v[92:95], a[12:15], v[164:167], v[92:95]
 ds_read_b128 a[0:3], v192 offset:16384
 buffer_load_dwordx4 v212, s[12:15], s34 offen offset:2048 nt lds
 v_mfma_f32_16x16x32_bf16 v[88:91], a[12:15], v[160:163], v[88:91]
 s_waitcnt lgkmcnt(7)
 v_exp_f32 v137, v137
 v_mfma_f32_16x16x32_bf16 v[96:99], a[16:19], v[160:163], v[96:99]
 ds_read_b128 a[4:7], v192 offset:16896
 v_add_f32 v222, v129, v222
 v_mfma_f32_16x16x32_bf16 v[100:103], a[16:19], v[164:167], v[100:103]
 s_waitcnt lgkmcnt(6)
 v_exp_f32 v138, v138
 v_mfma_f32_16x16x32_bf16 v[108:111], a[20:23], v[164:167], v[108:111]
 ds_read_b128 a[8:11], v193 offset:16384
 v_add_f32 v222, v130, v222
 v_mfma_f32_16x16x32_bf16 v[104:107], a[20:23], v[160:163], v[104:107]
 s_waitcnt lgkmcnt(5)
 v_exp_f32 v139, v139
 v_mfma_f32_16x16x32_bf16 v[112:115], a[24:27], v[160:163], v[112:115]
 ds_read_b128 a[12:15], v193 offset:16896
 v_add_f32 v222, v131, v222
 v_mfma_f32_16x16x32_bf16 v[116:119], a[24:27], v[164:167], v[116:119]
 s_waitcnt lgkmcnt(4)
 buffer_load_dwordx4 v213, s[12:15], s34 offen offset:3072 nt lds
 v_add_f32 v222, v136, v222
 v_mfma_f32_16x16x32_bf16 v[124:127], a[28:31], v[164:167], v[124:127]
 s_add_u32 m0, s33, 147456
 ds_read_b128 a[16:19], v192 offset:20480
 v_add_f32 v222, v137, v222
 v_mfma_f32_16x16x32_bf16 v[120:123], a[28:31], v[160:163], v[120:123]
 s_waitcnt lgkmcnt(4)
 v_exp_f32 v132, v132
 v_mfma_f32_16x16x32_bf16 v[144:147], a[0:3], a[64:67], v[168:171]
 s_mov_b32 s34, 376832
 ds_read_b128 a[20:23], v192 offset:20992
 v_cvt_pk_bf16_f32 v160, v128, v129
 v_mfma_f32_16x16x32_bf16 v[148:151], a[0:3], a[68:71], v[172:175]
 s_waitcnt lgkmcnt(4)
 v_exp_f32 v133, v133
 v_mfma_f32_16x16x32_bf16 v[156:159], a[4:7], a[68:71], v[172:175]
 ds_read_b128 a[24:27], v193 offset:20480
 v_cvt_pk_bf16_f32 v161, v130, v131
 v_mfma_f32_16x16x32_bf16 v[152:155], a[4:7], a[64:67], v[168:171]
 s_waitcnt lgkmcnt(4)
 v_exp_f32 v134, v134
 v_mfma_f32_16x16x32_bf16 v[144:147], a[8:11], a[72:75], v[144:147]
 ds_read_b128 a[28:31], v193 offset:20992
 buffer_load_dwordx4 v210, s[8:11], s34 offen nt lds
 v_mfma_f32_16x16x32_bf16 v[148:151], a[8:11], a[76:79], v[148:151]
 s_waitcnt lgkmcnt(4)
 v_exp_f32 v135, v135
 v_mfma_f32_16x16x32_bf16 v[156:159], a[12:15], a[76:79], v[156:159]
 ds_read_b128 a[0:3], v192 offset:24576
 v_cvt_pk_bf16_f32 v162, v136, v137
 v_mfma_f32_16x16x32_bf16 v[152:155], a[12:15], a[72:75], v[152:155]
 s_waitcnt lgkmcnt(4)
 v_exp_f32 v140, v140
 v_mfma_f32_16x16x32_bf16 v[144:147], a[16:19], a[80:83], v[144:147]
 ds_read_b128 a[4:7], v192 offset:25088
 v_cvt_pk_bf16_f32 v163, v138, v139
 v_mfma_f32_16x16x32_bf16 v[148:151], a[16:19], a[84:87], v[148:151]
 s_waitcnt lgkmcnt(4)
 v_exp_f32 v141, v141
 v_mfma_f32_16x16x32_bf16 v[156:159], a[20:23], a[84:87], v[156:159]
 ds_read_b128 a[8:11], v193 offset:24576
 v_cvt_pk_bf16_f32 v164, v132, v133
 v_mfma_f32_16x16x32_bf16 v[152:155], a[20:23], a[80:83], v[152:155]
 s_waitcnt lgkmcnt(4)
 buffer_load_dwordx4 v211, s[8:11], s34 offen offset:1024 nt lds
 v_cvt_pk_bf16_f32 v165, v134, v135
 v_mfma_f32_16x16x32_bf16 v[144:147], a[24:27], a[88:91], v[144:147]
 ds_read_b128 a[12:15], v193 offset:25088
 v_cvt_pk_bf16_f32 v166, v140, v141
 v_mfma_f32_16x16x32_bf16 v[148:151], a[24:27], a[92:95], v[148:151]
 s_waitcnt lgkmcnt(4)
 v_exp_f32 v142, v142
 v_mfma_f32_16x16x32_bf16 v[156:159], a[28:31], a[92:95], v[156:159]
 ds_read_b128 a[16:19], v192 offset:28672
 v_add_f32 v222, v138, v222
 v_mfma_f32_16x16x32_bf16 v[152:155], a[28:31], a[88:91], v[152:155]
 s_waitcnt lgkmcnt(4)
 v_exp_f32 v143, v143
 v_mfma_f32_16x16x32_bf16 v[144:147], a[0:3], a[96:99], v[144:147]
 ds_read_b128 a[20:23], v192 offset:29184
 v_cvt_pk_bf16_f32 v167, v142, v143
 v_mfma_f32_16x16x32_bf16 v[148:151], a[0:3], a[100:103], v[148:151]
 s_waitcnt lgkmcnt(4)
 v_add_f32 v222, v139, v222
 v_add_f32 v223, v132, v223
 v_mfma_f32_16x16x32_bf16 v[156:159], a[4:7], a[100:103], v[156:159]
 ds_read_b128 a[24:27], v193 offset:28672
 buffer_load_dwordx4 v212, s[8:11], s34 offen offset:2048 nt lds
 v_mfma_f32_16x16x32_bf16 v[152:155], a[4:7], a[96:99], v[152:155]
 s_waitcnt lgkmcnt(4)
 v_add_f32 v223, v133, v223
 v_add_f32 v223, v134, v223
 v_mfma_f32_16x16x32_bf16 v[144:147], a[8:11], a[104:107], v[144:147]
 ds_read_b128 a[28:31], v193 offset:29184
 v_add_f32 v223, v135, v223
 v_mfma_f32_16x16x32_bf16 v[148:151], a[8:11], a[108:111], v[148:151]
 s_waitcnt lgkmcnt(4)
 v_add_f32 v223, v140, v223
 v_add_f32 v223, v141, v223
 v_mfma_f32_16x16x32_bf16 v[156:159], a[12:15], a[108:111], v[156:159]
 ds_read_b64_tr_b16 a[0:1], v198 offset:32768
 ds_read_b64_tr_b16 a[2:3], v198 offset:33280
 v_mfma_f32_16x16x32_bf16 v[152:155], a[12:15], a[104:107], v[152:155]
 s_waitcnt lgkmcnt(5)
 v_add_f32 v223, v142, v223
 v_add_f32 v223, v143, v223
 v_mfma_f32_16x16x32_bf16 v[144:147], a[16:19], a[112:115], v[144:147]
 ds_read_b64_tr_b16 a[4:5], v199 offset:32768
 ds_read_b64_tr_b16 a[6:7], v199 offset:33280
 v_mfma_f32_16x16x32_bf16 v[148:151], a[16:19], a[116:119], v[148:151]
 s_waitcnt lgkmcnt(6)
 buffer_load_dwordx4 v213, s[8:11], s34 offen offset:3072 nt lds
 v_mfma_f32_16x16x32_bf16 v[156:159], a[20:23], a[116:119], v[156:159]
 ds_read_b64_tr_b16 a[8:9], v200 offset:32768
 ds_read_b64_tr_b16 a[10:11], v200 offset:33280
 v_mfma_f32_16x16x32_bf16 v[152:155], a[20:23], a[112:115], v[152:155]
 s_waitcnt lgkmcnt(7)
 v_mfma_f32_16x16x32_bf16 v[144:147], a[24:27], a[120:123], v[144:147]
 ds_read_b64_tr_b16 a[12:13], v201 offset:32768
 ds_read_b64_tr_b16 a[14:15], v201 offset:33280
 v_mfma_f32_16x16x32_bf16 v[148:151], a[24:27], a[124:127], v[148:151]
 s_waitcnt lgkmcnt(8)
 v_mfma_f32_16x16x32_bf16 v[156:159], a[28:31], a[124:127], v[156:159]
 ds_read_b64_tr_b16 a[16:17], v198 offset:36864
 ds_read_b64_tr_b16 a[18:19], v198 offset:37376
 v_mfma_f32_16x16x32_bf16 v[152:155], a[28:31], a[120:123], v[152:155]
 s_waitcnt lgkmcnt(8)
 v_mfma_f32_16x16x32_bf16 v[0:3], a[0:3], v[160:163], v[0:3]
 s_add_u32 s92, s54, 49152
 s_addc_u32 s93, s55, 0
 ds_read_b64_tr_b16 a[20:21], v199 offset:36864
 ds_read_b64_tr_b16 a[22:23], v199 offset:37376
 v_mfma_f32_16x16x32_bf16 v[4:7], a[0:3], v[164:167], v[4:7]
 s_waitcnt vmcnt(20) lgkmcnt(8)
 global_load_dword v252, v245, s[92:93]
 v_max3_f32 v224, v144, v145, v146
 v_mfma_f32_16x16x32_bf16 v[12:15], a[4:7], v[164:167], v[12:15]
 s_barrier
 ds_read_b64_tr_b16 a[24:25], v200 offset:36864
 ds_read_b64_tr_b16 a[26:27], v200 offset:37376
 v_mfma_f32_16x16x32_bf16 v[8:11], a[4:7], v[160:163], v[8:11]
 s_waitcnt lgkmcnt(8)
 v_max3_f32 v224, v147, v148, v224
 v_max3_f32 v224, v149, v150, v224
 v_mfma_f32_16x16x32_bf16 v[16:19], a[8:11], v[160:163], v[16:19]
 s_add_u32 m0, s33, 0
 ds_read_b64_tr_b16 a[28:29], v201 offset:36864
 ds_read_b64_tr_b16 a[30:31], v201 offset:37376
 v_mfma_f32_16x16x32_bf16 v[20:23], a[8:11], v[164:167], v[20:23]
 s_waitcnt lgkmcnt(8)
 v_max3_f32 v224, v151, v152, v224
 v_max3_f32 v224, v153, v154, v224
 v_mfma_f32_16x16x32_bf16 v[28:31], a[12:15], v[164:167], v[28:31]
 s_mov_b32 s34, 360448
 ds_read_b64_tr_b16 a[0:1], v198 offset:40960
 ds_read_b64_tr_b16 a[2:3], v198 offset:41472
 v_mfma_f32_16x16x32_bf16 v[24:27], a[12:15], v[160:163], v[24:27]
 s_waitcnt lgkmcnt(8)
 buffer_load_dwordx4 v210, s[12:15], s34 offen nt lds
 v_max3_f32 v224, v155, v156, v224
 v_mfma_f32_16x16x32_bf16 v[32:35], a[16:19], v[160:163], v[32:35]
 ds_read_b64_tr_b16 a[4:5], v199 offset:40960
 ds_read_b64_tr_b16 a[6:7], v199 offset:41472
 v_mfma_f32_16x16x32_bf16 v[36:39], a[16:19], v[164:167], v[36:39]
 s_waitcnt lgkmcnt(8)
 v_max3_f32 v224, v157, v158, v224
 v_max_f32 v224, v159, v224
 v_mfma_f32_16x16x32_bf16 v[44:47], a[20:23], v[164:167], v[44:47]
 ds_read_b64_tr_b16 a[8:9], v200 offset:40960
 ds_read_b64_tr_b16 a[10:11], v200 offset:41472
 v_mfma_f32_16x16x32_bf16 v[40:43], a[20:23], v[160:163], v[40:43]
 s_waitcnt lgkmcnt(8)
 v_cmp_lt_f32 vcc, s35, v224
 v_mfma_f32_16x16x32_bf16 v[48:51], a[24:27], v[160:163], v[48:51]
 s_cbranch_vccnz L_stub18
L_ret18:
 ds_read_b64_tr_b16 a[12:13], v201 offset:40960
 ds_read_b64_tr_b16 a[14:15], v201 offset:41472
 v_mfma_f32_16x16x32_bf16 v[52:55], a[24:27], v[164:167], v[52:55]
 s_waitcnt lgkmcnt(8)
 v_exp_f32 v144, v144
 v_mfma_f32_16x16x32_bf16 v[60:63], a[28:31], v[164:167], v[60:63]
 ds_read_b64_tr_b16 a[16:17], v198 offset:45056
 ds_read_b64_tr_b16 a[18:19], v198 offset:45568
 v_mfma_f32_16x16x32_bf16 v[56:59], a[28:31], v[160:163], v[56:59]
 s_waitcnt lgkmcnt(8)
 buffer_load_dwordx4 v211, s[12:15], s34 offen offset:1024 nt lds
 v_add_f32 v222, v144, v222
 v_mfma_f32_16x16x32_bf16 v[64:67], a[0:3], v[160:163], v[64:67]
 ds_read_b64_tr_b16 a[20:21], v199 offset:45056
 ds_read_b64_tr_b16 a[22:23], v199 offset:45568
 v_mfma_f32_16x16x32_bf16 v[68:71], a[0:3], v[164:167], v[68:71]
 s_waitcnt lgkmcnt(8)
 v_exp_f32 v145, v145
 v_mfma_f32_16x16x32_bf16 v[76:79], a[4:7], v[164:167], v[76:79]
 ds_read_b64_tr_b16 a[24:25], v200 offset:45056
 ds_read_b64_tr_b16 a[26:27], v200 offset:45568
 v_mfma_f32_16x16x32_bf16 v[72:75], a[4:7], v[160:163], v[72:75]
 s_waitcnt lgkmcnt(8)
 v_exp_f32 v146, v146
 v_mfma_f32_16x16x32_bf16 v[80:83], a[8:11], v[160:163], v[80:83]
 ds_read_b64_tr_b16 a[28:29], v201 offset:45056
 ds_read_b64_tr_b16 a[30:31], v201 offset:45568
 v_mfma_f32_16x16x32_bf16 v[84:87], a[8:11], v[164:167], v[84:87]
 s_waitcnt lgkmcnt(8)
 v_exp_f32 v147, v147
 v_mfma_f32_16x16x32_bf16 v[92:95], a[12:15], v[164:167], v[92:95]
 ds_read_b128 a[0:3], v192 offset:49152
 buffer_load_dwordx4 v212, s[12:15], s34 offen offset:2048 nt lds
 v_mfma_f32_16x16x32_bf16 v[88:91], a[12:15], v[160:163], v[88:91]
 s_waitcnt lgkmcnt(7)
 v_exp_f32 v152, v152
 v_mfma_f32_16x16x32_bf16 v[96:99], a[16:19], v[160:163], v[96:99]
 ds_read_b128 a[4:7], v192 offset:49664
 v_add_f32 v222, v145, v222
 v_mfma_f32_16x16x32_bf16 v[100:103], a[16:19], v[164:167], v[100:103]
 s_waitcnt lgkmcnt(6)
 v_exp_f32 v153, v153
 v_mfma_f32_16x16x32_bf16 v[108:111], a[20:23], v[164:167], v[108:111]
 ds_read_b128 a[8:11], v193 offset:49152
 v_add_f32 v222, v146, v222
 v_mfma_f32_16x16x32_bf16 v[104:107], a[20:23], v[160:163], v[104:107]
 s_waitcnt lgkmcnt(5)
 v_exp_f32 v154, v154
 v_mfma_f32_16x16x32_bf16 v[112:115], a[24:27], v[160:163], v[112:115]
 ds_read_b128 a[12:15], v193 offset:49664
 v_add_f32 v222, v147, v222
 v_mfma_f32_16x16x32_bf16 v[116:119], a[24:27], v[164:167], v[116:119]
 s_waitcnt lgkmcnt(4)
 buffer_load_dwordx4 v213, s[12:15], s34 offen offset:3072 nt lds
 v_add_f32 v222, v152, v222
 v_mfma_f32_16x16x32_bf16 v[124:127], a[28:31], v[164:167], v[124:127]
 s_add_u32 m0, s33, 16384
 ds_read_b128 a[16:19], v192 offset:53248
 v_add_f32 v222, v153, v222
 v_mfma_f32_16x16x32_bf16 v[120:123], a[28:31], v[160:163], v[120:123]
 s_waitcnt lgkmcnt(4)
 v_exp_f32 v155, v155
 v_mfma_f32_16x16x32_bf16 v[128:131], a[0:3], a[64:67], v[168:171]
 s_mov_b32 s34, 393216
 ds_read_b128 a[20:23], v192 offset:53760
 v_cvt_pk_bf16_f32 v160, v144, v145
 v_mfma_f32_16x16x32_bf16 v[132:135], a[0:3], a[68:71], v[172:175]
 s_waitcnt lgkmcnt(4)
 v_exp_f32 v148, v148
 v_mfma_f32_16x16x32_bf16 v[140:143], a[4:7], a[68:71], v[172:175]
 ds_read_b128 a[24:27], v193 offset:53248
 v_cvt_pk_bf16_f32 v161, v146, v147
 v_mfma_f32_16x16x32_bf16 v[136:139], a[4:7], a[64:67], v[168:171]
 s_waitcnt lgkmcnt(4)
 v_exp_f32 v149, v149
 v_mfma_f32_16x16x32_bf16 v[128:131], a[8:11], a[72:75], v[128:131]
 ds_read_b128 a[28:31], v193 offset:53760
 buffer_load_dwordx4 v210, s[8:11], s34 offen nt lds
 v_mfma_f32_16x16x32_bf16 v[132:135], a[8:11], a[76:79], v[132:135]
 s_waitcnt lgkmcnt(4)
 v_exp_f32 v150, v150
 v_mfma_f32_16x16x32_bf16 v[140:143], a[12:15], a[76:79], v[140:143]
 ds_read_b128 a[0:3], v192 offset:57344
 v_cvt_pk_bf16_f32 v162, v152, v153
 v_mfma_f32_16x16x32_bf16 v[136:139], a[12:15], a[72:75], v[136:139]
 s_waitcnt lgkmcnt(4)
 v_exp_f32 v151, v151
 v_mfma_f32_16x16x32_bf16 v[128:131], a[16:19], a[80:83], v[128:131]
 ds_read_b128 a[4:7], v192 offset:57856
 v_cvt_pk_bf16_f32 v163, v154, v155
 v_mfma_f32_16x16x32_bf16 v[132:135], a[16:19], a[84:87], v[132:135]
 s_waitcnt lgkmcnt(4)
 v_exp_f32 v156, v156
 v_mfma_f32_16x16x32_bf16 v[140:143], a[20:23], a[84:87], v[140:143]
 ds_read_b128 a[8:11], v193 offset:57344
 v_cvt_pk_bf16_f32 v164, v148, v149
 v_mfma_f32_16x16x32_bf16 v[136:139], a[20:23], a[80:83], v[136:139]
 s_waitcnt lgkmcnt(4)
 buffer_load_dwordx4 v211, s[8:11], s34 offen offset:1024 nt lds
 v_cvt_pk_bf16_f32 v165, v150, v151
 v_mfma_f32_16x16x32_bf16 v[128:131], a[24:27], a[88:91], v[128:131]
 ds_read_b128 a[12:15], v193 offset:57856
 v_add_f32 v222, v154, v222
 v_mfma_f32_16x16x32_bf16 v[132:135], a[24:27], a[92:95], v[132:135]
 s_waitcnt lgkmcnt(4)
 v_exp_f32 v157, v157
 v_mfma_f32_16x16x32_bf16 v[140:143], a[28:31], a[92:95], v[140:143]
 ds_read_b128 a[16:19], v192 offset:61440
 v_cvt_pk_bf16_f32 v166, v156, v157
 v_mfma_f32_16x16x32_bf16 v[136:139], a[28:31], a[88:91], v[136:139]
 s_waitcnt lgkmcnt(4)
 v_exp_f32 v158, v158
 v_mfma_f32_16x16x32_bf16 v[128:131], a[0:3], a[96:99], v[128:131]
 ds_read_b128 a[20:23], v192 offset:61952
 v_add_f32 v222, v155, v222
 v_mfma_f32_16x16x32_bf16 v[132:135], a[0:3], a[100:103], v[132:135]
 s_waitcnt lgkmcnt(4)
 v_exp_f32 v159, v159
 v_mfma_f32_16x16x32_bf16 v[140:143], a[4:7], a[100:103], v[140:143]
 ds_read_b128 a[24:27], v193 offset:61440
 buffer_load_dwordx4 v212, s[8:11], s34 offen offset:2048 nt lds
 v_mfma_f32_16x16x32_bf16 v[136:139], a[4:7], a[96:99], v[136:139]
 s_waitcnt lgkmcnt(4)
 v_cvt_pk_bf16_f32 v167, v158, v159
 v_add_f32 v223, v148, v223
 v_mfma_f32_16x16x32_bf16 v[128:131], a[8:11], a[104:107], v[128:131]
 ds_read_b128 a[28:31], v193 offset:61952
 v_add_f32 v223, v149, v223
 v_mfma_f32_16x16x32_bf16 v[132:135], a[8:11], a[108:111], v[132:135]
 s_waitcnt lgkmcnt(4)
 v_add_f32 v223, v150, v223
 v_add_f32 v223, v151, v223
 v_mfma_f32_16x16x32_bf16 v[140:143], a[12:15], a[108:111], v[140:143]
 ds_read_b64_tr_b16 a[0:1], v202 offset:0
 ds_read_b64_tr_b16 a[2:3], v202 offset:512
 v_mfma_f32_16x16x32_bf16 v[136:139], a[12:15], a[104:107], v[136:139]
 s_waitcnt lgkmcnt(5)
 v_add_f32 v223, v156, v223
 v_add_f32 v223, v157, v223
 v_mfma_f32_16x16x32_bf16 v[128:131], a[16:19], a[112:115], v[128:131]
 ds_read_b64_tr_b16 a[4:5], v203 offset:0
 ds_read_b64_tr_b16 a[6:7], v203 offset:512
 v_mfma_f32_16x16x32_bf16 v[132:135], a[16:19], a[116:119], v[132:135]
 s_waitcnt lgkmcnt(6)
 buffer_load_dwordx4 v213, s[8:11], s34 offen offset:3072 nt lds
 v_add_f32 v223, v158, v223
 v_mfma_f32_16x16x32_bf16 v[140:143], a[20:23], a[116:119], v[140:143]
 ds_read_b64_tr_b16 a[8:9], v204 offset:0
 ds_read_b64_tr_b16 a[10:11], v204 offset:512
 v_mfma_f32_16x16x32_bf16 v[136:139], a[20:23], a[112:115], v[136:139]
 s_waitcnt lgkmcnt(7)
 v_add_f32 v223, v159, v223
 v_mfma_f32_16x16x32_bf16 v[128:131], a[24:27], a[120:123], v[128:131]
 ds_read_b64_tr_b16 a[12:13], v205 offset:0
 ds_read_b64_tr_b16 a[14:15], v205 offset:512
 v_mfma_f32_16x16x32_bf16 v[132:135], a[24:27], a[124:127], v[132:135]
 s_waitcnt lgkmcnt(8)
 v_mfma_f32_16x16x32_bf16 v[140:143], a[28:31], a[124:127], v[140:143]
 ds_read_b64_tr_b16 a[16:17], v202 offset:4096
 ds_read_b64_tr_b16 a[18:19], v202 offset:4608
 v_mfma_f32_16x16x32_bf16 v[136:139], a[28:31], a[120:123], v[136:139]
 s_waitcnt lgkmcnt(8)
 v_mfma_f32_16x16x32_bf16 v[0:3], a[0:3], v[160:163], v[0:3]
 ds_read_b64_tr_b16 a[20:21], v203 offset:4096
 ds_read_b64_tr_b16 a[22:23], v203 offset:4608
 v_mfma_f32_16x16x32_bf16 v[4:7], a[0:3], v[164:167], v[4:7]
 s_waitcnt vmcnt(21) lgkmcnt(8)
 v_max3_f32 v224, v128, v129, v130
 v_max3_f32 v224, v131, v132, v224
 v_mfma_f32_16x16x32_bf16 v[12:15], a[4:7], v[164:167], v[12:15]
 s_barrier
 ds_read_b64_tr_b16 a[24:25], v204 offset:4096
 ds_read_b64_tr_b16 a[26:27], v204 offset:4608
 v_mfma_f32_16x16x32_bf16 v[8:11], a[4:7], v[160:163], v[8:11]
 s_waitcnt lgkmcnt(8)
 v_max3_f32 v224, v133, v134, v224
 v_max3_f32 v224, v135, v136, v224
 v_mfma_f32_16x16x32_bf16 v[16:19], a[8:11], v[160:163], v[16:19]
 s_add_u32 m0, s33, 32768
 ds_read_b64_tr_b16 a[28:29], v205 offset:4096
 ds_read_b64_tr_b16 a[30:31], v205 offset:4608
 v_mfma_f32_16x16x32_bf16 v[20:23], a[8:11], v[164:167], v[20:23]
 s_waitcnt lgkmcnt(8)
 v_max3_f32 v224, v137, v138, v224
 v_max3_f32 v224, v139, v140, v224
 v_mfma_f32_16x16x32_bf16 v[28:31], a[12:15], v[164:167], v[28:31]
 s_mov_b32 s34, 376832
 ds_read_b64_tr_b16 a[0:1], v202 offset:8192
 ds_read_b64_tr_b16 a[2:3], v202 offset:8704
 v_mfma_f32_16x16x32_bf16 v[24:27], a[12:15], v[160:163], v[24:27]
 s_waitcnt lgkmcnt(8)
 buffer_load_dwordx4 v210, s[12:15], s34 offen nt lds
 v_max3_f32 v224, v141, v142, v224
 v_mfma_f32_16x16x32_bf16 v[32:35], a[16:19], v[160:163], v[32:35]
 ds_read_b64_tr_b16 a[4:5], v203 offset:8192
 ds_read_b64_tr_b16 a[6:7], v203 offset:8704
 v_mfma_f32_16x16x32_bf16 v[36:39], a[16:19], v[164:167], v[36:39]
 s_waitcnt lgkmcnt(8)
 v_max_f32 v224, v143, v224
 v_cmp_lt_f32 vcc, s35, v224
 v_mfma_f32_16x16x32_bf16 v[44:47], a[20:23], v[164:167], v[44:47]
 s_cbranch_vccnz L_stub19
L_ret19:
 ds_read_b64_tr_b16 a[8:9], v204 offset:8192
 ds_read_b64_tr_b16 a[10:11], v204 offset:8704
 v_mfma_f32_16x16x32_bf16 v[40:43], a[20:23], v[160:163], v[40:43]
 s_waitcnt lgkmcnt(8)
 v_exp_f32 v128, v128
 v_mfma_f32_16x16x32_bf16 v[48:51], a[24:27], v[160:163], v[48:51]
 ds_read_b64_tr_b16 a[12:13], v205 offset:8192
 ds_read_b64_tr_b16 a[14:15], v205 offset:8704
 v_mfma_f32_16x16x32_bf16 v[52:55], a[24:27], v[164:167], v[52:55]
 s_waitcnt lgkmcnt(8)
 v_exp_f32 v129, v129
 v_mfma_f32_16x16x32_bf16 v[60:63], a[28:31], v[164:167], v[60:63]
 ds_read_b64_tr_b16 a[16:17], v202 offset:12288
 ds_read_b64_tr_b16 a[18:19], v202 offset:12800
 v_mfma_f32_16x16x32_bf16 v[56:59], a[28:31], v[160:163], v[56:59]
 s_waitcnt lgkmcnt(8)
 buffer_load_dwordx4 v211, s[12:15], s34 offen offset:1024 nt lds
 v_add_f32 v222, v128, v222
 v_mfma_f32_16x16x32_bf16 v[64:67], a[0:3], v[160:163], v[64:67]
 ds_read_b64_tr_b16 a[20:21], v203 offset:12288
 ds_read_b64_tr_b16 a[22:23], v203 offset:12800
 v_mfma_f32_16x16x32_bf16 v[68:71], a[0:3], v[164:167], v[68:71]
 s_waitcnt lgkmcnt(8)
 v_exp_f32 v130, v130
 v_mfma_f32_16x16x32_bf16 v[76:79], a[4:7], v[164:167], v[76:79]
 ds_read_b64_tr_b16 a[24:25], v204 offset:12288
 ds_read_b64_tr_b16 a[26:27], v204 offset:12800
 v_mfma_f32_16x16x32_bf16 v[72:75], a[4:7], v[160:163], v[72:75]
 s_waitcnt lgkmcnt(8)
 v_exp_f32 v131, v131
 v_mfma_f32_16x16x32_bf16 v[80:83], a[8:11], v[160:163], v[80:83]
 ds_read_b64_tr_b16 a[28:29], v205 offset:12288
 ds_read_b64_tr_b16 a[30:31], v205 offset:12800
 v_mfma_f32_16x16x32_bf16 v[84:87], a[8:11], v[164:167], v[84:87]
 s_waitcnt lgkmcnt(8)
 v_exp_f32 v136, v136
 v_mfma_f32_16x16x32_bf16 v[92:95], a[12:15], v[164:167], v[92:95]
 ds_read_b128 a[0:3], v194 offset:16384
 buffer_load_dwordx4 v212, s[12:15], s34 offen offset:2048 nt lds
 v_mfma_f32_16x16x32_bf16 v[88:91], a[12:15], v[160:163], v[88:91]
 s_waitcnt lgkmcnt(7)
 v_exp_f32 v137, v137
 v_mfma_f32_16x16x32_bf16 v[96:99], a[16:19], v[160:163], v[96:99]
 ds_read_b128 a[4:7], v194 offset:16896
 v_add_f32 v222, v129, v222
 v_mfma_f32_16x16x32_bf16 v[100:103], a[16:19], v[164:167], v[100:103]
 s_waitcnt lgkmcnt(6)
 v_exp_f32 v138, v138
 v_mfma_f32_16x16x32_bf16 v[108:111], a[20:23], v[164:167], v[108:111]
 ds_read_b128 a[8:11], v195 offset:16384
 v_add_f32 v222, v130, v222
 v_mfma_f32_16x16x32_bf16 v[104:107], a[20:23], v[160:163], v[104:107]
 s_waitcnt lgkmcnt(5)
 v_exp_f32 v139, v139
 v_mfma_f32_16x16x32_bf16 v[112:115], a[24:27], v[160:163], v[112:115]
 ds_read_b128 a[12:15], v195 offset:16896
 v_add_f32 v222, v131, v222
 v_mfma_f32_16x16x32_bf16 v[116:119], a[24:27], v[164:167], v[116:119]
 s_waitcnt lgkmcnt(4)
 buffer_load_dwordx4 v213, s[12:15], s34 offen offset:3072 nt lds
 v_add_f32 v222, v136, v222
 v_mfma_f32_16x16x32_bf16 v[124:127], a[28:31], v[164:167], v[124:127]
 s_add_u32 m0, s33, 49152
 ds_read_b128 a[16:19], v194 offset:20480
 v_add_f32 v222, v137, v222
 v_mfma_f32_16x16x32_bf16 v[120:123], a[28:31], v[160:163], v[120:123]
 s_waitcnt lgkmcnt(4)
 v_exp_f32 v132, v132
 s_lshr_b32 s56, s5, 1
 s_lshl_b32 s56, s56, 11
 s_and_b32 s57, s5, 1
 s_lshl_b32 s58, s57, 7
 s_add_u32 s56, s56, s58
 s_lshl_b32 s58, s32, 8
 s_add_u32 s56, s56, s58
 s_lshl_b32 s57, s5, 3
 s_mul_i32 s57, s57, 896
 s_lshl_b32 s58, s32, 3
 s_add_u32 s57, s57, s58
 v_mfma_f32_16x16x32_bf16 v[144:147], a[0:3], a[64:67], v[168:171]
 s_mov_b32 s34, 409600
 ds_read_b128 a[20:23], v194 offset:20992
 buffer_load_dwordx4 v[248:251], v239, s[48:51], 0 offen sc1
 v_mfma_f32_16x16x32_bf16 v[148:151], a[0:3], a[68:71], v[172:175]
 s_waitcnt lgkmcnt(4)
 v_exp_f32 v133, v133
 v_mfma_f32_16x16x32_bf16 v[156:159], a[4:7], a[68:71], v[172:175]
 ds_read_b128 a[24:27], v195 offset:20480
 v_cvt_pk_bf16_f32 v160, v128, v129
 v_mfma_f32_16x16x32_bf16 v[152:155], a[4:7], a[64:67], v[168:171]
 s_waitcnt lgkmcnt(4)
 v_exp_f32 v134, v134
 v_mfma_f32_16x16x32_bf16 v[144:147], a[8:11], a[72:75], v[144:147]
 ds_read_b128 a[28:31], v195 offset:20992
 buffer_load_dwordx4 v210, s[8:11], s34 offen nt lds
 v_mfma_f32_16x16x32_bf16 v[148:151], a[8:11], a[76:79], v[148:151]
 s_waitcnt lgkmcnt(4)
 v_exp_f32 v135, v135
 v_mfma_f32_16x16x32_bf16 v[156:159], a[12:15], a[76:79], v[156:159]
 ds_read_b128 a[0:3], v194 offset:24576
 v_cvt_pk_bf16_f32 v161, v130, v131
 v_mfma_f32_16x16x32_bf16 v[152:155], a[12:15], a[72:75], v[152:155]
 s_waitcnt lgkmcnt(4)
 v_exp_f32 v140, v140
 v_mfma_f32_16x16x32_bf16 v[144:147], a[16:19], a[80:83], v[144:147]
 ds_read_b128 a[4:7], v194 offset:25088
 v_cvt_pk_bf16_f32 v162, v136, v137
 v_mfma_f32_16x16x32_bf16 v[148:151], a[16:19], a[84:87], v[148:151]
 s_waitcnt lgkmcnt(4)
 v_exp_f32 v141, v141
 v_mfma_f32_16x16x32_bf16 v[156:159], a[20:23], a[84:87], v[156:159]
 ds_read_b128 a[8:11], v195 offset:24576
 v_cvt_pk_bf16_f32 v163, v138, v139
 v_mfma_f32_16x16x32_bf16 v[152:155], a[20:23], a[80:83], v[152:155]
 s_waitcnt lgkmcnt(4)
 buffer_load_dwordx4 v211, s[8:11], s34 offen offset:1024 nt lds
 v_cvt_pk_bf16_f32 v164, v132, v133
 v_mfma_f32_16x16x32_bf16 v[144:147], a[24:27], a[88:91], v[144:147]
 ds_read_b128 a[12:15], v195 offset:25088
 v_cvt_pk_bf16_f32 v165, v134, v135
 v_mfma_f32_16x16x32_bf16 v[148:151], a[24:27], a[92:95], v[148:151]
 s_waitcnt lgkmcnt(4)
 v_exp_f32 v142, v142
 v_mfma_f32_16x16x32_bf16 v[156:159], a[28:31], a[92:95], v[156:159]
 ds_read_b128 a[16:19], v194 offset:28672
 v_cvt_pk_bf16_f32 v166, v140, v141
 v_mfma_f32_16x16x32_bf16 v[152:155], a[28:31], a[88:91], v[152:155]
 s_waitcnt lgkmcnt(4)
 v_exp_f32 v143, v143
 v_mfma_f32_16x16x32_bf16 v[144:147], a[0:3], a[96:99], v[144:147]
 ds_read_b128 a[20:23], v194 offset:29184
 v_cvt_pk_bf16_f32 v167, v142, v143
 v_mfma_f32_16x16x32_bf16 v[148:151], a[0:3], a[100:103], v[148:151]
 s_waitcnt lgkmcnt(4)
 v_add_f32 v222, v138, v222
 v_add_f32 v222, v139, v222
 v_mfma_f32_16x16x32_bf16 v[156:159], a[4:7], a[100:103], v[156:159]
 ds_read_b128 a[24:27], v195 offset:28672
 buffer_load_dwordx4 v212, s[8:11], s34 offen offset:2048 nt lds
 v_mfma_f32_16x16x32_bf16 v[152:155], a[4:7], a[96:99], v[152:155]
 s_waitcnt lgkmcnt(4)
 v_add_f32 v223, v132, v223
 v_add_f32 v223, v133, v223
 v_mfma_f32_16x16x32_bf16 v[144:147], a[8:11], a[104:107], v[144:147]
 ds_read_b128 a[28:31], v195 offset:29184
 v_add_f32 v223, v134, v223
 v_mfma_f32_16x16x32_bf16 v[148:151], a[8:11], a[108:111], v[148:151]
 s_waitcnt lgkmcnt(4)
 v_add_f32 v223, v135, v223
 v_add_f32 v223, v140, v223
 v_mfma_f32_16x16x32_bf16 v[156:159], a[12:15], a[108:111], v[156:159]
 ds_read_b64_tr_b16 a[0:1], v202 offset:32768
 ds_read_b64_tr_b16 a[2:3], v202 offset:33280
 v_mfma_f32_16x16x32_bf16 v[152:155], a[12:15], a[104:107], v[152:155]
 s_waitcnt lgkmcnt(5)
 v_add_f32 v223, v141, v223
 v_add_f32 v223, v142, v223
 v_mfma_f32_16x16x32_bf16 v[144:147], a[16:19], a[112:115], v[144:147]
 ds_read_b64_tr_b16 a[4:5], v203 offset:32768
 ds_read_b64_tr_b16 a[6:7], v203 offset:33280
 v_mfma_f32_16x16x32_bf16 v[148:151], a[16:19], a[116:119], v[148:151]
 s_waitcnt lgkmcnt(6)
 buffer_load_dwordx4 v213, s[8:11], s34 offen offset:3072 nt lds
 v_add_f32 v223, v143, v223
 v_mfma_f32_16x16x32_bf16 v[156:159], a[20:23], a[116:119], v[156:159]
 ds_read_b64_tr_b16 a[8:9], v204 offset:32768
 ds_read_b64_tr_b16 a[10:11], v204 offset:33280
 v_mfma_f32_16x16x32_bf16 v[152:155], a[20:23], a[112:115], v[152:155]
 s_waitcnt lgkmcnt(7)
 v_lshrrev_b32 v232, 4, v244
 v_mul_u32_u24 v233, 49152, v232
 v_mfma_f32_16x16x32_bf16 v[144:147], a[24:27], a[120:123], v[144:147]
 ds_read_b64_tr_b16 a[12:13], v205 offset:32768
 ds_read_b64_tr_b16 a[14:15], v205 offset:33280
 v_mfma_f32_16x16x32_bf16 v[148:151], a[24:27], a[124:127], v[148:151]
 s_waitcnt lgkmcnt(8)
 v_bfe_u32 v234, v244, 3, 1
 v_lshl_add_u32 v233, v234, 10, v233
 v_mfma_f32_16x16x32_bf16 v[156:159], a[28:31], a[124:127], v[156:159]
 ds_read_b64_tr_b16 a[16:17], v202 offset:36864
 ds_read_b64_tr_b16 a[18:19], v202 offset:37376
 v_mfma_f32_16x16x32_bf16 v[152:155], a[28:31], a[120:123], v[152:155]
 s_waitcnt lgkmcnt(8)
 v_and_b32 v214, 7, v244
 v_lshl_add_u32 v233, v214, 4, v233
 v_mfma_f32_16x16x32_bf16 v[0:3], a[0:3], v[160:163], v[0:3]
 ds_read_b64_tr_b16 a[20:21], v203 offset:36864
 ds_read_b64_tr_b16 a[22:23], v203 offset:37376
 v_mfma_f32_16x16x32_bf16 v[4:7], a[0:3], v[164:167], v[4:7]
 s_waitcnt vmcnt(22) lgkmcnt(8)
 v_max3_f32 v224, v144, v145, v146
 v_max3_f32 v224, v147, v148, v224
 v_mfma_f32_16x16x32_bf16 v[12:15], a[4:7], v[164:167], v[12:15]
 s_barrier
 ds_read_b64_tr_b16 a[24:25], v204 offset:36864
 ds_read_b64_tr_b16 a[26:27], v204 offset:37376
 v_mfma_f32_16x16x32_bf16 v[8:11], a[4:7], v[160:163], v[8:11]
 s_waitcnt lgkmcnt(8)
 v_max3_f32 v224, v149, v150, v224
 v_max3_f32 v224, v151, v152, v224
 v_mfma_f32_16x16x32_bf16 v[16:19], a[8:11], v[160:163], v[16:19]
 s_add_u32 m0, s33, 65536
 ds_read_b64_tr_b16 a[28:29], v205 offset:36864
 ds_read_b64_tr_b16 a[30:31], v205 offset:37376
 v_mfma_f32_16x16x32_bf16 v[20:23], a[8:11], v[164:167], v[20:23]
 s_waitcnt lgkmcnt(8)
 v_max3_f32 v224, v153, v154, v224
 v_max3_f32 v224, v155, v156, v224
 v_mfma_f32_16x16x32_bf16 v[28:31], a[12:15], v[164:167], v[28:31]
 s_mov_b32 s34, 393216
 ds_read_b64_tr_b16 a[0:1], v202 offset:40960
 ds_read_b64_tr_b16 a[2:3], v202 offset:41472
 v_mfma_f32_16x16x32_bf16 v[24:27], a[12:15], v[160:163], v[24:27]
 s_waitcnt lgkmcnt(8)
 buffer_load_dwordx4 v210, s[12:15], s34 offen nt lds
 v_max3_f32 v224, v157, v158, v224
 v_mfma_f32_16x16x32_bf16 v[32:35], a[16:19], v[160:163], v[32:35]
 ds_read_b64_tr_b16 a[4:5], v203 offset:40960
 ds_read_b64_tr_b16 a[6:7], v203 offset:41472
 v_mfma_f32_16x16x32_bf16 v[36:39], a[16:19], v[164:167], v[36:39]
 s_waitcnt lgkmcnt(8)
 v_max_f32 v224, v159, v224
 v_cmp_lt_f32 vcc, s35, v224
 v_mfma_f32_16x16x32_bf16 v[44:47], a[20:23], v[164:167], v[44:47]
 s_cbranch_vccnz L_stub20
L_ret20:
 ds_read_b64_tr_b16 a[8:9], v204 offset:40960
 ds_read_b64_tr_b16 a[10:11], v204 offset:41472
 v_mfma_f32_16x16x32_bf16 v[40:43], a[20:23], v[160:163], v[40:43]
 s_waitcnt lgkmcnt(8)
 v_exp_f32 v144, v144
 v_mfma_f32_16x16x32_bf16 v[48:51], a[24:27], v[160:163], v[48:51]
 ds_read_b64_tr_b16 a[12:13], v205 offset:40960
 ds_read_b64_tr_b16 a[14:15], v205 offset:41472
 v_mfma_f32_16x16x32_bf16 v[52:55], a[24:27], v[164:167], v[52:55]
 s_waitcnt lgkmcnt(8)
 v_exp_f32 v145, v145
 v_mfma_f32_16x16x32_bf16 v[60:63], a[28:31], v[164:167], v[60:63]
 ds_read_b64_tr_b16 a[16:17], v202 offset:45056
 ds_read_b64_tr_b16 a[18:19], v202 offset:45568
 v_mfma_f32_16x16x32_bf16 v[56:59], a[28:31], v[160:163], v[56:59]
 s_waitcnt lgkmcnt(8)
 buffer_load_dwordx4 v211, s[12:15], s34 offen offset:1024 nt lds
 v_add_f32 v222, v144, v222
 v_mfma_f32_16x16x32_bf16 v[64:67], a[0:3], v[160:163], v[64:67]
 ds_read_b64_tr_b16 a[20:21], v203 offset:45056
 ds_read_b64_tr_b16 a[22:23], v203 offset:45568
 v_mfma_f32_16x16x32_bf16 v[68:71], a[0:3], v[164:167], v[68:71]
 s_waitcnt lgkmcnt(8)
 v_exp_f32 v146, v146
 v_mfma_f32_16x16x32_bf16 v[76:79], a[4:7], v[164:167], v[76:79]
 ds_read_b64_tr_b16 a[24:25], v204 offset:45056
 ds_read_b64_tr_b16 a[26:27], v204 offset:45568
 v_mfma_f32_16x16x32_bf16 v[72:75], a[4:7], v[160:163], v[72:75]
 s_waitcnt lgkmcnt(8)
 v_exp_f32 v147, v147
 v_mfma_f32_16x16x32_bf16 v[80:83], a[8:11], v[160:163], v[80:83]
 ds_read_b64_tr_b16 a[28:29], v205 offset:45056
 ds_read_b64_tr_b16 a[30:31], v205 offset:45568
 v_mfma_f32_16x16x32_bf16 v[84:87], a[8:11], v[164:167], v[84:87]
 s_waitcnt lgkmcnt(8)
 v_exp_f32 v152, v152
 v_mfma_f32_16x16x32_bf16 v[92:95], a[12:15], v[164:167], v[92:95]
 ds_read_b128 a[0:3], v194 offset:49152
 buffer_load_dwordx4 v212, s[12:15], s34 offen offset:2048 nt lds
 v_mfma_f32_16x16x32_bf16 v[88:91], a[12:15], v[160:163], v[88:91]
 s_waitcnt lgkmcnt(7)
 v_exp_f32 v153, v153
 v_mfma_f32_16x16x32_bf16 v[96:99], a[16:19], v[160:163], v[96:99]
 ds_read_b128 a[4:7], v194 offset:49664
 v_add_f32 v222, v145, v222
 v_mfma_f32_16x16x32_bf16 v[100:103], a[16:19], v[164:167], v[100:103]
 s_waitcnt lgkmcnt(6)
 v_exp_f32 v154, v154
 v_mfma_f32_16x16x32_bf16 v[108:111], a[20:23], v[164:167], v[108:111]
 ds_read_b128 a[8:11], v195 offset:49152
 v_add_f32 v222, v146, v222
 v_mfma_f32_16x16x32_bf16 v[104:107], a[20:23], v[160:163], v[104:107]
 s_waitcnt lgkmcnt(5)
 v_exp_f32 v155, v155
 v_mfma_f32_16x16x32_bf16 v[112:115], a[24:27], v[160:163], v[112:115]
 ds_read_b128 a[12:15], v195 offset:49664
 v_add_f32 v222, v147, v222
 v_mfma_f32_16x16x32_bf16 v[116:119], a[24:27], v[164:167], v[116:119]
 s_waitcnt lgkmcnt(4)
 buffer_load_dwordx4 v213, s[12:15], s34 offen offset:3072 nt lds
 v_add_f32 v222, v152, v222
 v_mfma_f32_16x16x32_bf16 v[124:127], a[28:31], v[164:167], v[124:127]
 s_add_u32 m0, s33, 81920
 ds_read_b128 a[16:19], v194 offset:53248
 v_add_f32 v222, v153, v222
 v_mfma_f32_16x16x32_bf16 v[120:123], a[28:31], v[160:163], v[120:123]
 s_waitcnt lgkmcnt(4)
 v_exp_f32 v148, v148
 v_mfma_f32_16x16x32_bf16 v[128:131], a[0:3], a[64:67], v[168:171]
 s_mov_b32 s34, 425984
 ds_read_b128 a[20:23], v194 offset:53760
 v_cvt_pk_bf16_f32 v160, v144, v145
 v_mfma_f32_16x16x32_bf16 v[132:135], a[0:3], a[68:71], v[172:175]
 s_waitcnt lgkmcnt(4)
 v_exp_f32 v149, v149
 v_mfma_f32_16x16x32_bf16 v[140:143], a[4:7], a[68:71], v[172:175]
 s_add_u32 s92, s54, 53248
 s_addc_u32 s93, s55, 0
 ds_read_b128 a[24:27], v195 offset:53248
 global_load_dword v252, v245, s[92:93]
 v_mfma_f32_16x16x32_bf16 v[136:139], a[4:7], a[64:67], v[168:171]
 s_waitcnt lgkmcnt(4)
 v_exp_f32 v150, v150
 v_mfma_f32_16x16x32_bf16 v[128:131], a[8:11], a[72:75], v[128:131]
 ds_read_b128 a[28:31], v195 offset:53760
 buffer_load_dwordx4 v210, s[8:11], s34 offen nt lds
 v_mfma_f32_16x16x32_bf16 v[132:135], a[8:11], a[76:79], v[132:135]
 s_waitcnt lgkmcnt(4)
 v_exp_f32 v151, v151
 v_mfma_f32_16x16x32_bf16 v[140:143], a[12:15], a[76:79], v[140:143]
 ds_read_b128 a[0:3], v194 offset:57344
 v_cvt_pk_bf16_f32 v161, v146, v147
 v_mfma_f32_16x16x32_bf16 v[136:139], a[12:15], a[72:75], v[136:139]
 s_waitcnt lgkmcnt(4)
 v_exp_f32 v156, v156
 v_mfma_f32_16x16x32_bf16 v[128:131], a[16:19], a[80:83], v[128:131]
 ds_read_b128 a[4:7], v194 offset:57856
 v_cvt_pk_bf16_f32 v162, v152, v153
 v_mfma_f32_16x16x32_bf16 v[132:135], a[16:19], a[84:87], v[132:135]
 s_waitcnt lgkmcnt(4)
 v_exp_f32 v157, v157
 v_mfma_f32_16x16x32_bf16 v[140:143], a[20:23], a[84:87], v[140:143]
 ds_read_b128 a[8:11], v195 offset:57344
 v_cvt_pk_bf16_f32 v163, v154, v155
 v_mfma_f32_16x16x32_bf16 v[136:139], a[20:23], a[80:83], v[136:139]
 s_waitcnt lgkmcnt(4)
 buffer_load_dwordx4 v211, s[8:11], s34 offen offset:1024 nt lds
 v_cvt_pk_bf16_f32 v164, v148, v149
 v_mfma_f32_16x16x32_bf16 v[128:131], a[24:27], a[88:91], v[128:131]
 ds_read_b128 a[12:15], v195 offset:57856
 v_cvt_pk_bf16_f32 v165, v150, v151
 v_mfma_f32_16x16x32_bf16 v[132:135], a[24:27], a[92:95], v[132:135]
 s_waitcnt lgkmcnt(4)
 v_exp_f32 v158, v158
 v_mfma_f32_16x16x32_bf16 v[140:143], a[28:31], a[92:95], v[140:143]
 ds_read_b128 a[16:19], v194 offset:61440
 v_cvt_pk_bf16_f32 v166, v156, v157
 v_mfma_f32_16x16x32_bf16 v[136:139], a[28:31], a[88:91], v[136:139]
 s_waitcnt lgkmcnt(4)
 v_exp_f32 v159, v159
 v_mfma_f32_16x16x32_bf16 v[128:131], a[0:3], a[96:99], v[128:131]
 ds_read_b128 a[20:23], v194 offset:61952
 v_cvt_pk_bf16_f32 v167, v158, v159
 v_mfma_f32_16x16x32_bf16 v[132:135], a[0:3], a[100:103], v[132:135]
 s_waitcnt lgkmcnt(4)
 v_add_f32 v222, v154, v222
 v_add_f32 v222, v155, v222
 v_mfma_f32_16x16x32_bf16 v[140:143], a[4:7], a[100:103], v[140:143]
 ds_read_b128 a[24:27], v195 offset:61440
 buffer_load_dwordx4 v212, s[8:11], s34 offen offset:2048 nt lds
 v_mfma_f32_16x16x32_bf16 v[136:139], a[4:7], a[96:99], v[136:139]
 s_waitcnt lgkmcnt(4)
 v_add_f32 v223, v148, v223
 v_add_f32 v223, v149, v223
 v_mfma_f32_16x16x32_bf16 v[128:131], a[8:11], a[104:107], v[128:131]
 ds_read_b128 a[28:31], v195 offset:61952
 v_add_f32 v223, v150, v223
 v_mfma_f32_16x16x32_bf16 v[132:135], a[8:11], a[108:111], v[132:135]
 s_waitcnt lgkmcnt(4)
 v_add_f32 v223, v151, v223
 v_add_f32 v223, v156, v223
 v_mfma_f32_16x16x32_bf16 v[140:143], a[12:15], a[108:111], v[140:143]
 ds_read_b64_tr_b16 a[0:1], v206 offset:0
 ds_read_b64_tr_b16 a[2:3], v206 offset:512
 v_mfma_f32_16x16x32_bf16 v[136:139], a[12:15], a[104:107], v[136:139]
 s_waitcnt lgkmcnt(5)
 v_add_f32 v223, v157, v223
 v_add_f32 v223, v158, v223
 v_mfma_f32_16x16x32_bf16 v[128:131], a[16:19], a[112:115], v[128:131]
 ds_read_b64_tr_b16 a[4:5], v207 offset:0
 ds_read_b64_tr_b16 a[6:7], v207 offset:512
 v_mfma_f32_16x16x32_bf16 v[132:135], a[16:19], a[116:119], v[132:135]
 s_waitcnt lgkmcnt(6)
 buffer_load_dwordx4 v213, s[8:11], s34 offen offset:3072 nt lds
 v_add_f32 v223, v159, v223
 v_mfma_f32_16x16x32_bf16 v[140:143], a[20:23], a[116:119], v[140:143]
 ds_read_b64_tr_b16 a[8:9], v208 offset:0
 ds_read_b64_tr_b16 a[10:11], v208 offset:512
 v_mfma_f32_16x16x32_bf16 v[136:139], a[20:23], a[112:115], v[136:139]
 s_waitcnt lgkmcnt(7)
 v_mul_u32_u24 v243, 896, v214
 v_lshl_add_u32 v243, v234, 6, v243
 v_mfma_f32_16x16x32_bf16 v[128:131], a[24:27], a[120:123], v[128:131]
 ds_read_b64_tr_b16 a[12:13], v209 offset:0
 ds_read_b64_tr_b16 a[14:15], v209 offset:512
 v_mfma_f32_16x16x32_bf16 v[132:135], a[24:27], a[124:127], v[132:135]
 s_waitcnt lgkmcnt(8)
 v_lshl_add_u32 v243, v232, 5, v243
 v_add_u32 v243, s57, v243
 v_mfma_f32_16x16x32_bf16 v[140:143], a[28:31], a[124:127], v[140:143]
 ds_read_b64_tr_b16 a[16:17], v206 offset:4096
 ds_read_b64_tr_b16 a[18:19], v206 offset:4608
 v_mfma_f32_16x16x32_bf16 v[136:139], a[28:31], a[120:123], v[136:139]
 s_waitcnt lgkmcnt(8)
 v_lshlrev_b32 v232, 26, v244
 v_and_b32 v232, 0x80000000, v232
 v_mfma_f32_16x16x32_bf16 v[0:3], a[0:3], v[160:163], v[0:3]
 ds_read_b64_tr_b16 a[20:21], v207 offset:4096
 ds_read_b64_tr_b16 a[22:23], v207 offset:4608
 v_mfma_f32_16x16x32_bf16 v[4:7], a[0:3], v[164:167], v[4:7]
 s_waitcnt vmcnt(22) lgkmcnt(8)
 v_max3_f32 v224, v128, v129, v130
 v_max3_f32 v224, v131, v132, v224
 v_mfma_f32_16x16x32_bf16 v[12:15], a[4:7], v[164:167], v[12:15]
 s_barrier
 ds_read_b64_tr_b16 a[24:25], v208 offset:4096
 ds_read_b64_tr_b16 a[26:27], v208 offset:4608
 v_mfma_f32_16x16x32_bf16 v[8:11], a[4:7], v[160:163], v[8:11]
 s_waitcnt lgkmcnt(8)
 v_max3_f32 v224, v133, v134, v224
 v_max3_f32 v224, v135, v136, v224
 v_mfma_f32_16x16x32_bf16 v[16:19], a[8:11], v[160:163], v[16:19]
 s_add_u32 m0, s33, 98304
 ds_read_b64_tr_b16 a[28:29], v209 offset:4096
 ds_read_b64_tr_b16 a[30:31], v209 offset:4608
 v_mfma_f32_16x16x32_bf16 v[20:23], a[8:11], v[164:167], v[20:23]
 s_waitcnt lgkmcnt(8)
 v_max3_f32 v224, v137, v138, v224
 v_max3_f32 v224, v139, v140, v224
 v_mfma_f32_16x16x32_bf16 v[28:31], a[12:15], v[164:167], v[28:31]
 s_mov_b32 s34, 409600
 ds_read_b64_tr_b16 a[0:1], v206 offset:8192
 ds_read_b64_tr_b16 a[2:3], v206 offset:8704
 v_mfma_f32_16x16x32_bf16 v[24:27], a[12:15], v[160:163], v[24:27]
 s_waitcnt lgkmcnt(8)
 buffer_load_dwordx4 v210, s[12:15], s34 offen nt lds
 v_max3_f32 v224, v141, v142, v224
 v_mfma_f32_16x16x32_bf16 v[32:35], a[16:19], v[160:163], v[32:35]
 ds_read_b64_tr_b16 a[4:5], v207 offset:8192
 ds_read_b64_tr_b16 a[6:7], v207 offset:8704
 v_mfma_f32_16x16x32_bf16 v[36:39], a[16:19], v[164:167], v[36:39]
 s_waitcnt lgkmcnt(8)
 v_max_f32 v224, v143, v224
 v_cmp_lt_f32 vcc, s35, v224
 v_mfma_f32_16x16x32_bf16 v[44:47], a[20:23], v[164:167], v[44:47]
 s_cbranch_vccnz L_stub21
L_ret21:
 ds_read_b64_tr_b16 a[8:9], v208 offset:8192
 ds_read_b64_tr_b16 a[10:11], v208 offset:8704
 v_mfma_f32_16x16x32_bf16 v[40:43], a[20:23], v[160:163], v[40:43]
 s_waitcnt lgkmcnt(8)
 v_exp_f32 v128, v128
 v_mfma_f32_16x16x32_bf16 v[48:51], a[24:27], v[160:163], v[48:51]
 ds_read_b64_tr_b16 a[12:13], v209 offset:8192
 ds_read_b64_tr_b16 a[14:15], v209 offset:8704
 v_mfma_f32_16x16x32_bf16 v[52:55], a[24:27], v[164:167], v[52:55]
 s_waitcnt lgkmcnt(8)
 v_exp_f32 v129, v129
 v_mfma_f32_16x16x32_bf16 v[60:63], a[28:31], v[164:167], v[60:63]
 ds_read_b64_tr_b16 a[16:17], v206 offset:12288
 ds_read_b64_tr_b16 a[18:19], v206 offset:12800
 v_mfma_f32_16x16x32_bf16 v[56:59], a[28:31], v[160:163], v[56:59]
 s_waitcnt lgkmcnt(8)
 buffer_load_dwordx4 v211, s[12:15], s34 offen offset:1024 nt lds
 v_add_f32 v222, v128, v222
 v_mfma_f32_16x16x32_bf16 v[64:67], a[0:3], v[160:163], v[64:67]
 ds_read_b64_tr_b16 a[20:21], v207 offset:12288
 ds_read_b64_tr_b16 a[22:23], v207 offset:12800
 v_mfma_f32_16x16x32_bf16 v[68:71], a[0:3], v[164:167], v[68:71]
 s_waitcnt lgkmcnt(8)
 v_exp_f32 v130, v130
 v_mfma_f32_16x16x32_bf16 v[76:79], a[4:7], v[164:167], v[76:79]
 ds_read_b64_tr_b16 a[24:25], v208 offset:12288
 ds_read_b64_tr_b16 a[26:27], v208 offset:12800
 v_mfma_f32_16x16x32_bf16 v[72:75], a[4:7], v[160:163], v[72:75]
 s_waitcnt lgkmcnt(8)
 v_exp_f32 v131, v131
 v_mfma_f32_16x16x32_bf16 v[80:83], a[8:11], v[160:163], v[80:83]
 ds_read_b64_tr_b16 a[28:29], v209 offset:12288
 ds_read_b64_tr_b16 a[30:31], v209 offset:12800
 v_mfma_f32_16x16x32_bf16 v[84:87], a[8:11], v[164:167], v[84:87]
 s_waitcnt lgkmcnt(8)
 v_exp_f32 v136, v136
 v_mfma_f32_16x16x32_bf16 v[92:95], a[12:15], v[164:167], v[92:95]
 ds_read_b128 a[0:3], v196 offset:16384
 buffer_load_dwordx4 v212, s[12:15], s34 offen offset:2048 nt lds
 v_mfma_f32_16x16x32_bf16 v[88:91], a[12:15], v[160:163], v[88:91]
 s_waitcnt lgkmcnt(7)
 v_exp_f32 v137, v137
 v_mfma_f32_16x16x32_bf16 v[96:99], a[16:19], v[160:163], v[96:99]
 ds_read_b128 a[4:7], v196 offset:16896
 v_add_f32 v222, v129, v222
 v_mfma_f32_16x16x32_bf16 v[100:103], a[16:19], v[164:167], v[100:103]
 s_waitcnt lgkmcnt(6)
 v_exp_f32 v138, v138
 v_mfma_f32_16x16x32_bf16 v[108:111], a[20:23], v[164:167], v[108:111]
 ds_read_b128 a[8:11], v197 offset:16384
 v_add_f32 v222, v130, v222
 v_mfma_f32_16x16x32_bf16 v[104:107], a[20:23], v[160:163], v[104:107]
 s_waitcnt lgkmcnt(5)
 v_exp_f32 v139, v139
 v_mfma_f32_16x16x32_bf16 v[112:115], a[24:27], v[160:163], v[112:115]
 ds_read_b128 a[12:15], v197 offset:16896
 v_add_f32 v222, v131, v222
 v_mfma_f32_16x16x32_bf16 v[116:119], a[24:27], v[164:167], v[116:119]
 s_waitcnt lgkmcnt(4)
 buffer_load_dwordx4 v213, s[12:15], s34 offen offset:3072 nt lds
 v_add_f32 v222, v136, v222
 v_mfma_f32_16x16x32_bf16 v[124:127], a[28:31], v[164:167], v[124:127]
 s_add_u32 m0, s33, 114688
 ds_read_b128 a[16:19], v196 offset:20480
 v_add_f32 v222, v137, v222
 v_mfma_f32_16x16x32_bf16 v[120:123], a[28:31], v[160:163], v[120:123]
 s_waitcnt lgkmcnt(4)
 v_exp_f32 v132, v132
 v_mfma_f32_16x16x32_bf16 v[144:147], a[0:3], a[64:67], v[168:171]
 s_mov_b32 s34, 442368
 ds_read_b128 a[20:23], v196 offset:20992
 v_cvt_pk_bf16_f32 v160, v128, v129
 v_mfma_f32_16x16x32_bf16 v[148:151], a[0:3], a[68:71], v[172:175]
 s_waitcnt lgkmcnt(4)
 v_exp_f32 v133, v133
 v_mfma_f32_16x16x32_bf16 v[156:159], a[4:7], a[68:71], v[172:175]
 ds_read_b128 a[24:27], v197 offset:20480
 v_cvt_pk_bf16_f32 v161, v130, v131
 v_mfma_f32_16x16x32_bf16 v[152:155], a[4:7], a[64:67], v[168:171]
 s_waitcnt lgkmcnt(4)
 v_exp_f32 v134, v134
 v_mfma_f32_16x16x32_bf16 v[144:147], a[8:11], a[72:75], v[144:147]
 ds_read_b128 a[28:31], v197 offset:20992
 buffer_load_dwordx4 v210, s[8:11], s34 offen nt lds
 v_mfma_f32_16x16x32_bf16 v[148:151], a[8:11], a[76:79], v[148:151]
 s_waitcnt lgkmcnt(4)
 v_exp_f32 v135, v135
 v_mfma_f32_16x16x32_bf16 v[156:159], a[12:15], a[76:79], v[156:159]
 ds_read_b128 a[0:3], v196 offset:24576
 v_cvt_pk_bf16_f32 v162, v136, v137
 v_mfma_f32_16x16x32_bf16 v[152:155], a[12:15], a[72:75], v[152:155]
 s_waitcnt lgkmcnt(4)
 v_exp_f32 v140, v140
 v_mfma_f32_16x16x32_bf16 v[144:147], a[16:19], a[80:83], v[144:147]
 ds_read_b128 a[4:7], v196 offset:25088
 v_cvt_pk_bf16_f32 v163, v138, v139
 v_mfma_f32_16x16x32_bf16 v[148:151], a[16:19], a[84:87], v[148:151]
 s_waitcnt lgkmcnt(4)
 v_exp_f32 v141, v141
 v_mfma_f32_16x16x32_bf16 v[156:159], a[20:23], a[84:87], v[156:159]
 ds_read_b128 a[8:11], v197 offset:24576
 v_cvt_pk_bf16_f32 v164, v132, v133
 v_mfma_f32_16x16x32_bf16 v[152:155], a[20:23], a[80:83], v[152:155]
 s_waitcnt lgkmcnt(4)
 buffer_load_dwordx4 v211, s[8:11], s34 offen offset:1024 nt lds
 v_cvt_pk_bf16_f32 v165, v134, v135
 v_mfma_f32_16x16x32_bf16 v[144:147], a[24:27], a[88:91], v[144:147]
 ds_read_b128 a[12:15], v197 offset:25088
 v_cvt_pk_bf16_f32 v166, v140, v141
 v_mfma_f32_16x16x32_bf16 v[148:151], a[24:27], a[92:95], v[148:151]
 s_waitcnt lgkmcnt(4)
 v_exp_f32 v142, v142
 v_mfma_f32_16x16x32_bf16 v[156:159], a[28:31], a[92:95], v[156:159]
 ds_read_b128 a[16:19], v196 offset:28672
 v_add_f32 v222, v138, v222
 v_mfma_f32_16x16x32_bf16 v[152:155], a[28:31], a[88:91], v[152:155]
 s_waitcnt lgkmcnt(4)
 v_exp_f32 v143, v143
 v_mfma_f32_16x16x32_bf16 v[144:147], a[0:3], a[96:99], v[144:147]
 ds_read_b128 a[20:23], v196 offset:29184
 v_cvt_pk_bf16_f32 v167, v142, v143
 v_mfma_f32_16x16x32_bf16 v[148:151], a[0:3], a[100:103], v[148:151]
 s_waitcnt lgkmcnt(4)
 v_add_f32 v222, v139, v222
 v_add_f32 v223, v132, v223
 v_mfma_f32_16x16x32_bf16 v[156:159], a[4:7], a[100:103], v[156:159]
 ds_read_b128 a[24:27], v197 offset:28672
 buffer_load_dwordx4 v212, s[8:11], s34 offen offset:2048 nt lds
 v_mfma_f32_16x16x32_bf16 v[152:155], a[4:7], a[96:99], v[152:155]
 s_waitcnt lgkmcnt(4)
 v_add_f32 v223, v133, v223
 v_add_f32 v223, v134, v223
 v_mfma_f32_16x16x32_bf16 v[144:147], a[8:11], a[104:107], v[144:147]
 ds_read_b128 a[28:31], v197 offset:29184
 v_add_f32 v223, v135, v223
 v_mfma_f32_16x16x32_bf16 v[148:151], a[8:11], a[108:111], v[148:151]
 s_waitcnt lgkmcnt(4)
 v_add_f32 v223, v140, v223
 v_add_f32 v223, v141, v223
 v_mfma_f32_16x16x32_bf16 v[156:159], a[12:15], a[108:111], v[156:159]
 ds_read_b64_tr_b16 a[0:1], v198 offset:0
 ds_read_b64_tr_b16 a[2:3], v198 offset:512
 v_mfma_f32_16x16x32_bf16 v[152:155], a[12:15], a[104:107], v[152:155]
 s_waitcnt lgkmcnt(5)
 v_add_f32 v223, v142, v223
 v_add_f32 v223, v143, v223
 v_mfma_f32_16x16x32_bf16 v[144:147], a[16:19], a[112:115], v[144:147]
 ds_read_b64_tr_b16 a[4:5], v199 offset:0
 ds_read_b64_tr_b16 a[6:7], v199 offset:512
 v_mfma_f32_16x16x32_bf16 v[148:151], a[16:19], a[116:119], v[148:151]
 s_waitcnt lgkmcnt(6)
 buffer_load_dwordx4 v213, s[8:11], s34 offen offset:3072 nt lds
 v_or_b32 v243, v243, v232
 v_mfma_f32_16x16x32_bf16 v[156:159], a[20:23], a[116:119], v[156:159]
 ds_read_b64_tr_b16 a[8:9], v200 offset:0
 ds_read_b64_tr_b16 a[10:11], v200 offset:512
 v_mfma_f32_16x16x32_bf16 v[152:155], a[20:23], a[112:115], v[152:155]
 s_waitcnt lgkmcnt(7)
 v_add_u32 v214, s56, v233
 v_add_u32 v215, 196608, v214
 v_mfma_f32_16x16x32_bf16 v[144:147], a[24:27], a[120:123], v[144:147]
 ds_read_b64_tr_b16 a[12:13], v201 offset:0
 ds_read_b64_tr_b16 a[14:15], v201 offset:512
 v_mfma_f32_16x16x32_bf16 v[148:151], a[24:27], a[124:127], v[148:151]
 s_waitcnt lgkmcnt(8)
 v_add_u32 v216, 393216, v214
 v_add_u32 v217, 589824, v214
 v_mfma_f32_16x16x32_bf16 v[156:159], a[28:31], a[124:127], v[156:159]
 ds_read_b64_tr_b16 a[16:17], v198 offset:4096
 ds_read_b64_tr_b16 a[18:19], v198 offset:4608
 v_mfma_f32_16x16x32_bf16 v[152:155], a[28:31], a[120:123], v[152:155]
 s_waitcnt lgkmcnt(8)
 v_and_b32 v232, 1, v244
 v_lshlrev_b32 v232, 4, v232
 v_mfma_f32_16x16x32_bf16 v[0:3], a[0:3], v[160:163], v[0:3]
 ds_read_b64_tr_b16 a[20:21], v199 offset:4096
 ds_read_b64_tr_b16 a[22:23], v199 offset:4608
 v_mfma_f32_16x16x32_bf16 v[4:7], a[0:3], v[164:167], v[4:7]
 s_waitcnt vmcnt(22) lgkmcnt(8)
 v_max3_f32 v224, v144, v145, v146
 v_max3_f32 v224, v147, v148, v224
 v_mfma_f32_16x16x32_bf16 v[12:15], a[4:7], v[164:167], v[12:15]
 s_barrier
 ds_read_b64_tr_b16 a[24:25], v200 offset:4096
 ds_read_b64_tr_b16 a[26:27], v200 offset:4608
 v_mfma_f32_16x16x32_bf16 v[8:11], a[4:7], v[160:163], v[8:11]
 s_waitcnt lgkmcnt(8)
 v_max3_f32 v224, v149, v150, v224
 v_max3_f32 v224, v151, v152, v224
 v_mfma_f32_16x16x32_bf16 v[16:19], a[8:11], v[160:163], v[16:19]
 s_add_u32 m0, s33, 131072
 ds_read_b64_tr_b16 a[28:29], v201 offset:4096
 ds_read_b64_tr_b16 a[30:31], v201 offset:4608
 v_mfma_f32_16x16x32_bf16 v[20:23], a[8:11], v[164:167], v[20:23]
 s_waitcnt lgkmcnt(8)
 v_max3_f32 v224, v153, v154, v224
 v_max3_f32 v224, v155, v156, v224
 v_mfma_f32_16x16x32_bf16 v[28:31], a[12:15], v[164:167], v[28:31]
 s_mov_b32 s34, 425984
 ds_read_b64_tr_b16 a[0:1], v198 offset:8192
 ds_read_b64_tr_b16 a[2:3], v198 offset:8704
 v_mfma_f32_16x16x32_bf16 v[24:27], a[12:15], v[160:163], v[24:27]
 s_waitcnt lgkmcnt(8)
 buffer_load_dwordx4 v210, s[12:15], s34 offen nt lds
 v_max3_f32 v224, v157, v158, v224
 v_mfma_f32_16x16x32_bf16 v[32:35], a[16:19], v[160:163], v[32:35]
 ds_read_b64_tr_b16 a[4:5], v199 offset:8192
 ds_read_b64_tr_b16 a[6:7], v199 offset:8704
 v_mfma_f32_16x16x32_bf16 v[36:39], a[16:19], v[164:167], v[36:39]
 s_waitcnt lgkmcnt(8)
 v_max_f32 v224, v159, v224
 v_cmp_lt_f32 vcc, s35, v224
 v_mfma_f32_16x16x32_bf16 v[44:47], a[20:23], v[164:167], v[44:47]
 s_cbranch_vccnz L_stub22
L_ret22:
 ds_read_b64_tr_b16 a[8:9], v200 offset:8192
 ds_read_b64_tr_b16 a[10:11], v200 offset:8704
 v_mfma_f32_16x16x32_bf16 v[40:43], a[20:23], v[160:163], v[40:43]
 s_waitcnt lgkmcnt(8)
 v_exp_f32 v144, v144
 v_mfma_f32_16x16x32_bf16 v[48:51], a[24:27], v[160:163], v[48:51]
 ds_read_b64_tr_b16 a[12:13], v201 offset:8192
 ds_read_b64_tr_b16 a[14:15], v201 offset:8704
 v_mfma_f32_16x16x32_bf16 v[52:55], a[24:27], v[164:167], v[52:55]
 s_waitcnt lgkmcnt(8)
 v_exp_f32 v145, v145
 v_mfma_f32_16x16x32_bf16 v[60:63], a[28:31], v[164:167], v[60:63]
 ds_read_b64_tr_b16 a[16:17], v198 offset:12288
 ds_read_b64_tr_b16 a[18:19], v198 offset:12800
 v_mfma_f32_16x16x32_bf16 v[56:59], a[28:31], v[160:163], v[56:59]
 s_waitcnt lgkmcnt(8)
 buffer_load_dwordx4 v211, s[12:15], s34 offen offset:1024 nt lds
 v_add_f32 v222, v144, v222
 v_mfma_f32_16x16x32_bf16 v[64:67], a[0:3], v[160:163], v[64:67]
 ds_read_b64_tr_b16 a[20:21], v199 offset:12288
 ds_read_b64_tr_b16 a[22:23], v199 offset:12800
 v_mfma_f32_16x16x32_bf16 v[68:71], a[0:3], v[164:167], v[68:71]
 s_waitcnt lgkmcnt(8)
 v_exp_f32 v146, v146
 v_mfma_f32_16x16x32_bf16 v[76:79], a[4:7], v[164:167], v[76:79]
 ds_read_b64_tr_b16 a[24:25], v200 offset:12288
 ds_read_b64_tr_b16 a[26:27], v200 offset:12800
 v_mfma_f32_16x16x32_bf16 v[72:75], a[4:7], v[160:163], v[72:75]
 s_waitcnt lgkmcnt(8)
 v_exp_f32 v147, v147
 v_mfma_f32_16x16x32_bf16 v[80:83], a[8:11], v[160:163], v[80:83]
 ds_read_b64_tr_b16 a[28:29], v201 offset:12288
 ds_read_b64_tr_b16 a[30:31], v201 offset:12800
 v_mfma_f32_16x16x32_bf16 v[84:87], a[8:11], v[164:167], v[84:87]
 s_waitcnt lgkmcnt(8)
 v_exp_f32 v152, v152
 v_mfma_f32_16x16x32_bf16 v[92:95], a[12:15], v[164:167], v[92:95]
 ds_read_b128 a[0:3], v192 offset:16384
 buffer_load_dwordx4 v212, s[12:15], s34 offen offset:2048 nt lds
 v_mfma_f32_16x16x32_bf16 v[88:91], a[12:15], v[160:163], v[88:91]
 s_waitcnt lgkmcnt(7)
 v_exp_f32 v153, v153
 v_mfma_f32_16x16x32_bf16 v[96:99], a[16:19], v[160:163], v[96:99]
 ds_read_b128 a[4:7], v192 offset:16896
 v_add_f32 v222, v145, v222
 v_mfma_f32_16x16x32_bf16 v[100:103], a[16:19], v[164:167], v[100:103]
 s_waitcnt lgkmcnt(6)
 v_exp_f32 v154, v154
 v_mfma_f32_16x16x32_bf16 v[108:111], a[20:23], v[164:167], v[108:111]
 ds_read_b128 a[8:11], v193 offset:16384
 v_add_f32 v222, v146, v222
 v_mfma_f32_16x16x32_bf16 v[104:107], a[20:23], v[160:163], v[104:107]
 s_waitcnt lgkmcnt(5)
 v_exp_f32 v155, v155
 v_mfma_f32_16x16x32_bf16 v[112:115], a[24:27], v[160:163], v[112:115]
 ds_read_b128 a[12:15], v193 offset:16896
 v_add_f32 v222, v147, v222
 v_mfma_f32_16x16x32_bf16 v[116:119], a[24:27], v[164:167], v[116:119]
 s_waitcnt lgkmcnt(4)
 buffer_load_dwordx4 v213, s[12:15], s34 offen offset:3072 nt lds
 v_add_f32 v222, v152, v222
 v_mfma_f32_16x16x32_bf16 v[124:127], a[28:31], v[164:167], v[124:127]
 s_add_u32 m0, s33, 147456
 ds_read_b128 a[16:19], v192 offset:20480
 v_add_f32 v222, v153, v222
 v_mfma_f32_16x16x32_bf16 v[120:123], a[28:31], v[160:163], v[120:123]
 s_waitcnt lgkmcnt(4)
 v_exp_f32 v148, v148
 v_mfma_f32_16x16x32_bf16 v[128:131], a[0:3], a[64:67], v[168:171]
 s_mov_b32 s34, 458752
 ds_read_b128 a[20:23], v192 offset:20992
 v_cvt_pk_bf16_f32 v160, v144, v145
 v_mfma_f32_16x16x32_bf16 v[132:135], a[0:3], a[68:71], v[172:175]
 s_waitcnt lgkmcnt(4)
 v_exp_f32 v149, v149
 v_mfma_f32_16x16x32_bf16 v[140:143], a[4:7], a[68:71], v[172:175]
 ds_read_b128 a[24:27], v193 offset:20480
 v_cvt_pk_bf16_f32 v161, v146, v147
 v_mfma_f32_16x16x32_bf16 v[136:139], a[4:7], a[64:67], v[168:171]
 s_waitcnt lgkmcnt(4)
 v_exp_f32 v150, v150
 v_mfma_f32_16x16x32_bf16 v[128:131], a[8:11], a[72:75], v[128:131]
 ds_read_b128 a[28:31], v193 offset:20992
 buffer_load_dwordx4 v210, s[8:11], s34 offen nt lds
 v_mfma_f32_16x16x32_bf16 v[132:135], a[8:11], a[76:79], v[132:135]
 s_waitcnt lgkmcnt(4)
 v_exp_f32 v151, v151
 v_mfma_f32_16x16x32_bf16 v[140:143], a[12:15], a[76:79], v[140:143]
 ds_read_b128 a[0:3], v192 offset:24576
 v_cvt_pk_bf16_f32 v162, v152, v153
 v_mfma_f32_16x16x32_bf16 v[136:139], a[12:15], a[72:75], v[136:139]
 s_waitcnt lgkmcnt(4)
 v_exp_f32 v156, v156
 v_mfma_f32_16x16x32_bf16 v[128:131], a[16:19], a[80:83], v[128:131]
 ds_read_b128 a[4:7], v192 offset:25088
 v_cvt_pk_bf16_f32 v163, v154, v155
 v_mfma_f32_16x16x32_bf16 v[132:135], a[16:19], a[84:87], v[132:135]
 s_waitcnt lgkmcnt(4)
 v_exp_f32 v157, v157
 v_mfma_f32_16x16x32_bf16 v[140:143], a[20:23], a[84:87], v[140:143]
 ds_read_b128 a[8:11], v193 offset:24576
 v_cvt_pk_bf16_f32 v164, v148, v149
 v_mfma_f32_16x16x32_bf16 v[136:139], a[20:23], a[80:83], v[136:139]
 s_waitcnt lgkmcnt(4)
 buffer_load_dwordx4 v211, s[8:11], s34 offen offset:1024 nt lds
 v_cvt_pk_bf16_f32 v165, v150, v151
 v_mfma_f32_16x16x32_bf16 v[128:131], a[24:27], a[88:91], v[128:131]
 ds_read_b128 a[12:15], v193 offset:25088
 v_cvt_pk_bf16_f32 v166, v156, v157
 v_mfma_f32_16x16x32_bf16 v[132:135], a[24:27], a[92:95], v[132:135]
 s_waitcnt lgkmcnt(4)
 v_exp_f32 v158, v158
 v_mfma_f32_16x16x32_bf16 v[140:143], a[28:31], a[92:95], v[140:143]
 ds_read_b128 a[16:19], v192 offset:28672
 v_add_f32 v222, v154, v222
 v_mfma_f32_16x16x32_bf16 v[136:139], a[28:31], a[88:91], v[136:139]
 s_waitcnt lgkmcnt(4)
 v_exp_f32 v159, v159
 v_mfma_f32_16x16x32_bf16 v[128:131], a[0:3], a[96:99], v[128:131]
 ds_read_b128 a[20:23], v192 offset:29184
 v_cvt_pk_bf16_f32 v167, v158, v159
 v_mfma_f32_16x16x32_bf16 v[132:135], a[0:3], a[100:103], v[132:135]
 s_waitcnt lgkmcnt(4)
 v_add_f32 v222, v155, v222
 v_add_f32 v223, v148, v223
 v_mfma_f32_16x16x32_bf16 v[140:143], a[4:7], a[100:103], v[140:143]
 ds_read_b128 a[24:27], v193 offset:28672
 buffer_load_dwordx4 v212, s[8:11], s34 offen offset:2048 nt lds
 v_mfma_f32_16x16x32_bf16 v[136:139], a[4:7], a[96:99], v[136:139]
 s_waitcnt lgkmcnt(4)
 v_add_f32 v223, v149, v223
 v_add_f32 v223, v150, v223
 v_mfma_f32_16x16x32_bf16 v[128:131], a[8:11], a[104:107], v[128:131]
 ds_read_b128 a[28:31], v193 offset:29184
 v_add_f32 v223, v151, v223
 v_mfma_f32_16x16x32_bf16 v[132:135], a[8:11], a[108:111], v[132:135]
 s_waitcnt lgkmcnt(4)
 v_add_f32 v223, v156, v223
 v_add_f32 v223, v157, v223
 v_mfma_f32_16x16x32_bf16 v[140:143], a[12:15], a[108:111], v[140:143]
 ds_read_b64_tr_b16 a[0:1], v198 offset:32768
 ds_read_b64_tr_b16 a[2:3], v198 offset:33280
 v_mfma_f32_16x16x32_bf16 v[136:139], a[12:15], a[104:107], v[136:139]
 s_waitcnt lgkmcnt(5)
 v_add_f32 v223, v158, v223
 v_add_f32 v223, v159, v223
 v_mfma_f32_16x16x32_bf16 v[128:131], a[16:19], a[112:115], v[128:131]
 ds_read_b64_tr_b16 a[4:5], v199 offset:32768
 ds_read_b64_tr_b16 a[6:7], v199 offset:33280
 v_mfma_f32_16x16x32_bf16 v[132:135], a[16:19], a[116:119], v[132:135]
 s_waitcnt lgkmcnt(6)
 buffer_load_dwordx4 v213, s[8:11], s34 offen offset:3072 nt lds
 v_mov_b32 v233, 0x3f80
 v_mfma_f32_16x16x32_bf16 v[140:143], a[20:23], a[116:119], v[140:143]
 ds_read_b64_tr_b16 a[8:9], v200 offset:32768
 ds_read_b64_tr_b16 a[10:11], v200 offset:33280
 v_mfma_f32_16x16x32_bf16 v[136:139], a[20:23], a[112:115], v[136:139]
 s_waitcnt lgkmcnt(7)
 v_lshlrev_b32 v233, v232, v233
 v_bfe_u32 v232, v244, 1, 3
 v_mfma_f32_16x16x32_bf16 v[128:131], a[24:27], a[120:123], v[128:131]
 ds_read_b64_tr_b16 a[12:13], v201 offset:32768
 ds_read_b64_tr_b16 a[14:15], v201 offset:33280
 v_mfma_f32_16x16x32_bf16 v[132:135], a[24:27], a[124:127], v[132:135]
 s_waitcnt lgkmcnt(8)
 v_xor_b32 v234, 0, v232
 v_min_u32 v234, 1, v234
 v_mfma_f32_16x16x32_bf16 v[140:143], a[28:31], a[124:127], v[140:143]
 ds_read_b64_tr_b16 a[16:17], v198 offset:36864
 ds_read_b64_tr_b16 a[18:19], v198 offset:37376
 v_mfma_f32_16x16x32_bf16 v[136:139], a[28:31], a[120:123], v[136:139]
 s_waitcnt lgkmcnt(8)
 v_add_u32 v234, -1, v234
 v_and_b32 v234, v234, v233
 v_mfma_f32_16x16x32_bf16 v[0:3], a[0:3], v[160:163], v[0:3]
 ds_read_b64_tr_b16 a[20:21], v199 offset:36864
 ds_read_b64_tr_b16 a[22:23], v199 offset:37376
 v_mfma_f32_16x16x32_bf16 v[4:7], a[0:3], v[164:167], v[4:7]
 s_waitcnt vmcnt(21) lgkmcnt(8)
 v_max3_f32 v224, v128, v129, v130
 v_max3_f32 v224, v131, v132, v224
 v_mfma_f32_16x16x32_bf16 v[12:15], a[4:7], v[164:167], v[12:15]
 s_barrier
 ds_read_b64_tr_b16 a[24:25], v200 offset:36864
 ds_read_b64_tr_b16 a[26:27], v200 offset:37376
 v_mfma_f32_16x16x32_bf16 v[8:11], a[4:7], v[160:163], v[8:11]
 s_waitcnt lgkmcnt(8)
 v_max3_f32 v224, v133, v134, v224
 v_max3_f32 v224, v135, v136, v224
 v_mfma_f32_16x16x32_bf16 v[16:19], a[8:11], v[160:163], v[16:19]
 s_add_u32 m0, s33, 0
 ds_read_b64_tr_b16 a[28:29], v201 offset:36864
 ds_read_b64_tr_b16 a[30:31], v201 offset:37376
 v_mfma_f32_16x16x32_bf16 v[20:23], a[8:11], v[164:167], v[20:23]
 s_waitcnt lgkmcnt(8)
 v_max3_f32 v224, v137, v138, v224
 v_max3_f32 v224, v139, v140, v224
 v_mfma_f32_16x16x32_bf16 v[28:31], a[12:15], v[164:167], v[28:31]
 s_mov_b32 s34, 442368
 ds_read_b64_tr_b16 a[0:1], v198 offset:40960
 ds_read_b64_tr_b16 a[2:3], v198 offset:41472
 v_mfma_f32_16x16x32_bf16 v[24:27], a[12:15], v[160:163], v[24:27]
 s_waitcnt lgkmcnt(8)
 buffer_load_dwordx4 v210, s[12:15], s34 offen nt lds
 v_max3_f32 v224, v141, v142, v224
 v_mfma_f32_16x16x32_bf16 v[32:35], a[16:19], v[160:163], v[32:35]
 ds_read_b64_tr_b16 a[4:5], v199 offset:40960
 ds_read_b64_tr_b16 a[6:7], v199 offset:41472
 v_mfma_f32_16x16x32_bf16 v[36:39], a[16:19], v[164:167], v[36:39]
 s_waitcnt lgkmcnt(8)
 v_max_f32 v224, v143, v224
 v_cmp_lt_f32 vcc, s35, v224
 v_mfma_f32_16x16x32_bf16 v[44:47], a[20:23], v[164:167], v[44:47]
 s_cbranch_vccnz L_stub23
L_ret23:
 ds_read_b64_tr_b16 a[8:9], v200 offset:40960
 ds_read_b64_tr_b16 a[10:11], v200 offset:41472
 v_mfma_f32_16x16x32_bf16 v[40:43], a[20:23], v[160:163], v[40:43]
 s_waitcnt lgkmcnt(8)
 v_exp_f32 v128, v128
 v_mfma_f32_16x16x32_bf16 v[48:51], a[24:27], v[160:163], v[48:51]
 ds_read_b64_tr_b16 a[12:13], v201 offset:40960
 ds_read_b64_tr_b16 a[14:15], v201 offset:41472
 v_mfma_f32_16x16x32_bf16 v[52:55], a[24:27], v[164:167], v[52:55]
 s_waitcnt lgkmcnt(8)
 v_exp_f32 v129, v129
 v_mfma_f32_16x16x32_bf16 v[60:63], a[28:31], v[164:167], v[60:63]
 ds_read_b64_tr_b16 a[16:17], v198 offset:45056
 ds_read_b64_tr_b16 a[18:19], v198 offset:45568
 v_mfma_f32_16x16x32_bf16 v[56:59], a[28:31], v[160:163], v[56:59]
 s_waitcnt lgkmcnt(8)
 buffer_load_dwordx4 v211, s[12:15], s34 offen offset:1024 nt lds
 v_add_f32 v222, v128, v222
 v_mfma_f32_16x16x32_bf16 v[64:67], a[0:3], v[160:163], v[64:67]
 ds_read_b64_tr_b16 a[20:21], v199 offset:45056
 ds_read_b64_tr_b16 a[22:23], v199 offset:45568
 v_mfma_f32_16x16x32_bf16 v[68:71], a[0:3], v[164:167], v[68:71]
 s_waitcnt lgkmcnt(8)
 v_exp_f32 v130, v130
 v_mfma_f32_16x16x32_bf16 v[76:79], a[4:7], v[164:167], v[76:79]
 ds_read_b64_tr_b16 a[24:25], v200 offset:45056
 ds_read_b64_tr_b16 a[26:27], v200 offset:45568
 v_mfma_f32_16x16x32_bf16 v[72:75], a[4:7], v[160:163], v[72:75]
 s_waitcnt lgkmcnt(8)
 v_exp_f32 v131, v131
 v_mfma_f32_16x16x32_bf16 v[80:83], a[8:11], v[160:163], v[80:83]
 ds_read_b64_tr_b16 a[28:29], v201 offset:45056
 ds_read_b64_tr_b16 a[30:31], v201 offset:45568
 v_mfma_f32_16x16x32_bf16 v[84:87], a[8:11], v[164:167], v[84:87]
 s_waitcnt lgkmcnt(8)
 v_exp_f32 v136, v136
 v_mfma_f32_16x16x32_bf16 v[92:95], a[12:15], v[164:167], v[92:95]
 ds_read_b128 a[0:3], v192 offset:49152
 buffer_load_dwordx4 v212, s[12:15], s34 offen offset:2048 nt lds
 v_mfma_f32_16x16x32_bf16 v[88:91], a[12:15], v[160:163], v[88:91]
 s_waitcnt lgkmcnt(7)
 v_exp_f32 v137, v137
 v_mfma_f32_16x16x32_bf16 v[96:99], a[16:19], v[160:163], v[96:99]
 ds_read_b128 a[4:7], v192 offset:49664
 v_add_f32 v222, v129, v222
 v_mfma_f32_16x16x32_bf16 v[100:103], a[16:19], v[164:167], v[100:103]
 s_waitcnt lgkmcnt(6)
 v_exp_f32 v138, v138
 v_mfma_f32_16x16x32_bf16 v[108:111], a[20:23], v[164:167], v[108:111]
 ds_read_b128 a[8:11], v193 offset:49152
 v_add_f32 v222, v130, v222
 v_mfma_f32_16x16x32_bf16 v[104:107], a[20:23], v[160:163], v[104:107]
 s_waitcnt lgkmcnt(5)
 v_exp_f32 v139, v139
 v_mfma_f32_16x16x32_bf16 v[112:115], a[24:27], v[160:163], v[112:115]
 ds_read_b128 a[12:15], v193 offset:49664
 v_add_f32 v222, v131, v222
 v_mfma_f32_16x16x32_bf16 v[116:119], a[24:27], v[164:167], v[116:119]
 s_waitcnt lgkmcnt(4)
 buffer_load_dwordx4 v213, s[12:15], s34 offen offset:3072 nt lds
 v_add_f32 v222, v136, v222
 v_mfma_f32_16x16x32_bf16 v[124:127], a[28:31], v[164:167], v[124:127]
 s_add_u32 m0, s33, 16384
 ds_read_b128 a[16:19], v192 offset:53248
 v_add_f32 v222, v137, v222
 v_mfma_f32_16x16x32_bf16 v[120:123], a[28:31], v[160:163], v[120:123]
 s_waitcnt lgkmcnt(4)
 v_exp_f32 v132, v132
 v_mfma_f32_16x16x32_bf16 v[144:147], a[0:3], a[64:67], v[168:171]
 s_mov_b32 s34, 475136
 ds_read_b128 a[20:23], v192 offset:53760
 v_cvt_pk_bf16_f32 v160, v128, v129
 v_mfma_f32_16x16x32_bf16 v[148:151], a[0:3], a[68:71], v[172:175]
 s_waitcnt lgkmcnt(4)
 v_exp_f32 v133, v133
 v_mfma_f32_16x16x32_bf16 v[156:159], a[4:7], a[68:71], v[172:175]
 s_add_u32 s92, s54, 57344
 s_addc_u32 s93, s55, 0
 ds_read_b128 a[24:27], v193 offset:53248
 global_load_dword v252, v245, s[92:93]
 v_mfma_f32_16x16x32_bf16 v[152:155], a[4:7], a[64:67], v[168:171]
 s_waitcnt lgkmcnt(4)
 v_exp_f32 v134, v134
 v_mfma_f32_16x16x32_bf16 v[144:147], a[8:11], a[72:75], v[144:147]
 ds_read_b128 a[28:31], v193 offset:53760
 buffer_load_dwordx4 v210, s[8:11], s34 offen nt lds
 v_mfma_f32_16x16x32_bf16 v[148:151], a[8:11], a[76:79], v[148:151]
 s_waitcnt lgkmcnt(4)
 v_exp_f32 v135, v135
 v_mfma_f32_16x16x32_bf16 v[156:159], a[12:15], a[76:79], v[156:159]
 ds_read_b128 a[0:3], v192 offset:57344
 v_cvt_pk_bf16_f32 v161, v130, v131
 v_mfma_f32_16x16x32_bf16 v[152:155], a[12:15], a[72:75], v[152:155]
 s_waitcnt lgkmcnt(4)
 v_exp_f32 v140, v140
 v_mfma_f32_16x16x32_bf16 v[144:147], a[16:19], a[80:83], v[144:147]
 ds_read_b128 a[4:7], v192 offset:57856
 v_cvt_pk_bf16_f32 v162, v136, v137
 v_mfma_f32_16x16x32_bf16 v[148:151], a[16:19], a[84:87], v[148:151]
 s_waitcnt lgkmcnt(4)
 v_exp_f32 v141, v141
 v_mfma_f32_16x16x32_bf16 v[156:159], a[20:23], a[84:87], v[156:159]
 ds_read_b128 a[8:11], v193 offset:57344
 v_cvt_pk_bf16_f32 v163, v138, v139
 v_mfma_f32_16x16x32_bf16 v[152:155], a[20:23], a[80:83], v[152:155]
 s_waitcnt lgkmcnt(4)
 buffer_load_dwordx4 v211, s[8:11], s34 offen offset:1024 nt lds
 v_cvt_pk_bf16_f32 v164, v132, v133
 v_mfma_f32_16x16x32_bf16 v[144:147], a[24:27], a[88:91], v[144:147]
 ds_read_b128 a[12:15], v193 offset:57856
 v_cvt_pk_bf16_f32 v165, v134, v135
 v_mfma_f32_16x16x32_bf16 v[148:151], a[24:27], a[92:95], v[148:151]
 s_waitcnt lgkmcnt(4)
 v_exp_f32 v142, v142
 v_mfma_f32_16x16x32_bf16 v[156:159], a[28:31], a[92:95], v[156:159]
 ds_read_b128 a[16:19], v192 offset:61440
 v_cvt_pk_bf16_f32 v166, v140, v141
 v_mfma_f32_16x16x32_bf16 v[152:155], a[28:31], a[88:91], v[152:155]
 s_waitcnt lgkmcnt(4)
 v_exp_f32 v143, v143
 v_mfma_f32_16x16x32_bf16 v[144:147], a[0:3], a[96:99], v[144:147]
 ds_read_b128 a[20:23], v192 offset:61952
 v_cvt_pk_bf16_f32 v167, v142, v143
 v_mfma_f32_16x16x32_bf16 v[148:151], a[0:3], a[100:103], v[148:151]
 s_waitcnt lgkmcnt(4)
 v_add_f32 v222, v138, v222
 v_add_f32 v222, v139, v222
 v_mfma_f32_16x16x32_bf16 v[156:159], a[4:7], a[100:103], v[156:159]
 ds_read_b128 a[24:27], v193 offset:61440
 buffer_load_dwordx4 v212, s[8:11], s34 offen offset:2048 nt lds
 v_mfma_f32_16x16x32_bf16 v[152:155], a[4:7], a[96:99], v[152:155]
 s_waitcnt lgkmcnt(4)
 v_add_f32 v223, v132, v223
 v_add_f32 v223, v133, v223
 v_mfma_f32_16x16x32_bf16 v[144:147], a[8:11], a[104:107], v[144:147]
 ds_read_b128 a[28:31], v193 offset:61952
 v_add_f32 v223, v134, v223
 v_mfma_f32_16x16x32_bf16 v[148:151], a[8:11], a[108:111], v[148:151]
 s_waitcnt lgkmcnt(4)
 v_add_f32 v223, v135, v223
 v_add_f32 v223, v140, v223
 v_mfma_f32_16x16x32_bf16 v[156:159], a[12:15], a[108:111], v[156:159]
 ds_read_b64_tr_b16 a[0:1], v202 offset:0
 ds_read_b64_tr_b16 a[2:3], v202 offset:512
 v_mfma_f32_16x16x32_bf16 v[152:155], a[12:15], a[104:107], v[152:155]
 s_waitcnt lgkmcnt(5)
 v_add_f32 v223, v141, v223
 v_add_f32 v223, v142, v223
 v_mfma_f32_16x16x32_bf16 v[144:147], a[16:19], a[112:115], v[144:147]
 ds_read_b64_tr_b16 a[4:5], v203 offset:0
 ds_read_b64_tr_b16 a[6:7], v203 offset:512
 v_mfma_f32_16x16x32_bf16 v[148:151], a[16:19], a[116:119], v[148:151]
 s_waitcnt lgkmcnt(6)
 buffer_load_dwordx4 v213, s[8:11], s34 offen offset:3072 nt lds
 v_add_f32 v223, v143, v223
 v_mfma_f32_16x16x32_bf16 v[156:159], a[20:23], a[116:119], v[156:159]
 ds_read_b64_tr_b16 a[8:9], v204 offset:0
 ds_read_b64_tr_b16 a[10:11], v204 offset:512
 v_mfma_f32_16x16x32_bf16 v[152:155], a[20:23], a[112:115], v[152:155]
 s_waitcnt lgkmcnt(7)
 v_accvgpr_write_b32 a240, v234
 v_xor_b32 v234, 1, v232
 v_mfma_f32_16x16x32_bf16 v[144:147], a[24:27], a[120:123], v[144:147]
 ds_read_b64_tr_b16 a[12:13], v205 offset:0
 ds_read_b64_tr_b16 a[14:15], v205 offset:512
 v_mfma_f32_16x16x32_bf16 v[148:151], a[24:27], a[124:127], v[148:151]
 s_waitcnt lgkmcnt(8)
 v_min_u32 v234, 1, v234
 v_add_u32 v234, -1, v234
 v_mfma_f32_16x16x32_bf16 v[156:159], a[28:31], a[124:127], v[156:159]
 ds_read_b64_tr_b16 a[16:17], v202 offset:4096
 ds_read_b64_tr_b16 a[18:19], v202 offset:4608
 v_mfma_f32_16x16x32_bf16 v[152:155], a[28:31], a[120:123], v[152:155]
 s_waitcnt lgkmcnt(8)
 v_and_b32 v234, v234, v233
 v_accvgpr_write_b32 a241, v234
 v_mfma_f32_16x16x32_bf16 v[0:3], a[0:3], v[160:163], v[0:3]
 ds_read_b64_tr_b16 a[20:21], v203 offset:4096
 ds_read_b64_tr_b16 a[22:23], v203 offset:4608
 v_mfma_f32_16x16x32_bf16 v[4:7], a[0:3], v[164:167], v[4:7]
 s_waitcnt vmcnt(21) lgkmcnt(8)
 v_max3_f32 v224, v144, v145, v146
 v_max3_f32 v224, v147, v148, v224
 v_mfma_f32_16x16x32_bf16 v[12:15], a[4:7], v[164:167], v[12:15]
 s_barrier
 ds_read_b64_tr_b16 a[24:25], v204 offset:4096
 ds_read_b64_tr_b16 a[26:27], v204 offset:4608
 v_mfma_f32_16x16x32_bf16 v[8:11], a[4:7], v[160:163], v[8:11]
 s_waitcnt lgkmcnt(8)
 v_max3_f32 v224, v149, v150, v224
 v_max3_f32 v224, v151, v152, v224
 v_mfma_f32_16x16x32_bf16 v[16:19], a[8:11], v[160:163], v[16:19]
 s_add_u32 m0, s33, 32768
 ds_read_b64_tr_b16 a[28:29], v205 offset:4096
 ds_read_b64_tr_b16 a[30:31], v205 offset:4608
 v_mfma_f32_16x16x32_bf16 v[20:23], a[8:11], v[164:167], v[20:23]
 s_waitcnt lgkmcnt(8)
 v_max3_f32 v224, v153, v154, v224
 v_max3_f32 v224, v155, v156, v224
 v_mfma_f32_16x16x32_bf16 v[28:31], a[12:15], v[164:167], v[28:31]
 s_mov_b32 s34, 458752
 ds_read_b64_tr_b16 a[0:1], v202 offset:8192
 ds_read_b64_tr_b16 a[2:3], v202 offset:8704
 v_mfma_f32_16x16x32_bf16 v[24:27], a[12:15], v[160:163], v[24:27]
 s_waitcnt lgkmcnt(8)
 buffer_load_dwordx4 v210, s[12:15], s34 offen nt lds
 v_max3_f32 v224, v157, v158, v224
 v_mfma_f32_16x16x32_bf16 v[32:35], a[16:19], v[160:163], v[32:35]
 ds_read_b64_tr_b16 a[4:5], v203 offset:8192
 ds_read_b64_tr_b16 a[6:7], v203 offset:8704
 v_mfma_f32_16x16x32_bf16 v[36:39], a[16:19], v[164:167], v[36:39]
 s_waitcnt lgkmcnt(8)
 v_max_f32 v224, v159, v224
 v_cmp_lt_f32 vcc, s35, v224
 v_mfma_f32_16x16x32_bf16 v[44:47], a[20:23], v[164:167], v[44:47]
 s_cbranch_vccnz L_stub24
L_ret24:
 ds_read_b64_tr_b16 a[8:9], v204 offset:8192
 ds_read_b64_tr_b16 a[10:11], v204 offset:8704
 v_mfma_f32_16x16x32_bf16 v[40:43], a[20:23], v[160:163], v[40:43]
 s_waitcnt lgkmcnt(8)
 v_exp_f32 v144, v144
 v_mfma_f32_16x16x32_bf16 v[48:51], a[24:27], v[160:163], v[48:51]
 ds_read_b64_tr_b16 a[12:13], v205 offset:8192
 ds_read_b64_tr_b16 a[14:15], v205 offset:8704
 v_mfma_f32_16x16x32_bf16 v[52:55], a[24:27], v[164:167], v[52:55]
 s_waitcnt lgkmcnt(8)
 v_exp_f32 v145, v145
 v_mfma_f32_16x16x32_bf16 v[60:63], a[28:31], v[164:167], v[60:63]
 ds_read_b64_tr_b16 a[16:17], v202 offset:12288
 ds_read_b64_tr_b16 a[18:19], v202 offset:12800
 v_mfma_f32_16x16x32_bf16 v[56:59], a[28:31], v[160:163], v[56:59]
 s_waitcnt lgkmcnt(8)
 buffer_load_dwordx4 v211, s[12:15], s34 offen offset:1024 nt lds
 v_add_f32 v222, v144, v222
 v_mfma_f32_16x16x32_bf16 v[64:67], a[0:3], v[160:163], v[64:67]
 ds_read_b64_tr_b16 a[20:21], v203 offset:12288
 ds_read_b64_tr_b16 a[22:23], v203 offset:12800
 v_mfma_f32_16x16x32_bf16 v[68:71], a[0:3], v[164:167], v[68:71]
 s_waitcnt lgkmcnt(8)
 v_exp_f32 v146, v146
 v_mfma_f32_16x16x32_bf16 v[76:79], a[4:7], v[164:167], v[76:79]
 ds_read_b64_tr_b16 a[24:25], v204 offset:12288
 ds_read_b64_tr_b16 a[26:27], v204 offset:12800
 v_mfma_f32_16x16x32_bf16 v[72:75], a[4:7], v[160:163], v[72:75]
 s_waitcnt lgkmcnt(8)
 v_exp_f32 v147, v147
 v_mfma_f32_16x16x32_bf16 v[80:83], a[8:11], v[160:163], v[80:83]
 ds_read_b64_tr_b16 a[28:29], v205 offset:12288
 ds_read_b64_tr_b16 a[30:31], v205 offset:12800
 v_mfma_f32_16x16x32_bf16 v[84:87], a[8:11], v[164:167], v[84:87]
 s_waitcnt lgkmcnt(8)
 v_exp_f32 v152, v152
 v_mfma_f32_16x16x32_bf16 v[92:95], a[12:15], v[164:167], v[92:95]
 ds_read_b128 a[0:3], v194 offset:16384
 buffer_load_dwordx4 v212, s[12:15], s34 offen offset:2048 nt lds
 v_mfma_f32_16x16x32_bf16 v[88:91], a[12:15], v[160:163], v[88:91]
 s_waitcnt lgkmcnt(7)
 v_exp_f32 v153, v153
 v_mfma_f32_16x16x32_bf16 v[96:99], a[16:19], v[160:163], v[96:99]
 ds_read_b128 a[4:7], v194 offset:16896
 v_add_f32 v222, v145, v222
 v_mfma_f32_16x16x32_bf16 v[100:103], a[16:19], v[164:167], v[100:103]
 s_waitcnt lgkmcnt(6)
 v_exp_f32 v154, v154
 v_mfma_f32_16x16x32_bf16 v[108:111], a[20:23], v[164:167], v[108:111]
 ds_read_b128 a[8:11], v195 offset:16384
 v_add_f32 v222, v146, v222
 v_mfma_f32_16x16x32_bf16 v[104:107], a[20:23], v[160:163], v[104:107]
 s_waitcnt lgkmcnt(5)
 v_exp_f32 v155, v155
 v_mfma_f32_16x16x32_bf16 v[112:115], a[24:27], v[160:163], v[112:115]
 ds_read_b128 a[12:15], v195 offset:16896
 v_add_f32 v222, v147, v222
 v_mfma_f32_16x16x32_bf16 v[116:119], a[24:27], v[164:167], v[116:119]
 s_waitcnt lgkmcnt(4)
 buffer_load_dwordx4 v213, s[12:15], s34 offen offset:3072 nt lds
 v_add_f32 v222, v152, v222
 v_mfma_f32_16x16x32_bf16 v[124:127], a[28:31], v[164:167], v[124:127]
 s_add_u32 m0, s33, 49152
 ds_read_b128 a[16:19], v194 offset:20480
 v_add_f32 v222, v153, v222
 v_mfma_f32_16x16x32_bf16 v[120:123], a[28:31], v[160:163], v[120:123]
 s_waitcnt lgkmcnt(4)
 v_exp_f32 v148, v148
 v_mfma_f32_16x16x32_bf16 v[128:131], a[0:3], a[64:67], v[168:171]
 s_mov_b32 s34, 491520
 ds_read_b128 a[20:23], v194 offset:20992
 v_cvt_pk_bf16_f32 v160, v144, v145
 v_mfma_f32_16x16x32_bf16 v[132:135], a[0:3], a[68:71], v[172:175]
 s_waitcnt lgkmcnt(4)
 v_exp_f32 v149, v149
 v_mfma_f32_16x16x32_bf16 v[140:143], a[4:7], a[68:71], v[172:175]
 ds_read_b128 a[24:27], v195 offset:20480
 v_cvt_pk_bf16_f32 v161, v146, v147
 v_mfma_f32_16x16x32_bf16 v[136:139], a[4:7], a[64:67], v[168:171]
 s_waitcnt lgkmcnt(4)
 v_exp_f32 v150, v150
 v_mfma_f32_16x16x32_bf16 v[128:131], a[8:11], a[72:75], v[128:131]
 ds_read_b128 a[28:31], v195 offset:20992
 buffer_load_dwordx4 v210, s[8:11], s34 offen nt lds
 v_mfma_f32_16x16x32_bf16 v[132:135], a[8:11], a[76:79], v[132:135]
 s_waitcnt lgkmcnt(4)
 v_exp_f32 v151, v151
 v_mfma_f32_16x16x32_bf16 v[140:143], a[12:15], a[76:79], v[140:143]
 ds_read_b128 a[0:3], v194 offset:24576
 v_cvt_pk_bf16_f32 v162, v152, v153
 v_mfma_f32_16x16x32_bf16 v[136:139], a[12:15], a[72:75], v[136:139]
 s_waitcnt lgkmcnt(4)
 v_exp_f32 v156, v156
 v_mfma_f32_16x16x32_bf16 v[128:131], a[16:19], a[80:83], v[128:131]
 ds_read_b128 a[4:7], v194 offset:25088
 v_cvt_pk_bf16_f32 v163, v154, v155
 v_mfma_f32_16x16x32_bf16 v[132:135], a[16:19], a[84:87], v[132:135]
 s_waitcnt lgkmcnt(4)
 v_exp_f32 v157, v157
 v_mfma_f32_16x16x32_bf16 v[140:143], a[20:23], a[84:87], v[140:143]
 ds_read_b128 a[8:11], v195 offset:24576
 v_cvt_pk_bf16_f32 v164, v148, v149
 v_mfma_f32_16x16x32_bf16 v[136:139], a[20:23], a[80:83], v[136:139]
 s_waitcnt lgkmcnt(4)
 buffer_load_dwordx4 v211, s[8:11], s34 offen offset:1024 nt lds
 v_cvt_pk_bf16_f32 v165, v150, v151
 v_mfma_f32_16x16x32_bf16 v[128:131], a[24:27], a[88:91], v[128:131]
 ds_read_b128 a[12:15], v195 offset:25088
 v_cvt_pk_bf16_f32 v166, v156, v157
 v_mfma_f32_16x16x32_bf16 v[132:135], a[24:27], a[92:95], v[132:135]
 s_waitcnt lgkmcnt(4)
 v_exp_f32 v158, v158
 v_mfma_f32_16x16x32_bf16 v[140:143], a[28:31], a[92:95], v[140:143]
 ds_read_b128 a[16:19], v194 offset:28672
 v_add_f32 v222, v154, v222
 v_mfma_f32_16x16x32_bf16 v[136:139], a[28:31], a[88:91], v[136:139]
 s_waitcnt lgkmcnt(4)
 v_exp_f32 v159, v159
 v_mfma_f32_16x16x32_bf16 v[128:131], a[0:3], a[96:99], v[128:131]
 ds_read_b128 a[20:23], v194 offset:29184
 v_cvt_pk_bf16_f32 v167, v158, v159
 v_mfma_f32_16x16x32_bf16 v[132:135], a[0:3], a[100:103], v[132:135]
 s_waitcnt lgkmcnt(4)
 v_add_f32 v222, v155, v222
 v_add_f32 v223, v148, v223
 v_mfma_f32_16x16x32_bf16 v[140:143], a[4:7], a[100:103], v[140:143]
 ds_read_b128 a[24:27], v195 offset:28672
 buffer_load_dwordx4 v212, s[8:11], s34 offen offset:2048 nt lds
 v_mfma_f32_16x16x32_bf16 v[136:139], a[4:7], a[96:99], v[136:139]
 s_waitcnt lgkmcnt(4)
 v_add_f32 v223, v149, v223
 v_add_f32 v223, v150, v223
 v_mfma_f32_16x16x32_bf16 v[128:131], a[8:11], a[104:107], v[128:131]
 ds_read_b128 a[28:31], v195 offset:29184
 v_add_f32 v223, v151, v223
 v_mfma_f32_16x16x32_bf16 v[132:135], a[8:11], a[108:111], v[132:135]
 s_waitcnt lgkmcnt(4)
 v_add_f32 v223, v156, v223
 v_add_f32 v223, v157, v223
 v_mfma_f32_16x16x32_bf16 v[140:143], a[12:15], a[108:111], v[140:143]
 ds_read_b64_tr_b16 a[0:1], v202 offset:32768
 ds_read_b64_tr_b16 a[2:3], v202 offset:33280
 v_mfma_f32_16x16x32_bf16 v[136:139], a[12:15], a[104:107], v[136:139]
 s_waitcnt lgkmcnt(5)
 v_add_f32 v223, v158, v223
 v_add_f32 v223, v159, v223
 v_mfma_f32_16x16x32_bf16 v[128:131], a[16:19], a[112:115], v[128:131]
 ds_read_b64_tr_b16 a[4:5], v203 offset:32768
 ds_read_b64_tr_b16 a[6:7], v203 offset:33280
 v_mfma_f32_16x16x32_bf16 v[132:135], a[16:19], a[116:119], v[132:135]
 s_waitcnt lgkmcnt(6)
 buffer_load_dwordx4 v213, s[8:11], s34 offen offset:3072 nt lds
 v_xor_b32 v234, 2, v232
 v_mfma_f32_16x16x32_bf16 v[140:143], a[20:23], a[116:119], v[140:143]
 ds_read_b64_tr_b16 a[8:9], v204 offset:32768
 ds_read_b64_tr_b16 a[10:11], v204 offset:33280
 v_mfma_f32_16x16x32_bf16 v[136:139], a[20:23], a[112:115], v[136:139]
 s_waitcnt lgkmcnt(7)
 v_min_u32 v234, 1, v234
 v_add_u32 v234, -1, v234
 v_mfma_f32_16x16x32_bf16 v[128:131], a[24:27], a[120:123], v[128:131]
 ds_read_b64_tr_b16 a[12:13], v205 offset:32768
 ds_read_b64_tr_b16 a[14:15], v205 offset:33280
 v_mfma_f32_16x16x32_bf16 v[132:135], a[24:27], a[124:127], v[132:135]
 s_waitcnt lgkmcnt(8)
 v_and_b32 v234, v234, v233
 v_accvgpr_write_b32 a242, v234
 v_mfma_f32_16x16x32_bf16 v[140:143], a[28:31], a[124:127], v[140:143]
 ds_read_b64_tr_b16 a[16:17], v202 offset:36864
 ds_read_b64_tr_b16 a[18:19], v202 offset:37376
 v_mfma_f32_16x16x32_bf16 v[136:139], a[28:31], a[120:123], v[136:139]
 s_waitcnt lgkmcnt(8)
 v_xor_b32 v234, 3, v232
 v_min_u32 v234, 1, v234
 v_mfma_f32_16x16x32_bf16 v[0:3], a[0:3], v[160:163], v[0:3]
 ds_read_b64_tr_b16 a[20:21], v203 offset:36864
 ds_read_b64_tr_b16 a[22:23], v203 offset:37376
 v_mfma_f32_16x16x32_bf16 v[4:7], a[0:3], v[164:167], v[4:7]
 s_waitcnt vmcnt(21) lgkmcnt(8)
 v_max3_f32 v224, v128, v129, v130
 v_max3_f32 v224, v131, v132, v224
 v_mfma_f32_16x16x32_bf16 v[12:15], a[4:7], v[164:167], v[12:15]
 s_barrier
 ds_read_b64_tr_b16 a[24:25], v204 offset:36864
 ds_read_b64_tr_b16 a[26:27], v204 offset:37376
 v_mfma_f32_16x16x32_bf16 v[8:11], a[4:7], v[160:163], v[8:11]
 s_waitcnt lgkmcnt(8)
 v_max3_f32 v224, v133, v134, v224
 v_max3_f32 v224, v135, v136, v224
 v_mfma_f32_16x16x32_bf16 v[16:19], a[8:11], v[160:163], v[16:19]
 s_add_u32 m0, s33, 65536
 ds_read_b64_tr_b16 a[28:29], v205 offset:36864
 ds_read_b64_tr_b16 a[30:31], v205 offset:37376
 v_mfma_f32_16x16x32_bf16 v[20:23], a[8:11], v[164:167], v[20:23]
 s_waitcnt lgkmcnt(8)
 v_max3_f32 v224, v137, v138, v224
 v_max3_f32 v224, v139, v140, v224
 v_mfma_f32_16x16x32_bf16 v[28:31], a[12:15], v[164:167], v[28:31]
 s_mov_b32 s34, 475136
 ds_read_b64_tr_b16 a[0:1], v202 offset:40960
 ds_read_b64_tr_b16 a[2:3], v202 offset:41472
 v_mfma_f32_16x16x32_bf16 v[24:27], a[12:15], v[160:163], v[24:27]
 s_waitcnt lgkmcnt(8)
 buffer_load_dwordx4 v210, s[12:15], s34 offen nt lds
 v_max3_f32 v224, v141, v142, v224
 v_mfma_f32_16x16x32_bf16 v[32:35], a[16:19], v[160:163], v[32:35]
 ds_read_b64_tr_b16 a[4:5], v203 offset:40960
 ds_read_b64_tr_b16 a[6:7], v203 offset:41472
 v_mfma_f32_16x16x32_bf16 v[36:39], a[16:19], v[164:167], v[36:39]
 s_waitcnt lgkmcnt(8)
 v_max_f32 v224, v143, v224
 v_cmp_lt_f32 vcc, s35, v224
 v_mfma_f32_16x16x32_bf16 v[44:47], a[20:23], v[164:167], v[44:47]
 s_cbranch_vccnz L_stub25
L_ret25:
 ds_read_b64_tr_b16 a[8:9], v204 offset:40960
 ds_read_b64_tr_b16 a[10:11], v204 offset:41472
 v_mfma_f32_16x16x32_bf16 v[40:43], a[20:23], v[160:163], v[40:43]
 s_waitcnt lgkmcnt(8)
 v_exp_f32 v128, v128
 v_mfma_f32_16x16x32_bf16 v[48:51], a[24:27], v[160:163], v[48:51]
 ds_read_b64_tr_b16 a[12:13], v205 offset:40960
 ds_read_b64_tr_b16 a[14:15], v205 offset:41472
 v_mfma_f32_16x16x32_bf16 v[52:55], a[24:27], v[164:167], v[52:55]
 s_waitcnt lgkmcnt(8)
 v_exp_f32 v129, v129
 v_mfma_f32_16x16x32_bf16 v[60:63], a[28:31], v[164:167], v[60:63]
 ds_read_b64_tr_b16 a[16:17], v202 offset:45056
 ds_read_b64_tr_b16 a[18:19], v202 offset:45568
 v_mfma_f32_16x16x32_bf16 v[56:59], a[28:31], v[160:163], v[56:59]
 s_waitcnt lgkmcnt(8)
 buffer_load_dwordx4 v211, s[12:15], s34 offen offset:1024 nt lds
 v_add_f32 v222, v128, v222
 v_mfma_f32_16x16x32_bf16 v[64:67], a[0:3], v[160:163], v[64:67]
 ds_read_b64_tr_b16 a[20:21], v203 offset:45056
 ds_read_b64_tr_b16 a[22:23], v203 offset:45568
 v_mfma_f32_16x16x32_bf16 v[68:71], a[0:3], v[164:167], v[68:71]
 s_waitcnt lgkmcnt(8)
 v_exp_f32 v130, v130
 v_mfma_f32_16x16x32_bf16 v[76:79], a[4:7], v[164:167], v[76:79]
 ds_read_b64_tr_b16 a[24:25], v204 offset:45056
 ds_read_b64_tr_b16 a[26:27], v204 offset:45568
 v_mfma_f32_16x16x32_bf16 v[72:75], a[4:7], v[160:163], v[72:75]
 s_waitcnt lgkmcnt(8)
 v_exp_f32 v131, v131
 v_mfma_f32_16x16x32_bf16 v[80:83], a[8:11], v[160:163], v[80:83]
 ds_read_b64_tr_b16 a[28:29], v205 offset:45056
 ds_read_b64_tr_b16 a[30:31], v205 offset:45568
 v_mfma_f32_16x16x32_bf16 v[84:87], a[8:11], v[164:167], v[84:87]
 s_waitcnt lgkmcnt(8)
 v_exp_f32 v136, v136
 v_mfma_f32_16x16x32_bf16 v[92:95], a[12:15], v[164:167], v[92:95]
 ds_read_b128 a[0:3], v194 offset:49152
 buffer_load_dwordx4 v212, s[12:15], s34 offen offset:2048 nt lds
 v_mfma_f32_16x16x32_bf16 v[88:91], a[12:15], v[160:163], v[88:91]
 s_waitcnt lgkmcnt(7)
 v_exp_f32 v137, v137
 v_mfma_f32_16x16x32_bf16 v[96:99], a[16:19], v[160:163], v[96:99]
 ds_read_b128 a[4:7], v194 offset:49664
 v_add_f32 v222, v129, v222
 v_mfma_f32_16x16x32_bf16 v[100:103], a[16:19], v[164:167], v[100:103]
 s_waitcnt lgkmcnt(6)
 v_exp_f32 v138, v138
 v_mfma_f32_16x16x32_bf16 v[108:111], a[20:23], v[164:167], v[108:111]
 ds_read_b128 a[8:11], v195 offset:49152
 v_add_f32 v222, v130, v222
 v_mfma_f32_16x16x32_bf16 v[104:107], a[20:23], v[160:163], v[104:107]
 s_waitcnt lgkmcnt(5)
 v_exp_f32 v139, v139
 v_mfma_f32_16x16x32_bf16 v[112:115], a[24:27], v[160:163], v[112:115]
 ds_read_b128 a[12:15], v195 offset:49664
 v_add_f32 v222, v131, v222
 v_mfma_f32_16x16x32_bf16 v[116:119], a[24:27], v[164:167], v[116:119]
 s_waitcnt lgkmcnt(4)
 buffer_load_dwordx4 v213, s[12:15], s34 offen offset:3072 nt lds
 v_add_f32 v222, v136, v222
 v_mfma_f32_16x16x32_bf16 v[124:127], a[28:31], v[164:167], v[124:127]
 s_add_u32 m0, s33, 81920
 ds_read_b128 a[16:19], v194 offset:53248
 v_add_f32 v222, v137, v222
 v_mfma_f32_16x16x32_bf16 v[120:123], a[28:31], v[160:163], v[120:123]
 s_waitcnt lgkmcnt(4)
 v_exp_f32 v132, v132
 v_add_u32 v234, -1, v234
 v_and_b32 v234, v234, v233
 v_accvgpr_write_b32 a243, v234
L_cen_chk:
 v_readfirstlane_b32 s56, v248
 v_readfirstlane_b32 s57, v249
 v_readfirstlane_b32 s58, v250
 v_readfirstlane_b32 s59, v251
 s_mov_b32 s52, 0x80808080
 s_add_u32 s53, s56, 0x7f7f7f7f
 s_and_b32 s52, s52, s53
 s_add_u32 s53, s57, 0x7f7f7f7f
 s_and_b32 s52, s52, s53
 s_add_u32 s53, s58, 0x7f7f7f7f
 s_and_b32 s52, s52, s53
 s_add_u32 s53, s59, 0x7f7f7f7f
 s_and_b32 s52, s52, s53
 s_cmp_lg_u32 s52, 0x80808080
 s_cbranch_scc1 L_cen_spin
L_cen_ok:
 s_mul_i32 s52, s91, 0x01010101
 s_xor_b32 s56, s56, s52
 s_xor_b32 s57, s57, s52
 s_xor_b32 s58, s58, s52
 s_xor_b32 s59, s59, s52
 s_or_b32 s56, s56, s57
 s_or_b32 s58, s58, s59
 s_or_b32 s56, s56, s58
 s_cmp_lg_u32 s56, 0
 s_cselect_b64 s[94:95], -1, 0
 v_mov_b32 v239, 1
 v_mfma_f32_16x16x32_bf16 v[144:147], a[0:3], a[64:67], v[168:171]
 s_mov_b32 s34, 507904
 ds_read_b128 a[20:23], v194 offset:53760
 v_cvt_pk_bf16_f32 v160, v128, v129
 v_mfma_f32_16x16x32_bf16 v[148:151], a[0:3], a[68:71], v[172:175]
 s_waitcnt lgkmcnt(4)
 v_exp_f32 v133, v133
 v_mfma_f32_16x16x32_bf16 v[156:159], a[4:7], a[68:71], v[172:175]
 ds_read_b128 a[24:27], v195 offset:53248
 v_cvt_pk_bf16_f32 v161, v130, v131
 v_mfma_f32_16x16x32_bf16 v[152:155], a[4:7], a[64:67], v[168:171]
 s_waitcnt lgkmcnt(4)
 v_exp_f32 v134, v134
 v_mfma_f32_16x16x32_bf16 v[144:147], a[8:11], a[72:75], v[144:147]
 ds_read_b128 a[28:31], v195 offset:53760
 buffer_load_dwordx4 v210, s[8:11], s34 offen nt lds
 v_mfma_f32_16x16x32_bf16 v[148:151], a[8:11], a[76:79], v[148:151]
 s_waitcnt lgkmcnt(4)
 v_exp_f32 v135, v135
 v_mfma_f32_16x16x32_bf16 v[156:159], a[12:15], a[76:79], v[156:159]
 ds_read_b128 a[0:3], v194 offset:57344
 v_cvt_pk_bf16_f32 v162, v136, v137
 v_mfma_f32_16x16x32_bf16 v[152:155], a[12:15], a[72:75], v[152:155]
 s_waitcnt lgkmcnt(4)
 v_exp_f32 v140, v140
 v_mfma_f32_16x16x32_bf16 v[144:147], a[16:19], a[80:83], v[144:147]
 ds_read_b128 a[4:7], v194 offset:57856
 v_cvt_pk_bf16_f32 v163, v138, v139
 v_mfma_f32_16x16x32_bf16 v[148:151], a[16:19], a[84:87], v[148:151]
 s_waitcnt lgkmcnt(4)
 v_exp_f32 v141, v141
 v_mfma_f32_16x16x32_bf16 v[156:159], a[20:23], a[84:87], v[156:159]
 ds_read_b128 a[8:11], v195 offset:57344
 v_cvt_pk_bf16_f32 v164, v132, v133
 v_mfma_f32_16x16x32_bf16 v[152:155], a[20:23], a[80:83], v[152:155]
 s_waitcnt lgkmcnt(4)
 buffer_load_dwordx4 v211, s[8:11], s34 offen offset:1024 nt lds
 v_cvt_pk_bf16_f32 v165, v134, v135
 v_mfma_f32_16x16x32_bf16 v[144:147], a[24:27], a[88:91], v[144:147]
 ds_read_b128 a[12:15], v195 offset:57856
 v_cvt_pk_bf16_f32 v166, v140, v141
 v_mfma_f32_16x16x32_bf16 v[148:151], a[24:27], a[92:95], v[148:151]
 s_waitcnt lgkmcnt(4)
 v_exp_f32 v142, v142
 v_mfma_f32_16x16x32_bf16 v[156:159], a[28:31], a[92:95], v[156:159]
 ds_read_b128 a[16:19], v194 offset:61440
 v_add_f32 v222, v138, v222
 v_mfma_f32_16x16x32_bf16 v[152:155], a[28:31], a[88:91], v[152:155]
 s_waitcnt lgkmcnt(4)
 v_exp_f32 v143, v143
 v_mfma_f32_16x16x32_bf16 v[144:147], a[0:3], a[96:99], v[144:147]
 ds_read_b128 a[20:23], v194 offset:61952
 v_cvt_pk_bf16_f32 v167, v142, v143
 v_mfma_f32_16x16x32_bf16 v[148:151], a[0:3], a[100:103], v[148:151]
 s_waitcnt lgkmcnt(4)
 v_add_f32 v222, v139, v222
 v_add_f32 v223, v132, v223
 v_mfma_f32_16x16x32_bf16 v[156:159], a[4:7], a[100:103], v[156:159]
 ds_read_b128 a[24:27], v195 offset:61440
 buffer_load_dwordx4 v212, s[8:11], s34 offen offset:2048 nt lds
 v_mfma_f32_16x16x32_bf16 v[152:155], a[4:7], a[96:99], v[152:155]
 s_waitcnt lgkmcnt(4)
 v_add_f32 v223, v133, v223
 v_add_f32 v223, v134, v223
 v_mfma_f32_16x16x32_bf16 v[144:147], a[8:11], a[104:107], v[144:147]
 ds_read_b128 a[28:31], v195 offset:61952
 v_add_f32 v223, v135, v223
 v_mfma_f32_16x16x32_bf16 v[148:151], a[8:11], a[108:111], v[148:151]
 s_waitcnt lgkmcnt(4)
 v_add_f32 v223, v140, v223
 v_add_f32 v223, v141, v223
 v_mfma_f32_16x16x32_bf16 v[156:159], a[12:15], a[108:111], v[156:159]
 ds_read_b64_tr_b16 a[0:1], v206 offset:0
 ds_read_b64_tr_b16 a[2:3], v206 offset:512
 v_mfma_f32_16x16x32_bf16 v[152:155], a[12:15], a[104:107], v[152:155]
 s_waitcnt lgkmcnt(5)
 v_add_f32 v223, v142, v223
 v_add_f32 v223, v143, v223
 v_mfma_f32_16x16x32_bf16 v[144:147], a[16:19], a[112:115], v[144:147]
 ds_read_b64_tr_b16 a[4:5], v207 offset:0
 ds_read_b64_tr_b16 a[6:7], v207 offset:512
 v_mfma_f32_16x16x32_bf16 v[148:151], a[16:19], a[116:119], v[148:151]
 s_waitcnt lgkmcnt(6)
 buffer_load_dwordx4 v213, s[8:11], s34 offen offset:3072 nt lds
 v_and_b32 v232, 15, v244
 v_mfma_f32_16x16x32_bf16 v[156:159], a[20:23], a[116:119], v[156:159]
 ds_read_b64_tr_b16 a[8:9], v208 offset:0
 ds_read_b64_tr_b16 a[10:11], v208 offset:512
 v_mfma_f32_16x16x32_bf16 v[152:155], a[20:23], a[112:115], v[152:155]
 s_waitcnt lgkmcnt(7)
 v_lshlrev_b32 v232, 7, v232
 v_add_u32 v232, 786432, v232
 v_mfma_f32_16x16x32_bf16 v[144:147], a[24:27], a[120:123], v[144:147]
 ds_read_b64_tr_b16 a[12:13], v209 offset:0
 ds_read_b64_tr_b16 a[14:15], v209 offset:512
 v_mfma_f32_16x16x32_bf16 v[148:151], a[24:27], a[124:127], v[148:151]
 s_waitcnt lgkmcnt(8)
 buffer_load_dword v253, v232, s[28:31], 0 offen nt
 v_mfma_f32_16x16x32_bf16 v[156:159], a[28:31], a[124:127], v[156:159]
 ds_read_b64_tr_b16 a[16:17], v206 offset:4096
 ds_read_b64_tr_b16 a[18:19], v206 offset:4608
 v_mfma_f32_16x16x32_bf16 v[152:155], a[28:31], a[120:123], v[152:155]
 s_waitcnt lgkmcnt(8)
 v_mfma_f32_16x16x32_bf16 v[0:3], a[0:3], v[160:163], v[0:3]
 ds_read_b64_tr_b16 a[20:21], v207 offset:4096
 ds_read_b64_tr_b16 a[22:23], v207 offset:4608
 v_mfma_f32_16x16x32_bf16 v[4:7], a[0:3], v[164:167], v[4:7]
 s_waitcnt vmcnt(22) lgkmcnt(8)
 v_max3_f32 v224, v144, v145, v146
 v_max3_f32 v224, v147, v148, v224
 v_mfma_f32_16x16x32_bf16 v[12:15], a[4:7], v[164:167], v[12:15]
 s_barrier
 ds_read_b64_tr_b16 a[24:25], v208 offset:4096
 ds_read_b64_tr_b16 a[26:27], v208 offset:4608
 v_mfma_f32_16x16x32_bf16 v[8:11], a[4:7], v[160:163], v[8:11]
 s_waitcnt lgkmcnt(8)
 v_max3_f32 v224, v149, v150, v224
 v_max3_f32 v224, v151, v152, v224
 v_mfma_f32_16x16x32_bf16 v[16:19], a[8:11], v[160:163], v[16:19]
 s_add_u32 m0, s33, 98304
 ds_read_b64_tr_b16 a[28:29], v209 offset:4096
 ds_read_b64_tr_b16 a[30:31], v209 offset:4608
 v_mfma_f32_16x16x32_bf16 v[20:23], a[8:11], v[164:167], v[20:23]
 s_waitcnt lgkmcnt(8)
 v_max3_f32 v224, v153, v154, v224
 v_max3_f32 v224, v155, v156, v224
 v_mfma_f32_16x16x32_bf16 v[28:31], a[12:15], v[164:167], v[28:31]
 s_mov_b32 s34, 491520
 ds_read_b64_tr_b16 a[0:1], v206 offset:8192
 ds_read_b64_tr_b16 a[2:3], v206 offset:8704
 v_mfma_f32_16x16x32_bf16 v[24:27], a[12:15], v[160:163], v[24:27]
 s_waitcnt lgkmcnt(8)
 buffer_load_dwordx4 v210, s[12:15], s34 offen nt lds
 v_max3_f32 v224, v157, v158, v224
 v_mfma_f32_16x16x32_bf16 v[32:35], a[16:19], v[160:163], v[32:35]
 ds_read_b64_tr_b16 a[4:5], v207 offset:8192
 ds_read_b64_tr_b16 a[6:7], v207 offset:8704
 v_mfma_f32_16x16x32_bf16 v[36:39], a[16:19], v[164:167], v[36:39]
 s_waitcnt lgkmcnt(8)
 v_max_f32 v224, v159, v224
 v_cmp_lt_f32 vcc, s35, v224
 v_mfma_f32_16x16x32_bf16 v[44:47], a[20:23], v[164:167], v[44:47]
 s_cbranch_vccnz L_stub26
L_ret26:
 ds_read_b64_tr_b16 a[8:9], v208 offset:8192
 ds_read_b64_tr_b16 a[10:11], v208 offset:8704
 v_mfma_f32_16x16x32_bf16 v[40:43], a[20:23], v[160:163], v[40:43]
 s_waitcnt lgkmcnt(8)
 v_exp_f32 v144, v144
 v_mfma_f32_16x16x32_bf16 v[48:51], a[24:27], v[160:163], v[48:51]
 ds_read_b64_tr_b16 a[12:13], v209 offset:8192
 ds_read_b64_tr_b16 a[14:15], v209 offset:8704
 v_mfma_f32_16x16x32_bf16 v[52:55], a[24:27], v[164:167], v[52:55]
 s_waitcnt lgkmcnt(8)
 v_exp_f32 v145, v145
 v_mfma_f32_16x16x32_bf16 v[60:63], a[28:31], v[164:167], v[60:63]
 ds_read_b64_tr_b16 a[16:17], v206 offset:12288
 ds_read_b64_tr_b16 a[18:19], v206 offset:12800
 v_mfma_f32_16x16x32_bf16 v[56:59], a[28:31], v[160:163], v[56:59]
 s_waitcnt lgkmcnt(8)
 buffer_load_dwordx4 v211, s[12:15], s34 offen offset:1024 nt lds
 v_add_f32 v222, v144, v222
 v_mfma_f32_16x16x32_bf16 v[64:67], a[0:3], v[160:163], v[64:67]
 ds_read_b64_tr_b16 a[20:21], v207 offset:12288
 ds_read_b64_tr_b16 a[22:23], v207 offset:12800
 v_mfma_f32_16x16x32_bf16 v[68:71], a[0:3], v[164:167], v[68:71]
 s_waitcnt lgkmcnt(8)
 v_exp_f32 v146, v146
 v_mfma_f32_16x16x32_bf16 v[76:79], a[4:7], v[164:167], v[76:79]
 ds_read_b64_tr_b16 a[24:25], v208 offset:12288
 ds_read_b64_tr_b16 a[26:27], v208 offset:12800
 v_mfma_f32_16x16x32_bf16 v[72:75], a[4:7], v[160:163], v[72:75]
 s_waitcnt lgkmcnt(8)
 v_exp_f32 v147, v147
 v_mfma_f32_16x16x32_bf16 v[80:83], a[8:11], v[160:163], v[80:83]
 ds_read_b64_tr_b16 a[28:29], v209 offset:12288
 ds_read_b64_tr_b16 a[30:31], v209 offset:12800
 v_mfma_f32_16x16x32_bf16 v[84:87], a[8:11], v[164:167], v[84:87]
 s_waitcnt lgkmcnt(8)
 v_exp_f32 v152, v152
 v_mfma_f32_16x16x32_bf16 v[92:95], a[12:15], v[164:167], v[92:95]
 ds_read_b128 a[0:3], v196 offset:16384
 buffer_load_dwordx4 v212, s[12:15], s34 offen offset:2048 nt lds
 v_mfma_f32_16x16x32_bf16 v[88:91], a[12:15], v[160:163], v[88:91]
 s_waitcnt lgkmcnt(7)
 v_exp_f32 v153, v153
 v_mfma_f32_16x16x32_bf16 v[96:99], a[16:19], v[160:163], v[96:99]
 ds_read_b128 a[4:7], v196 offset:16896
 v_add_f32 v222, v145, v222
 v_mfma_f32_16x16x32_bf16 v[100:103], a[16:19], v[164:167], v[100:103]
 s_waitcnt lgkmcnt(6)
 v_exp_f32 v154, v154
 v_mfma_f32_16x16x32_bf16 v[108:111], a[20:23], v[164:167], v[108:111]
 ds_read_b128 a[8:11], v197 offset:16384
 v_add_f32 v222, v146, v222
 v_mfma_f32_16x16x32_bf16 v[104:107], a[20:23], v[160:163], v[104:107]
 s_waitcnt lgkmcnt(5)
 v_exp_f32 v155, v155
 v_mfma_f32_16x16x32_bf16 v[112:115], a[24:27], v[160:163], v[112:115]
 ds_read_b128 a[12:15], v197 offset:16896
 v_add_f32 v222, v147, v222
 v_mfma_f32_16x16x32_bf16 v[116:119], a[24:27], v[164:167], v[116:119]
 s_waitcnt lgkmcnt(4)
 buffer_load_dwordx4 v213, s[12:15], s34 offen offset:3072 nt lds
 v_add_f32 v222, v152, v222
 v_mfma_f32_16x16x32_bf16 v[124:127], a[28:31], v[164:167], v[124:127]
 s_add_u32 m0, s33, 114688
 ds_read_b128 a[16:19], v196 offset:20480
 v_add_f32 v222, v153, v222
 v_mfma_f32_16x16x32_bf16 v[120:123], a[28:31], v[160:163], v[120:123]
 s_waitcnt lgkmcnt(4)
 v_exp_f32 v148, v148
 v_mfma_f32_16x16x32_bf16 v[128:131], a[0:3], a[64:67], v[168:171]
 s_mov_b32 s34, 507904
 ds_read_b128 a[20:23], v196 offset:20992
 v_cvt_pk_bf16_f32 v160, v144, v145
 v_mfma_f32_16x16x32_bf16 v[132:135], a[0:3], a[68:71], v[172:175]
 s_waitcnt lgkmcnt(4)
 v_exp_f32 v149, v149
 v_mfma_f32_16x16x32_bf16 v[140:143], a[4:7], a[68:71], v[172:175]
 s_add_u32 s92, s54, 61440
 s_addc_u32 s93, s55, 0
 ds_read_b128 a[24:27], v197 offset:20480
 global_load_dword v252, v245, s[92:93]
 v_mfma_f32_16x16x32_bf16 v[136:139], a[4:7], a[64:67], v[168:171]
 s_waitcnt lgkmcnt(4)
 v_exp_f32 v150, v150
 v_mfma_f32_16x16x32_bf16 v[128:131], a[8:11], a[72:75], v[128:131]
 ds_read_b128 a[28:31], v197 offset:20992
 buffer_load_dwordx4 v210, s[12:15], s34 offen nt lds
 v_mfma_f32_16x16x32_bf16 v[132:135], a[8:11], a[76:79], v[132:135]
 s_waitcnt lgkmcnt(4)
 v_exp_f32 v151, v151
 v_mfma_f32_16x16x32_bf16 v[140:143], a[12:15], a[76:79], v[140:143]
 ds_read_b128 a[0:3], v196 offset:24576
 v_cvt_pk_bf16_f32 v161, v146, v147
 v_mfma_f32_16x16x32_bf16 v[136:139], a[12:15], a[72:75], v[136:139]
 s_waitcnt lgkmcnt(4)
 v_exp_f32 v156, v156
 v_mfma_f32_16x16x32_bf16 v[128:131], a[16:19], a[80:83], v[128:131]
 ds_read_b128 a[4:7], v196 offset:25088
 v_cvt_pk_bf16_f32 v162, v152, v153
 v_mfma_f32_16x16x32_bf16 v[132:135], a[16:19], a[84:87], v[132:135]
 s_waitcnt lgkmcnt(4)
 v_exp_f32 v157, v157
 v_mfma_f32_16x16x32_bf16 v[140:143], a[20:23], a[84:87], v[140:143]
 ds_read_b128 a[8:11], v197 offset:24576
 v_cvt_pk_bf16_f32 v163, v154, v155
 v_mfma_f32_16x16x32_bf16 v[136:139], a[20:23], a[80:83], v[136:139]
 s_waitcnt lgkmcnt(4)
 buffer_load_dwordx4 v211, s[12:15], s34 offen offset:1024 nt lds
 v_cvt_pk_bf16_f32 v164, v148, v149
 v_mfma_f32_16x16x32_bf16 v[128:131], a[24:27], a[88:91], v[128:131]
 ds_read_b128 a[12:15], v197 offset:25088
 v_cvt_pk_bf16_f32 v165, v150, v151
 v_mfma_f32_16x16x32_bf16 v[132:135], a[24:27], a[92:95], v[132:135]
 s_waitcnt lgkmcnt(4)
 v_exp_f32 v158, v158
 v_mfma_f32_16x16x32_bf16 v[140:143], a[28:31], a[92:95], v[140:143]
 ds_read_b128 a[16:19], v196 offset:28672
 v_cvt_pk_bf16_f32 v166, v156, v157
 v_mfma_f32_16x16x32_bf16 v[136:139], a[28:31], a[88:91], v[136:139]
 s_waitcnt lgkmcnt(4)
 v_exp_f32 v159, v159
 v_mfma_f32_16x16x32_bf16 v[128:131], a[0:3], a[96:99], v[128:131]
 ds_read_b128 a[20:23], v196 offset:29184
 v_cvt_pk_bf16_f32 v167, v158, v159
 v_mfma_f32_16x16x32_bf16 v[132:135], a[0:3], a[100:103], v[132:135]
 s_waitcnt lgkmcnt(4)
 v_add_f32 v222, v154, v222
 v_add_f32 v222, v155, v222
 v_mfma_f32_16x16x32_bf16 v[140:143], a[4:7], a[100:103], v[140:143]
 ds_read_b128 a[24:27], v197 offset:28672
 buffer_load_dwordx4 v212, s[12:15], s34 offen offset:2048 nt lds
 v_mfma_f32_16x16x32_bf16 v[136:139], a[4:7], a[96:99], v[136:139]
 s_waitcnt lgkmcnt(4)
 v_add_f32 v223, v148, v223
 v_add_f32 v223, v149, v223
 v_mfma_f32_16x16x32_bf16 v[128:131], a[8:11], a[104:107], v[128:131]
 ds_read_b128 a[28:31], v197 offset:29184
 v_add_f32 v223, v150, v223
 v_mfma_f32_16x16x32_bf16 v[132:135], a[8:11], a[108:111], v[132:135]
 s_waitcnt lgkmcnt(4)
 v_add_f32 v223, v151, v223
 v_add_f32 v223, v156, v223
 v_mfma_f32_16x16x32_bf16 v[140:143], a[12:15], a[108:111], v[140:143]
 ds_read_b64_tr_b16 a[0:1], v198 offset:0
 ds_read_b64_tr_b16 a[2:3], v198 offset:512
 v_mfma_f32_16x16x32_bf16 v[136:139], a[12:15], a[104:107], v[136:139]
 s_waitcnt lgkmcnt(5)
 v_add_f32 v223, v157, v223
 v_add_f32 v223, v158, v223
 v_mfma_f32_16x16x32_bf16 v[128:131], a[16:19], a[112:115], v[128:131]
 ds_read_b64_tr_b16 a[4:5], v199 offset:0
 ds_read_b64_tr_b16 a[6:7], v199 offset:512
 v_mfma_f32_16x16x32_bf16 v[132:135], a[16:19], a[116:119], v[132:135]
 s_waitcnt lgkmcnt(6)
 buffer_load_dwordx4 v213, s[12:15], s34 offen offset:3072 nt lds
 v_add_f32 v223, v159, v223
 v_mfma_f32_16x16x32_bf16 v[140:143], a[20:23], a[116:119], v[140:143]
 ds_read_b64_tr_b16 a[8:9], v200 offset:0
 ds_read_b64_tr_b16 a[10:11], v200 offset:512
 v_mfma_f32_16x16x32_bf16 v[136:139], a[20:23], a[112:115], v[136:139]
 s_waitcnt lgkmcnt(7)
 v_mfma_f32_16x16x32_bf16 v[128:131], a[24:27], a[120:123], v[128:131]
 ds_read_b64_tr_b16 a[12:13], v201 offset:0
 ds_read_b64_tr_b16 a[14:15], v201 offset:512
 v_mfma_f32_16x16x32_bf16 v[132:135], a[24:27], a[124:127], v[132:135]
 s_waitcnt lgkmcnt(8)
 v_mfma_f32_16x16x32_bf16 v[140:143], a[28:31], a[124:127], v[140:143]
 ds_read_b64_tr_b16 a[16:17], v198 offset:4096
 ds_read_b64_tr_b16 a[18:19], v198 offset:4608
 v_mfma_f32_16x16x32_bf16 v[136:139], a[28:31], a[120:123], v[136:139]
 s_waitcnt lgkmcnt(8)
 v_mfma_f32_16x16x32_bf16 v[0:3], a[0:3], v[160:163], v[0:3]
 ds_read_b64_tr_b16 a[20:21], v199 offset:4096
 ds_read_b64_tr_b16 a[22:23], v199 offset:4608
 v_mfma_f32_16x16x32_bf16 v[4:7], a[0:3], v[164:167], v[4:7]
 s_waitcnt vmcnt(22) lgkmcnt(8)
 v_max3_f32 v224, v128, v129, v130
 v_max3_f32 v224, v131, v132, v224
 v_mfma_f32_16x16x32_bf16 v[12:15], a[4:7], v[164:167], v[12:15]
 s_barrier
 ds_read_b64_tr_b16 a[24:25], v200 offset:4096
 ds_read_b64_tr_b16 a[26:27], v200 offset:4608
 v_mfma_f32_16x16x32_bf16 v[8:11], a[4:7], v[160:163], v[8:11]
 s_waitcnt lgkmcnt(8)
 v_max3_f32 v224, v133, v134, v224
 v_max3_f32 v224, v135, v136, v224
 v_mfma_f32_16x16x32_bf16 v[16:19], a[8:11], v[160:163], v[16:19]
 s_add_u32 m0, s33, 131072
 ds_read_b64_tr_b16 a[28:29], v201 offset:4096
 ds_read_b64_tr_b16 a[30:31], v201 offset:4608
 v_mfma_f32_16x16x32_bf16 v[20:23], a[8:11], v[164:167], v[20:23]
 s_waitcnt lgkmcnt(8)
 v_max3_f32 v224, v137, v138, v224
 v_max3_f32 v224, v139, v140, v224
 v_mfma_f32_16x16x32_bf16 v[28:31], a[12:15], v[164:167], v[28:31]
 s_mov_b32 s34, 0
 ds_read_b64_tr_b16 a[0:1], v198 offset:8192
 ds_read_b64_tr_b16 a[2:3], v198 offset:8704
 v_mfma_f32_16x16x32_bf16 v[24:27], a[12:15], v[160:163], v[24:27]
 s_waitcnt lgkmcnt(8)
 buffer_load_dwordx4 v218, s[20:23], s34 offen lds
 v_max3_f32 v224, v141, v142, v224
 v_mfma_f32_16x16x32_bf16 v[32:35], a[16:19], v[160:163], v[32:35]
 ds_read_b64_tr_b16 a[4:5], v199 offset:8192
 ds_read_b64_tr_b16 a[6:7], v199 offset:8704
 v_mfma_f32_16x16x32_bf16 v[36:39], a[16:19], v[164:167], v[36:39]
 s_waitcnt lgkmcnt(8)
 v_max_f32 v224, v143, v224
 v_cmp_lt_f32 vcc, s35, v224
 v_mfma_f32_16x16x32_bf16 v[44:47], a[20:23], v[164:167], v[44:47]
 s_cbranch_vccnz L_stub27
L_ret27:
 ds_read_b64_tr_b16 a[8:9], v200 offset:8192
 ds_read_b64_tr_b16 a[10:11], v200 offset:8704
 v_mfma_f32_16x16x32_bf16 v[40:43], a[20:23], v[160:163], v[40:43]
 s_waitcnt lgkmcnt(8)
 v_exp_f32 v128, v128
 v_mfma_f32_16x16x32_bf16 v[48:51], a[24:27], v[160:163], v[48:51]
 ds_read_b64_tr_b16 a[12:13], v201 offset:8192
 ds_read_b64_tr_b16 a[14:15], v201 offset:8704
 v_mfma_f32_16x16x32_bf16 v[52:55], a[24:27], v[164:167], v[52:55]
 s_waitcnt lgkmcnt(8)
 v_exp_f32 v129, v129
 v_mfma_f32_16x16x32_bf16 v[60:63], a[28:31], v[164:167], v[60:63]
 ds_read_b64_tr_b16 a[16:17], v198 offset:12288
 ds_read_b64_tr_b16 a[18:19], v198 offset:12800
 v_mfma_f32_16x16x32_bf16 v[56:59], a[28:31], v[160:163], v[56:59]
 s_waitcnt lgkmcnt(8)
 buffer_load_dwordx4 v219, s[20:23], s34 offen offset:1024 lds
 v_add_f32 v222, v128, v222
 v_mfma_f32_16x16x32_bf16 v[64:67], a[0:3], v[160:163], v[64:67]
 ds_read_b64_tr_b16 a[20:21], v199 offset:12288
 ds_read_b64_tr_b16 a[22:23], v199 offset:12800
 v_mfma_f32_16x16x32_bf16 v[68:71], a[0:3], v[164:167], v[68:71]
 s_waitcnt lgkmcnt(8)
 v_exp_f32 v130, v130
 v_mfma_f32_16x16x32_bf16 v[76:79], a[4:7], v[164:167], v[76:79]
 ds_read_b64_tr_b16 a[24:25], v200 offset:12288
 ds_read_b64_tr_b16 a[26:27], v200 offset:12800
 v_mfma_f32_16x16x32_bf16 v[72:75], a[4:7], v[160:163], v[72:75]
 s_waitcnt lgkmcnt(8)
 v_exp_f32 v131, v131
 v_mfma_f32_16x16x32_bf16 v[80:83], a[8:11], v[160:163], v[80:83]
 ds_read_b64_tr_b16 a[28:29], v201 offset:12288
 ds_read_b64_tr_b16 a[30:31], v201 offset:12800
 v_mfma_f32_16x16x32_bf16 v[84:87], a[8:11], v[164:167], v[84:87]
 s_waitcnt lgkmcnt(8)
 v_exp_f32 v136, v136
 v_mfma_f32_16x16x32_bf16 v[92:95], a[12:15], v[164:167], v[92:95]
 ds_read_b128 a[0:3], v192 offset:16384
 buffer_load_dwordx4 v220, s[20:23], s34 offen offset:2048 lds
 v_mfma_f32_16x16x32_bf16 v[88:91], a[12:15], v[160:163], v[88:91]
 s_waitcnt lgkmcnt(7)
 v_exp_f32 v137, v137
 v_mfma_f32_16x16x32_bf16 v[96:99], a[16:19], v[160:163], v[96:99]
 ds_read_b128 a[4:7], v192 offset:16896
 v_add_f32 v222, v129, v222
 v_mfma_f32_16x16x32_bf16 v[100:103], a[16:19], v[164:167], v[100:103]
 s_waitcnt lgkmcnt(6)
 v_exp_f32 v138, v138
 v_mfma_f32_16x16x32_bf16 v[108:111], a[20:23], v[164:167], v[108:111]
 ds_read_b128 a[8:11], v193 offset:16384
 v_add_f32 v222, v130, v222
 v_mfma_f32_16x16x32_bf16 v[104:107], a[20:23], v[160:163], v[104:107]
 s_waitcnt lgkmcnt(5)
 v_exp_f32 v139, v139
 v_mfma_f32_16x16x32_bf16 v[112:115], a[24:27], v[160:163], v[112:115]
 ds_read_b128 a[12:15], v193 offset:16896
 v_add_f32 v222, v131, v222
 v_mfma_f32_16x16x32_bf16 v[116:119], a[24:27], v[164:167], v[116:119]
 s_waitcnt lgkmcnt(4)
 buffer_load_dwordx4 v221, s[20:23], s34 offen offset:3072 lds
 v_add_f32 v222, v136, v222
 v_mfma_f32_16x16x32_bf16 v[124:127], a[28:31], v[164:167], v[124:127]
 s_add_u32 m0, s33, 147456
 ds_read_b128 a[16:19], v192 offset:20480
 v_add_f32 v222, v137, v222
 v_mfma_f32_16x16x32_bf16 v[120:123], a[28:31], v[160:163], v[120:123]
 s_waitcnt lgkmcnt(4)
 v_exp_f32 v132, v132
 v_mfma_f32_16x16x32_bf16 v[144:147], a[0:3], a[64:67], v[168:171]
 s_mov_b32 s34, 114688
 ds_read_b128 a[20:23], v192 offset:20992
 v_cvt_pk_bf16_f32 v160, v128, v129
 v_mfma_f32_16x16x32_bf16 v[148:151], a[0:3], a[68:71], v[172:175]
 s_waitcnt lgkmcnt(4)
 v_exp_f32 v133, v133
 v_mfma_f32_16x16x32_bf16 v[156:159], a[4:7], a[68:71], v[172:175]
 ds_read_b128 a[24:27], v193 offset:20480
 v_cvt_pk_bf16_f32 v161, v130, v131
 v_mfma_f32_16x16x32_bf16 v[152:155], a[4:7], a[64:67], v[168:171]
 s_waitcnt lgkmcnt(4)
 v_exp_f32 v134, v134
 v_mfma_f32_16x16x32_bf16 v[144:147], a[8:11], a[72:75], v[144:147]
 ds_read_b128 a[28:31], v193 offset:20992
 buffer_load_dwordx4 v218, s[20:23], s34 offen lds
 v_mfma_f32_16x16x32_bf16 v[148:151], a[8:11], a[76:79], v[148:151]
 s_waitcnt lgkmcnt(4)
 v_exp_f32 v135, v135
 v_mfma_f32_16x16x32_bf16 v[156:159], a[12:15], a[76:79], v[156:159]
 ds_read_b128 a[0:3], v192 offset:24576
 v_cvt_pk_bf16_f32 v162, v136, v137
 v_mfma_f32_16x16x32_bf16 v[152:155], a[12:15], a[72:75], v[152:155]
 s_waitcnt lgkmcnt(4)
 v_exp_f32 v140, v140
 v_mfma_f32_16x16x32_bf16 v[144:147], a[16:19], a[80:83], v[144:147]
 ds_read_b128 a[4:7], v192 offset:25088
 v_cvt_pk_bf16_f32 v163, v138, v139
 v_mfma_f32_16x16x32_bf16 v[148:151], a[16:19], a[84:87], v[148:151]
 s_waitcnt lgkmcnt(4)
 v_exp_f32 v141, v141
 v_mfma_f32_16x16x32_bf16 v[156:159], a[20:23], a[84:87], v[156:159]
 ds_read_b128 a[8:11], v193 offset:24576
 v_cvt_pk_bf16_f32 v164, v132, v133
 v_mfma_f32_16x16x32_bf16 v[152:155], a[20:23], a[80:83], v[152:155]
 s_waitcnt lgkmcnt(4)
 buffer_load_dwordx4 v219, s[20:23], s34 offen offset:1024 lds
 v_cvt_pk_bf16_f32 v165, v134, v135
 v_mfma_f32_16x16x32_bf16 v[144:147], a[24:27], a[88:91], v[144:147]
 ds_read_b128 a[12:15], v193 offset:25088
 v_cvt_pk_bf16_f32 v166, v140, v141
 v_mfma_f32_16x16x32_bf16 v[148:151], a[24:27], a[92:95], v[148:151]
 s_waitcnt lgkmcnt(4)
 v_exp_f32 v142, v142
 v_mfma_f32_16x16x32_bf16 v[156:159], a[28:31], a[92:95], v[156:159]
 ds_read_b128 a[16:19], v192 offset:28672
 v_add_f32 v222, v138, v222
 v_mfma_f32_16x16x32_bf16 v[152:155], a[28:31], a[88:91], v[152:155]
 s_waitcnt lgkmcnt(4)
 v_exp_f32 v143, v143
 v_mfma_f32_16x16x32_bf16 v[144:147], a[0:3], a[96:99], v[144:147]
 ds_read_b128 a[20:23], v192 offset:29184
 v_cvt_pk_bf16_f32 v167, v142, v143
 v_mfma_f32_16x16x32_bf16 v[148:151], a[0:3], a[100:103], v[148:151]
 s_waitcnt lgkmcnt(4)
 v_add_f32 v222, v139, v222
 v_add_f32 v223, v132, v223
 v_mfma_f32_16x16x32_bf16 v[156:159], a[4:7], a[100:103], v[156:159]
 ds_read_b128 a[24:27], v193 offset:28672
 buffer_load_dwordx4 v220, s[20:23], s34 offen offset:2048 lds
 v_mfma_f32_16x16x32_bf16 v[152:155], a[4:7], a[96:99], v[152:155]
 s_waitcnt lgkmcnt(4)
 v_add_f32 v223, v133, v223
 v_add_f32 v223, v134, v223
 v_mfma_f32_16x16x32_bf16 v[144:147], a[8:11], a[104:107], v[144:147]
 ds_read_b128 a[28:31], v193 offset:29184
 v_add_f32 v223, v135, v223
 v_mfma_f32_16x16x32_bf16 v[148:151], a[8:11], a[108:111], v[148:151]
 s_waitcnt lgkmcnt(4)
 v_add_f32 v223, v140, v223
 v_add_f32 v223, v141, v223
 v_mfma_f32_16x16x32_bf16 v[156:159], a[12:15], a[108:111], v[156:159]
 ds_read_b64_tr_b16 a[0:1], v198 offset:32768
 ds_read_b64_tr_b16 a[2:3], v198 offset:33280
 v_mfma_f32_16x16x32_bf16 v[152:155], a[12:15], a[104:107], v[152:155]
 s_waitcnt lgkmcnt(5)
 v_add_f32 v223, v142, v223
 v_add_f32 v223, v143, v223
 v_mfma_f32_16x16x32_bf16 v[144:147], a[16:19], a[112:115], v[144:147]
 ds_read_b64_tr_b16 a[4:5], v199 offset:32768
 ds_read_b64_tr_b16 a[6:7], v199 offset:33280
 v_mfma_f32_16x16x32_bf16 v[148:151], a[16:19], a[116:119], v[148:151]
 s_waitcnt lgkmcnt(6)
 buffer_load_dwordx4 v221, s[20:23], s34 offen offset:3072 lds
 v_mfma_f32_16x16x32_bf16 v[156:159], a[20:23], a[116:119], v[156:159]
 ds_read_b64_tr_b16 a[8:9], v200 offset:32768
 ds_read_b64_tr_b16 a[10:11], v200 offset:33280
 v_mfma_f32_16x16x32_bf16 v[152:155], a[20:23], a[112:115], v[152:155]
 s_waitcnt lgkmcnt(7)
 v_mfma_f32_16x16x32_bf16 v[144:147], a[24:27], a[120:123], v[144:147]
 ds_read_b64_tr_b16 a[12:13], v201 offset:32768
 ds_read_b64_tr_b16 a[14:15], v201 offset:33280
 v_mfma_f32_16x16x32_bf16 v[148:151], a[24:27], a[124:127], v[148:151]
 s_waitcnt lgkmcnt(8)
 v_mfma_f32_16x16x32_bf16 v[156:159], a[28:31], a[124:127], v[156:159]
 ds_read_b64_tr_b16 a[16:17], v198 offset:36864
 ds_read_b64_tr_b16 a[18:19], v198 offset:37376
 v_mfma_f32_16x16x32_bf16 v[152:155], a[28:31], a[120:123], v[152:155]
 s_waitcnt lgkmcnt(8)
 v_mfma_f32_16x16x32_bf16 v[0:3], a[0:3], v[160:163], v[0:3]
 ds_read_b64_tr_b16 a[20:21], v199 offset:36864
 ds_read_b64_tr_b16 a[22:23], v199 offset:37376
 v_mfma_f32_16x16x32_bf16 v[4:7], a[0:3], v[164:167], v[4:7]
 s_waitcnt vmcnt(22) lgkmcnt(8)
 v_max3_f32 v224, v144, v145, v146
 v_max3_f32 v224, v147, v148, v224
 v_mfma_f32_16x16x32_bf16 v[12:15], a[4:7], v[164:167], v[12:15]
 s_barrier
 ds_read_b64_tr_b16 a[24:25], v200 offset:36864
 ds_read_b64_tr_b16 a[26:27], v200 offset:37376
 v_mfma_f32_16x16x32_bf16 v[8:11], a[4:7], v[160:163], v[8:11]
 s_waitcnt lgkmcnt(8)
 v_max3_f32 v224, v149, v150, v224
 v_max3_f32 v224, v151, v152, v224
 v_mfma_f32_16x16x32_bf16 v[16:19], a[8:11], v[160:163], v[16:19]
 s_add_u32 m0, s33, 0
 ds_read_b64_tr_b16 a[28:29], v201 offset:36864
 ds_read_b64_tr_b16 a[30:31], v201 offset:37376
 v_mfma_f32_16x16x32_bf16 v[20:23], a[8:11], v[164:167], v[20:23]
 s_waitcnt lgkmcnt(8)
 v_max3_f32 v224, v153, v154, v224
 v_max3_f32 v224, v155, v156, v224
 v_mfma_f32_16x16x32_bf16 v[28:31], a[12:15], v[164:167], v[28:31]
 s_mov_b32 s34, 128
 ds_read_b64_tr_b16 a[0:1], v198 offset:40960
 ds_read_b64_tr_b16 a[2:3], v198 offset:41472
 v_mfma_f32_16x16x32_bf16 v[24:27], a[12:15], v[160:163], v[24:27]
 s_waitcnt lgkmcnt(8)
 buffer_load_dwordx4 v218, s[20:23], s34 offen lds
 v_max3_f32 v224, v157, v158, v224
 v_mfma_f32_16x16x32_bf16 v[32:35], a[16:19], v[160:163], v[32:35]
 ds_read_b64_tr_b16 a[4:5], v199 offset:40960
 ds_read_b64_tr_b16 a[6:7], v199 offset:41472
 v_mfma_f32_16x16x32_bf16 v[36:39], a[16:19], v[164:167], v[36:39]
 s_waitcnt lgkmcnt(8)
 v_max_f32 v224, v159, v224
 v_cmp_lt_f32 vcc, s35, v224
 v_mfma_f32_16x16x32_bf16 v[44:47], a[20:23], v[164:167], v[44:47]
 s_cbranch_vccnz L_stub28
L_ret28:
 ds_read_b64_tr_b16 a[8:9], v200 offset:40960
 ds_read_b64_tr_b16 a[10:11], v200 offset:41472
 v_mfma_f32_16x16x32_bf16 v[40:43], a[20:23], v[160:163], v[40:43]
 s_waitcnt lgkmcnt(8)
 v_exp_f32 v144, v144
 v_mfma_f32_16x16x32_bf16 v[48:51], a[24:27], v[160:163], v[48:51]
 ds_read_b64_tr_b16 a[12:13], v201 offset:40960
 ds_read_b64_tr_b16 a[14:15], v201 offset:41472
 v_mfma_f32_16x16x32_bf16 v[52:55], a[24:27], v[164:167], v[52:55]
 s_waitcnt lgkmcnt(8)
 v_exp_f32 v145, v145
 v_mfma_f32_16x16x32_bf16 v[60:63], a[28:31], v[164:167], v[60:63]
 ds_read_b64_tr_b16 a[16:17], v198 offset:45056
 ds_read_b64_tr_b16 a[18:19], v198 offset:45568
 v_mfma_f32_16x16x32_bf16 v[56:59], a[28:31], v[160:163], v[56:59]
 s_waitcnt lgkmcnt(8)
 buffer_load_dwordx4 v219, s[20:23], s34 offen offset:1024 lds
 v_add_f32 v222, v144, v222
 v_mfma_f32_16x16x32_bf16 v[64:67], a[0:3], v[160:163], v[64:67]
 ds_read_b64_tr_b16 a[20:21], v199 offset:45056
 ds_read_b64_tr_b16 a[22:23], v199 offset:45568
 v_mfma_f32_16x16x32_bf16 v[68:71], a[0:3], v[164:167], v[68:71]
 s_waitcnt lgkmcnt(8)
 v_exp_f32 v146, v146
 v_mfma_f32_16x16x32_bf16 v[76:79], a[4:7], v[164:167], v[76:79]
 ds_read_b64_tr_b16 a[24:25], v200 offset:45056
 ds_read_b64_tr_b16 a[26:27], v200 offset:45568
 v_mfma_f32_16x16x32_bf16 v[72:75], a[4:7], v[160:163], v[72:75]
 s_waitcnt lgkmcnt(8)
 v_exp_f32 v147, v147
 v_mfma_f32_16x16x32_bf16 v[80:83], a[8:11], v[160:163], v[80:83]
 ds_read_b64_tr_b16 a[28:29], v201 offset:45056
 ds_read_b64_tr_b16 a[30:31], v201 offset:45568
 v_mfma_f32_16x16x32_bf16 v[84:87], a[8:11], v[164:167], v[84:87]
 s_waitcnt lgkmcnt(8)
 v_exp_f32 v152, v152
 v_mfma_f32_16x16x32_bf16 v[92:95], a[12:15], v[164:167], v[92:95]
 ds_read_b128 a[0:3], v192 offset:49152
 buffer_load_dwordx4 v220, s[20:23], s34 offen offset:2048 lds
 v_mfma_f32_16x16x32_bf16 v[88:91], a[12:15], v[160:163], v[88:91]
 s_waitcnt lgkmcnt(7)
 v_exp_f32 v153, v153
 v_mfma_f32_16x16x32_bf16 v[96:99], a[16:19], v[160:163], v[96:99]
 ds_read_b128 a[4:7], v192 offset:49664
 v_add_f32 v222, v145, v222
 v_mfma_f32_16x16x32_bf16 v[100:103], a[16:19], v[164:167], v[100:103]
 s_waitcnt lgkmcnt(6)
 v_exp_f32 v154, v154
 v_mfma_f32_16x16x32_bf16 v[108:111], a[20:23], v[164:167], v[108:111]
 ds_read_b128 a[8:11], v193 offset:49152
 v_add_f32 v222, v146, v222
 v_mfma_f32_16x16x32_bf16 v[104:107], a[20:23], v[160:163], v[104:107]
 s_waitcnt lgkmcnt(5)
 v_exp_f32 v155, v155
 v_mfma_f32_16x16x32_bf16 v[112:115], a[24:27], v[160:163], v[112:115]
 ds_read_b128 a[12:15], v193 offset:49664
 v_add_f32 v222, v147, v222
 v_mfma_f32_16x16x32_bf16 v[116:119], a[24:27], v[164:167], v[116:119]
 s_waitcnt lgkmcnt(4)
 buffer_load_dwordx4 v221, s[20:23], s34 offen offset:3072 lds
 v_add_f32 v222, v152, v222
 v_mfma_f32_16x16x32_bf16 v[124:127], a[28:31], v[164:167], v[124:127]
 s_add_u32 m0, s33, 16384
 ds_read_b128 a[16:19], v192 offset:53248
 v_add_f32 v222, v153, v222
 v_mfma_f32_16x16x32_bf16 v[120:123], a[28:31], v[160:163], v[120:123]
 s_waitcnt lgkmcnt(4)
 v_exp_f32 v148, v148
 v_mfma_f32_16x16x32_bf16 v[128:131], a[0:3], a[64:67], v[168:171]
 s_mov_b32 s34, 114816
 ds_read_b128 a[20:23], v192 offset:53760
 v_cvt_pk_bf16_f32 v160, v144, v145
 v_mfma_f32_16x16x32_bf16 v[132:135], a[0:3], a[68:71], v[172:175]
 s_waitcnt lgkmcnt(4)
 v_exp_f32 v149, v149
 v_mfma_f32_16x16x32_bf16 v[140:143], a[4:7], a[68:71], v[172:175]
 ds_read_b128 a[24:27], v193 offset:53248
 v_cvt_pk_bf16_f32 v161, v146, v147
 v_mfma_f32_16x16x32_bf16 v[136:139], a[4:7], a[64:67], v[168:171]
 s_waitcnt lgkmcnt(4)
 v_exp_f32 v150, v150
 v_mfma_f32_16x16x32_bf16 v[128:131], a[8:11], a[72:75], v[128:131]
 ds_read_b128 a[28:31], v193 offset:53760
 buffer_load_dwordx4 v218, s[20:23], s34 offen lds
 v_mfma_f32_16x16x32_bf16 v[132:135], a[8:11], a[76:79], v[132:135]
 s_waitcnt lgkmcnt(4)
 v_exp_f32 v151, v151
 v_mfma_f32_16x16x32_bf16 v[140:143], a[12:15], a[76:79], v[140:143]
 ds_read_b128 a[0:3], v192 offset:57344
 v_cvt_pk_bf16_f32 v162, v152, v153
 v_mfma_f32_16x16x32_bf16 v[136:139], a[12:15], a[72:75], v[136:139]
 s_waitcnt lgkmcnt(4)
 v_exp_f32 v156, v156
 v_mfma_f32_16x16x32_bf16 v[128:131], a[16:19], a[80:83], v[128:131]
 ds_read_b128 a[4:7], v192 offset:57856
 v_cvt_pk_bf16_f32 v163, v154, v155
 v_mfma_f32_16x16x32_bf16 v[132:135], a[16:19], a[84:87], v[132:135]
 s_waitcnt lgkmcnt(4)
 v_exp_f32 v157, v157
 v_mfma_f32_16x16x32_bf16 v[140:143], a[20:23], a[84:87], v[140:143]
 ds_read_b128 a[8:11], v193 offset:57344
 v_cvt_pk_bf16_f32 v164, v148, v149
 v_mfma_f32_16x16x32_bf16 v[136:139], a[20:23], a[80:83], v[136:139]
 s_waitcnt lgkmcnt(4)
 buffer_load_dwordx4 v219, s[20:23], s34 offen offset:1024 lds
 v_cvt_pk_bf16_f32 v165, v150, v151
 v_mfma_f32_16x16x32_bf16 v[128:131], a[24:27], a[88:91], v[128:131]
 ds_read_b128 a[12:15], v193 offset:57856
 v_cvt_pk_bf16_f32 v166, v156, v157
 v_mfma_f32_16x16x32_bf16 v[132:135], a[24:27], a[92:95], v[132:135]
 s_waitcnt lgkmcnt(4)
 v_exp_f32 v158, v158
 v_mfma_f32_16x16x32_bf16 v[140:143], a[28:31], a[92:95], v[140:143]
 ds_read_b128 a[16:19], v192 offset:61440
 v_add_f32 v222, v154, v222
 v_mfma_f32_16x16x32_bf16 v[136:139], a[28:31], a[88:91], v[136:139]
 s_waitcnt lgkmcnt(4)
 v_exp_f32 v159, v159
 v_mfma_f32_16x16x32_bf16 v[128:131], a[0:3], a[96:99], v[128:131]
 ds_read_b128 a[20:23], v192 offset:61952
 v_cvt_pk_bf16_f32 v167, v158, v159
 v_mfma_f32_16x16x32_bf16 v[132:135], a[0:3], a[100:103], v[132:135]
 s_waitcnt lgkmcnt(4)
 v_add_f32 v222, v155, v222
 v_add_f32 v223, v148, v223
 v_mfma_f32_16x16x32_bf16 v[140:143], a[4:7], a[100:103], v[140:143]
 ds_read_b128 a[24:27], v193 offset:61440
 buffer_load_dwordx4 v220, s[20:23], s34 offen offset:2048 lds
 v_mfma_f32_16x16x32_bf16 v[136:139], a[4:7], a[96:99], v[136:139]
 s_waitcnt lgkmcnt(4)
 v_add_f32 v223, v149, v223
 v_add_f32 v223, v150, v223
 v_mfma_f32_16x16x32_bf16 v[128:131], a[8:11], a[104:107], v[128:131]
 ds_read_b128 a[28:31], v193 offset:61952
 v_add_f32 v223, v151, v223
 v_mfma_f32_16x16x32_bf16 v[132:135], a[8:11], a[108:111], v[132:135]
 s_waitcnt lgkmcnt(4)
 v_add_f32 v223, v156, v223
 v_add_f32 v223, v157, v223
 v_mfma_f32_16x16x32_bf16 v[140:143], a[12:15], a[108:111], v[140:143]
 ds_read_b64_tr_b16 a[0:1], v202 offset:0
 ds_read_b64_tr_b16 a[2:3], v202 offset:512
 v_mfma_f32_16x16x32_bf16 v[136:139], a[12:15], a[104:107], v[136:139]
 s_waitcnt lgkmcnt(5)
 v_add_f32 v223, v158, v223
 v_add_f32 v223, v159, v223
 v_mfma_f32_16x16x32_bf16 v[128:131], a[16:19], a[112:115], v[128:131]
 ds_read_b64_tr_b16 a[4:5], v203 offset:0
 ds_read_b64_tr_b16 a[6:7], v203 offset:512
 v_mfma_f32_16x16x32_bf16 v[132:135], a[16:19], a[116:119], v[132:135]
 s_waitcnt lgkmcnt(6)
 buffer_load_dwordx4 v221, s[20:23], s34 offen offset:3072 lds
 v_mfma_f32_16x16x32_bf16 v[140:143], a[20:23], a[116:119], v[140:143]
 ds_read_b64_tr_b16 a[8:9], v204 offset:0
 ds_read_b64_tr_b16 a[10:11], v204 offset:512
 v_mfma_f32_16x16x32_bf16 v[136:139], a[20:23], a[112:115], v[136:139]
 s_waitcnt lgkmcnt(7)
 v_mfma_f32_16x16x32_bf16 v[128:131], a[24:27], a[120:123], v[128:131]
 ds_read_b64_tr_b16 a[12:13], v205 offset:0
 ds_read_b64_tr_b16 a[14:15], v205 offset:512
 v_mfma_f32_16x16x32_bf16 v[132:135], a[24:27], a[124:127], v[132:135]
 s_waitcnt lgkmcnt(8)
 v_mfma_f32_16x16x32_bf16 v[140:143], a[28:31], a[124:127], v[140:143]
 ds_read_b64_tr_b16 a[16:17], v202 offset:4096
 ds_read_b64_tr_b16 a[18:19], v202 offset:4608
 v_mfma_f32_16x16x32_bf16 v[136:139], a[28:31], a[120:123], v[136:139]
 s_waitcnt lgkmcnt(8)
 v_mfma_f32_16x16x32_bf16 v[0:3], a[0:3], v[160:163], v[0:3]
 ds_read_b64_tr_b16 a[20:21], v203 offset:4096
 ds_read_b64_tr_b16 a[22:23], v203 offset:4608
 v_mfma_f32_16x16x32_bf16 v[4:7], a[0:3], v[164:167], v[4:7]
 s_waitcnt vmcnt(21) lgkmcnt(8)
 v_max3_f32 v224, v128, v129, v130
 v_max3_f32 v224, v131, v132, v224
 v_mfma_f32_16x16x32_bf16 v[12:15], a[4:7], v[164:167], v[12:15]
 s_barrier
 ds_read_b64_tr_b16 a[24:25], v204 offset:4096
 ds_read_b64_tr_b16 a[26:27], v204 offset:4608
 v_mfma_f32_16x16x32_bf16 v[8:11], a[4:7], v[160:163], v[8:11]
 s_waitcnt lgkmcnt(8)
 v_max3_f32 v224, v133, v134, v224
 v_max3_f32 v224, v135, v136, v224
 v_mfma_f32_16x16x32_bf16 v[16:19], a[8:11], v[160:163], v[16:19]
 s_add_u32 m0, s33, 32768
 ds_read_b64_tr_b16 a[28:29], v205 offset:4096
 ds_read_b64_tr_b16 a[30:31], v205 offset:4608
 v_mfma_f32_16x16x32_bf16 v[20:23], a[8:11], v[164:167], v[20:23]
 s_waitcnt lgkmcnt(8)
 v_max3_f32 v224, v137, v138, v224
 v_max3_f32 v224, v139, v140, v224
 v_mfma_f32_16x16x32_bf16 v[28:31], a[12:15], v[164:167], v[28:31]
 s_mov_b32 s34, 256
 ds_read_b64_tr_b16 a[0:1], v202 offset:8192
 ds_read_b64_tr_b16 a[2:3], v202 offset:8704
 v_mfma_f32_16x16x32_bf16 v[24:27], a[12:15], v[160:163], v[24:27]
 s_waitcnt lgkmcnt(8)
 buffer_load_dwordx4 v218, s[20:23], s34 offen lds
 v_max3_f32 v224, v141, v142, v224
 v_mfma_f32_16x16x32_bf16 v[32:35], a[16:19], v[160:163], v[32:35]
 ds_read_b64_tr_b16 a[4:5], v203 offset:8192
 ds_read_b64_tr_b16 a[6:7], v203 offset:8704
 v_mfma_f32_16x16x32_bf16 v[36:39], a[16:19], v[164:167], v[36:39]
 s_waitcnt lgkmcnt(8)
 v_max_f32 v224, v143, v224
 v_cmp_lt_f32 vcc, s35, v224
 v_mfma_f32_16x16x32_bf16 v[44:47], a[20:23], v[164:167], v[44:47]
 s_cbranch_vccnz L_stub29
L_ret29:
 ds_read_b64_tr_b16 a[8:9], v204 offset:8192
 ds_read_b64_tr_b16 a[10:11], v204 offset:8704
 v_mfma_f32_16x16x32_bf16 v[40:43], a[20:23], v[160:163], v[40:43]
 s_waitcnt lgkmcnt(8)
 v_exp_f32 v128, v128
 v_mfma_f32_16x16x32_bf16 v[48:51], a[24:27], v[160:163], v[48:51]
 ds_read_b64_tr_b16 a[12:13], v205 offset:8192
 ds_read_b64_tr_b16 a[14:15], v205 offset:8704
 v_mfma_f32_16x16x32_bf16 v[52:55], a[24:27], v[164:167], v[52:55]
 s_waitcnt lgkmcnt(8)
 v_exp_f32 v129, v129
 v_mfma_f32_16x16x32_bf16 v[60:63], a[28:31], v[164:167], v[60:63]
 ds_read_b64_tr_b16 a[16:17], v202 offset:12288
 ds_read_b64_tr_b16 a[18:19], v202 offset:12800
 v_mfma_f32_16x16x32_bf16 v[56:59], a[28:31], v[160:163], v[56:59]
 s_waitcnt lgkmcnt(8)
 buffer_load_dwordx4 v219, s[20:23], s34 offen offset:1024 lds
 v_add_f32 v222, v128, v222
 v_mfma_f32_16x16x32_bf16 v[64:67], a[0:3], v[160:163], v[64:67]
 ds_read_b64_tr_b16 a[20:21], v203 offset:12288
 ds_read_b64_tr_b16 a[22:23], v203 offset:12800
 v_mfma_f32_16x16x32_bf16 v[68:71], a[0:3], v[164:167], v[68:71]
 s_waitcnt lgkmcnt(8)
 v_exp_f32 v130, v130
 v_mfma_f32_16x16x32_bf16 v[76:79], a[4:7], v[164:167], v[76:79]
 ds_read_b64_tr_b16 a[24:25], v204 offset:12288
 ds_read_b64_tr_b16 a[26:27], v204 offset:12800
 v_mfma_f32_16x16x32_bf16 v[72:75], a[4:7], v[160:163], v[72:75]
 s_waitcnt lgkmcnt(8)
 v_exp_f32 v131, v131
 v_mfma_f32_16x16x32_bf16 v[80:83], a[8:11], v[160:163], v[80:83]
 ds_read_b64_tr_b16 a[28:29], v205 offset:12288
 ds_read_b64_tr_b16 a[30:31], v205 offset:12800
 v_mfma_f32_16x16x32_bf16 v[84:87], a[8:11], v[164:167], v[84:87]
 s_waitcnt lgkmcnt(8)
 v_exp_f32 v136, v136
 v_mfma_f32_16x16x32_bf16 v[92:95], a[12:15], v[164:167], v[92:95]
 ds_read_b128 a[0:3], v194 offset:16384
 buffer_load_dwordx4 v220, s[20:23], s34 offen offset:2048 lds
 v_mfma_f32_16x16x32_bf16 v[88:91], a[12:15], v[160:163], v[88:91]
 s_waitcnt lgkmcnt(7)
 v_exp_f32 v137, v137
 v_mfma_f32_16x16x32_bf16 v[96:99], a[16:19], v[160:163], v[96:99]
 ds_read_b128 a[4:7], v194 offset:16896
 v_add_f32 v222, v129, v222
 v_mfma_f32_16x16x32_bf16 v[100:103], a[16:19], v[164:167], v[100:103]
 s_waitcnt lgkmcnt(6)
 v_exp_f32 v138, v138
 v_mfma_f32_16x16x32_bf16 v[108:111], a[20:23], v[164:167], v[108:111]
 ds_read_b128 a[8:11], v195 offset:16384
 v_add_f32 v222, v130, v222
 v_mfma_f32_16x16x32_bf16 v[104:107], a[20:23], v[160:163], v[104:107]
 s_waitcnt lgkmcnt(5)
 v_exp_f32 v139, v139
 v_mfma_f32_16x16x32_bf16 v[112:115], a[24:27], v[160:163], v[112:115]
 ds_read_b128 a[12:15], v195 offset:16896
 v_add_f32 v222, v131, v222
 v_mfma_f32_16x16x32_bf16 v[116:119], a[24:27], v[164:167], v[116:119]
 s_waitcnt lgkmcnt(4)
 buffer_load_dwordx4 v221, s[20:23], s34 offen offset:3072 lds
 v_add_f32 v222, v136, v222
 v_mfma_f32_16x16x32_bf16 v[124:127], a[28:31], v[164:167], v[124:127]
 s_add_u32 m0, s33, 49152
 ds_read_b128 a[16:19], v194 offset:20480
 v_add_f32 v222, v137, v222
 v_mfma_f32_16x16x32_bf16 v[120:123], a[28:31], v[160:163], v[120:123]
 s_waitcnt lgkmcnt(4)
 v_exp_f32 v132, v132
 v_mfma_f32_16x16x32_bf16 v[144:147], a[0:3], a[64:67], v[168:171]
 s_mov_b32 s34, 114944
 ds_read_b128 a[20:23], v194 offset:20992
 v_cvt_pk_bf16_f32 v160, v128, v129
 v_mfma_f32_16x16x32_bf16 v[148:151], a[0:3], a[68:71], v[172:175]
 s_waitcnt lgkmcnt(4)
 v_exp_f32 v133, v133
 v_mfma_f32_16x16x32_bf16 v[156:159], a[4:7], a[68:71], v[172:175]
 s_add_u32 s92, s54, 65536
 s_addc_u32 s93, s55, 0
 ds_read_b128 a[24:27], v195 offset:20480
 global_load_dword v252, v245, s[92:93]
 v_mfma_f32_16x16x32_bf16 v[152:155], a[4:7], a[64:67], v[168:171]
 s_waitcnt lgkmcnt(4)
 v_exp_f32 v134, v134
 v_mfma_f32_16x16x32_bf16 v[144:147], a[8:11], a[72:75], v[144:147]
 ds_read_b128 a[28:31], v195 offset:20992
 buffer_load_dwordx4 v218, s[20:23], s34 offen lds
 v_mfma_f32_16x16x32_bf16 v[148:151], a[8:11], a[76:79], v[148:151]
 s_waitcnt lgkmcnt(4)
 v_exp_f32 v135, v135
 v_mfma_f32_16x16x32_bf16 v[156:159], a[12:15], a[76:79], v[156:159]
 ds_read_b128 a[0:3], v194 offset:24576
 v_cvt_pk_bf16_f32 v161, v130, v131
 v_mfma_f32_16x16x32_bf16 v[152:155], a[12:15], a[72:75], v[152:155]
 s_waitcnt lgkmcnt(4)
 v_exp_f32 v140, v140
 v_mfma_f32_16x16x32_bf16 v[144:147], a[16:19], a[80:83], v[144:147]
 ds_read_b128 a[4:7], v194 offset:25088
 v_cvt_pk_bf16_f32 v162, v136, v137
 v_mfma_f32_16x16x32_bf16 v[148:151], a[16:19], a[84:87], v[148:151]
 s_waitcnt lgkmcnt(4)
 v_exp_f32 v141, v141
 v_mfma_f32_16x16x32_bf16 v[156:159], a[20:23], a[84:87], v[156:159]
 ds_read_b128 a[8:11], v195 offset:24576
 v_cvt_pk_bf16_f32 v163, v138, v139
 v_mfma_f32_16x16x32_bf16 v[152:155], a[20:23], a[80:83], v[152:155]
 s_waitcnt lgkmcnt(4)
 buffer_load_dwordx4 v219, s[20:23], s34 offen offset:1024 lds
 v_cvt_pk_bf16_f32 v164, v132, v133
 v_mfma_f32_16x16x32_bf16 v[144:147], a[24:27], a[88:91], v[144:147]
 ds_read_b128 a[12:15], v195 offset:25088
 v_cvt_pk_bf16_f32 v165, v134, v135
 v_mfma_f32_16x16x32_bf16 v[148:151], a[24:27], a[92:95], v[148:151]
 s_waitcnt lgkmcnt(4)
 v_exp_f32 v142, v142
 v_mfma_f32_16x16x32_bf16 v[156:159], a[28:31], a[92:95], v[156:159]
 ds_read_b128 a[16:19], v194 offset:28672
 v_cvt_pk_bf16_f32 v166, v140, v141
 v_mfma_f32_16x16x32_bf16 v[152:155], a[28:31], a[88:91], v[152:155]
 s_waitcnt lgkmcnt(4)
 v_exp_f32 v143, v143
 v_mfma_f32_16x16x32_bf16 v[144:147], a[0:3], a[96:99], v[144:147]
 ds_read_b128 a[20:23], v194 offset:29184
 v_cvt_pk_bf16_f32 v167, v142, v143
 v_mfma_f32_16x16x32_bf16 v[148:151], a[0:3], a[100:103], v[148:151]
 s_waitcnt lgkmcnt(4)
 v_add_f32 v222, v138, v222
 v_add_f32 v222, v139, v222
 v_mfma_f32_16x16x32_bf16 v[156:159], a[4:7], a[100:103], v[156:159]
 ds_read_b128 a[24:27], v195 offset:28672
 buffer_load_dwordx4 v220, s[20:23], s34 offen offset:2048 lds
 v_mfma_f32_16x16x32_bf16 v[152:155], a[4:7], a[96:99], v[152:155]
 s_waitcnt lgkmcnt(4)
 v_add_f32 v223, v132, v223
 v_add_f32 v223, v133, v223
 v_mfma_f32_16x16x32_bf16 v[144:147], a[8:11], a[104:107], v[144:147]
 ds_read_b128 a[28:31], v195 offset:29184
 v_add_f32 v223, v134, v223
 v_mfma_f32_16x16x32_bf16 v[148:151], a[8:11], a[108:111], v[148:151]
 s_waitcnt lgkmcnt(4)
 v_add_f32 v223, v135, v223
 v_add_f32 v223, v140, v223
 v_mfma_f32_16x16x32_bf16 v[156:159], a[12:15], a[108:111], v[156:159]
 ds_read_b64_tr_b16 a[0:1], v202 offset:32768
 ds_read_b64_tr_b16 a[2:3], v202 offset:33280
 v_mfma_f32_16x16x32_bf16 v[152:155], a[12:15], a[104:107], v[152:155]
 s_waitcnt lgkmcnt(5)
 v_add_f32 v223, v141, v223
 v_add_f32 v223, v142, v223
 v_mfma_f32_16x16x32_bf16 v[144:147], a[16:19], a[112:115], v[144:147]
 ds_read_b64_tr_b16 a[4:5], v203 offset:32768
 ds_read_b64_tr_b16 a[6:7], v203 offset:33280
 v_mfma_f32_16x16x32_bf16 v[148:151], a[16:19], a[116:119], v[148:151]
 s_waitcnt lgkmcnt(6)
 buffer_load_dwordx4 v221, s[20:23], s34 offen offset:3072 lds
 v_add_f32 v223, v143, v223
 v_mfma_f32_16x16x32_bf16 v[156:159], a[20:23], a[116:119], v[156:159]
 ds_read_b64_tr_b16 a[8:9], v204 offset:32768
 ds_read_b64_tr_b16 a[10:11], v204 offset:33280
 v_mfma_f32_16x16x32_bf16 v[152:155], a[20:23], a[112:115], v[152:155]
 s_waitcnt lgkmcnt(7)
 v_mfma_f32_16x16x32_bf16 v[144:147], a[24:27], a[120:123], v[144:147]
 ds_read_b64_tr_b16 a[12:13], v205 offset:32768
 ds_read_b64_tr_b16 a[14:15], v205 offset:33280
 v_mfma_f32_16x16x32_bf16 v[148:151], a[24:27], a[124:127], v[148:151]
 s_waitcnt lgkmcnt(8)
 v_mfma_f32_16x16x32_bf16 v[156:159], a[28:31], a[124:127], v[156:159]
 ds_read_b64_tr_b16 a[16:17], v202 offset:36864
 ds_read_b64_tr_b16 a[18:19], v202 offset:37376
 v_mfma_f32_16x16x32_bf16 v[152:155], a[28:31], a[120:123], v[152:155]
 s_waitcnt lgkmcnt(8)
 v_mfma_f32_16x16x32_bf16 v[0:3], a[0:3], v[160:163], v[0:3]
 ds_read_b64_tr_b16 a[20:21], v203 offset:36864
 ds_read_b64_tr_b16 a[22:23], v203 offset:37376
 v_mfma_f32_16x16x32_bf16 v[4:7], a[0:3], v[164:167], v[4:7]
 s_waitcnt vmcnt(21) lgkmcnt(8)
 v_max3_f32 v224, v144, v145, v146
 v_max3_f32 v224, v147, v148, v224
 v_mfma_f32_16x16x32_bf16 v[12:15], a[4:7], v[164:167], v[12:15]
 s_barrier
 ds_read_b64_tr_b16 a[24:25], v204 offset:36864
 ds_read_b64_tr_b16 a[26:27], v204 offset:37376
 v_mfma_f32_16x16x32_bf16 v[8:11], a[4:7], v[160:163], v[8:11]
 s_waitcnt lgkmcnt(8)
 v_max3_f32 v224, v149, v150, v224
 v_max3_f32 v224, v151, v152, v224
 v_mfma_f32_16x16x32_bf16 v[16:19], a[8:11], v[160:163], v[16:19]
 s_add_u32 m0, s33, 65536
 ds_read_b64_tr_b16 a[28:29], v205 offset:36864
 ds_read_b64_tr_b16 a[30:31], v205 offset:37376
 v_mfma_f32_16x16x32_bf16 v[20:23], a[8:11], v[164:167], v[20:23]
 s_waitcnt lgkmcnt(8)
 v_max3_f32 v224, v153, v154, v224
 v_max3_f32 v224, v155, v156, v224
 v_mfma_f32_16x16x32_bf16 v[28:31], a[12:15], v[164:167], v[28:31]
 s_mov_b32 s34, 384
 ds_read_b64_tr_b16 a[0:1], v202 offset:40960
 ds_read_b64_tr_b16 a[2:3], v202 offset:41472
 v_mfma_f32_16x16x32_bf16 v[24:27], a[12:15], v[160:163], v[24:27]
 s_waitcnt lgkmcnt(8)
 buffer_load_dwordx4 v218, s[20:23], s34 offen lds
 v_max3_f32 v224, v157, v158, v224
 v_mfma_f32_16x16x32_bf16 v[32:35], a[16:19], v[160:163], v[32:35]
 ds_read_b64_tr_b16 a[4:5], v203 offset:40960
 ds_read_b64_tr_b16 a[6:7], v203 offset:41472
 v_mfma_f32_16x16x32_bf16 v[36:39], a[16:19], v[164:167], v[36:39]
 s_waitcnt lgkmcnt(8)
 v_max_f32 v224, v159, v224
 v_cmp_lt_f32 vcc, s35, v224
 v_mfma_f32_16x16x32_bf16 v[44:47], a[20:23], v[164:167], v[44:47]
 s_cbranch_vccnz L_stub30
L_ret30:
 ds_read_b64_tr_b16 a[8:9], v204 offset:40960
 ds_read_b64_tr_b16 a[10:11], v204 offset:41472
 v_mfma_f32_16x16x32_bf16 v[40:43], a[20:23], v[160:163], v[40:43]
 s_waitcnt lgkmcnt(8)
 v_exp_f32 v144, v144
 v_mfma_f32_16x16x32_bf16 v[48:51], a[24:27], v[160:163], v[48:51]
 ds_read_b64_tr_b16 a[12:13], v205 offset:40960
 ds_read_b64_tr_b16 a[14:15], v205 offset:41472
 v_mfma_f32_16x16x32_bf16 v[52:55], a[24:27], v[164:167], v[52:55]
 s_waitcnt lgkmcnt(8)
 v_exp_f32 v145, v145
 v_mfma_f32_16x16x32_bf16 v[60:63], a[28:31], v[164:167], v[60:63]
 ds_read_b64_tr_b16 a[16:17], v202 offset:45056
 ds_read_b64_tr_b16 a[18:19], v202 offset:45568
 v_mfma_f32_16x16x32_bf16 v[56:59], a[28:31], v[160:163], v[56:59]
 s_waitcnt lgkmcnt(8)
 buffer_load_dwordx4 v219, s[20:23], s34 offen offset:1024 lds
 v_add_f32 v222, v144, v222
 v_mfma_f32_16x16x32_bf16 v[64:67], a[0:3], v[160:163], v[64:67]
 ds_read_b64_tr_b16 a[20:21], v203 offset:45056
 ds_read_b64_tr_b16 a[22:23], v203 offset:45568
 v_mfma_f32_16x16x32_bf16 v[68:71], a[0:3], v[164:167], v[68:71]
 s_waitcnt lgkmcnt(8)
 v_exp_f32 v146, v146
 v_mfma_f32_16x16x32_bf16 v[76:79], a[4:7], v[164:167], v[76:79]
 ds_read_b64_tr_b16 a[24:25], v204 offset:45056
 ds_read_b64_tr_b16 a[26:27], v204 offset:45568
 v_mfma_f32_16x16x32_bf16 v[72:75], a[4:7], v[160:163], v[72:75]
 s_waitcnt lgkmcnt(8)
 v_exp_f32 v147, v147
 v_mfma_f32_16x16x32_bf16 v[80:83], a[8:11], v[160:163], v[80:83]
 ds_read_b64_tr_b16 a[28:29], v205 offset:45056
 ds_read_b64_tr_b16 a[30:31], v205 offset:45568
 v_mfma_f32_16x16x32_bf16 v[84:87], a[8:11], v[164:167], v[84:87]
 s_waitcnt lgkmcnt(8)
 v_exp_f32 v152, v152
 v_mfma_f32_16x16x32_bf16 v[92:95], a[12:15], v[164:167], v[92:95]
 ds_read_b64_tr_b16 a[0:1], v202 offset:49152
 ds_read_b64_tr_b16 a[2:3], v202 offset:49664
 v_mfma_f32_16x16x32_bf16 v[88:91], a[12:15], v[160:163], v[88:91]
 s_waitcnt lgkmcnt(8)
 buffer_load_dwordx4 v220, s[20:23], s34 offen offset:2048 lds
 v_add_f32 v222, v145, v222
 v_mfma_f32_16x16x32_bf16 v[96:99], a[16:19], v[160:163], v[96:99]
 ds_read_b64_tr_b16 a[4:5], v203 offset:49152
 ds_read_b64_tr_b16 a[6:7], v203 offset:49664
 v_mfma_f32_16x16x32_bf16 v[100:103], a[16:19], v[164:167], v[100:103]
 s_waitcnt lgkmcnt(8)
 v_exp_f32 v153, v153
 v_mfma_f32_16x16x32_bf16 v[108:111], a[20:23], v[164:167], v[108:111]
 ds_read_b64_tr_b16 a[8:9], v204 offset:49152
 ds_read_b64_tr_b16 a[10:11], v204 offset:49664
 v_mfma_f32_16x16x32_bf16 v[104:107], a[20:23], v[160:163], v[104:107]
 s_waitcnt lgkmcnt(8)
 v_exp_f32 v154, v154
 v_mfma_f32_16x16x32_bf16 v[112:115], a[24:27], v[160:163], v[112:115]
 ds_read_b64_tr_b16 a[12:13], v205 offset:49152
 ds_read_b64_tr_b16 a[14:15], v205 offset:49664
 v_mfma_f32_16x16x32_bf16 v[116:119], a[24:27], v[164:167], v[116:119]
 s_waitcnt lgkmcnt(8)
 v_exp_f32 v155, v155
 v_mfma_f32_16x16x32_bf16 v[124:127], a[28:31], v[164:167], v[124:127]
 ds_read_b64_tr_b16 a[16:17], v202 offset:53248
 ds_read_b64_tr_b16 a[18:19], v202 offset:53760
 v_mfma_f32_16x16x32_bf16 v[120:123], a[28:31], v[160:163], v[120:123]
 s_waitcnt lgkmcnt(8)
 buffer_load_dwordx4 v221, s[20:23], s34 offen offset:3072 lds
 v_add_f32 v222, v146, v222
 v_cvt_pk_bf16_f32 v160, v144, v145
 v_cvt_pk_bf16_f32 v161, v146, v147
 v_cvt_pk_bf16_f32 v162, v152, v153
 v_cvt_pk_bf16_f32 v163, v154, v155
 s_nop 1
 v_mfma_f32_16x16x32_bf16 v[0:3], a[0:3], v[160:163], v[0:3]
 s_add_u32 m0, s33, 81920
 ds_read_b64_tr_b16 a[20:21], v203 offset:53248
 ds_read_b64_tr_b16 a[22:23], v203 offset:53760
 v_exp_f32 v148, v148
 v_exp_f32 v149, v149
 v_exp_f32 v150, v150
 v_cvt_pk_bf16_f32 v164, v148, v149
 v_exp_f32 v151, v151
 v_exp_f32 v156, v156
 v_cvt_pk_bf16_f32 v165, v150, v151
 v_exp_f32 v157, v157
 v_exp_f32 v158, v158
 v_cvt_pk_bf16_f32 v166, v156, v157
 v_exp_f32 v159, v159
 s_nop 0
 v_cvt_pk_bf16_f32 v167, v158, v159
 s_nop 1
 v_mfma_f32_16x16x32_bf16 v[4:7], a[0:3], v[164:167], v[4:7]
 s_waitcnt lgkmcnt(8)
 v_add_f32 v222, v147, v222
 v_add_f32 v222, v152, v222
 v_mfma_f32_16x16x32_bf16 v[12:15], a[4:7], v[164:167], v[12:15]
 s_mov_b32 s34, 115072
 ds_read_b64_tr_b16 a[24:25], v204 offset:53248
 ds_read_b64_tr_b16 a[26:27], v204 offset:53760
 v_mfma_f32_16x16x32_bf16 v[8:11], a[4:7], v[160:163], v[8:11]
 s_waitcnt lgkmcnt(8)
 v_add_f32 v222, v153, v222
 v_add_f32 v222, v154, v222
 v_mfma_f32_16x16x32_bf16 v[16:19], a[8:11], v[160:163], v[16:19]
 ds_read_b64_tr_b16 a[28:29], v205 offset:53248
 ds_read_b64_tr_b16 a[30:31], v205 offset:53760
 v_mfma_f32_16x16x32_bf16 v[20:23], a[8:11], v[164:167], v[20:23]
 s_waitcnt lgkmcnt(8)
 v_add_f32 v222, v155, v222
 v_add_f32 v223, v148, v223
 v_mfma_f32_16x16x32_bf16 v[28:31], a[12:15], v[164:167], v[28:31]
 ds_read_b64_tr_b16 a[0:1], v202 offset:57344
 ds_read_b64_tr_b16 a[2:3], v202 offset:57856
 v_mfma_f32_16x16x32_bf16 v[24:27], a[12:15], v[160:163], v[24:27]
 s_waitcnt lgkmcnt(8)
 buffer_load_dwordx4 v218, s[20:23], s34 offen lds
 v_add_f32 v223, v149, v223
 v_mfma_f32_16x16x32_bf16 v[32:35], a[16:19], v[160:163], v[32:35]
 ds_read_b64_tr_b16 a[4:5], v203 offset:57344
 ds_read_b64_tr_b16 a[6:7], v203 offset:57856
 v_mfma_f32_16x16x32_bf16 v[36:39], a[16:19], v[164:167], v[36:39]
 s_waitcnt lgkmcnt(8)
 v_add_f32 v223, v150, v223
 v_add_f32 v223, v151, v223
 v_mfma_f32_16x16x32_bf16 v[44:47], a[20:23], v[164:167], v[44:47]
 ds_read_b64_tr_b16 a[8:9], v204 offset:57344
 ds_read_b64_tr_b16 a[10:11], v204 offset:57856
 v_mfma_f32_16x16x32_bf16 v[40:43], a[20:23], v[160:163], v[40:43]
 s_waitcnt lgkmcnt(8)
 v_add_f32 v223, v156, v223
 v_add_f32 v223, v157, v223
 v_mfma_f32_16x16x32_bf16 v[48:51], a[24:27], v[160:163], v[48:51]
 ds_read_b64_tr_b16 a[12:13], v205 offset:57344
 ds_read_b64_tr_b16 a[14:15], v205 offset:57856
 v_mfma_f32_16x16x32_bf16 v[52:55], a[24:27], v[164:167], v[52:55]
 s_waitcnt lgkmcnt(8)
 v_add_f32 v223, v158, v223
 v_add_f32 v223, v159, v223
 v_mfma_f32_16x16x32_bf16 v[60:63], a[28:31], v[164:167], v[60:63]
 ds_read_b64_tr_b16 a[16:17], v202 offset:61440
 ds_read_b64_tr_b16 a[18:19], v202 offset:61952
 v_mfma_f32_16x16x32_bf16 v[56:59], a[28:31], v[160:163], v[56:59]
 s_waitcnt lgkmcnt(8)
 buffer_load_dwordx4 v219, s[20:23], s34 offen offset:1024 lds
 v_mov_b32 v224, v222
 v_mfma_f32_16x16x32_bf16 v[64:67], a[0:3], v[160:163], v[64:67]
 ds_read_b64_tr_b16 a[20:21], v203 offset:61440
 ds_read_b64_tr_b16 a[22:23], v203 offset:61952
 v_mfma_f32_16x16x32_bf16 v[68:71], a[0:3], v[164:167], v[68:71]
 s_waitcnt lgkmcnt(8)
 v_permlane32_swap_b32 v222, v224
 v_mfma_f32_16x16x32_bf16 v[76:79], a[4:7], v[164:167], v[76:79]
 ds_read_b64_tr_b16 a[24:25], v204 offset:61440
 ds_read_b64_tr_b16 a[26:27], v204 offset:61952
 v_mfma_f32_16x16x32_bf16 v[72:75], a[4:7], v[160:163], v[72:75]
 s_waitcnt lgkmcnt(8)
 v_mov_b32 v225, v223
 v_add_f32 v222, v222, v224
 v_mfma_f32_16x16x32_bf16 v[80:83], a[8:11], v[160:163], v[80:83]
 ds_read_b64_tr_b16 a[28:29], v205 offset:61440
 ds_read_b64_tr_b16 a[30:31], v205 offset:61952
 v_mfma_f32_16x16x32_bf16 v[84:87], a[8:11], v[164:167], v[84:87]
 s_waitcnt lgkmcnt(8)
 v_permlane32_swap_b32 v223, v225
 v_mfma_f32_16x16x32_bf16 v[92:95], a[12:15], v[164:167], v[92:95]
 ds_read_b64_tr_b16 a[0:1], v206 offset:0
 ds_read_b64_tr_b16 a[2:3], v206 offset:512
 v_mfma_f32_16x16x32_bf16 v[88:91], a[12:15], v[160:163], v[88:91]
 s_waitcnt lgkmcnt(8)
 buffer_load_dwordx4 v220, s[20:23], s34 offen offset:2048 lds
 v_add_f32 v223, v223, v225
 v_mfma_f32_16x16x32_bf16 v[96:99], a[16:19], v[160:163], v[96:99]
 ds_read_b64_tr_b16 a[4:5], v207 offset:0
 ds_read_b64_tr_b16 a[6:7], v207 offset:512
 v_mfma_f32_16x16x32_bf16 v[100:103], a[16:19], v[164:167], v[100:103]
 s_waitcnt lgkmcnt(8)
 v_mov_b32 v224, v222
 v_mov_b32 v225, v223
 v_mfma_f32_16x16x32_bf16 v[108:111], a[20:23], v[164:167], v[108:111]
 ds_read_b64_tr_b16 a[8:9], v208 offset:0
 ds_read_b64_tr_b16 a[10:11], v208 offset:512
 v_mfma_f32_16x16x32_bf16 v[104:107], a[20:23], v[160:163], v[104:107]
 s_waitcnt lgkmcnt(8)
 v_permlane16_swap_b32 v222, v224
 v_mfma_f32_16x16x32_bf16 v[112:115], a[24:27], v[160:163], v[112:115]
 ds_read_b64_tr_b16 a[12:13], v209 offset:0
 ds_read_b64_tr_b16 a[14:15], v209 offset:512
 v_mfma_f32_16x16x32_bf16 v[116:119], a[24:27], v[164:167], v[116:119]
 s_waitcnt lgkmcnt(8)
 v_permlane16_swap_b32 v223, v225
 v_mfma_f32_16x16x32_bf16 v[124:127], a[28:31], v[164:167], v[124:127]
 ds_read_b64_tr_b16 a[16:17], v206 offset:4096
 ds_read_b64_tr_b16 a[18:19], v206 offset:4608
 v_mfma_f32_16x16x32_bf16 v[120:123], a[28:31], v[160:163], v[120:123]
 s_waitcnt lgkmcnt(8)
 buffer_load_dwordx4 v221, s[20:23], s34 offen offset:3072 lds
 v_add_f32 v222, v222, v224
 v_add_f32 v223, v223, v225
 v_rcp_f32 v226, v222
 v_rcp_f32 v228, v223
 v_mul_f32 v0, v226, v0
 v_mul_f32 v1, v226, v1
 v_mul_f32 v2, v226, v2
 v_mul_f32 v3, v226, v3
 v_mul_f32 v8, v226, v8
 v_mul_f32 v9, v226, v9
 v_mul_f32 v10, v226, v10
 v_mul_f32 v11, v226, v11
 v_cvt_pk_bf16_f32 v128, v0, v1
 v_cvt_pk_bf16_f32 v129, v2, v3
 v_cvt_pk_bf16_f32 v130, v8, v9
 v_cvt_pk_bf16_f32 v131, v10, v11
 v_mul_f32 v4, v228, v4
 v_mul_f32 v5, v228, v5
 v_mul_f32 v6, v228, v6
 v_mul_f32 v7, v228, v7
 v_mul_f32 v12, v228, v12
 v_mul_f32 v13, v228, v13
 v_mul_f32 v14, v228, v14
 v_mul_f32 v15, v228, v15
 v_cvt_pk_bf16_f32 v132, v4, v5
 v_cvt_pk_bf16_f32 v133, v6, v7
 v_cvt_pk_bf16_f32 v134, v12, v13
 v_cvt_pk_bf16_f32 v135, v14, v15
 v_mfma_f32_16x16x32_bf16 v[0:3], a[0:3], v[128:131], 0
 ds_read_b64_tr_b16 a[20:21], v207 offset:4096
 ds_read_b64_tr_b16 a[22:23], v207 offset:4608
 v_mfma_f32_16x16x32_bf16 v[4:7], a[0:3], v[132:135], 0
 s_waitcnt vmcnt(21) lgkmcnt(8)
 v_mul_f32 v16, v226, v16
 v_mul_f32 v17, v226, v17
 v_mfma_f32_16x16x32_bf16 v[12:15], a[4:7], v[132:135], 0
 s_barrier
 ds_read_b64_tr_b16 a[24:25], v208 offset:4096
 ds_read_b64_tr_b16 a[26:27], v208 offset:4608
 v_mfma_f32_16x16x32_bf16 v[8:11], a[4:7], v[128:131], 0
 s_waitcnt lgkmcnt(8)
 v_mul_f32 v18, v226, v18
 v_mul_f32 v19, v226, v19
 v_mul_f32 v24, v226, v24
 v_mul_f32 v25, v226, v25
 v_mul_f32 v26, v226, v26
 v_mul_f32 v27, v226, v27
 v_cvt_pk_bf16_f32 v136, v16, v17
 v_cvt_pk_bf16_f32 v137, v18, v19
 v_cvt_pk_bf16_f32 v138, v24, v25
 v_cvt_pk_bf16_f32 v139, v26, v27
 v_mul_f32 v20, v228, v20
 v_mul_f32 v21, v228, v21
 v_mul_f32 v22, v228, v22
 v_mul_f32 v23, v228, v23
 v_mul_f32 v28, v228, v28
 v_mul_f32 v29, v228, v29
 v_mul_f32 v30, v228, v30
 v_mul_f32 v31, v228, v31
 v_cvt_pk_bf16_f32 v140, v20, v21
 v_cvt_pk_bf16_f32 v141, v22, v23
 v_cvt_pk_bf16_f32 v142, v28, v29
 v_cvt_pk_bf16_f32 v143, v30, v31
 v_mfma_f32_16x16x32_bf16 v[16:19], a[8:11], v[128:131], 0
 s_add_u32 m0, s33, 98304
 ds_read_b64_tr_b16 a[28:29], v209 offset:4096
 ds_read_b64_tr_b16 a[30:31], v209 offset:4608
 v_mfma_f32_16x16x32_bf16 v[20:23], a[8:11], v[132:135], 0
 s_waitcnt lgkmcnt(8)
 v_mul_f32 v32, v226, v32
 v_mul_f32 v33, v226, v33
 v_mfma_f32_16x16x32_bf16 v[28:31], a[12:15], v[132:135], 0
 s_mov_b32 s34, 512
 ds_read_b64_tr_b16 a[0:1], v206 offset:8192
 ds_read_b64_tr_b16 a[2:3], v206 offset:8704
 v_mfma_f32_16x16x32_bf16 v[24:27], a[12:15], v[128:131], 0
 s_waitcnt lgkmcnt(8)
 buffer_load_dwordx4 v218, s[20:23], s34 offen lds
 v_mul_f32 v34, v226, v34
 v_mfma_f32_16x16x32_bf16 v[0:3], a[16:19], v[136:139], v[0:3]
 ds_read_b64_tr_b16 a[4:5], v207 offset:8192
 ds_read_b64_tr_b16 a[6:7], v207 offset:8704
 v_mfma_f32_16x16x32_bf16 v[4:7], a[16:19], v[140:143], v[4:7]
 s_waitcnt lgkmcnt(8)
 v_mul_f32 v35, v226, v35
 v_mul_f32 v40, v226, v40
 v_mfma_f32_16x16x32_bf16 v[12:15], a[20:23], v[140:143], v[12:15]
 ds_read_b64_tr_b16 a[8:9], v208 offset:8192
 ds_read_b64_tr_b16 a[10:11], v208 offset:8704
 v_mfma_f32_16x16x32_bf16 v[8:11], a[20:23], v[136:139], v[8:11]
 s_waitcnt lgkmcnt(8)
 v_mul_f32 v41, v226, v41
 v_mul_f32 v42, v226, v42
 v_mfma_f32_16x16x32_bf16 v[16:19], a[24:27], v[136:139], v[16:19]
 ds_read_b64_tr_b16 a[12:13], v209 offset:8192
 ds_read_b64_tr_b16 a[14:15], v209 offset:8704
 v_mfma_f32_16x16x32_bf16 v[20:23], a[24:27], v[140:143], v[20:23]
 s_waitcnt lgkmcnt(8)
 v_mul_f32 v43, v226, v43
 v_cvt_pk_bf16_f32 v144, v32, v33
 v_mfma_f32_16x16x32_bf16 v[28:31], a[28:31], v[140:143], v[28:31]
 ds_read_b64_tr_b16 a[16:17], v206 offset:12288
 ds_read_b64_tr_b16 a[18:19], v206 offset:12800
 v_mfma_f32_16x16x32_bf16 v[24:27], a[28:31], v[136:139], v[24:27]
 s_waitcnt lgkmcnt(8)
 buffer_load_dwordx4 v219, s[20:23], s34 offen offset:1024 lds
 v_cvt_pk_bf16_f32 v145, v34, v35
 v_cvt_pk_bf16_f32 v146, v40, v41
 v_cvt_pk_bf16_f32 v147, v42, v43
 v_mul_f32 v36, v228, v36
 v_mul_f32 v37, v228, v37
 v_mul_f32 v38, v228, v38
 v_mul_f32 v39, v228, v39
 v_mul_f32 v44, v228, v44
 v_mul_f32 v45, v228, v45
 v_mul_f32 v46, v228, v46
 v_mul_f32 v47, v228, v47
 v_cvt_pk_bf16_f32 v148, v36, v37
 v_cvt_pk_bf16_f32 v149, v38, v39
 v_cvt_pk_bf16_f32 v150, v44, v45
 v_cvt_pk_bf16_f32 v151, v46, v47
 v_mfma_f32_16x16x32_bf16 v[0:3], a[0:3], v[144:147], v[0:3]
 ds_read_b64_tr_b16 a[20:21], v207 offset:12288
 ds_read_b64_tr_b16 a[22:23], v207 offset:12800
 v_mfma_f32_16x16x32_bf16 v[4:7], a[0:3], v[148:151], v[4:7]
 s_waitcnt lgkmcnt(8)
 v_mul_f32 v48, v226, v48
 v_mul_f32 v49, v226, v49
 v_mfma_f32_16x16x32_bf16 v[12:15], a[4:7], v[148:151], v[12:15]
 ds_read_b64_tr_b16 a[24:25], v208 offset:12288
 ds_read_b64_tr_b16 a[26:27], v208 offset:12800
 v_mfma_f32_16x16x32_bf16 v[8:11], a[4:7], v[144:147], v[8:11]
 s_waitcnt lgkmcnt(8)
 v_mul_f32 v50, v226, v50
 v_mul_f32 v51, v226, v51
 v_mfma_f32_16x16x32_bf16 v[16:19], a[8:11], v[144:147], v[16:19]
 ds_read_b64_tr_b16 a[28:29], v209 offset:12288
 ds_read_b64_tr_b16 a[30:31], v209 offset:12800
 v_mfma_f32_16x16x32_bf16 v[20:23], a[8:11], v[148:151], v[20:23]
 s_waitcnt lgkmcnt(8)
 v_mul_f32 v56, v226, v56
 v_mul_f32 v57, v226, v57
 v_mfma_f32_16x16x32_bf16 v[28:31], a[12:15], v[148:151], v[28:31]
 ds_read_b64_tr_b16 a[0:1], v206 offset:16384
 ds_read_b64_tr_b16 a[2:3], v206 offset:16896
 v_mfma_f32_16x16x32_bf16 v[24:27], a[12:15], v[144:147], v[24:27]
 s_waitcnt lgkmcnt(8)
 buffer_load_dwordx4 v220, s[20:23], s34 offen offset:2048 lds
 v_mul_f32 v58, v226, v58
 v_mul_f32 v59, v226, v59
 v_cvt_pk_bf16_f32 v152, v48, v49
 v_cvt_pk_bf16_f32 v153, v50, v51
 v_cvt_pk_bf16_f32 v154, v56, v57
 v_cvt_pk_bf16_f32 v155, v58, v59
 v_mul_f32 v52, v228, v52
 v_mul_f32 v53, v228, v53
 v_mul_f32 v54, v228, v54
 v_mul_f32 v55, v228, v55
 v_mul_f32 v60, v228, v60
 v_mul_f32 v61, v228, v61
 v_mul_f32 v62, v228, v62
 v_mul_f32 v63, v228, v63
 v_cvt_pk_bf16_f32 v156, v52, v53
 v_cvt_pk_bf16_f32 v157, v54, v55
 v_cvt_pk_bf16_f32 v158, v60, v61
 v_cvt_pk_bf16_f32 v159, v62, v63
 v_mfma_f32_16x16x32_bf16 v[0:3], a[16:19], v[152:155], v[0:3]
 ds_read_b64_tr_b16 a[4:5], v207 offset:16384
 ds_read_b64_tr_b16 a[6:7], v207 offset:16896
 v_mfma_f32_16x16x32_bf16 v[4:7], a[16:19], v[156:159], v[4:7]
 s_waitcnt lgkmcnt(8)
 v_mul_f32 v64, v226, v64
 v_mul_f32 v65, v226, v65
 v_mfma_f32_16x16x32_bf16 v[12:15], a[20:23], v[156:159], v[12:15]
 ds_read_b64_tr_b16 a[8:9], v208 offset:16384
 ds_read_b64_tr_b16 a[10:11], v208 offset:16896
 v_mfma_f32_16x16x32_bf16 v[8:11], a[20:23], v[152:155], v[8:11]
 s_waitcnt lgkmcnt(8)
 v_mul_f32 v66, v226, v66
 v_mul_f32 v67, v226, v67
 v_mfma_f32_16x16x32_bf16 v[16:19], a[24:27], v[152:155], v[16:19]
 ds_read_b64_tr_b16 a[12:13], v209 offset:16384
 ds_read_b64_tr_b16 a[14:15], v209 offset:16896
 v_mfma_f32_16x16x32_bf16 v[20:23], a[24:27], v[156:159], v[20:23]
 s_waitcnt lgkmcnt(8)
 v_mul_f32 v72, v226, v72
 v_mul_f32 v73, v226, v73
 v_mfma_f32_16x16x32_bf16 v[28:31], a[28:31], v[156:159], v[28:31]
 ds_read_b64_tr_b16 a[16:17], v206 offset:20480
 ds_read_b64_tr_b16 a[18:19], v206 offset:20992
 v_mfma_f32_16x16x32_bf16 v[24:27], a[28:31], v[152:155], v[24:27]
 s_waitcnt lgkmcnt(8)
 buffer_load_dwordx4 v221, s[20:23], s34 offen offset:3072 lds
 v_mul_f32 v74, v226, v74
 v_mul_f32 v75, v226, v75
 v_cvt_pk_bf16_f32 v160, v64, v65
 v_cvt_pk_bf16_f32 v161, v66, v67
 v_cvt_pk_bf16_f32 v162, v72, v73
 v_cvt_pk_bf16_f32 v163, v74, v75
 v_mul_f32 v68, v228, v68
 v_mul_f32 v69, v228, v69
 v_mul_f32 v70, v228, v70
 v_mul_f32 v71, v228, v71
 v_mul_f32 v76, v228, v76
 v_mul_f32 v77, v228, v77
 v_mul_f32 v78, v228, v78
 v_mul_f32 v79, v228, v79
 v_cvt_pk_bf16_f32 v164, v68, v69
 v_cvt_pk_bf16_f32 v165, v70, v71
 v_cvt_pk_bf16_f32 v166, v76, v77
 v_cvt_pk_bf16_f32 v167, v78, v79
 v_mfma_f32_16x16x32_bf16 v[0:3], a[0:3], v[160:163], v[0:3]
 s_add_u32 m0, s33, 114688
 ds_read_b64_tr_b16 a[20:21], v207 offset:20480
 ds_read_b64_tr_b16 a[22:23], v207 offset:20992
 v_mfma_f32_16x16x32_bf16 v[4:7], a[0:3], v[164:167], v[4:7]
 s_waitcnt lgkmcnt(8)
 v_mul_f32 v80, v226, v80
 v_mul_f32 v81, v226, v81
 v_mfma_f32_16x16x32_bf16 v[12:15], a[4:7], v[164:167], v[12:15]
 s_mov_b32 s34, 115200
 ds_read_b64_tr_b16 a[24:25], v208 offset:20480
 ds_read_b64_tr_b16 a[26:27], v208 offset:20992
 v_mfma_f32_16x16x32_bf16 v[8:11], a[4:7], v[160:163], v[8:11]
 s_waitcnt lgkmcnt(8)
 v_mul_f32 v82, v226, v82
 v_mul_f32 v83, v226, v83
 v_mfma_f32_16x16x32_bf16 v[16:19], a[8:11], v[160:163], v[16:19]
 ds_read_b64_tr_b16 a[28:29], v209 offset:20480
 ds_read_b64_tr_b16 a[30:31], v209 offset:20992
 v_mfma_f32_16x16x32_bf16 v[20:23], a[8:11], v[164:167], v[20:23]
 s_waitcnt lgkmcnt(8)
 v_mul_f32 v88, v226, v88
 v_mul_f32 v89, v226, v89
 v_mfma_f32_16x16x32_bf16 v[28:31], a[12:15], v[164:167], v[28:31]
 ds_read_b64_tr_b16 a[0:1], v206 offset:24576
 ds_read_b64_tr_b16 a[2:3], v206 offset:25088
 v_mfma_f32_16x16x32_bf16 v[24:27], a[12:15], v[160:163], v[24:27]
 s_waitcnt lgkmcnt(8)
 buffer_load_dwordx4 v218, s[20:23], s34 offen lds
 v_mul_f32 v90, v226, v90
 v_mul_f32 v91, v226, v91
 v_cvt_pk_bf16_f32 v168, v80, v81
 v_cvt_pk_bf16_f32 v169, v82, v83
 v_cvt_pk_bf16_f32 v170, v88, v89
 v_cvt_pk_bf16_f32 v171, v90, v91
 v_mul_f32 v84, v228, v84
 v_mul_f32 v85, v228, v85
 v_mul_f32 v86, v228, v86
 v_mul_f32 v87, v228, v87
 v_mul_f32 v92, v228, v92
 v_mul_f32 v93, v228, v93
 v_mul_f32 v94, v228, v94
 v_mul_f32 v95, v228, v95
 v_cvt_pk_bf16_f32 v172, v84, v85
 v_cvt_pk_bf16_f32 v173, v86, v87
 v_cvt_pk_bf16_f32 v174, v92, v93
 v_cvt_pk_bf16_f32 v175, v94, v95
 v_mfma_f32_16x16x32_bf16 v[0:3], a[16:19], v[168:171], v[0:3]
 ds_read_b64_tr_b16 a[4:5], v207 offset:24576
 ds_read_b64_tr_b16 a[6:7], v207 offset:25088
 v_mfma_f32_16x16x32_bf16 v[4:7], a[16:19], v[172:175], v[4:7]
 s_waitcnt lgkmcnt(8)
 v_mul_f32 v96, v226, v96
 v_mul_f32 v97, v226, v97
 v_mfma_f32_16x16x32_bf16 v[12:15], a[20:23], v[172:175], v[12:15]
 ds_read_b64_tr_b16 a[8:9], v208 offset:24576
 ds_read_b64_tr_b16 a[10:11], v208 offset:25088
 v_mfma_f32_16x16x32_bf16 v[8:11], a[20:23], v[168:171], v[8:11]
 s_waitcnt lgkmcnt(8)
 v_mul_f32 v98, v226, v98
 v_mul_f32 v99, v226, v99
 v_mfma_f32_16x16x32_bf16 v[16:19], a[24:27], v[168:171], v[16:19]
 ds_read_b64_tr_b16 a[12:13], v209 offset:24576
 ds_read_b64_tr_b16 a[14:15], v209 offset:25088
 v_mfma_f32_16x16x32_bf16 v[20:23], a[24:27], v[172:175], v[20:23]
 s_waitcnt lgkmcnt(8)
 v_mul_f32 v104, v226, v104
 v_mul_f32 v105, v226, v105
 v_mfma_f32_16x16x32_bf16 v[28:31], a[28:31], v[172:175], v[28:31]
 ds_read_b64_tr_b16 a[16:17], v206 offset:28672
 ds_read_b64_tr_b16 a[18:19], v206 offset:29184
 v_mfma_f32_16x16x32_bf16 v[24:27], a[28:31], v[168:171], v[24:27]
 s_waitcnt lgkmcnt(8)
 buffer_load_dwordx4 v219, s[20:23], s34 offen offset:1024 lds
 v_mul_f32 v106, v226, v106
 v_mul_f32 v107, v226, v107
 v_cvt_pk_bf16_f32 v176, v96, v97
 v_cvt_pk_bf16_f32 v177, v98, v99
 v_cvt_pk_bf16_f32 v178, v104, v105
 v_cvt_pk_bf16_f32 v179, v106, v107
 v_mul_f32 v100, v228, v100
 v_mul_f32 v101, v228, v101
 v_mul_f32 v102, v228, v102
 v_mul_f32 v103, v228, v103
 v_mul_f32 v108, v228, v108
 v_mul_f32 v109, v228, v109
 v_mul_f32 v110, v228, v110
 v_mul_f32 v111, v228, v111
 v_cvt_pk_bf16_f32 v180, v100, v101
 v_cvt_pk_bf16_f32 v181, v102, v103
 v_cvt_pk_bf16_f32 v182, v108, v109
 v_cvt_pk_bf16_f32 v183, v110, v111
 v_mfma_f32_16x16x32_bf16 v[0:3], a[0:3], v[176:179], v[0:3]
 ds_read_b64_tr_b16 a[20:21], v207 offset:28672
 ds_read_b64_tr_b16 a[22:23], v207 offset:29184
 v_mfma_f32_16x16x32_bf16 v[4:7], a[0:3], v[180:183], v[4:7]
 s_waitcnt lgkmcnt(8)
 v_mul_f32 v112, v226, v112
 v_mul_f32 v113, v226, v113
 v_mfma_f32_16x16x32_bf16 v[12:15], a[4:7], v[180:183], v[12:15]
 ds_read_b64_tr_b16 a[24:25], v208 offset:28672
 ds_read_b64_tr_b16 a[26:27], v208 offset:29184
 v_mfma_f32_16x16x32_bf16 v[8:11], a[4:7], v[176:179], v[8:11]
 s_waitcnt lgkmcnt(8)
 v_mul_f32 v114, v226, v114
 v_mul_f32 v115, v226, v115
 v_mfma_f32_16x16x32_bf16 v[16:19], a[8:11], v[176:179], v[16:19]
 ds_read_b64_tr_b16 a[28:29], v209 offset:28672
 ds_read_b64_tr_b16 a[30:31], v209 offset:29184
 v_mfma_f32_16x16x32_bf16 v[20:23], a[8:11], v[180:183], v[20:23]
 s_waitcnt lgkmcnt(8)
 v_mul_f32 v120, v226, v120
 v_mul_f32 v121, v226, v121
 v_mfma_f32_16x16x32_bf16 v[28:31], a[12:15], v[180:183], v[28:31]
 ds_read_b64_tr_b16 a[0:1], v198 offset:0
 ds_read_b64_tr_b16 a[2:3], v198 offset:512
 v_mfma_f32_16x16x32_bf16 v[24:27], a[12:15], v[176:179], v[24:27]
 s_waitcnt lgkmcnt(8)
 buffer_load_dwordx4 v220, s[20:23], s34 offen offset:2048 lds
 v_mul_f32 v122, v226, v122
 v_mul_f32 v123, v226, v123
 v_cvt_pk_bf16_f32 v184, v112, v113
 v_cvt_pk_bf16_f32 v185, v114, v115
 v_cvt_pk_bf16_f32 v186, v120, v121
 v_cvt_pk_bf16_f32 v187, v122, v123
 v_mul_f32 v116, v228, v116
 v_mul_f32 v117, v228, v117
 v_mul_f32 v118, v228, v118
 v_mul_f32 v119, v228, v119
 v_mul_f32 v124, v228, v124
 v_mul_f32 v125, v228, v125
 v_mul_f32 v126, v228, v126
 v_mul_f32 v127, v228, v127
 v_cvt_pk_bf16_f32 v188, v116, v117
 v_cvt_pk_bf16_f32 v189, v118, v119
 v_cvt_pk_bf16_f32 v190, v124, v125
 v_cvt_pk_bf16_f32 v191, v126, v127
 v_mfma_f32_16x16x32_bf16 v[0:3], a[16:19], v[184:187], v[0:3]
 ds_read_b64_tr_b16 a[4:5], v199 offset:0
 ds_read_b64_tr_b16 a[6:7], v199 offset:512
 v_mfma_f32_16x16x32_bf16 v[4:7], a[16:19], v[188:191], v[4:7]
 s_waitcnt lgkmcnt(8)
 v_mfma_f32_16x16x32_bf16 v[12:15], a[20:23], v[188:191], v[12:15]
 ds_read_b64_tr_b16 a[8:9], v200 offset:0
 ds_read_b64_tr_b16 a[10:11], v200 offset:512
 v_mfma_f32_16x16x32_bf16 v[8:11], a[20:23], v[184:187], v[8:11]
 s_waitcnt lgkmcnt(8)
 v_mfma_f32_16x16x32_bf16 v[16:19], a[24:27], v[184:187], v[16:19]
 ds_read_b64_tr_b16 a[12:13], v201 offset:0
 ds_read_b64_tr_b16 a[14:15], v201 offset:512
 v_mfma_f32_16x16x32_bf16 v[20:23], a[24:27], v[188:191], v[20:23]
 s_waitcnt lgkmcnt(8)
 v_mfma_f32_16x16x32_bf16 v[28:31], a[28:31], v[188:191], v[28:31]
 ds_read_b64_tr_b16 a[16:17], v198 offset:4096
 ds_read_b64_tr_b16 a[18:19], v198 offset:4608
 v_mfma_f32_16x16x32_bf16 v[24:27], a[28:31], v[184:187], v[24:27]
 s_waitcnt lgkmcnt(8)
 buffer_load_dwordx4 v221, s[20:23], s34 offen offset:3072 lds
 v_mfma_f32_16x16x32_bf16 v[32:35], a[0:3], v[128:131], 0
 s_mov_b32 s40, 0
 ds_read_b64_tr_b16 a[20:21], v199 offset:4096
 ds_read_b64_tr_b16 a[22:23], v199 offset:4608
 v_mfma_f32_16x16x32_bf16 v[36:39], a[0:3], v[132:135], 0
 s_waitcnt vmcnt(21) lgkmcnt(8)
 v_cvt_pk_bf16_f32 v64, v0, v1
 v_cvt_pk_bf16_f32 v65, v2, v3
 v_mfma_f32_16x16x32_bf16 v[44:47], a[4:7], v[132:135], 0
 s_barrier
 ds_read_b64_tr_b16 a[24:25], v200 offset:4096
 ds_read_b64_tr_b16 a[26:27], v200 offset:4608
 v_mfma_f32_16x16x32_bf16 v[40:43], a[4:7], v[128:131], 0
 s_waitcnt lgkmcnt(8)
 v_cvt_pk_bf16_f32 v66, v8, v9
 v_cvt_pk_bf16_f32 v67, v10, v11
 v_mfma_f32_16x16x32_bf16 v[48:51], a[8:11], v[128:131], 0
 s_add_u32 m0, s33, 131072
 ds_read_b64_tr_b16 a[28:29], v201 offset:4096
 ds_read_b64_tr_b16 a[30:31], v201 offset:4608
 v_mfma_f32_16x16x32_bf16 v[52:55], a[8:11], v[132:135], 0
 s_waitcnt lgkmcnt(8)
 buffer_store_dwordx4 v[64:67], v240, s[28:31], s40 offen
 v_cvt_pk_bf16_f32 v68, v16, v17
 v_mfma_f32_16x16x32_bf16 v[60:63], a[12:15], v[132:135], 0
 s_mov_b32 s34, 640
 ds_read_b64_tr_b16 a[0:1], v198 offset:8192
 ds_read_b64_tr_b16 a[2:3], v198 offset:8704
 v_mfma_f32_16x16x32_bf16 v[56:59], a[12:15], v[128:131], 0
 s_waitcnt lgkmcnt(8)
 buffer_load_dwordx4 v218, s[20:23], s34 offen lds
 v_cvt_pk_bf16_f32 v69, v18, v19
 v_mfma_f32_16x16x32_bf16 v[32:35], a[16:19], v[136:139], v[32:35]
 s_add_u32 s92, s54, 69632
 s_addc_u32 s93, s55, 0
 ds_read_b64_tr_b16 a[4:5], v199 offset:8192
 ds_read_b64_tr_b16 a[6:7], v199 offset:8704
 v_mfma_f32_16x16x32_bf16 v[36:39], a[16:19], v[140:143], v[36:39]
 s_waitcnt lgkmcnt(8)
 global_load_dword v252, v245, s[92:93]
 v_cvt_pk_bf16_f32 v70, v24, v25
 v_mfma_f32_16x16x32_bf16 v[44:47], a[20:23], v[140:143], v[44:47]
 ds_read_b64_tr_b16 a[8:9], v200 offset:8192
 ds_read_b64_tr_b16 a[10:11], v200 offset:8704
 v_mfma_f32_16x16x32_bf16 v[40:43], a[20:23], v[136:139], v[40:43]
 s_waitcnt lgkmcnt(8)
 v_cvt_pk_bf16_f32 v71, v26, v27
 v_cvt_pk_bf16_f32 v72, v4, v5
 v_mfma_f32_16x16x32_bf16 v[48:51], a[24:27], v[136:139], v[48:51]
 ds_read_b64_tr_b16 a[12:13], v201 offset:8192
 ds_read_b64_tr_b16 a[14:15], v201 offset:8704
 v_mfma_f32_16x16x32_bf16 v[52:55], a[24:27], v[140:143], v[52:55]
 s_waitcnt lgkmcnt(8)
 buffer_store_dwordx4 v[68:71], v240, s[28:31], s40 offen offset:1024
 v_cvt_pk_bf16_f32 v73, v6, v7
 v_mfma_f32_16x16x32_bf16 v[60:63], a[28:31], v[140:143], v[60:63]
 ds_read_b64_tr_b16 a[16:17], v198 offset:12288
 ds_read_b64_tr_b16 a[18:19], v198 offset:12800
 v_mfma_f32_16x16x32_bf16 v[56:59], a[28:31], v[136:139], v[56:59]
 s_waitcnt lgkmcnt(8)
 buffer_load_dwordx4 v219, s[20:23], s34 offen offset:1024 lds
 v_cvt_pk_bf16_f32 v74, v12, v13
 v_mfma_f32_16x16x32_bf16 v[32:35], a[0:3], v[144:147], v[32:35]
 ds_read_b64_tr_b16 a[20:21], v199 offset:12288
 ds_read_b64_tr_b16 a[22:23], v199 offset:12800
 v_mfma_f32_16x16x32_bf16 v[36:39], a[0:3], v[148:151], v[36:39]
 s_waitcnt lgkmcnt(8)
 v_cvt_pk_bf16_f32 v75, v14, v15
 v_cvt_pk_bf16_f32 v76, v20, v21
 v_mfma_f32_16x16x32_bf16 v[44:47], a[4:7], v[148:151], v[44:47]
 ds_read_b64_tr_b16 a[24:25], v200 offset:12288
 ds_read_b64_tr_b16 a[26:27], v200 offset:12800
 v_mfma_f32_16x16x32_bf16 v[40:43], a[4:7], v[144:147], v[40:43]
 s_waitcnt lgkmcnt(8)
 buffer_store_dwordx4 v[72:75], v240, s[28:31], s40 offen offset:2048
 v_cvt_pk_bf16_f32 v77, v22, v23
 v_mfma_f32_16x16x32_bf16 v[48:51], a[8:11], v[144:147], v[48:51]
 ds_read_b64_tr_b16 a[28:29], v201 offset:12288
 ds_read_b64_tr_b16 a[30:31], v201 offset:12800
 v_mfma_f32_16x16x32_bf16 v[52:55], a[8:11], v[148:151], v[52:55]
 s_waitcnt lgkmcnt(8)
 v_cvt_pk_bf16_f32 v78, v28, v29
 v_cvt_pk_bf16_f32 v79, v30, v31
 v_mfma_f32_16x16x32_bf16 v[60:63], a[12:15], v[148:151], v[60:63]
 ds_read_b64_tr_b16 a[0:1], v198 offset:16384
 ds_read_b64_tr_b16 a[2:3], v198 offset:16896
 v_mfma_f32_16x16x32_bf16 v[56:59], a[12:15], v[144:147], v[56:59]
 s_waitcnt lgkmcnt(8)
 buffer_load_dwordx4 v220, s[20:23], s34 offen offset:2048 lds
 buffer_store_dwordx4 v[76:79], v240, s[28:31], s40 offen offset:3072
 v_mfma_f32_16x16x32_bf16 v[32:35], a[16:19], v[152:155], v[32:35]
 ds_read_b64_tr_b16 a[4:5], v199 offset:16384
 ds_read_b64_tr_b16 a[6:7], v199 offset:16896
 v_mfma_f32_16x16x32_bf16 v[36:39], a[16:19], v[156:159], v[36:39]
 s_waitcnt lgkmcnt(8)
 v_mfma_f32_16x16x32_bf16 v[44:47], a[20:23], v[156:159], v[44:47]
 ds_read_b64_tr_b16 a[8:9], v200 offset:16384
 ds_read_b64_tr_b16 a[10:11], v200 offset:16896
 v_mfma_f32_16x16x32_bf16 v[40:43], a[20:23], v[152:155], v[40:43]
 s_waitcnt lgkmcnt(8)
 v_mfma_f32_16x16x32_bf16 v[48:51], a[24:27], v[152:155], v[48:51]
 ds_read_b64_tr_b16 a[12:13], v201 offset:16384
 ds_read_b64_tr_b16 a[14:15], v201 offset:16896
 v_mfma_f32_16x16x32_bf16 v[52:55], a[24:27], v[156:159], v[52:55]
 s_waitcnt lgkmcnt(8)
 v_mfma_f32_16x16x32_bf16 v[60:63], a[28:31], v[156:159], v[60:63]
 ds_read_b64_tr_b16 a[16:17], v198 offset:20480
 ds_read_b64_tr_b16 a[18:19], v198 offset:20992
 v_mfma_f32_16x16x32_bf16 v[56:59], a[28:31], v[152:155], v[56:59]
 s_waitcnt lgkmcnt(8)
 buffer_load_dwordx4 v221, s[20:23], s34 offen offset:3072 lds
 v_mfma_f32_16x16x32_bf16 v[32:35], a[0:3], v[160:163], v[32:35]
 s_add_u32 m0, s33, 147456
 ds_read_b64_tr_b16 a[20:21], v199 offset:20480
 ds_read_b64_tr_b16 a[22:23], v199 offset:20992
 v_mfma_f32_16x16x32_bf16 v[36:39], a[0:3], v[164:167], v[36:39]
 s_waitcnt lgkmcnt(8)
 v_mfma_f32_16x16x32_bf16 v[44:47], a[4:7], v[164:167], v[44:47]
 s_mov_b32 s34, 115328
 ds_read_b64_tr_b16 a[24:25], v200 offset:20480
 ds_read_b64_tr_b16 a[26:27], v200 offset:20992
 v_mfma_f32_16x16x32_bf16 v[40:43], a[4:7], v[160:163], v[40:43]
 s_waitcnt lgkmcnt(8)
 v_mfma_f32_16x16x32_bf16 v[48:51], a[8:11], v[160:163], v[48:51]
 ds_read_b64_tr_b16 a[28:29], v201 offset:20480
 ds_read_b64_tr_b16 a[30:31], v201 offset:20992
 v_mfma_f32_16x16x32_bf16 v[52:55], a[8:11], v[164:167], v[52:55]
 s_waitcnt lgkmcnt(8)
 v_mfma_f32_16x16x32_bf16 v[60:63], a[12:15], v[164:167], v[60:63]
 ds_read_b64_tr_b16 a[0:1], v198 offset:24576
 ds_read_b64_tr_b16 a[2:3], v198 offset:25088
 v_mfma_f32_16x16x32_bf16 v[56:59], a[12:15], v[160:163], v[56:59]
 s_waitcnt lgkmcnt(8)
 buffer_load_dwordx4 v218, s[20:23], s34 offen lds
 v_mfma_f32_16x16x32_bf16 v[32:35], a[16:19], v[168:171], v[32:35]
 ds_read_b64_tr_b16 a[4:5], v199 offset:24576
 ds_read_b64_tr_b16 a[6:7], v199 offset:25088
 v_mfma_f32_16x16x32_bf16 v[36:39], a[16:19], v[172:175], v[36:39]
 s_waitcnt lgkmcnt(8)
 v_mfma_f32_16x16x32_bf16 v[44:47], a[20:23], v[172:175], v[44:47]
 ds_read_b64_tr_b16 a[8:9], v200 offset:24576
 ds_read_b64_tr_b16 a[10:11], v200 offset:25088
 v_mfma_f32_16x16x32_bf16 v[40:43], a[20:23], v[168:171], v[40:43]
 s_waitcnt lgkmcnt(8)
 v_mfma_f32_16x16x32_bf16 v[48:51], a[24:27], v[168:171], v[48:51]
 ds_read_b64_tr_b16 a[12:13], v201 offset:24576
 ds_read_b64_tr_b16 a[14:15], v201 offset:25088
 v_mfma_f32_16x16x32_bf16 v[52:55], a[24:27], v[172:175], v[52:55]
 s_waitcnt lgkmcnt(8)
 v_mfma_f32_16x16x32_bf16 v[60:63], a[28:31], v[172:175], v[60:63]
 ds_read_b64_tr_b16 a[16:17], v198 offset:28672
 ds_read_b64_tr_b16 a[18:19], v198 offset:29184
 v_mfma_f32_16x16x32_bf16 v[56:59], a[28:31], v[168:171], v[56:59]
 s_waitcnt lgkmcnt(8)
 buffer_load_dwordx4 v219, s[20:23], s34 offen offset:1024 lds
 v_mfma_f32_16x16x32_bf16 v[32:35], a[0:3], v[176:179], v[32:35]
 ds_read_b64_tr_b16 a[20:21], v199 offset:28672
 ds_read_b64_tr_b16 a[22:23], v199 offset:29184
 v_mfma_f32_16x16x32_bf16 v[36:39], a[0:3], v[180:183], v[36:39]
 s_waitcnt lgkmcnt(8)
 v_mfma_f32_16x16x32_bf16 v[44:47], a[4:7], v[180:183], v[44:47]
 ds_read_b64_tr_b16 a[24:25], v200 offset:28672
 ds_read_b64_tr_b16 a[26:27], v200 offset:29184
 v_mfma_f32_16x16x32_bf16 v[40:43], a[4:7], v[176:179], v[40:43]
 s_waitcnt lgkmcnt(8)
 v_mfma_f32_16x16x32_bf16 v[48:51], a[8:11], v[176:179], v[48:51]
 ds_read_b64_tr_b16 a[28:29], v201 offset:28672
 ds_read_b64_tr_b16 a[30:31], v201 offset:29184
 v_mfma_f32_16x16x32_bf16 v[52:55], a[8:11], v[180:183], v[52:55]
 s_waitcnt lgkmcnt(8)
 v_mfma_f32_16x16x32_bf16 v[60:63], a[12:15], v[180:183], v[60:63]
 s_waitcnt vmcnt(3)
 ds_read_b64_tr_b16 a[0:1], v198 offset:32768
 ds_read_b64_tr_b16 a[2:3], v198 offset:33280
 v_mfma_f32_16x16x32_bf16 v[56:59], a[12:15], v[176:179], v[56:59]
 s_waitcnt lgkmcnt(8)
 s_cmp_lg_u64 s[94:95], 0
 s_cbranch_scc1 L_fl0
 buffer_store_dword v239, v242, s[28:31], 0 offen
L_flr0:
 buffer_load_dwordx4 v220, s[20:23], s34 offen offset:2048 lds
 v_mfma_f32_16x16x32_bf16 v[32:35], a[16:19], v[184:187], v[32:35]
 ds_read_b64_tr_b16 a[4:5], v199 offset:32768
 ds_read_b64_tr_b16 a[6:7], v199 offset:33280
 v_mfma_f32_16x16x32_bf16 v[36:39], a[16:19], v[188:191], v[36:39]
 s_waitcnt lgkmcnt(8)
 v_mfma_f32_16x16x32_bf16 v[44:47], a[20:23], v[188:191], v[44:47]
 ds_read_b64_tr_b16 a[8:9], v200 offset:32768
 ds_read_b64_tr_b16 a[10:11], v200 offset:33280
 v_mfma_f32_16x16x32_bf16 v[40:43], a[20:23], v[184:187], v[40:43]
 s_waitcnt lgkmcnt(8)
 v_mfma_f32_16x16x32_bf16 v[48:51], a[24:27], v[184:187], v[48:51]
 ds_read_b64_tr_b16 a[12:13], v201 offset:32768
 ds_read_b64_tr_b16 a[14:15], v201 offset:33280
 v_mfma_f32_16x16x32_bf16 v[52:55], a[24:27], v[188:191], v[52:55]
 s_waitcnt lgkmcnt(8)
 v_mfma_f32_16x16x32_bf16 v[60:63], a[28:31], v[188:191], v[60:63]
 ds_read_b64_tr_b16 a[16:17], v198 offset:36864
 ds_read_b64_tr_b16 a[18:19], v198 offset:37376
 v_mfma_f32_16x16x32_bf16 v[56:59], a[28:31], v[184:187], v[56:59]
 s_waitcnt lgkmcnt(8)
 buffer_load_dwordx4 v221, s[20:23], s34 offen offset:3072 lds
 v_mfma_f32_16x16x32_bf16 v[0:3], a[0:3], v[128:131], 0
 s_mov_b32 s40, 16384
 ds_read_b64_tr_b16 a[20:21], v199 offset:36864
 ds_read_b64_tr_b16 a[22:23], v199 offset:37376
 v_mfma_f32_16x16x32_bf16 v[4:7], a[0:3], v[132:135], 0
 s_waitcnt lgkmcnt(8)
 v_cvt_pk_bf16_f32 v80, v32, v33
 v_cvt_pk_bf16_f32 v81, v34, v35
 v_mfma_f32_16x16x32_bf16 v[12:15], a[4:7], v[132:135], 0
 s_barrier
 ds_read_b64_tr_b16 a[24:25], v200 offset:36864
 ds_read_b64_tr_b16 a[26:27], v200 offset:37376
 v_mfma_f32_16x16x32_bf16 v[8:11], a[4:7], v[128:131], 0
 s_waitcnt lgkmcnt(8)
 buffer_load_dword v238, v241, s[28:31], 0 offen nt
 v_cvt_pk_bf16_f32 v82, v40, v41
 v_mfma_f32_16x16x32_bf16 v[16:19], a[8:11], v[128:131], 0
 s_add_u32 m0, s33, 0
 ds_read_b64_tr_b16 a[28:29], v201 offset:36864
 ds_read_b64_tr_b16 a[30:31], v201 offset:37376
 v_mfma_f32_16x16x32_bf16 v[20:23], a[8:11], v[132:135], 0
 s_waitcnt lgkmcnt(8)
 v_cvt_pk_bf16_f32 v83, v42, v43
 v_cvt_pk_bf16_f32 v84, v48, v49
 v_mfma_f32_16x16x32_bf16 v[28:31], a[12:15], v[132:135], 0
 s_mov_b32 s34, 768
 ds_read_b64_tr_b16 a[0:1], v198 offset:40960
 ds_read_b64_tr_b16 a[2:3], v198 offset:41472
 v_mfma_f32_16x16x32_bf16 v[24:27], a[12:15], v[128:131], 0
 s_waitcnt lgkmcnt(8)
 buffer_load_dwordx4 v218, s[20:23], s34 offen lds
 buffer_store_dwordx4 v[80:83], v240, s[28:31], s40 offen
 v_mfma_f32_16x16x32_bf16 v[0:3], a[16:19], v[136:139], v[0:3]
 ds_read_b64_tr_b16 a[4:5], v199 offset:40960
 ds_read_b64_tr_b16 a[6:7], v199 offset:41472
 v_mfma_f32_16x16x32_bf16 v[4:7], a[16:19], v[140:143], v[4:7]
 s_waitcnt lgkmcnt(8)
 v_cvt_pk_bf16_f32 v85, v50, v51
 v_cvt_pk_bf16_f32 v86, v56, v57
 v_mfma_f32_16x16x32_bf16 v[12:15], a[20:23], v[140:143], v[12:15]
 ds_read_b64_tr_b16 a[8:9], v200 offset:40960
 ds_read_b64_tr_b16 a[10:11], v200 offset:41472
 v_mfma_f32_16x16x32_bf16 v[8:11], a[20:23], v[136:139], v[8:11]
 s_waitcnt lgkmcnt(8)
 v_cvt_pk_bf16_f32 v87, v58, v59
 v_cvt_pk_bf16_f32 v88, v36, v37
 v_mfma_f32_16x16x32_bf16 v[16:19], a[24:27], v[136:139], v[16:19]
 ds_read_b64_tr_b16 a[12:13], v201 offset:40960
 ds_read_b64_tr_b16 a[14:15], v201 offset:41472
 v_mfma_f32_16x16x32_bf16 v[20:23], a[24:27], v[140:143], v[20:23]
 s_waitcnt lgkmcnt(8)
 buffer_store_dwordx4 v[84:87], v240, s[28:31], s40 offen offset:1024
 v_cvt_pk_bf16_f32 v89, v38, v39
 v_mfma_f32_16x16x32_bf16 v[28:31], a[28:31], v[140:143], v[28:31]
 ds_read_b64_tr_b16 a[16:17], v198 offset:45056
 ds_read_b64_tr_b16 a[18:19], v198 offset:45568
 v_mfma_f32_16x16x32_bf16 v[24:27], a[28:31], v[136:139], v[24:27]
 s_waitcnt lgkmcnt(8)
 buffer_load_dwordx4 v219, s[20:23], s34 offen offset:1024 lds
 v_cvt_pk_bf16_f32 v90, v44, v45
 v_mfma_f32_16x16x32_bf16 v[0:3], a[0:3], v[144:147], v[0:3]
 ds_read_b64_tr_b16 a[20:21], v199 offset:45056
 ds_read_b64_tr_b16 a[22:23], v199 offset:45568
 v_mfma_f32_16x16x32_bf16 v[4:7], a[0:3], v[148:151], v[4:7]
 s_waitcnt lgkmcnt(8)
 v_cvt_pk_bf16_f32 v91, v46, v47
 v_cvt_pk_bf16_f32 v92, v52, v53
 v_mfma_f32_16x16x32_bf16 v[12:15], a[4:7], v[148:151], v[12:15]
 ds_read_b64_tr_b16 a[24:25], v200 offset:45056
 ds_read_b64_tr_b16 a[26:27], v200 offset:45568
 v_mfma_f32_16x16x32_bf16 v[8:11], a[4:7], v[144:147], v[8:11]
 s_waitcnt lgkmcnt(8)
 buffer_store_dwordx4 v[88:91], v240, s[28:31], s40 offen offset:2048
 v_cvt_pk_bf16_f32 v93, v54, v55
 v_mfma_f32_16x16x32_bf16 v[16:19], a[8:11], v[144:147], v[16:19]
 ds_read_b64_tr_b16 a[28:29], v201 offset:45056
 ds_read_b64_tr_b16 a[30:31], v201 offset:45568
 v_mfma_f32_16x16x32_bf16 v[20:23], a[8:11], v[148:151], v[20:23]
 s_waitcnt lgkmcnt(8)
 v_cvt_pk_bf16_f32 v94, v60, v61
 v_cvt_pk_bf16_f32 v95, v62, v63
 v_mfma_f32_16x16x32_bf16 v[28:31], a[12:15], v[148:151], v[28:31]
 ds_read_b64_tr_b16 a[0:1], v198 offset:49152
 ds_read_b64_tr_b16 a[2:3], v198 offset:49664
 v_mfma_f32_16x16x32_bf16 v[24:27], a[12:15], v[144:147], v[24:27]
 s_waitcnt lgkmcnt(8)
 buffer_load_dwordx4 v220, s[20:23], s34 offen offset:2048 lds
 buffer_store_dwordx4 v[92:95], v240, s[28:31], s40 offen offset:3072
 v_mfma_f32_16x16x32_bf16 v[0:3], a[16:19], v[152:155], v[0:3]
 s_waitcnt vmcnt(7)
 ds_read_b64_tr_b16 a[4:5], v199 offset:49152
 ds_read_b64_tr_b16 a[6:7], v199 offset:49664
 v_mfma_f32_16x16x32_bf16 v[4:7], a[16:19], v[156:159], v[4:7]
 s_waitcnt lgkmcnt(8)
 v_cmp_eq_u32 vcc, 0, v238
 s_or_b64 vcc, vcc, s[94:95]
 s_cbranch_vccnz L_po0
L_por0:
 v_mfma_f32_16x16x32_bf16 v[12:15], a[20:23], v[156:159], v[12:15]
 s_mov_b32 s41, 0
 ds_read_b64_tr_b16 a[8:9], v200 offset:49152
 ds_read_b64_tr_b16 a[10:11], v200 offset:49664
 v_mfma_f32_16x16x32_bf16 v[8:11], a[20:23], v[152:155], v[8:11]
 s_waitcnt lgkmcnt(8)
 buffer_load_dwordx4 a[128:131], v214, s[28:31], s41 offen nt
 buffer_load_dwordx4 a[132:135], v215, s[28:31], s41 offen nt
 v_mfma_f32_16x16x32_bf16 v[16:19], a[24:27], v[152:155], v[16:19]
 ds_read_b64_tr_b16 a[12:13], v201 offset:49152
 ds_read_b64_tr_b16 a[14:15], v201 offset:49664
 v_mfma_f32_16x16x32_bf16 v[20:23], a[24:27], v[156:159], v[20:23]
 s_waitcnt lgkmcnt(8)
 buffer_load_dwordx4 a[136:139], v216, s[28:31], s41 offen nt
 buffer_load_dwordx4 a[140:143], v217, s[28:31], s41 offen nt
 v_mfma_f32_16x16x32_bf16 v[28:31], a[28:31], v[156:159], v[28:31]
 ds_read_b64_tr_b16 a[16:17], v198 offset:53248
 ds_read_b64_tr_b16 a[18:19], v198 offset:53760
 v_mfma_f32_16x16x32_bf16 v[24:27], a[28:31], v[152:155], v[24:27]
 s_waitcnt lgkmcnt(8)
 buffer_load_dwordx4 v221, s[20:23], s34 offen offset:3072 lds
 v_mfma_f32_16x16x32_bf16 v[0:3], a[0:3], v[160:163], v[0:3]
 s_add_u32 m0, s33, 16384
 ds_read_b64_tr_b16 a[20:21], v199 offset:53248
 ds_read_b64_tr_b16 a[22:23], v199 offset:53760
 v_mfma_f32_16x16x32_bf16 v[4:7], a[0:3], v[164:167], v[4:7]
 s_waitcnt lgkmcnt(8)
 v_mfma_f32_16x16x32_bf16 v[12:15], a[4:7], v[164:167], v[12:15]
 s_mov_b32 s34, 115456
 ds_read_b64_tr_b16 a[24:25], v200 offset:53248
 ds_read_b64_tr_b16 a[26:27], v200 offset:53760
 v_mfma_f32_16x16x32_bf16 v[8:11], a[4:7], v[160:163], v[8:11]
 s_waitcnt lgkmcnt(8)
 v_mfma_f32_16x16x32_bf16 v[16:19], a[8:11], v[160:163], v[16:19]
 ds_read_b64_tr_b16 a[28:29], v201 offset:53248
 ds_read_b64_tr_b16 a[30:31], v201 offset:53760
 v_mfma_f32_16x16x32_bf16 v[20:23], a[8:11], v[164:167], v[20:23]
 s_waitcnt lgkmcnt(8)
 v_mfma_f32_16x16x32_bf16 v[28:31], a[12:15], v[164:167], v[28:31]
 ds_read_b64_tr_b16 a[0:1], v198 offset:57344
 ds_read_b64_tr_b16 a[2:3], v198 offset:57856
 v_mfma_f32_16x16x32_bf16 v[24:27], a[12:15], v[160:163], v[24:27]
 s_waitcnt lgkmcnt(8)
 buffer_load_dwordx4 v218, s[20:23], s34 offen lds
 v_mfma_f32_16x16x32_bf16 v[0:3], a[16:19], v[168:171], v[0:3]
 ds_read_b64_tr_b16 a[4:5], v199 offset:57344
 ds_read_b64_tr_b16 a[6:7], v199 offset:57856
 v_mfma_f32_16x16x32_bf16 v[4:7], a[16:19], v[172:175], v[4:7]
 s_waitcnt lgkmcnt(8)
 v_mfma_f32_16x16x32_bf16 v[12:15], a[20:23], v[172:175], v[12:15]
 ds_read_b64_tr_b16 a[8:9], v200 offset:57344
 ds_read_b64_tr_b16 a[10:11], v200 offset:57856
 v_mfma_f32_16x16x32_bf16 v[8:11], a[20:23], v[168:171], v[8:11]
 s_waitcnt lgkmcnt(8)
 v_mfma_f32_16x16x32_bf16 v[16:19], a[24:27], v[168:171], v[16:19]
 ds_read_b64_tr_b16 a[12:13], v201 offset:57344
 ds_read_b64_tr_b16 a[14:15], v201 offset:57856
 v_mfma_f32_16x16x32_bf16 v[20:23], a[24:27], v[172:175], v[20:23]
 s_waitcnt lgkmcnt(8)
 v_mfma_f32_16x16x32_bf16 v[28:31], a[28:31], v[172:175], v[28:31]
 ds_read_b64_tr_b16 a[16:17], v198 offset:61440
 ds_read_b64_tr_b16 a[18:19], v198 offset:61952
 v_mfma_f32_16x16x32_bf16 v[24:27], a[28:31], v[168:171], v[24:27]
 s_waitcnt lgkmcnt(8)
 buffer_load_dwordx4 v219, s[20:23], s34 offen offset:1024 lds
 v_mfma_f32_16x16x32_bf16 v[0:3], a[0:3], v[176:179], v[0:3]
 ds_read_b64_tr_b16 a[20:21], v199 offset:61440
 ds_read_b64_tr_b16 a[22:23], v199 offset:61952
 v_mfma_f32_16x16x32_bf16 v[4:7], a[0:3], v[180:183], v[4:7]
 s_waitcnt lgkmcnt(8)
 v_mfma_f32_16x16x32_bf16 v[12:15], a[4:7], v[180:183], v[12:15]
 ds_read_b64_tr_b16 a[24:25], v200 offset:61440
 ds_read_b64_tr_b16 a[26:27], v200 offset:61952
 v_mfma_f32_16x16x32_bf16 v[8:11], a[4:7], v[176:179], v[8:11]
 s_waitcnt lgkmcnt(8)
 v_mfma_f32_16x16x32_bf16 v[16:19], a[8:11], v[176:179], v[16:19]
 ds_read_b64_tr_b16 a[28:29], v201 offset:61440
 ds_read_b64_tr_b16 a[30:31], v201 offset:61952
 v_mfma_f32_16x16x32_bf16 v[20:23], a[8:11], v[180:183], v[20:23]
 s_waitcnt lgkmcnt(8)
 v_mfma_f32_16x16x32_bf16 v[28:31], a[12:15], v[180:183], v[28:31]
 ds_read_b64_tr_b16 a[0:1], v202 offset:0
 ds_read_b64_tr_b16 a[2:3], v202 offset:512
 v_mfma_f32_16x16x32_bf16 v[24:27], a[12:15], v[176:179], v[24:27]
 s_waitcnt lgkmcnt(8)
 buffer_load_dwordx4 v220, s[20:23], s34 offen offset:2048 lds
 v_mfma_f32_16x16x32_bf16 v[0:3], a[16:19], v[184:187], v[0:3]
 ds_read_b64_tr_b16 a[4:5], v203 offset:0
 ds_read_b64_tr_b16 a[6:7], v203 offset:512
 v_mfma_f32_16x16x32_bf16 v[4:7], a[16:19], v[188:191], v[4:7]
 s_waitcnt lgkmcnt(8)
 v_mfma_f32_16x16x32_bf16 v[12:15], a[20:23], v[188:191], v[12:15]
 ds_read_b64_tr_b16 a[8:9], v204 offset:0
 ds_read_b64_tr_b16 a[10:11], v204 offset:512
 v_mfma_f32_16x16x32_bf16 v[8:11], a[20:23], v[184:187], v[8:11]
 s_waitcnt lgkmcnt(8)
 v_mfma_f32_16x16x32_bf16 v[16:19], a[24:27], v[184:187], v[16:19]
 ds_read_b64_tr_b16 a[12:13], v205 offset:0
 ds_read_b64_tr_b16 a[14:15], v205 offset:512
 v_mfma_f32_16x16x32_bf16 v[20:23], a[24:27], v[188:191], v[20:23]
 s_waitcnt lgkmcnt(8)
 v_mfma_f32_16x16x32_bf16 v[28:31], a[28:31], v[188:191], v[28:31]
 ds_read_b64_tr_b16 a[16:17], v202 offset:4096
 ds_read_b64_tr_b16 a[18:19], v202 offset:4608
 v_mfma_f32_16x16x32_bf16 v[24:27], a[28:31], v[184:187], v[24:27]
 s_waitcnt lgkmcnt(8)
 buffer_load_dwordx4 v221, s[20:23], s34 offen offset:3072 lds
 v_mfma_f32_16x16x32_bf16 v[32:35], a[0:3], v[128:131], 0
 s_mov_b32 s40, 32768
 ds_read_b64_tr_b16 a[20:21], v203 offset:4096
 ds_read_b64_tr_b16 a[22:23], v203 offset:4608
 v_mfma_f32_16x16x32_bf16 v[36:39], a[0:3], v[132:135], 0
 s_waitcnt lgkmcnt(8)
 v_cvt_pk_bf16_f32 v64, v0, v1
 v_cvt_pk_bf16_f32 v65, v2, v3
 v_mfma_f32_16x16x32_bf16 v[44:47], a[4:7], v[132:135], 0
 s_barrier
 ds_read_b64_tr_b16 a[24:25], v204 offset:4096
 ds_read_b64_tr_b16 a[26:27], v204 offset:4608
 v_mfma_f32_16x16x32_bf16 v[40:43], a[4:7], v[128:131], 0
 s_waitcnt lgkmcnt(8)
 v_cvt_pk_bf16_f32 v66, v8, v9
 v_cvt_pk_bf16_f32 v67, v10, v11
 v_mfma_f32_16x16x32_bf16 v[48:51], a[8:11], v[128:131], 0
 ds_read_b64_tr_b16 a[28:29], v205 offset:4096
 ds_read_b64_tr_b16 a[30:31], v205 offset:4608
 v_mfma_f32_16x16x32_bf16 v[52:55], a[8:11], v[132:135], 0
 s_waitcnt lgkmcnt(8)
 buffer_store_dwordx4 v[64:67], v240, s[28:31], s40 offen
 v_cvt_pk_bf16_f32 v68, v16, v17
 v_mfma_f32_16x16x32_bf16 v[60:63], a[12:15], v[132:135], 0
 s_waitcnt vmcnt(6)
 ds_read_b64_tr_b16 a[0:1], v202 offset:8192
 ds_read_b64_tr_b16 a[2:3], v202 offset:8704
 v_mfma_f32_16x16x32_bf16 v[96:99], a[240:243], a[128:131], 0
 v_mfma_f32_16x16x32_bf16 v[56:59], a[12:15], v[128:131], 0
 s_waitcnt lgkmcnt(8)
 v_cvt_pk_bf16_f32 v69, v18, v19
 v_cvt_pk_bf16_f32 v70, v24, v25
 v_mfma_f32_16x16x32_bf16 v[96:99], a[240:243], a[132:135], v[96:99]
 v_mfma_f32_16x16x32_bf16 v[32:35], a[16:19], v[136:139], v[32:35]
 ds_read_b64_tr_b16 a[4:5], v203 offset:8192
 ds_read_b64_tr_b16 a[6:7], v203 offset:8704
 v_mfma_f32_16x16x32_bf16 v[96:99], a[240:243], a[136:139], v[96:99]
 v_mfma_f32_16x16x32_bf16 v[36:39], a[16:19], v[140:143], v[36:39]
 s_waitcnt lgkmcnt(8)
 s_cmp_lg_u64 s[94:95], 0
 s_cbranch_scc1 L_fl1
 buffer_store_dword v239, v242, s[28:31], 0 offen offset:256
L_flr1:
 v_cvt_pk_bf16_f32 v71, v26, v27
 v_mfma_f32_16x16x32_bf16 v[96:99], a[240:243], a[140:143], v[96:99]
 v_mfma_f32_16x16x32_bf16 v[44:47], a[20:23], v[140:143], v[44:47]
 ds_read_b64_tr_b16 a[8:9], v204 offset:8192
 ds_read_b64_tr_b16 a[10:11], v204 offset:8704
 v_mfma_f32_16x16x32_bf16 v[40:43], a[20:23], v[136:139], v[40:43]
 s_waitcnt lgkmcnt(8)
 buffer_store_dwordx4 v[68:71], v240, s[28:31], s40 offen offset:1024
 v_cvt_pk_bf16_f32 v72, v4, v5
 v_mfma_f32_16x16x32_bf16 v[48:51], a[24:27], v[136:139], v[48:51]
 ds_read_b64_tr_b16 a[12:13], v205 offset:8192
 ds_read_b64_tr_b16 a[14:15], v205 offset:8704
 v_mfma_f32_16x16x32_bf16 v[52:55], a[24:27], v[140:143], v[52:55]
 s_waitcnt lgkmcnt(8)
 v_cvt_pk_bf16_f32 v100, v96, v97
 v_cvt_pk_bf16_f32 v101, v98, v99
 v_mfma_f32_16x16x32_bf16 v[60:63], a[28:31], v[140:143], v[60:63]
 ds_read_b64_tr_b16 a[16:17], v202 offset:12288
 ds_read_b64_tr_b16 a[18:19], v202 offset:12800
 v_mfma_f32_16x16x32_bf16 v[56:59], a[28:31], v[136:139], v[56:59]
 s_waitcnt lgkmcnt(8)
 v_cvt_pk_bf16_f32 v73, v6, v7
 v_cvt_pk_bf16_f32 v74, v12, v13
 v_mfma_f32_16x16x32_bf16 v[32:35], a[0:3], v[144:147], v[32:35]
 ds_read_b64_tr_b16 a[20:21], v203 offset:12288
 ds_read_b64_tr_b16 a[22:23], v203 offset:12800
 v_mfma_f32_16x16x32_bf16 v[36:39], a[0:3], v[148:151], v[36:39]
 s_waitcnt lgkmcnt(8)
 v_cvt_pk_bf16_f32 v75, v14, v15
 v_cvt_pk_bf16_f32 v76, v20, v21
 v_mfma_f32_16x16x32_bf16 v[44:47], a[4:7], v[148:151], v[44:47]
 ds_read_b64_tr_b16 a[24:25], v204 offset:12288
 ds_read_b64_tr_b16 a[26:27], v204 offset:12800
 v_mfma_f32_16x16x32_bf16 v[40:43], a[4:7], v[144:147], v[40:43]
 s_waitcnt lgkmcnt(8)
 buffer_store_dwordx4 v[72:75], v240, s[28:31], s40 offen offset:2048
 v_cvt_pk_bf16_f32 v77, v22, v23
 v_mfma_f32_16x16x32_bf16 v[48:51], a[8:11], v[144:147], v[48:51]
 ds_read_b64_tr_b16 a[28:29], v205 offset:12288
 ds_read_b64_tr_b16 a[30:31], v205 offset:12800
 v_mfma_f32_16x16x32_bf16 v[52:55], a[8:11], v[148:151], v[52:55]
 s_waitcnt lgkmcnt(8)
 buffer_load_dword v238, v241, s[28:31], 0 offen offset:256 nt
 buffer_store_dwordx2 v[100:101], v243, s[44:47], 0 offen
 v_mfma_f32_16x16x32_bf16 v[60:63], a[12:15], v[148:151], v[60:63]
 ds_read_b64_tr_b16 a[0:1], v202 offset:16384
 ds_read_b64_tr_b16 a[2:3], v202 offset:16896
 v_mfma_f32_16x16x32_bf16 v[56:59], a[12:15], v[144:147], v[56:59]
 s_waitcnt lgkmcnt(8)
 v_cvt_pk_bf16_f32 v78, v28, v29
 v_cvt_pk_bf16_f32 v79, v30, v31
 v_mfma_f32_16x16x32_bf16 v[32:35], a[16:19], v[152:155], v[32:35]
 ds_read_b64_tr_b16 a[4:5], v203 offset:16384
 ds_read_b64_tr_b16 a[6:7], v203 offset:16896
 v_mfma_f32_16x16x32_bf16 v[36:39], a[16:19], v[156:159], v[36:39]
 s_waitcnt lgkmcnt(8)
 buffer_store_dwordx4 v[76:79], v240, s[28:31], s40 offen offset:3072
 v_mfma_f32_16x16x32_bf16 v[44:47], a[20:23], v[156:159], v[44:47]
 ds_read_b64_tr_b16 a[8:9], v204 offset:16384
 ds_read_b64_tr_b16 a[10:11], v204 offset:16896
 v_mfma_f32_16x16x32_bf16 v[40:43], a[20:23], v[152:155], v[40:43]
 s_waitcnt lgkmcnt(8)
 v_mfma_f32_16x16x32_bf16 v[48:51], a[24:27], v[152:155], v[48:51]
 ds_read_b64_tr_b16 a[12:13], v205 offset:16384
 ds_read_b64_tr_b16 a[14:15], v205 offset:16896
 v_mfma_f32_16x16x32_bf16 v[52:55], a[24:27], v[156:159], v[52:55]
 s_waitcnt lgkmcnt(8)
 v_mfma_f32_16x16x32_bf16 v[60:63], a[28:31], v[156:159], v[60:63]
 ds_read_b64_tr_b16 a[16:17], v202 offset:20480
 ds_read_b64_tr_b16 a[18:19], v202 offset:20992
 v_mfma_f32_16x16x32_bf16 v[56:59], a[28:31], v[152:155], v[56:59]
 s_waitcnt lgkmcnt(8)
 v_mfma_f32_16x16x32_bf16 v[32:35], a[0:3], v[160:163], v[32:35]
 s_add_u32 s92, s54, 73728
 s_addc_u32 s93, s55, 0
 ds_read_b64_tr_b16 a[20:21], v203 offset:20480
 ds_read_b64_tr_b16 a[22:23], v203 offset:20992
 v_mfma_f32_16x16x32_bf16 v[36:39], a[0:3], v[164:167], v[36:39]
 s_waitcnt lgkmcnt(8)
 global_load_dword v252, v245, s[92:93]
 v_mfma_f32_16x16x32_bf16 v[44:47], a[4:7], v[164:167], v[44:47]
 ds_read_b64_tr_b16 a[24:25], v204 offset:20480
 ds_read_b64_tr_b16 a[26:27], v204 offset:20992
 v_mfma_f32_16x16x32_bf16 v[40:43], a[4:7], v[160:163], v[40:43]
 s_waitcnt lgkmcnt(8)
 v_mfma_f32_16x16x32_bf16 v[48:51], a[8:11], v[160:163], v[48:51]
 ds_read_b64_tr_b16 a[28:29], v205 offset:20480
 ds_read_b64_tr_b16 a[30:31], v205 offset:20992
 v_mfma_f32_16x16x32_bf16 v[52:55], a[8:11], v[164:167], v[52:55]
 s_waitcnt lgkmcnt(8)
 v_mfma_f32_16x16x32_bf16 v[60:63], a[12:15], v[164:167], v[60:63]
 ds_read_b64_tr_b16 a[0:1], v202 offset:24576
 ds_read_b64_tr_b16 a[2:3], v202 offset:25088
 v_mfma_f32_16x16x32_bf16 v[56:59], a[12:15], v[160:163], v[56:59]
 s_waitcnt lgkmcnt(8)
 v_mfma_f32_16x16x32_bf16 v[32:35], a[16:19], v[168:171], v[32:35]
 ds_read_b64_tr_b16 a[4:5], v203 offset:24576
 ds_read_b64_tr_b16 a[6:7], v203 offset:25088
 v_mfma_f32_16x16x32_bf16 v[36:39], a[16:19], v[172:175], v[36:39]
 s_waitcnt lgkmcnt(8)
 v_mfma_f32_16x16x32_bf16 v[44:47], a[20:23], v[172:175], v[44:47]
 s_waitcnt vmcnt(3)
 ds_read_b64_tr_b16 a[8:9], v204 offset:24576
 ds_read_b64_tr_b16 a[10:11], v204 offset:25088
 v_mfma_f32_16x16x32_bf16 v[40:43], a[20:23], v[168:171], v[40:43]
 s_waitcnt lgkmcnt(8)
 v_cmp_eq_u32 vcc, 0, v238
 s_or_b64 vcc, vcc, s[94:95]
 s_cbranch_vccnz L_po1
L_por1:
 v_mfma_f32_16x16x32_bf16 v[48:51], a[24:27], v[168:171], v[48:51]
 s_mov_b32 s41, 16384
 ds_read_b64_tr_b16 a[12:13], v205 offset:24576
 ds_read_b64_tr_b16 a[14:15], v205 offset:25088
 v_mfma_f32_16x16x32_bf16 v[52:55], a[24:27], v[172:175], v[52:55]
 s_waitcnt lgkmcnt(8)
 buffer_load_dwordx4 a[144:147], v214, s[28:31], s41 offen nt
 buffer_load_dwordx4 a[148:151], v215, s[28:31], s41 offen nt
 v_mfma_f32_16x16x32_bf16 v[60:63], a[28:31], v[172:175], v[60:63]
 ds_read_b64_tr_b16 a[16:17], v202 offset:28672
 ds_read_b64_tr_b16 a[18:19], v202 offset:29184
 v_mfma_f32_16x16x32_bf16 v[56:59], a[28:31], v[168:171], v[56:59]
 s_waitcnt lgkmcnt(8)
 buffer_load_dwordx4 a[152:155], v216, s[28:31], s41 offen nt
 buffer_load_dwordx4 a[156:159], v217, s[28:31], s41 offen nt
 v_mfma_f32_16x16x32_bf16 v[32:35], a[0:3], v[176:179], v[32:35]
 ds_read_b64_tr_b16 a[20:21], v203 offset:28672
 ds_read_b64_tr_b16 a[22:23], v203 offset:29184
 v_mfma_f32_16x16x32_bf16 v[36:39], a[0:3], v[180:183], v[36:39]
 s_waitcnt lgkmcnt(8)
 v_mfma_f32_16x16x32_bf16 v[44:47], a[4:7], v[180:183], v[44:47]
 ds_read_b64_tr_b16 a[24:25], v204 offset:28672
 ds_read_b64_tr_b16 a[26:27], v204 offset:29184
 v_mfma_f32_16x16x32_bf16 v[40:43], a[4:7], v[176:179], v[40:43]
 s_waitcnt lgkmcnt(8)
 v_mfma_f32_16x16x32_bf16 v[48:51], a[8:11], v[176:179], v[48:51]
 ds_read_b64_tr_b16 a[28:29], v205 offset:28672
 ds_read_b64_tr_b16 a[30:31], v205 offset:29184
 v_mfma_f32_16x16x32_bf16 v[52:55], a[8:11], v[180:183], v[52:55]
 s_waitcnt lgkmcnt(8)
 v_mfma_f32_16x16x32_bf16 v[60:63], a[12:15], v[180:183], v[60:63]
 ds_read_b64_tr_b16 a[0:1], v202 offset:32768
 ds_read_b64_tr_b16 a[2:3], v202 offset:33280
 v_mfma_f32_16x16x32_bf16 v[56:59], a[12:15], v[176:179], v[56:59]
 s_waitcnt lgkmcnt(8)
 v_mfma_f32_16x16x32_bf16 v[32:35], a[16:19], v[184:187], v[32:35]
 ds_read_b64_tr_b16 a[4:5], v203 offset:32768
 ds_read_b64_tr_b16 a[6:7], v203 offset:33280
 v_mfma_f32_16x16x32_bf16 v[36:39], a[16:19], v[188:191], v[36:39]
 s_waitcnt lgkmcnt(8)
 v_mfma_f32_16x16x32_bf16 v[44:47], a[20:23], v[188:191], v[44:47]
 ds_read_b64_tr_b16 a[8:9], v204 offset:32768
 ds_read_b64_tr_b16 a[10:11], v204 offset:33280
 v_mfma_f32_16x16x32_bf16 v[40:43], a[20:23], v[184:187], v[40:43]
 s_waitcnt lgkmcnt(8)
 v_mfma_f32_16x16x32_bf16 v[48:51], a[24:27], v[184:187], v[48:51]
 ds_read_b64_tr_b16 a[12:13], v205 offset:32768
 ds_read_b64_tr_b16 a[14:15], v205 offset:33280
 v_mfma_f32_16x16x32_bf16 v[52:55], a[24:27], v[188:191], v[52:55]
 s_waitcnt lgkmcnt(8)
 v_mfma_f32_16x16x32_bf16 v[60:63], a[28:31], v[188:191], v[60:63]
 ds_read_b64_tr_b16 a[16:17], v202 offset:36864
 ds_read_b64_tr_b16 a[18:19], v202 offset:37376
 v_mfma_f32_16x16x32_bf16 v[56:59], a[28:31], v[184:187], v[56:59]
 s_waitcnt lgkmcnt(8)
 v_mfma_f32_16x16x32_bf16 v[0:3], a[0:3], v[128:131], 0
 s_mov_b32 s40, 0
 ds_read_b64_tr_b16 a[20:21], v203 offset:36864
 ds_read_b64_tr_b16 a[22:23], v203 offset:37376
 v_mfma_f32_16x16x32_bf16 v[4:7], a[0:3], v[132:135], 0
 s_waitcnt lgkmcnt(8)
 v_cvt_pk_bf16_f32 v80, v32, v33
 v_cvt_pk_bf16_f32 v81, v34, v35
 v_mfma_f32_16x16x32_bf16 v[12:15], a[4:7], v[132:135], 0
 s_barrier
 ds_read_b64_tr_b16 a[24:25], v204 offset:36864
 ds_read_b64_tr_b16 a[26:27], v204 offset:37376
 v_mfma_f32_16x16x32_bf16 v[8:11], a[4:7], v[128:131], 0
 s_waitcnt lgkmcnt(8)
 v_cvt_pk_bf16_f32 v82, v40, v41
 v_cvt_pk_bf16_f32 v83, v42, v43
 v_mfma_f32_16x16x32_bf16 v[16:19], a[8:11], v[128:131], 0
 ds_read_b64_tr_b16 a[28:29], v205 offset:36864
 ds_read_b64_tr_b16 a[30:31], v205 offset:37376
 v_mfma_f32_16x16x32_bf16 v[20:23], a[8:11], v[132:135], 0
 s_waitcnt lgkmcnt(8)
 buffer_store_dwordx4 v[80:83], v240, s[28:31], s40 offen
 v_cvt_pk_bf16_f32 v84, v48, v49
 v_mfma_f32_16x16x32_bf16 v[28:31], a[12:15], v[132:135], 0
 ds_read_b64_tr_b16 a[0:1], v202 offset:40960
 ds_read_b64_tr_b16 a[2:3], v202 offset:41472
 v_mfma_f32_16x16x32_bf16 v[24:27], a[12:15], v[128:131], 0
 s_waitcnt lgkmcnt(8)
 v_cvt_pk_bf16_f32 v85, v50, v51
 v_cvt_pk_bf16_f32 v86, v56, v57
 v_mfma_f32_16x16x32_bf16 v[0:3], a[16:19], v[136:139], v[0:3]
 ds_read_b64_tr_b16 a[4:5], v203 offset:40960
 ds_read_b64_tr_b16 a[6:7], v203 offset:41472
 v_mfma_f32_16x16x32_bf16 v[4:7], a[16:19], v[140:143], v[4:7]
 s_waitcnt lgkmcnt(8)
 v_cvt_pk_bf16_f32 v87, v58, v59
 v_cvt_pk_bf16_f32 v88, v36, v37
 v_mfma_f32_16x16x32_bf16 v[12:15], a[20:23], v[140:143], v[12:15]
 ds_read_b64_tr_b16 a[8:9], v204 offset:40960
 ds_read_b64_tr_b16 a[10:11], v204 offset:41472
 v_mfma_f32_16x16x32_bf16 v[8:11], a[20:23], v[136:139], v[8:11]
 s_waitcnt lgkmcnt(8)
 buffer_store_dwordx4 v[84:87], v240, s[28:31], s40 offen offset:1024
 v_cvt_pk_bf16_f32 v89, v38, v39
 v_mfma_f32_16x16x32_bf16 v[16:19], a[24:27], v[136:139], v[16:19]
 ds_read_b64_tr_b16 a[12:13], v205 offset:40960
 ds_read_b64_tr_b16 a[14:15], v205 offset:41472
 v_mfma_f32_16x16x32_bf16 v[20:23], a[24:27], v[140:143], v[20:23]
 s_waitcnt lgkmcnt(8)
 v_cvt_pk_bf16_f32 v90, v44, v45
 v_cvt_pk_bf16_f32 v91, v46, v47
 v_mfma_f32_16x16x32_bf16 v[28:31], a[28:31], v[140:143], v[28:31]
 ds_read_b64_tr_b16 a[16:17], v202 offset:45056
 ds_read_b64_tr_b16 a[18:19], v202 offset:45568
 v_mfma_f32_16x16x32_bf16 v[24:27], a[28:31], v[136:139], v[24:27]
 s_waitcnt lgkmcnt(8)
 buffer_store_dwordx4 v[88:91], v240, s[28:31], s40 offen offset:2048
 v_cvt_pk_bf16_f32 v92, v52, v53
 v_mfma_f32_16x16x32_bf16 v[0:3], a[0:3], v[144:147], v[0:3]
 ds_read_b64_tr_b16 a[20:21], v203 offset:45056
 ds_read_b64_tr_b16 a[22:23], v203 offset:45568
 v_mfma_f32_16x16x32_bf16 v[4:7], a[0:3], v[148:151], v[4:7]
 s_waitcnt lgkmcnt(8)
 v_cvt_pk_bf16_f32 v93, v54, v55
 v_cvt_pk_bf16_f32 v94, v60, v61
 v_mfma_f32_16x16x32_bf16 v[12:15], a[4:7], v[148:151], v[12:15]
 ds_read_b64_tr_b16 a[24:25], v204 offset:45056
 ds_read_b64_tr_b16 a[26:27], v204 offset:45568
 v_mfma_f32_16x16x32_bf16 v[8:11], a[4:7], v[144:147], v[8:11]
 s_waitcnt lgkmcnt(8)
 v_cvt_pk_bf16_f32 v95, v62, v63
 v_mfma_f32_16x16x32_bf16 v[16:19], a[8:11], v[144:147], v[16:19]
 ds_read_b64_tr_b16 a[28:29], v205 offset:45056
 ds_read_b64_tr_b16 a[30:31], v205 offset:45568
 v_mfma_f32_16x16x32_bf16 v[20:23], a[8:11], v[148:151], v[20:23]
 s_waitcnt lgkmcnt(8)
 buffer_store_dwordx4 v[92:95], v240, s[28:31], s40 offen offset:3072
 v_mfma_f32_16x16x32_bf16 v[28:31], a[12:15], v[148:151], v[28:31]
 ds_read_b64_tr_b16 a[0:1], v202 offset:49152
 ds_read_b64_tr_b16 a[2:3], v202 offset:49664
 v_mfma_f32_16x16x32_bf16 v[24:27], a[12:15], v[144:147], v[24:27]
 s_waitcnt lgkmcnt(8)
 v_mfma_f32_16x16x32_bf16 v[0:3], a[16:19], v[152:155], v[0:3]
 s_waitcnt vmcnt(4)
 ds_read_b64_tr_b16 a[4:5], v203 offset:49152
 ds_read_b64_tr_b16 a[6:7], v203 offset:49664
 v_mfma_f32_16x16x32_bf16 v[104:107], a[240:243], a[144:147], 0
 v_mfma_f32_16x16x32_bf16 v[4:7], a[16:19], v[156:159], v[4:7]
 s_waitcnt lgkmcnt(8)
 v_mfma_f32_16x16x32_bf16 v[104:107], a[240:243], a[148:151], v[104:107]
 v_mfma_f32_16x16x32_bf16 v[12:15], a[20:23], v[156:159], v[12:15]
 ds_read_b64_tr_b16 a[8:9], v204 offset:49152
 ds_read_b64_tr_b16 a[10:11], v204 offset:49664
 v_mfma_f32_16x16x32_bf16 v[104:107], a[240:243], a[152:155], v[104:107]
 v_mfma_f32_16x16x32_bf16 v[8:11], a[20:23], v[152:155], v[8:11]
 s_waitcnt lgkmcnt(8)
 s_cmp_lg_u64 s[94:95], 0
 s_cbranch_scc1 L_fl2
 buffer_store_dword v239, v242, s[28:31], 0 offen offset:512
L_flr2:
 v_mfma_f32_16x16x32_bf16 v[104:107], a[240:243], a[156:159], v[104:107]
 v_mfma_f32_16x16x32_bf16 v[16:19], a[24:27], v[152:155], v[16:19]
 ds_read_b64_tr_b16 a[12:13], v205 offset:49152
 ds_read_b64_tr_b16 a[14:15], v205 offset:49664
 v_mfma_f32_16x16x32_bf16 v[20:23], a[24:27], v[156:159], v[20:23]
 s_waitcnt lgkmcnt(8)
 v_mfma_f32_16x16x32_bf16 v[28:31], a[28:31], v[156:159], v[28:31]
 ds_read_b64_tr_b16 a[16:17], v202 offset:53248
 ds_read_b64_tr_b16 a[18:19], v202 offset:53760
 v_mfma_f32_16x16x32_bf16 v[24:27], a[28:31], v[152:155], v[24:27]
 s_waitcnt lgkmcnt(8)
 v_cvt_pk_bf16_f32 v108, v104, v105
 v_cvt_pk_bf16_f32 v109, v106, v107
 v_mfma_f32_16x16x32_bf16 v[0:3], a[0:3], v[160:163], v[0:3]
 ds_read_b64_tr_b16 a[20:21], v203 offset:53248
 ds_read_b64_tr_b16 a[22:23], v203 offset:53760
 v_mfma_f32_16x16x32_bf16 v[4:7], a[0:3], v[164:167], v[4:7]
 s_waitcnt lgkmcnt(8)
 v_mfma_f32_16x16x32_bf16 v[12:15], a[4:7], v[164:167], v[12:15]
 ds_read_b64_tr_b16 a[24:25], v204 offset:53248
 ds_read_b64_tr_b16 a[26:27], v204 offset:53760
 v_mfma_f32_16x16x32_bf16 v[8:11], a[4:7], v[160:163], v[8:11]
 s_waitcnt lgkmcnt(8)
 v_mfma_f32_16x16x32_bf16 v[16:19], a[8:11], v[160:163], v[16:19]
 ds_read_b64_tr_b16 a[28:29], v205 offset:53248
 ds_read_b64_tr_b16 a[30:31], v205 offset:53760
 v_mfma_f32_16x16x32_bf16 v[20:23], a[8:11], v[164:167], v[20:23]
 s_waitcnt lgkmcnt(8)
 v_mfma_f32_16x16x32_bf16 v[28:31], a[12:15], v[164:167], v[28:31]
 ds_read_b64_tr_b16 a[0:1], v202 offset:57344
 ds_read_b64_tr_b16 a[2:3], v202 offset:57856
 v_mfma_f32_16x16x32_bf16 v[24:27], a[12:15], v[160:163], v[24:27]
 s_waitcnt lgkmcnt(8)
 buffer_load_dword v238, v241, s[28:31], 0 offen offset:512 nt
 buffer_store_dwordx2 v[108:109], v243, s[44:47], 0 offen offset:128
 v_mfma_f32_16x16x32_bf16 v[0:3], a[16:19], v[168:171], v[0:3]
 ds_read_b64_tr_b16 a[4:5], v203 offset:57344
 ds_read_b64_tr_b16 a[6:7], v203 offset:57856
 v_mfma_f32_16x16x32_bf16 v[4:7], a[16:19], v[172:175], v[4:7]
 s_waitcnt lgkmcnt(8)
 v_mfma_f32_16x16x32_bf16 v[12:15], a[20:23], v[172:175], v[12:15]
 ds_read_b64_tr_b16 a[8:9], v204 offset:57344
 ds_read_b64_tr_b16 a[10:11], v204 offset:57856
 v_mfma_f32_16x16x32_bf16 v[8:11], a[20:23], v[168:171], v[8:11]
 s_waitcnt lgkmcnt(8)
 v_mfma_f32_16x16x32_bf16 v[16:19], a[24:27], v[168:171], v[16:19]
 ds_read_b64_tr_b16 a[12:13], v205 offset:57344
 ds_read_b64_tr_b16 a[14:15], v205 offset:57856
 v_mfma_f32_16x16x32_bf16 v[20:23], a[24:27], v[172:175], v[20:23]
 s_waitcnt lgkmcnt(8)
 v_mfma_f32_16x16x32_bf16 v[28:31], a[28:31], v[172:175], v[28:31]
 ds_read_b64_tr_b16 a[16:17], v202 offset:61440
 ds_read_b64_tr_b16 a[18:19], v202 offset:61952
 v_mfma_f32_16x16x32_bf16 v[24:27], a[28:31], v[168:171], v[24:27]
 s_waitcnt lgkmcnt(8)
 v_mfma_f32_16x16x32_bf16 v[0:3], a[0:3], v[176:179], v[0:3]
 ds_read_b64_tr_b16 a[20:21], v203 offset:61440
 ds_read_b64_tr_b16 a[22:23], v203 offset:61952
 v_mfma_f32_16x16x32_bf16 v[4:7], a[0:3], v[180:183], v[4:7]
 s_waitcnt lgkmcnt(8)
 v_mfma_f32_16x16x32_bf16 v[12:15], a[4:7], v[180:183], v[12:15]
 ds_read_b64_tr_b16 a[24:25], v204 offset:61440
 ds_read_b64_tr_b16 a[26:27], v204 offset:61952
 v_mfma_f32_16x16x32_bf16 v[8:11], a[4:7], v[176:179], v[8:11]
 s_waitcnt lgkmcnt(8)
 v_mfma_f32_16x16x32_bf16 v[16:19], a[8:11], v[176:179], v[16:19]
 ds_read_b64_tr_b16 a[28:29], v205 offset:61440
 ds_read_b64_tr_b16 a[30:31], v205 offset:61952
 v_mfma_f32_16x16x32_bf16 v[20:23], a[8:11], v[180:183], v[20:23]
 s_waitcnt lgkmcnt(8)
 v_mfma_f32_16x16x32_bf16 v[28:31], a[12:15], v[180:183], v[28:31]
 ds_read_b64_tr_b16 a[0:1], v206 offset:0
 ds_read_b64_tr_b16 a[2:3], v206 offset:512
 v_mfma_f32_16x16x32_bf16 v[24:27], a[12:15], v[176:179], v[24:27]
 s_waitcnt lgkmcnt(8)
 v_mfma_f32_16x16x32_bf16 v[0:3], a[16:19], v[184:187], v[0:3]
 ds_read_b64_tr_b16 a[4:5], v207 offset:0
 ds_read_b64_tr_b16 a[6:7], v207 offset:512
 v_mfma_f32_16x16x32_bf16 v[4:7], a[16:19], v[188:191], v[4:7]
 s_waitcnt lgkmcnt(8)
 v_mfma_f32_16x16x32_bf16 v[12:15], a[20:23], v[188:191], v[12:15]
 ds_read_b64_tr_b16 a[8:9], v208 offset:0
 ds_read_b64_tr_b16 a[10:11], v208 offset:512
 v_mfma_f32_16x16x32_bf16 v[8:11], a[20:23], v[184:187], v[8:11]
 s_waitcnt lgkmcnt(8)
 v_mfma_f32_16x16x32_bf16 v[16:19], a[24:27], v[184:187], v[16:19]
 s_waitcnt vmcnt(1)
 ds_read_b64_tr_b16 a[12:13], v209 offset:0
 ds_read_b64_tr_b16 a[14:15], v209 offset:512
 v_mfma_f32_16x16x32_bf16 v[20:23], a[24:27], v[188:191], v[20:23]
 s_waitcnt lgkmcnt(8)
 v_cmp_eq_u32 vcc, 0, v238
 s_or_b64 vcc, vcc, s[94:95]
 s_cbranch_vccnz L_po2
L_por2:
 v_mfma_f32_16x16x32_bf16 v[28:31], a[28:31], v[188:191], v[28:31]
 s_mov_b32 s41, 32768
 ds_read_b64_tr_b16 a[16:17], v206 offset:4096
 ds_read_b64_tr_b16 a[18:19], v206 offset:4608
 v_mfma_f32_16x16x32_bf16 v[24:27], a[28:31], v[184:187], v[24:27]
 s_waitcnt lgkmcnt(8)
 buffer_load_dwordx4 a[160:163], v214, s[28:31], s41 offen nt
 buffer_load_dwordx4 a[164:167], v215, s[28:31], s41 offen nt
 v_mfma_f32_16x16x32_bf16 v[32:35], a[0:3], v[128:131], 0
 s_mov_b32 s40, 16384
 ds_read_b64_tr_b16 a[20:21], v207 offset:4096
 ds_read_b64_tr_b16 a[22:23], v207 offset:4608
 v_mfma_f32_16x16x32_bf16 v[36:39], a[0:3], v[132:135], 0
 s_waitcnt lgkmcnt(8)
 buffer_load_dwordx4 a[168:171], v216, s[28:31], s41 offen nt
 buffer_load_dwordx4 a[172:175], v217, s[28:31], s41 offen nt
 v_mfma_f32_16x16x32_bf16 v[44:47], a[4:7], v[132:135], 0
 s_barrier
 ds_read_b64_tr_b16 a[24:25], v208 offset:4096
 ds_read_b64_tr_b16 a[26:27], v208 offset:4608
 v_mfma_f32_16x16x32_bf16 v[40:43], a[4:7], v[128:131], 0
 s_waitcnt lgkmcnt(8)
 v_cvt_pk_bf16_f32 v64, v0, v1
 v_cvt_pk_bf16_f32 v65, v2, v3
 v_mfma_f32_16x16x32_bf16 v[48:51], a[8:11], v[128:131], 0
 ds_read_b64_tr_b16 a[28:29], v209 offset:4096
 ds_read_b64_tr_b16 a[30:31], v209 offset:4608
 v_mfma_f32_16x16x32_bf16 v[52:55], a[8:11], v[132:135], 0
 s_waitcnt lgkmcnt(8)
 v_cvt_pk_bf16_f32 v66, v8, v9
 v_cvt_pk_bf16_f32 v67, v10, v11
 v_mfma_f32_16x16x32_bf16 v[60:63], a[12:15], v[132:135], 0
 ds_read_b64_tr_b16 a[0:1], v206 offset:8192
 ds_read_b64_tr_b16 a[2:3], v206 offset:8704
 v_mfma_f32_16x16x32_bf16 v[56:59], a[12:15], v[128:131], 0
 s_waitcnt lgkmcnt(8)
 buffer_store_dwordx4 v[64:67], v240, s[28:31], s40 offen
 v_cvt_pk_bf16_f32 v68, v16, v17
 v_mfma_f32_16x16x32_bf16 v[32:35], a[16:19], v[136:139], v[32:35]
 ds_read_b64_tr_b16 a[4:5], v207 offset:8192
 ds_read_b64_tr_b16 a[6:7], v207 offset:8704
 v_mfma_f32_16x16x32_bf16 v[36:39], a[16:19], v[140:143], v[36:39]
 s_waitcnt lgkmcnt(8)
 v_cvt_pk_bf16_f32 v69, v18, v19
 v_cvt_pk_bf16_f32 v70, v24, v25
 v_mfma_f32_16x16x32_bf16 v[44:47], a[20:23], v[140:143], v[44:47]
 ds_read_b64_tr_b16 a[8:9], v208 offset:8192
 ds_read_b64_tr_b16 a[10:11], v208 offset:8704
 v_mfma_f32_16x16x32_bf16 v[40:43], a[20:23], v[136:139], v[40:43]
 s_waitcnt lgkmcnt(8)
 v_cvt_pk_bf16_f32 v71, v26, v27
 v_cvt_pk_bf16_f32 v72, v4, v5
 v_mfma_f32_16x16x32_bf16 v[48:51], a[24:27], v[136:139], v[48:51]
 ds_read_b64_tr_b16 a[12:13], v209 offset:8192
 ds_read_b64_tr_b16 a[14:15], v209 offset:8704
 v_mfma_f32_16x16x32_bf16 v[52:55], a[24:27], v[140:143], v[52:55]
 s_waitcnt lgkmcnt(8)
 buffer_store_dwordx4 v[68:71], v240, s[28:31], s40 offen offset:1024
 v_cvt_pk_bf16_f32 v73, v6, v7
 v_mfma_f32_16x16x32_bf16 v[60:63], a[28:31], v[140:143], v[60:63]
 ds_read_b64_tr_b16 a[16:17], v206 offset:12288
 ds_read_b64_tr_b16 a[18:19], v206 offset:12800
 v_mfma_f32_16x16x32_bf16 v[56:59], a[28:31], v[136:139], v[56:59]
 s_waitcnt lgkmcnt(8)
 v_cvt_pk_bf16_f32 v74, v12, v13
 v_cvt_pk_bf16_f32 v75, v14, v15
 v_mfma_f32_16x16x32_bf16 v[32:35], a[0:3], v[144:147], v[32:35]
 ds_read_b64_tr_b16 a[20:21], v207 offset:12288
 ds_read_b64_tr_b16 a[22:23], v207 offset:12800
 v_mfma_f32_16x16x32_bf16 v[36:39], a[0:3], v[148:151], v[36:39]
 s_waitcnt lgkmcnt(8)
 buffer_store_dwordx4 v[72:75], v240, s[28:31], s40 offen offset:2048
 v_cvt_pk_bf16_f32 v76, v20, v21
 v_mfma_f32_16x16x32_bf16 v[44:47], a[4:7], v[148:151], v[44:47]
 ds_read_b64_tr_b16 a[24:25], v208 offset:12288
 ds_read_b64_tr_b16 a[26:27], v208 offset:12800
 v_mfma_f32_16x16x32_bf16 v[40:43], a[4:7], v[144:147], v[40:43]
 s_waitcnt lgkmcnt(8)
 v_cvt_pk_bf16_f32 v77, v22, v23
 v_cvt_pk_bf16_f32 v78, v28, v29
 v_mfma_f32_16x16x32_bf16 v[48:51], a[8:11], v[144:147], v[48:51]
 ds_read_b64_tr_b16 a[28:29], v209 offset:12288
 ds_read_b64_tr_b16 a[30:31], v209 offset:12800
 v_mfma_f32_16x16x32_bf16 v[52:55], a[8:11], v[148:151], v[52:55]
 s_waitcnt lgkmcnt(8)
 v_cvt_pk_bf16_f32 v79, v30, v31
 v_mfma_f32_16x16x32_bf16 v[60:63], a[12:15], v[148:151], v[60:63]
 ds_read_b64_tr_b16 a[0:1], v206 offset:16384
 ds_read_b64_tr_b16 a[2:3], v206 offset:16896
 v_mfma_f32_16x16x32_bf16 v[56:59], a[12:15], v[144:147], v[56:59]
 s_waitcnt lgkmcnt(8)
 buffer_store_dwordx4 v[76:79], v240, s[28:31], s40 offen offset:3072
 v_mfma_f32_16x16x32_bf16 v[32:35], a[16:19], v[152:155], v[32:35]
 ds_read_b64_tr_b16 a[4:5], v207 offset:16384
 ds_read_b64_tr_b16 a[6:7], v207 offset:16896
 v_mfma_f32_16x16x32_bf16 v[36:39], a[16:19], v[156:159], v[36:39]
 s_waitcnt lgkmcnt(8)
 v_mfma_f32_16x16x32_bf16 v[44:47], a[20:23], v[156:159], v[44:47]
 ds_read_b64_tr_b16 a[8:9], v208 offset:16384
 ds_read_b64_tr_b16 a[10:11], v208 offset:16896
 v_mfma_f32_16x16x32_bf16 v[40:43], a[20:23], v[152:155], v[40:43]
 s_waitcnt lgkmcnt(8)
 v_mfma_f32_16x16x32_bf16 v[48:51], a[24:27], v[152:155], v[48:51]
 ds_read_b64_tr_b16 a[12:13], v209 offset:16384
 ds_read_b64_tr_b16 a[14:15], v209 offset:16896
 v_mfma_f32_16x16x32_bf16 v[52:55], a[24:27], v[156:159], v[52:55]
 s_waitcnt lgkmcnt(8)
 v_mfma_f32_16x16x32_bf16 v[60:63], a[28:31], v[156:159], v[60:63]
 ds_read_b64_tr_b16 a[16:17], v206 offset:20480
 ds_read_b64_tr_b16 a[18:19], v206 offset:20992
 v_mfma_f32_16x16x32_bf16 v[56:59], a[28:31], v[152:155], v[56:59]
 s_waitcnt lgkmcnt(8)
 v_mfma_f32_16x16x32_bf16 v[32:35], a[0:3], v[160:163], v[32:35]
 ds_read_b64_tr_b16 a[20:21], v207 offset:20480
 ds_read_b64_tr_b16 a[22:23], v207 offset:20992
 v_mfma_f32_16x16x32_bf16 v[36:39], a[0:3], v[164:167], v[36:39]
 s_waitcnt lgkmcnt(8)
 v_mfma_f32_16x16x32_bf16 v[44:47], a[4:7], v[164:167], v[44:47]
 ds_read_b64_tr_b16 a[24:25], v208 offset:20480
 ds_read_b64_tr_b16 a[26:27], v208 offset:20992
 v_mfma_f32_16x16x32_bf16 v[40:43], a[4:7], v[160:163], v[40:43]
 s_waitcnt lgkmcnt(8)
 v_mfma_f32_16x16x32_bf16 v[48:51], a[8:11], v[160:163], v[48:51]
 ds_read_b64_tr_b16 a[28:29], v209 offset:20480
 ds_read_b64_tr_b16 a[30:31], v209 offset:20992
 v_mfma_f32_16x16x32_bf16 v[52:55], a[8:11], v[164:167], v[52:55]
 s_waitcnt lgkmcnt(8)
 v_mfma_f32_16x16x32_bf16 v[60:63], a[12:15], v[164:167], v[60:63]
 ds_read_b64_tr_b16 a[0:1], v206 offset:24576
 ds_read_b64_tr_b16 a[2:3], v206 offset:25088
 v_mfma_f32_16x16x32_bf16 v[56:59], a[12:15], v[160:163], v[56:59]
 s_waitcnt lgkmcnt(8)
 v_mfma_f32_16x16x32_bf16 v[32:35], a[16:19], v[168:171], v[32:35]
 ds_read_b64_tr_b16 a[4:5], v207 offset:24576
 ds_read_b64_tr_b16 a[6:7], v207 offset:25088
 v_mfma_f32_16x16x32_bf16 v[36:39], a[16:19], v[172:175], v[36:39]
 s_waitcnt lgkmcnt(8)
 v_mfma_f32_16x16x32_bf16 v[44:47], a[20:23], v[172:175], v[44:47]
 s_waitcnt vmcnt(4)
 ds_read_b64_tr_b16 a[8:9], v208 offset:24576
 ds_read_b64_tr_b16 a[10:11], v208 offset:25088
 v_mfma_f32_16x16x32_bf16 v[96:99], a[240:243], a[160:163], 0
 v_mfma_f32_16x16x32_bf16 v[40:43], a[20:23], v[168:171], v[40:43]
 s_waitcnt lgkmcnt(8)
 v_mfma_f32_16x16x32_bf16 v[96:99], a[240:243], a[164:167], v[96:99]
 v_mfma_f32_16x16x32_bf16 v[48:51], a[24:27], v[168:171], v[48:51]
 ds_read_b64_tr_b16 a[12:13], v209 offset:24576
 ds_read_b64_tr_b16 a[14:15], v209 offset:25088
 v_mfma_f32_16x16x32_bf16 v[96:99], a[240:243], a[168:171], v[96:99]
 v_mfma_f32_16x16x32_bf16 v[52:55], a[24:27], v[172:175], v[52:55]
 s_waitcnt lgkmcnt(8)
 s_cmp_lg_u64 s[94:95], 0
 s_cbranch_scc1 L_fl3
 buffer_store_dword v239, v242, s[28:31], 0 offen offset:768
L_flr3:
 v_mfma_f32_16x16x32_bf16 v[96:99], a[240:243], a[172:175], v[96:99]
 v_mfma_f32_16x16x32_bf16 v[60:63], a[28:31], v[172:175], v[60:63]
 ds_read_b64_tr_b16 a[16:17], v206 offset:28672
 ds_read_b64_tr_b16 a[18:19], v206 offset:29184
 v_mfma_f32_16x16x32_bf16 v[56:59], a[28:31], v[168:171], v[56:59]
 s_waitcnt lgkmcnt(8)
 v_mfma_f32_16x16x32_bf16 v[32:35], a[0:3], v[176:179], v[32:35]
 ds_read_b64_tr_b16 a[20:21], v207 offset:28672
 ds_read_b64_tr_b16 a[22:23], v207 offset:29184
 v_mfma_f32_16x16x32_bf16 v[36:39], a[0:3], v[180:183], v[36:39]
 s_waitcnt lgkmcnt(8)
 v_cvt_pk_bf16_f32 v100, v96, v97
 v_cvt_pk_bf16_f32 v101, v98, v99
 v_mfma_f32_16x16x32_bf16 v[44:47], a[4:7], v[180:183], v[44:47]
 ds_read_b64_tr_b16 a[24:25], v208 offset:28672
 ds_read_b64_tr_b16 a[26:27], v208 offset:29184
 v_mfma_f32_16x16x32_bf16 v[40:43], a[4:7], v[176:179], v[40:43]
 s_waitcnt lgkmcnt(8)
 v_mfma_f32_16x16x32_bf16 v[48:51], a[8:11], v[176:179], v[48:51]
 ds_read_b64_tr_b16 a[28:29], v209 offset:28672
 ds_read_b64_tr_b16 a[30:31], v209 offset:29184
 v_mfma_f32_16x16x32_bf16 v[52:55], a[8:11], v[180:183], v[52:55]
 s_waitcnt lgkmcnt(8)
 v_mfma_f32_16x16x32_bf16 v[60:63], a[12:15], v[180:183], v[60:63]
 ds_read_b64_tr_b16 a[0:1], v198 offset:0
 ds_read_b64_tr_b16 a[2:3], v198 offset:512
 v_mfma_f32_16x16x32_bf16 v[56:59], a[12:15], v[176:179], v[56:59]
 s_waitcnt lgkmcnt(8)
 v_mfma_f32_16x16x32_bf16 v[32:35], a[16:19], v[184:187], v[32:35]
 ds_read_b64_tr_b16 a[4:5], v199 offset:0
 ds_read_b64_tr_b16 a[6:7], v199 offset:512
 v_mfma_f32_16x16x32_bf16 v[36:39], a[16:19], v[188:191], v[36:39]
 s_waitcnt lgkmcnt(8)
 buffer_load_dword v238, v241, s[28:31], 0 offen offset:768 nt
 buffer_store_dwordx2 v[100:101], v243, s[44:47], 0 offen offset:256
 v_mfma_f32_16x16x32_bf16 v[44:47], a[20:23], v[188:191], v[44:47]
 ds_read_b64_tr_b16 a[8:9], v200 offset:0
 ds_read_b64_tr_b16 a[10:11], v200 offset:512
 v_mfma_f32_16x16x32_bf16 v[40:43], a[20:23], v[184:187], v[40:43]
 s_waitcnt lgkmcnt(8)
 v_mfma_f32_16x16x32_bf16 v[48:51], a[24:27], v[184:187], v[48:51]
 ds_read_b64_tr_b16 a[12:13], v201 offset:0
 ds_read_b64_tr_b16 a[14:15], v201 offset:512
 v_mfma_f32_16x16x32_bf16 v[52:55], a[24:27], v[188:191], v[52:55]
 s_waitcnt lgkmcnt(8)
 v_mfma_f32_16x16x32_bf16 v[60:63], a[28:31], v[188:191], v[60:63]
 ds_read_b64_tr_b16 a[16:17], v198 offset:4096
 ds_read_b64_tr_b16 a[18:19], v198 offset:4608
 v_mfma_f32_16x16x32_bf16 v[56:59], a[28:31], v[184:187], v[56:59]
 s_waitcnt lgkmcnt(8)
 v_mfma_f32_16x16x32_bf16 v[0:3], a[0:3], v[128:131], 0
 s_mov_b32 s40, 32768
 ds_read_b64_tr_b16 a[20:21], v199 offset:4096
 ds_read_b64_tr_b16 a[22:23], v199 offset:4608
 v_mfma_f32_16x16x32_bf16 v[4:7], a[0:3], v[132:135], 0
 s_waitcnt lgkmcnt(8)
 v_cvt_pk_bf16_f32 v80, v32, v33
 v_cvt_pk_bf16_f32 v81, v34, v35
 v_mfma_f32_16x16x32_bf16 v[12:15], a[4:7], v[132:135], 0
 s_barrier
 ds_read_b64_tr_b16 a[24:25], v200 offset:4096
 ds_read_b64_tr_b16 a[26:27], v200 offset:4608
 v_mfma_f32_16x16x32_bf16 v[8:11], a[4:7], v[128:131], 0
 s_waitcnt lgkmcnt(8)
 v_cvt_pk_bf16_f32 v82, v40, v41
 v_cvt_pk_bf16_f32 v83, v42, v43
 v_mfma_f32_16x16x32_bf16 v[16:19], a[8:11], v[128:131], 0
 ds_read_b64_tr_b16 a[28:29], v201 offset:4096
 ds_read_b64_tr_b16 a[30:31], v201 offset:4608
 v_mfma_f32_16x16x32_bf16 v[20:23], a[8:11], v[132:135], 0
 s_waitcnt lgkmcnt(8)
 v_cvt_pk_bf16_f32 v84, v48, v49
 v_cvt_pk_bf16_f32 v85, v50, v51
 v_mfma_f32_16x16x32_bf16 v[28:31], a[12:15], v[132:135], 0
 ds_read_b64_tr_b16 a[0:1], v198 offset:8192
 ds_read_b64_tr_b16 a[2:3], v198 offset:8704
 v_mfma_f32_16x16x32_bf16 v[24:27], a[12:15], v[128:131], 0
 s_waitcnt lgkmcnt(8)
 v_cvt_pk_bf16_f32 v86, v56, v57
 v_cvt_pk_bf16_f32 v87, v58, v59
 v_mfma_f32_16x16x32_bf16 v[0:3], a[16:19], v[136:139], v[0:3]
 ds_read_b64_tr_b16 a[4:5], v199 offset:8192
 ds_read_b64_tr_b16 a[6:7], v199 offset:8704
 v_mfma_f32_16x16x32_bf16 v[4:7], a[16:19], v[140:143], v[4:7]
 s_waitcnt lgkmcnt(8)
 v_cvt_pk_bf16_f32 v88, v36, v37
 v_cvt_pk_bf16_f32 v89, v38, v39
 v_mfma_f32_16x16x32_bf16 v[12:15], a[20:23], v[140:143], v[12:15]
 ds_read_b64_tr_b16 a[8:9], v200 offset:8192
 ds_read_b64_tr_b16 a[10:11], v200 offset:8704
 v_mfma_f32_16x16x32_bf16 v[8:11], a[20:23], v[136:139], v[8:11]
 s_waitcnt lgkmcnt(8)
 v_cvt_pk_bf16_f32 v90, v44, v45
 v_cvt_pk_bf16_f32 v91, v46, v47
 v_mfma_f32_16x16x32_bf16 v[16:19], a[24:27], v[136:139], v[16:19]
 ds_read_b64_tr_b16 a[12:13], v201 offset:8192
 ds_read_b64_tr_b16 a[14:15], v201 offset:8704
 v_mfma_f32_16x16x32_bf16 v[20:23], a[24:27], v[140:143], v[20:23]
 s_waitcnt lgkmcnt(8)
 v_cvt_pk_bf16_f32 v92, v52, v53
 v_cvt_pk_bf16_f32 v93, v54, v55
 v_mfma_f32_16x16x32_bf16 v[28:31], a[28:31], v[140:143], v[28:31]
 s_waitcnt vmcnt(1)
 ds_read_b64_tr_b16 a[16:17], v198 offset:12288
 ds_read_b64_tr_b16 a[18:19], v198 offset:12800
 v_mfma_f32_16x16x32_bf16 v[24:27], a[28:31], v[136:139], v[24:27]
 s_waitcnt lgkmcnt(8)
 v_cmp_eq_u32 vcc, 0, v238
 s_or_b64 vcc, vcc, s[94:95]
 s_cbranch_vccnz L_po3
L_por3:
 v_mfma_f32_16x16x32_bf16 v[0:3], a[0:3], v[144:147], v[0:3]
 s_mov_b32 s41, 0
 ds_read_b64_tr_b16 a[20:21], v199 offset:12288
 ds_read_b64_tr_b16 a[22:23], v199 offset:12800
 v_mfma_f32_16x16x32_bf16 v[4:7], a[0:3], v[148:151], v[4:7]
 s_waitcnt lgkmcnt(8)
 buffer_store_dwordx4 v[80:83], v240, s[28:31], s40 offen
 buffer_store_dwordx4 v[84:87], v240, s[28:31], s40 offen offset:1024
 v_mfma_f32_16x16x32_bf16 v[12:15], a[4:7], v[148:151], v[12:15]
 ds_read_b64_tr_b16 a[24:25], v200 offset:12288
 ds_read_b64_tr_b16 a[26:27], v200 offset:12800
 v_mfma_f32_16x16x32_bf16 v[8:11], a[4:7], v[144:147], v[8:11]
 s_waitcnt lgkmcnt(8)
 buffer_store_dwordx4 v[88:91], v240, s[28:31], s40 offen offset:2048
 buffer_load_dwordx4 a[176:179], v214, s[28:31], s41 offen nt
 v_mfma_f32_16x16x32_bf16 v[16:19], a[8:11], v[144:147], v[16:19]
 ds_read_b64_tr_b16 a[28:29], v201 offset:12288
 ds_read_b64_tr_b16 a[30:31], v201 offset:12800
 v_mfma_f32_16x16x32_bf16 v[20:23], a[8:11], v[148:151], v[20:23]
 s_waitcnt lgkmcnt(8)
 buffer_load_dwordx4 a[180:183], v215, s[28:31], s41 offen nt
 buffer_load_dwordx4 a[184:187], v216, s[28:31], s41 offen nt
 v_mfma_f32_16x16x32_bf16 v[28:31], a[12:15], v[148:151], v[28:31]
 ds_read_b64_tr_b16 a[0:1], v198 offset:16384
 ds_read_b64_tr_b16 a[2:3], v198 offset:16896
 v_mfma_f32_16x16x32_bf16 v[24:27], a[12:15], v[144:147], v[24:27]
 s_waitcnt lgkmcnt(8)
 buffer_load_dwordx4 a[188:191], v217, s[28:31], s41 offen nt
 v_cvt_pk_bf16_f32 v94, v60, v61
 v_mfma_f32_16x16x32_bf16 v[0:3], a[16:19], v[152:155], v[0:3]
 ds_read_b64_tr_b16 a[4:5], v199 offset:16384
 ds_read_b64_tr_b16 a[6:7], v199 offset:16896
 v_mfma_f32_16x16x32_bf16 v[4:7], a[16:19], v[156:159], v[4:7]
 s_waitcnt lgkmcnt(8)
 v_cvt_pk_bf16_f32 v95, v62, v63
 v_mfma_f32_16x16x32_bf16 v[12:15], a[20:23], v[156:159], v[12:15]
 ds_read_b64_tr_b16 a[8:9], v200 offset:16384
 ds_read_b64_tr_b16 a[10:11], v200 offset:16896
 v_mfma_f32_16x16x32_bf16 v[8:11], a[20:23], v[152:155], v[8:11]
 s_waitcnt lgkmcnt(8)
 buffer_store_dwordx4 v[92:95], v240, s[28:31], s40 offen offset:3072
 v_mfma_f32_16x16x32_bf16 v[16:19], a[24:27], v[152:155], v[16:19]
 ds_read_b64_tr_b16 a[12:13], v201 offset:16384
 ds_read_b64_tr_b16 a[14:15], v201 offset:16896
 v_mfma_f32_16x16x32_bf16 v[20:23], a[24:27], v[156:159], v[20:23]
 s_waitcnt lgkmcnt(8)
 v_mfma_f32_16x16x32_bf16 v[28:31], a[28:31], v[156:159], v[28:31]
 ds_read_b64_tr_b16 a[16:17], v198 offset:20480
 ds_read_b64_tr_b16 a[18:19], v198 offset:20992
 v_mfma_f32_16x16x32_bf16 v[24:27], a[28:31], v[152:155], v[24:27]
 s_waitcnt lgkmcnt(8)
 v_mfma_f32_16x16x32_bf16 v[0:3], a[0:3], v[160:163], v[0:3]
 ds_read_b64_tr_b16 a[20:21], v199 offset:20480
 ds_read_b64_tr_b16 a[22:23], v199 offset:20992
 v_mfma_f32_16x16x32_bf16 v[4:7], a[0:3], v[164:167], v[4:7]
 s_waitcnt lgkmcnt(8)
 v_mfma_f32_16x16x32_bf16 v[12:15], a[4:7], v[164:167], v[12:15]
 ds_read_b64_tr_b16 a[24:25], v200 offset:20480
 ds_read_b64_tr_b16 a[26:27], v200 offset:20992
 v_mfma_f32_16x16x32_bf16 v[8:11], a[4:7], v[160:163], v[8:11]
 s_waitcnt lgkmcnt(8)
 v_mfma_f32_16x16x32_bf16 v[16:19], a[8:11], v[160:163], v[16:19]
 ds_read_b64_tr_b16 a[28:29], v201 offset:20480
 ds_read_b64_tr_b16 a[30:31], v201 offset:20992
 v_mfma_f32_16x16x32_bf16 v[20:23], a[8:11], v[164:167], v[20:23]
 s_waitcnt lgkmcnt(8)
 v_mfma_f32_16x16x32_bf16 v[28:31], a[12:15], v[164:167], v[28:31]
 ds_read_b64_tr_b16 a[0:1], v198 offset:24576
 ds_read_b64_tr_b16 a[2:3], v198 offset:25088
 v_mfma_f32_16x16x32_bf16 v[24:27], a[12:15], v[160:163], v[24:27]
 s_waitcnt lgkmcnt(8)
 v_mfma_f32_16x16x32_bf16 v[0:3], a[16:19], v[168:171], v[0:3]
 ds_read_b64_tr_b16 a[4:5], v199 offset:24576
 ds_read_b64_tr_b16 a[6:7], v199 offset:25088
 v_mfma_f32_16x16x32_bf16 v[4:7], a[16:19], v[172:175], v[4:7]
 s_waitcnt lgkmcnt(8)
 v_mfma_f32_16x16x32_bf16 v[12:15], a[20:23], v[172:175], v[12:15]
 ds_read_b64_tr_b16 a[8:9], v200 offset:24576
 ds_read_b64_tr_b16 a[10:11], v200 offset:25088
 v_mfma_f32_16x16x32_bf16 v[8:11], a[20:23], v[168:171], v[8:11]
 s_waitcnt lgkmcnt(8)
 v_mfma_f32_16x16x32_bf16 v[16:19], a[24:27], v[168:171], v[16:19]
 s_waitcnt vmcnt(1)
 ds_read_b64_tr_b16 a[12:13], v201 offset:24576
 ds_read_b64_tr_b16 a[14:15], v201 offset:25088
 v_mfma_f32_16x16x32_bf16 v[104:107], a[240:243], a[176:179], 0
 v_mfma_f32_16x16x32_bf16 v[20:23], a[24:27], v[172:175], v[20:23]
 s_waitcnt lgkmcnt(8)
 v_mfma_f32_16x16x32_bf16 v[104:107], a[240:243], a[180:183], v[104:107]
 v_mfma_f32_16x16x32_bf16 v[28:31], a[28:31], v[172:175], v[28:31]
 ds_read_b64_tr_b16 a[16:17], v198 offset:28672
 ds_read_b64_tr_b16 a[18:19], v198 offset:29184
 v_mfma_f32_16x16x32_bf16 v[104:107], a[240:243], a[184:187], v[104:107]
 v_mfma_f32_16x16x32_bf16 v[24:27], a[28:31], v[168:171], v[24:27]
 s_waitcnt lgkmcnt(8)
 s_cmp_lg_u64 s[94:95], 0
 s_cbranch_scc1 L_fl4
 buffer_store_dword v239, v242, s[28:31], 0 offen offset:1024
L_flr4:
 v_mfma_f32_16x16x32_bf16 v[104:107], a[240:243], a[188:191], v[104:107]
 v_mfma_f32_16x16x32_bf16 v[0:3], a[0:3], v[176:179], v[0:3]
 ds_read_b64_tr_b16 a[20:21], v199 offset:28672
 ds_read_b64_tr_b16 a[22:23], v199 offset:29184
 v_mfma_f32_16x16x32_bf16 v[4:7], a[0:3], v[180:183], v[4:7]
 s_waitcnt lgkmcnt(8)
 v_mfma_f32_16x16x32_bf16 v[12:15], a[4:7], v[180:183], v[12:15]
 ds_read_b64_tr_b16 a[24:25], v200 offset:28672
 ds_read_b64_tr_b16 a[26:27], v200 offset:29184
 v_mfma_f32_16x16x32_bf16 v[8:11], a[4:7], v[176:179], v[8:11]
 s_waitcnt lgkmcnt(8)
 v_cvt_pk_bf16_f32 v108, v104, v105
 v_cvt_pk_bf16_f32 v109, v106, v107
 v_mfma_f32_16x16x32_bf16 v[16:19], a[8:11], v[176:179], v[16:19]
 ds_read_b64_tr_b16 a[28:29], v201 offset:28672
 ds_read_b64_tr_b16 a[30:31], v201 offset:29184
 v_mfma_f32_16x16x32_bf16 v[20:23], a[8:11], v[180:183], v[20:23]
 s_waitcnt lgkmcnt(8)
 v_mfma_f32_16x16x32_bf16 v[28:31], a[12:15], v[180:183], v[28:31]
 v_mfma_f32_16x16x32_bf16 v[24:27], a[12:15], v[176:179], v[24:27]
 s_waitcnt lgkmcnt(6)
 v_mfma_f32_16x16x32_bf16 v[0:3], a[16:19], v[184:187], v[0:3]
 v_mfma_f32_16x16x32_bf16 v[4:7], a[16:19], v[188:191], v[4:7]
 s_waitcnt lgkmcnt(4)
 v_mfma_f32_16x16x32_bf16 v[12:15], a[20:23], v[188:191], v[12:15]
 s_waitcnt vmcnt(1)
 s_cmp_lg_u64 s[94:95], 0
 s_cbranch_scc1 L_fl5
 buffer_store_dword v239, v242, s[28:31], 0 offen offset:1280
L_flr5:
 v_mfma_f32_16x16x32_bf16 v[8:11], a[20:23], v[184:187], v[8:11]
 s_waitcnt lgkmcnt(2)
 buffer_load_dword v238, v241, s[28:31], 0 offen offset:1024 nt
 buffer_store_dwordx2 v[108:109], v243, s[44:47], 0 offen offset:384
 v_mfma_f32_16x16x32_bf16 v[16:19], a[24:27], v[184:187], v[16:19]
 v_mfma_f32_16x16x32_bf16 v[20:23], a[24:27], v[188:191], v[20:23]
 s_waitcnt lgkmcnt(0)
 v_mfma_f32_16x16x32_bf16 v[28:31], a[28:31], v[188:191], v[28:31]
 v_mfma_f32_16x16x32_bf16 v[24:27], a[28:31], v[184:187], v[24:27]
 s_waitcnt vmcnt(1)
 s_mov_b32 s40, 0
 v_cmp_eq_u32 vcc, 0, v238
 s_or_b64 vcc, vcc, s[94:95]
 s_cbranch_vccnz L_po4
L_por4:
 v_cvt_pk_bf16_f32 v64, v0, v1
 v_cvt_pk_bf16_f32 v65, v2, v3
 v_cvt_pk_bf16_f32 v66, v8, v9
 v_cvt_pk_bf16_f32 v67, v10, v11
 buffer_store_dwordx4 v[64:67], v240, s[28:31], s40 offen
 v_cvt_pk_bf16_f32 v68, v16, v17
 v_cvt_pk_bf16_f32 v69, v18, v19
 v_cvt_pk_bf16_f32 v70, v24, v25
 v_cvt_pk_bf16_f32 v71, v26, v27
 buffer_store_dwordx4 v[68:71], v240, s[28:31], s40 offen offset:1024
 v_cvt_pk_bf16_f32 v72, v4, v5
 v_cvt_pk_bf16_f32 v73, v6, v7
 v_cvt_pk_bf16_f32 v74, v12, v13
 v_cvt_pk_bf16_f32 v75, v14, v15
 buffer_store_dwordx4 v[72:75], v240, s[28:31], s40 offen offset:2048
 v_cvt_pk_bf16_f32 v76, v20, v21
 v_cvt_pk_bf16_f32 v77, v22, v23
 v_cvt_pk_bf16_f32 v78, v28, v29
 v_cvt_pk_bf16_f32 v79, v30, v31
 buffer_store_dwordx4 v[76:79], v240, s[28:31], s40 offen offset:3072
 s_mov_b32 s41, 16384
 buffer_load_dword v238, v241, s[28:31], 0 offen offset:1280 nt
 s_waitcnt vmcnt(0)
 v_cmp_eq_u32 vcc, 0, v238
 s_or_b64 vcc, vcc, s[94:95]
 s_cbranch_vccnz L_po5
L_por5:
 buffer_load_dwordx4 a[192:195], v214, s[28:31], s41 offen nt
 buffer_load_dwordx4 a[196:199], v215, s[28:31], s41 offen nt
 buffer_load_dwordx4 a[200:203], v216, s[28:31], s41 offen nt
 buffer_load_dwordx4 a[204:207], v217, s[28:31], s41 offen nt
 s_mov_b32 s41, 32768
 buffer_load_dwordx4 a[208:211], v214, s[28:31], s41 offen nt
 buffer_load_dwordx4 a[212:215], v215, s[28:31], s41 offen nt
 buffer_load_dwordx4 a[216:219], v216, s[28:31], s41 offen nt
 buffer_load_dwordx4 a[220:223], v217, s[28:31], s41 offen nt
 s_cmp_lg_u64 s[94:95], 0
 s_cbranch_scc1 L_fl6
 buffer_store_dword v239, v242, s[28:31], 0 offen offset:1536
L_flr6:
 buffer_load_dword v238, v241, s[28:31], 0 offen offset:1536 nt
 s_waitcnt vmcnt(6)
 s_waitcnt vmcnt(2)
 v_mfma_f32_16x16x32_bf16 v[96:99], a[240:243], a[192:195], 0
 v_mfma_f32_16x16x32_bf16 v[96:99], a[240:243], a[196:199], v[96:99]
 v_mfma_f32_16x16x32_bf16 v[96:99], a[240:243], a[200:203], v[96:99]
 v_mfma_f32_16x16x32_bf16 v[96:99], a[240:243], a[204:207], v[96:99]
 v_mfma_f32_16x16x32_bf16 v[104:107], a[240:243], a[208:211], 0
 v_mfma_f32_16x16x32_bf16 v[104:107], a[240:243], a[212:215], v[104:107]
 v_mfma_f32_16x16x32_bf16 v[104:107], a[240:243], a[216:219], v[104:107]
 v_mfma_f32_16x16x32_bf16 v[104:107], a[240:243], a[220:223], v[104:107]
 s_nop 3
 v_cvt_pk_bf16_f32 v100, v96, v97
 v_cvt_pk_bf16_f32 v101, v98, v99
 buffer_store_dwordx2 v[100:101], v243, s[44:47], 0 offen offset:512
 s_nop 0
 v_cvt_pk_bf16_f32 v108, v104, v105
 v_cvt_pk_bf16_f32 v109, v106, v107
 buffer_store_dwordx2 v[108:109], v243, s[44:47], 0 offen offset:640
 s_waitcnt vmcnt(2)
 v_cmp_eq_u32 vcc, 0, v238
 s_or_b64 vcc, vcc, s[94:95]
 s_cbranch_vccnz L_po6
L_por6:
 s_mov_b32 s41, 0
 buffer_load_dwordx4 a[224:227], v214, s[28:31], s41 offen nt
 buffer_load_dwordx4 a[228:231], v215, s[28:31], s41 offen nt
 buffer_load_dwordx4 a[232:235], v216, s[28:31], s41 offen nt
 buffer_load_dwordx4 a[236:239], v217, s[28:31], s41 offen nt
 s_waitcnt vmcnt(0)
 v_mfma_f32_16x16x32_bf16 v[96:99], a[240:243], a[224:227], 0
 v_mfma_f32_16x16x32_bf16 v[96:99], a[240:243], a[228:231], v[96:99]
 v_mfma_f32_16x16x32_bf16 v[96:99], a[240:243], a[232:235], v[96:99]
 v_mfma_f32_16x16x32_bf16 v[96:99], a[240:243], a[236:239], v[96:99]
 s_nop 7
 v_cvt_pk_bf16_f32 v100, v96, v97
 v_cvt_pk_bf16_f32 v101, v98, v99
 buffer_store_dwordx2 v[100:101], v243, s[44:47], 0 offen offset:768
L_exit:
 s_endpgm
L_cen_spin:
 s_add_u32 s60, s60, 1
 s_cmp_gt_u32 s60, 8192
 s_cbranch_scc1 L_cen_ok
 buffer_load_dwordx4 v[248:251], v239, s[48:51], 0 offen sc1
 s_waitcnt vmcnt(0)
 s_branch L_cen_chk
L_fl0:
 s_waitcnt vmcnt(0)
 buffer_wbl2 sc1
 s_waitcnt vmcnt(0)
 buffer_store_dword v239, v242, s[28:31], 0 offen sc1
 s_branch L_flr0
L_po0:
 buffer_load_dword v238, v241, s[28:31], 0 offen sc1
 s_waitcnt vmcnt(0)
 v_cmp_eq_u32 vcc, 0, v238
 s_cbranch_vccz L_pod0
 s_add_u32 s60, s60, 1
 s_cmp_le_u32 s60, 8192
 s_cbranch_scc1 L_po0
L_pod0:
 s_cmp_eq_u64 s[94:95], 0
 s_cbranch_scc1 L_por0
 buffer_inv sc1
 s_waitcnt vmcnt(0)
 s_branch L_por0
L_fl1:
 s_waitcnt vmcnt(0)
 buffer_wbl2 sc1
 s_waitcnt vmcnt(0)
 buffer_store_dword v239, v242, s[28:31], 0 offen offset:256 sc1
 s_branch L_flr1
L_po1:
 buffer_load_dword v238, v241, s[28:31], 0 offen offset:256 sc1
 s_waitcnt vmcnt(0)
 v_cmp_eq_u32 vcc, 0, v238
 s_cbranch_vccz L_pod1
 s_add_u32 s60, s60, 1
 s_cmp_le_u32 s60, 8192
 s_cbranch_scc1 L_po1
L_pod1:
 s_cmp_eq_u64 s[94:95], 0
 s_cbranch_scc1 L_por1
 buffer_inv sc1
 s_waitcnt vmcnt(0)
 s_branch L_por1
L_fl2:
 s_waitcnt vmcnt(0)
 buffer_wbl2 sc1
 s_waitcnt vmcnt(0)
 buffer_store_dword v239, v242, s[28:31], 0 offen offset:512 sc1
 s_branch L_flr2
L_po2:
 buffer_load_dword v238, v241, s[28:31], 0 offen offset:512 sc1
 s_waitcnt vmcnt(0)
 v_cmp_eq_u32 vcc, 0, v238
 s_cbranch_vccz L_pod2
 s_add_u32 s60, s60, 1
 s_cmp_le_u32 s60, 8192
 s_cbranch_scc1 L_po2
L_pod2:
 s_cmp_eq_u64 s[94:95], 0
 s_cbranch_scc1 L_por2
 buffer_inv sc1
 s_waitcnt vmcnt(0)
 s_branch L_por2
L_fl3:
 s_waitcnt vmcnt(0)
 buffer_wbl2 sc1
 s_waitcnt vmcnt(0)
 buffer_store_dword v239, v242, s[28:31], 0 offen offset:768 sc1
 s_branch L_flr3
L_po3:
 buffer_load_dword v238, v241, s[28:31], 0 offen offset:768 sc1
 s_waitcnt vmcnt(0)
 v_cmp_eq_u32 vcc, 0, v238
 s_cbranch_vccz L_pod3
 s_add_u32 s60, s60, 1
 s_cmp_le_u32 s60, 8192
 s_cbranch_scc1 L_po3
L_pod3:
 s_cmp_eq_u64 s[94:95], 0
 s_cbranch_scc1 L_por3
 buffer_inv sc1
 s_waitcnt vmcnt(0)
 s_branch L_por3
L_fl4:
 s_waitcnt vmcnt(0)
 buffer_wbl2 sc1
 s_waitcnt vmcnt(0)
 buffer_store_dword v239, v242, s[28:31], 0 offen offset:1024 sc1
 s_branch L_flr4
L_po4:
 buffer_load_dword v238, v241, s[28:31], 0 offen offset:1024 sc1
 s_waitcnt vmcnt(0)
 v_cmp_eq_u32 vcc, 0, v238
 s_cbranch_vccz L_pod4
 s_add_u32 s60, s60, 1
 s_cmp_le_u32 s60, 8192
 s_cbranch_scc1 L_po4
L_pod4:
 s_cmp_eq_u64 s[94:95], 0
 s_cbranch_scc1 L_por4
 buffer_inv sc1
 s_waitcnt vmcnt(0)
 s_branch L_por4
L_fl5:
 s_waitcnt vmcnt(0)
 buffer_wbl2 sc1
 s_waitcnt vmcnt(0)
 buffer_store_dword v239, v242, s[28:31], 0 offen offset:1280 sc1
 s_branch L_flr5
L_po5:
 buffer_load_dword v238, v241, s[28:31], 0 offen offset:1280 sc1
 s_waitcnt vmcnt(0)
 v_cmp_eq_u32 vcc, 0, v238
 s_cbranch_vccz L_pod5
 s_add_u32 s60, s60, 1
 s_cmp_le_u32 s60, 8192
 s_cbranch_scc1 L_po5
L_pod5:
 s_cmp_eq_u64 s[94:95], 0
 s_cbranch_scc1 L_por5
 buffer_inv sc1
 s_waitcnt vmcnt(0)
 s_branch L_por5
L_fl6:
 s_waitcnt vmcnt(0)
 buffer_wbl2 sc1
 s_waitcnt vmcnt(0)
 buffer_store_dword v239, v242, s[28:31], 0 offen offset:1536 sc1
 s_branch L_flr6
L_po6:
 buffer_load_dword v238, v241, s[28:31], 0 offen offset:1536 sc1
 s_waitcnt vmcnt(0)
 v_cmp_eq_u32 vcc, 0, v238
 s_cbranch_vccz L_pod6
 s_add_u32 s60, s60, 1
 s_cmp_le_u32 s60, 8192
 s_cbranch_scc1 L_po6
L_pod6:
 s_cmp_eq_u64 s[94:95], 0
 s_cbranch_scc1 L_por6
 buffer_inv sc1
 s_waitcnt vmcnt(0)
 s_branch L_por6
L_stub0:
 s_call_b64 s[36:37], L_resc1
 s_branch L_ret0
L_stub1:
 s_call_b64 s[36:37], L_resc0
 s_branch L_ret1
L_stub2:
 s_call_b64 s[36:37], L_resc1
 s_branch L_ret2
L_stub3:
 s_call_b64 s[36:37], L_resc0
 s_branch L_ret3
L_stub4:
 s_call_b64 s[36:37], L_resc1
 s_branch L_ret4
L_stub5:
 s_call_b64 s[36:37], L_resc0
 s_branch L_ret5
L_stub6:
 s_call_b64 s[36:37], L_resc1
 s_branch L_ret6
L_stub7:
 s_call_b64 s[36:37], L_resc0
 s_branch L_ret7
L_stub8:
 s_call_b64 s[36:37], L_resc1
 s_branch L_ret8
L_stub9:
 s_call_b64 s[36:37], L_resc0
 s_branch L_ret9
L_stub10:
 s_call_b64 s[36:37], L_resc1
 s_branch L_ret10
L_stub11:
 s_call_b64 s[36:37], L_resc0
 s_branch L_ret11
L_stub12:
 s_call_b64 s[36:37], L_resc1
 s_branch L_ret12
L_stub13:
 s_call_b64 s[36:37], L_resc0
 s_branch L_ret13
L_stub14:
 s_call_b64 s[36:37], L_resc1
 s_branch L_ret14
L_stub15:
 s_call_b64 s[36:37], L_resc0
 s_branch L_ret15
L_stub16:
 s_call_b64 s[36:37], L_resc1
 s_branch L_ret16
L_stub17:
 s_call_b64 s[36:37], L_resc0
 s_branch L_ret17
L_stub18:
 s_call_b64 s[36:37], L_resc1
 s_branch L_ret18
L_stub19:
 s_call_b64 s[36:37], L_resc0
 s_branch L_ret19
L_stub20:
 s_call_b64 s[36:37], L_resc1
 s_branch L_ret20
L_stub21:
 s_call_b64 s[36:37], L_resc0
 s_branch L_ret21
L_stub22:
 s_call_b64 s[36:37], L_resc1
 s_branch L_ret22
L_stub23:
 s_call_b64 s[36:37], L_resc0
 s_branch L_ret23
L_stub24:
 s_call_b64 s[36:37], L_resc1
 s_branch L_ret24
L_stub25:
 s_call_b64 s[36:37], L_resc0
 s_branch L_ret25
L_stub26:
 s_call_b64 s[36:37], L_resc1
 s_branch L_ret26
L_stub27:
 s_call_b64 s[36:37], L_resc0
 s_branch L_ret27
L_stub28:
 s_call_b64 s[36:37], L_resc1
 s_branch L_ret28
L_stub29:
 s_call_b64 s[36:37], L_resc0
 s_branch L_ret29
L_stub30:
 s_call_b64 s[36:37], L_resc1
 s_branch L_ret30
L_resc0:
 s_nop 15
 v_max3_f32 v226, v128, v129, v130
 v_max3_f32 v226, v131, v136, v226
 v_max3_f32 v226, v137, v138, v226
 v_max_f32 v226, v139, v226
 v_mov_b32 v227, v226
 s_nop 1
 v_permlane32_swap_b32 v226, v227
 v_max_f32 v226, v226, v227
 v_mov_b32 v227, v226
 s_nop 1
 v_permlane16_swap_b32 v226, v227
 v_max_f32 v226, v226, v227
 v_max_f32 v226, 0, v226
 v_ceil_f32 v226, v226
 v_min_f32 v227, 0x43800000, v226
 v_cvt_i32_f32 v227, v227
 v_sub_u32 v227, 0, v227
 v_ldexp_f32 v228, 1.0, v227
 v_sub_f32 v128, v128, v226
 v_sub_f32 v129, v129, v226
 v_sub_f32 v130, v130, v226
 v_sub_f32 v131, v131, v226
 v_sub_f32 v136, v136, v226
 v_sub_f32 v137, v137, v226
 v_sub_f32 v138, v138, v226
 v_sub_f32 v139, v139, v226
 v_sub_f32 v168, v168, v226
 v_sub_f32 v169, v169, v226
 v_sub_f32 v170, v170, v226
 v_sub_f32 v171, v171, v226
 v_mul_f32 v222, v222, v228
 v_mul_f32 v0, v0, v228
 v_mul_f32 v1, v1, v228
 v_mul_f32 v2, v2, v228
 v_mul_f32 v3, v3, v228
 v_mul_f32 v8, v8, v228
 v_mul_f32 v9, v9, v228
 v_mul_f32 v10, v10, v228
 v_mul_f32 v11, v11, v228
 v_mul_f32 v16, v16, v228
 v_mul_f32 v17, v17, v228
 v_mul_f32 v18, v18, v228
 v_mul_f32 v19, v19, v228
 v_mul_f32 v24, v24, v228
 v_mul_f32 v25, v25, v228
 v_mul_f32 v26, v26, v228
 v_mul_f32 v27, v27, v228
 v_mul_f32 v32, v32, v228
 v_mul_f32 v33, v33, v228
 v_mul_f32 v34, v34, v228
 v_mul_f32 v35, v35, v228
 v_mul_f32 v40, v40, v228
 v_mul_f32 v41, v41, v228
 v_mul_f32 v42, v42, v228
 v_mul_f32 v43, v43, v228
 v_mul_f32 v48, v48, v228
 v_mul_f32 v49, v49, v228
 v_mul_f32 v50, v50, v228
 v_mul_f32 v51, v51, v228
 v_mul_f32 v56, v56, v228
 v_mul_f32 v57, v57, v228
 v_mul_f32 v58, v58, v228
 v_mul_f32 v59, v59, v228
 v_mul_f32 v64, v64, v228
 v_mul_f32 v65, v65, v228
 v_mul_f32 v66, v66, v228
 v_mul_f32 v67, v67, v228
 v_mul_f32 v72, v72, v228
 v_mul_f32 v73, v73, v228
 v_mul_f32 v74, v74, v228
 v_mul_f32 v75, v75, v228
 v_mul_f32 v80, v80, v228
 v_mul_f32 v81, v81, v228
 v_mul_f32 v82, v82, v228
 v_mul_f32 v83, v83, v228
 v_mul_f32 v88, v88, v228
 v_mul_f32 v89, v89, v228
 v_mul_f32 v90, v90, v228
 v_mul_f32 v91, v91, v228
 v_mul_f32 v96, v96, v228
 v_mul_f32 v97, v97, v228
 v_mul_f32 v98, v98, v228
 v_mul_f32 v99, v99, v228
 v_mul_f32 v104, v104, v228
 v_mul_f32 v105, v105, v228
 v_mul_f32 v106, v106, v228
 v_mul_f32 v107, v107, v228
 v_mul_f32 v112, v112, v228
 v_mul_f32 v113, v113, v228
 v_mul_f32 v114, v114, v228
 v_mul_f32 v115, v115, v228
 v_mul_f32 v120, v120, v228
 v_mul_f32 v121, v121, v228
 v_mul_f32 v122, v122, v228
 v_mul_f32 v123, v123, v228
 v_lshlrev_b32 v229, 16, v160
 v_and_b32 v230, 0xffff0000, v160
 v_mul_f32 v229, v229, v228
 v_mul_f32 v230, v230, v228
 v_cvt_pk_bf16_f32 v160, v229, v230
 v_lshlrev_b32 v229, 16, v161
 v_and_b32 v230, 0xffff0000, v161
 v_mul_f32 v229, v229, v228
 v_mul_f32 v230, v230, v228
 v_cvt_pk_bf16_f32 v161, v229, v230
 v_lshlrev_b32 v229, 16, v162
 v_and_b32 v230, 0xffff0000, v162
 v_mul_f32 v229, v229, v228
 v_mul_f32 v230, v230, v228
 v_cvt_pk_bf16_f32 v162, v229, v230
 v_lshlrev_b32 v229, 16, v163
 v_and_b32 v230, 0xffff0000, v163
 v_mul_f32 v229, v229, v228
 v_mul_f32 v230, v230, v228
 v_cvt_pk_bf16_f32 v163, v229, v230
 v_max3_f32 v226, v132, v133, v134
 v_max3_f32 v226, v135, v140, v226
 v_max3_f32 v226, v141, v142, v226
 v_max_f32 v226, v143, v226
 v_mov_b32 v227, v226
 s_nop 1
 v_permlane32_swap_b32 v226, v227
 v_max_f32 v226, v226, v227
 v_mov_b32 v227, v226
 s_nop 1
 v_permlane16_swap_b32 v226, v227
 v_max_f32 v226, v226, v227
 v_max_f32 v226, 0, v226
 v_ceil_f32 v226, v226
 v_min_f32 v227, 0x43800000, v226
 v_cvt_i32_f32 v227, v227
 v_sub_u32 v227, 0, v227
 v_ldexp_f32 v228, 1.0, v227
 v_sub_f32 v132, v132, v226
 v_sub_f32 v133, v133, v226
 v_sub_f32 v134, v134, v226
 v_sub_f32 v135, v135, v226
 v_sub_f32 v140, v140, v226
 v_sub_f32 v141, v141, v226
 v_sub_f32 v142, v142, v226
 v_sub_f32 v143, v143, v226
 v_sub_f32 v172, v172, v226
 v_sub_f32 v173, v173, v226
 v_sub_f32 v174, v174, v226
 v_sub_f32 v175, v175, v226
 v_mul_f32 v223, v223, v228
 v_mul_f32 v4, v4, v228
 v_mul_f32 v5, v5, v228
 v_mul_f32 v6, v6, v228
 v_mul_f32 v7, v7, v228
 v_mul_f32 v12, v12, v228
 v_mul_f32 v13, v13, v228
 v_mul_f32 v14, v14, v228
 v_mul_f32 v15, v15, v228
 v_mul_f32 v20, v20, v228
 v_mul_f32 v21, v21, v228
 v_mul_f32 v22, v22, v228
 v_mul_f32 v23, v23, v228
 v_mul_f32 v28, v28, v228
 v_mul_f32 v29, v29, v228
 v_mul_f32 v30, v30, v228
 v_mul_f32 v31, v31, v228
 v_mul_f32 v36, v36, v228
 v_mul_f32 v37, v37, v228
 v_mul_f32 v38, v38, v228
 v_mul_f32 v39, v39, v228
 v_mul_f32 v44, v44, v228
 v_mul_f32 v45, v45, v228
 v_mul_f32 v46, v46, v228
 v_mul_f32 v47, v47, v228
 v_mul_f32 v52, v52, v228
 v_mul_f32 v53, v53, v228
 v_mul_f32 v54, v54, v228
 v_mul_f32 v55, v55, v228
 v_mul_f32 v60, v60, v228
 v_mul_f32 v61, v61, v228
 v_mul_f32 v62, v62, v228
 v_mul_f32 v63, v63, v228
 v_mul_f32 v68, v68, v228
 v_mul_f32 v69, v69, v228
 v_mul_f32 v70, v70, v228
 v_mul_f32 v71, v71, v228
 v_mul_f32 v76, v76, v228
 v_mul_f32 v77, v77, v228
 v_mul_f32 v78, v78, v228
 v_mul_f32 v79, v79, v228
 v_mul_f32 v84, v84, v228
 v_mul_f32 v85, v85, v228
 v_mul_f32 v86, v86, v228
 v_mul_f32 v87, v87, v228
 v_mul_f32 v92, v92, v228
 v_mul_f32 v93, v93, v228
 v_mul_f32 v94, v94, v228
 v_mul_f32 v95, v95, v228
 v_mul_f32 v100, v100, v228
 v_mul_f32 v101, v101, v228
 v_mul_f32 v102, v102, v228
 v_mul_f32 v103, v103, v228
 v_mul_f32 v108, v108, v228
 v_mul_f32 v109, v109, v228
 v_mul_f32 v110, v110, v228
 v_mul_f32 v111, v111, v228
 v_mul_f32 v116, v116, v228
 v_mul_f32 v117, v117, v228
 v_mul_f32 v118, v118, v228
 v_mul_f32 v119, v119, v228
 v_mul_f32 v124, v124, v228
 v_mul_f32 v125, v125, v228
 v_mul_f32 v126, v126, v228
 v_mul_f32 v127, v127, v228
 v_lshlrev_b32 v229, 16, v164
 v_and_b32 v230, 0xffff0000, v164
 v_mul_f32 v229, v229, v228
 v_mul_f32 v230, v230, v228
 v_cvt_pk_bf16_f32 v164, v229, v230
 v_lshlrev_b32 v229, 16, v165
 v_and_b32 v230, 0xffff0000, v165
 v_mul_f32 v229, v229, v228
 v_mul_f32 v230, v230, v228
 v_cvt_pk_bf16_f32 v165, v229, v230
 v_lshlrev_b32 v229, 16, v166
 v_and_b32 v230, 0xffff0000, v166
 v_mul_f32 v229, v229, v228
 v_mul_f32 v230, v230, v228
 v_cvt_pk_bf16_f32 v166, v229, v230
 v_lshlrev_b32 v229, 16, v167
 v_and_b32 v230, 0xffff0000, v167
 v_mul_f32 v229, v229, v228
 v_mul_f32 v230, v230, v228
 v_cvt_pk_bf16_f32 v167, v229, v230
 s_nop 3
 s_setpc_b64 s[36:37]
L_resc1:
 s_nop 15
 v_max3_f32 v226, v144, v145, v146
 v_max3_f32 v226, v147, v152, v226
 v_max3_f32 v226, v153, v154, v226
 v_max_f32 v226, v155, v226
 v_mov_b32 v227, v226
 s_nop 1
 v_permlane32_swap_b32 v226, v227
 v_max_f32 v226, v226, v227
 v_mov_b32 v227, v226
 s_nop 1
 v_permlane16_swap_b32 v226, v227
 v_max_f32 v226, v226, v227
 v_max_f32 v226, 0, v226
 v_ceil_f32 v226, v226
 v_min_f32 v227, 0x43800000, v226
 v_cvt_i32_f32 v227, v227
 v_sub_u32 v227, 0, v227
 v_ldexp_f32 v228, 1.0, v227
 v_sub_f32 v144, v144, v226
 v_sub_f32 v145, v145, v226
 v_sub_f32 v146, v146, v226
 v_sub_f32 v147, v147, v226
 v_sub_f32 v152, v152, v226
 v_sub_f32 v153, v153, v226
 v_sub_f32 v154, v154, v226
 v_sub_f32 v155, v155, v226
 v_sub_f32 v168, v168, v226
 v_sub_f32 v169, v169, v226
 v_sub_f32 v170, v170, v226
 v_sub_f32 v171, v171, v226
 v_mul_f32 v222, v222, v228
 v_mul_f32 v0, v0, v228
 v_mul_f32 v1, v1, v228
 v_mul_f32 v2, v2, v228
 v_mul_f32 v3, v3, v228
 v_mul_f32 v8, v8, v228
 v_mul_f32 v9, v9, v228
 v_mul_f32 v10, v10, v228
 v_mul_f32 v11, v11, v228
 v_mul_f32 v16, v16, v228
 v_mul_f32 v17, v17, v228
 v_mul_f32 v18, v18, v228
 v_mul_f32 v19, v19, v228
 v_mul_f32 v24, v24, v228
 v_mul_f32 v25, v25, v228
 v_mul_f32 v26, v26, v228
 v_mul_f32 v27, v27, v228
 v_mul_f32 v32, v32, v228
 v_mul_f32 v33, v33, v228
 v_mul_f32 v34, v34, v228
 v_mul_f32 v35, v35, v228
 v_mul_f32 v40, v40, v228
 v_mul_f32 v41, v41, v228
 v_mul_f32 v42, v42, v228
 v_mul_f32 v43, v43, v228
 v_mul_f32 v48, v48, v228
 v_mul_f32 v49, v49, v228
 v_mul_f32 v50, v50, v228
 v_mul_f32 v51, v51, v228
 v_mul_f32 v56, v56, v228
 v_mul_f32 v57, v57, v228
 v_mul_f32 v58, v58, v228
 v_mul_f32 v59, v59, v228
 v_mul_f32 v64, v64, v228
 v_mul_f32 v65, v65, v228
 v_mul_f32 v66, v66, v228
 v_mul_f32 v67, v67, v228
 v_mul_f32 v72, v72, v228
 v_mul_f32 v73, v73, v228
 v_mul_f32 v74, v74, v228
 v_mul_f32 v75, v75, v228
 v_mul_f32 v80, v80, v228
 v_mul_f32 v81, v81, v228
 v_mul_f32 v82, v82, v228
 v_mul_f32 v83, v83, v228
 v_mul_f32 v88, v88, v228
 v_mul_f32 v89, v89, v228
 v_mul_f32 v90, v90, v228
 v_mul_f32 v91, v91, v228
 v_mul_f32 v96, v96, v228
 v_mul_f32 v97, v97, v228
 v_mul_f32 v98, v98, v228
 v_mul_f32 v99, v99, v228
 v_mul_f32 v104, v104, v228
 v_mul_f32 v105, v105, v228
 v_mul_f32 v106, v106, v228
 v_mul_f32 v107, v107, v228
 v_mul_f32 v112, v112, v228
 v_mul_f32 v113, v113, v228
 v_mul_f32 v114, v114, v228
 v_mul_f32 v115, v115, v228
 v_mul_f32 v120, v120, v228
 v_mul_f32 v121, v121, v228
 v_mul_f32 v122, v122, v228
 v_mul_f32 v123, v123, v228
 v_lshlrev_b32 v229, 16, v160
 v_and_b32 v230, 0xffff0000, v160
 v_mul_f32 v229, v229, v228
 v_mul_f32 v230, v230, v228
 v_cvt_pk_bf16_f32 v160, v229, v230
 v_lshlrev_b32 v229, 16, v161
 v_and_b32 v230, 0xffff0000, v161
 v_mul_f32 v229, v229, v228
 v_mul_f32 v230, v230, v228
 v_cvt_pk_bf16_f32 v161, v229, v230
 v_lshlrev_b32 v229, 16, v162
 v_and_b32 v230, 0xffff0000, v162
 v_mul_f32 v229, v229, v228
 v_mul_f32 v230, v230, v228
 v_cvt_pk_bf16_f32 v162, v229, v230
 v_lshlrev_b32 v229, 16, v163
 v_and_b32 v230, 0xffff0000, v163
 v_mul_f32 v229, v229, v228
 v_mul_f32 v230, v230, v228
 v_cvt_pk_bf16_f32 v163, v229, v230
 v_max3_f32 v226, v148, v149, v150
 v_max3_f32 v226, v151, v156, v226
 v_max3_f32 v226, v157, v158, v226
 v_max_f32 v226, v159, v226
 v_mov_b32 v227, v226
 s_nop 1
 v_permlane32_swap_b32 v226, v227
 v_max_f32 v226, v226, v227
 v_mov_b32 v227, v226
 s_nop 1
 v_permlane16_swap_b32 v226, v227
 v_max_f32 v226, v226, v227
 v_max_f32 v226, 0, v226
 v_ceil_f32 v226, v226
 v_min_f32 v227, 0x43800000, v226
 v_cvt_i32_f32 v227, v227
 v_sub_u32 v227, 0, v227
 v_ldexp_f32 v228, 1.0, v227
 v_sub_f32 v148, v148, v226
 v_sub_f32 v149, v149, v226
 v_sub_f32 v150, v150, v226
 v_sub_f32 v151, v151, v226
 v_sub_f32 v156, v156, v226
 v_sub_f32 v157, v157, v226
 v_sub_f32 v158, v158, v226
 v_sub_f32 v159, v159, v226
 v_sub_f32 v172, v172, v226
 v_sub_f32 v173, v173, v226
 v_sub_f32 v174, v174, v226
 v_sub_f32 v175, v175, v226
 v_mul_f32 v223, v223, v228
 v_mul_f32 v4, v4, v228
 v_mul_f32 v5, v5, v228
 v_mul_f32 v6, v6, v228
 v_mul_f32 v7, v7, v228
 v_mul_f32 v12, v12, v228
 v_mul_f32 v13, v13, v228
 v_mul_f32 v14, v14, v228
 v_mul_f32 v15, v15, v228
 v_mul_f32 v20, v20, v228
 v_mul_f32 v21, v21, v228
 v_mul_f32 v22, v22, v228
 v_mul_f32 v23, v23, v228
 v_mul_f32 v28, v28, v228
 v_mul_f32 v29, v29, v228
 v_mul_f32 v30, v30, v228
 v_mul_f32 v31, v31, v228
 v_mul_f32 v36, v36, v228
 v_mul_f32 v37, v37, v228
 v_mul_f32 v38, v38, v228
 v_mul_f32 v39, v39, v228
 v_mul_f32 v44, v44, v228
 v_mul_f32 v45, v45, v228
 v_mul_f32 v46, v46, v228
 v_mul_f32 v47, v47, v228
 v_mul_f32 v52, v52, v228
 v_mul_f32 v53, v53, v228
 v_mul_f32 v54, v54, v228
 v_mul_f32 v55, v55, v228
 v_mul_f32 v60, v60, v228
 v_mul_f32 v61, v61, v228
 v_mul_f32 v62, v62, v228
 v_mul_f32 v63, v63, v228
 v_mul_f32 v68, v68, v228
 v_mul_f32 v69, v69, v228
 v_mul_f32 v70, v70, v228
 v_mul_f32 v71, v71, v228
 v_mul_f32 v76, v76, v228
 v_mul_f32 v77, v77, v228
 v_mul_f32 v78, v78, v228
 v_mul_f32 v79, v79, v228
 v_mul_f32 v84, v84, v228
 v_mul_f32 v85, v85, v228
 v_mul_f32 v86, v86, v228
 v_mul_f32 v87, v87, v228
 v_mul_f32 v92, v92, v228
 v_mul_f32 v93, v93, v228
 v_mul_f32 v94, v94, v228
 v_mul_f32 v95, v95, v228
 v_mul_f32 v100, v100, v228
 v_mul_f32 v101, v101, v228
 v_mul_f32 v102, v102, v228
 v_mul_f32 v103, v103, v228
 v_mul_f32 v108, v108, v228
 v_mul_f32 v109, v109, v228
 v_mul_f32 v110, v110, v228
 v_mul_f32 v111, v111, v228
 v_mul_f32 v116, v116, v228
 v_mul_f32 v117, v117, v228
 v_mul_f32 v118, v118, v228
 v_mul_f32 v119, v119, v228
 v_mul_f32 v124, v124, v228
 v_mul_f32 v125, v125, v228
 v_mul_f32 v126, v126, v228
 v_mul_f32 v127, v127, v228
 v_lshlrev_b32 v229, 16, v164
 v_and_b32 v230, 0xffff0000, v164
 v_mul_f32 v229, v229, v228
 v_mul_f32 v230, v230, v228
 v_cvt_pk_bf16_f32 v164, v229, v230
 v_lshlrev_b32 v229, 16, v165
 v_and_b32 v230, 0xffff0000, v165
 v_mul_f32 v229, v229, v228
 v_mul_f32 v230, v230, v228
 v_cvt_pk_bf16_f32 v165, v229, v230
 v_lshlrev_b32 v229, 16, v166
 v_and_b32 v230, 0xffff0000, v166
 v_mul_f32 v229, v229, v228
 v_mul_f32 v230, v230, v228
 v_cvt_pk_bf16_f32 v166, v229, v230
 v_lshlrev_b32 v229, 16, v167
 v_and_b32 v230, 0xffff0000, v167
 v_mul_f32 v229, v229, v228
 v_mul_f32 v230, v230, v228
 v_cvt_pk_bf16_f32 v167, v229, v230
 s_nop 3
 s_setpc_b64 s[36:37]
.fill 8192, 4, 0xBF800000
.section .rodata,"a"
.p2align 6
.amdhsa_kernel standalone__mha_block_cached__near_ridge_kernel
  .amdhsa_next_free_vgpr 504
  .amdhsa_next_free_sgpr 102
  .amdhsa_accum_offset 256
  .amdhsa_group_segment_fixed_size 0
  .amdhsa_kernarg_size 64
  .amdhsa_user_sgpr_count 2
  .amdhsa_user_sgpr_kernarg_segment_ptr 1
  .amdhsa_system_sgpr_workgroup_id_x 1
.end_amdhsa_kernel
```
